```python
import torch

def _softmax(x, axis=-1):
    return torch.softmax(x, dim=axis)

def _gelu(x):
    return torch.nn.functional.gelu(x, approximate='tanh')

def _silu(x):
    return torch.nn.functional.silu(x)

def _sigmoid(x):
    return torch.sigmoid(x)

def _layernorm(x, axis=-1, eps=1e-05):
    m = x.mean(dim=axis, keepdim=True)
    v = x.var(dim=axis, keepdim=True, unbiased=False)
    return (x - m) / torch.sqrt(v + eps)

def _scatter_add(tgt, idx, src, axis=0):
    return tgt.clone().index_add_(axis, idx, src)

def _segment_sum(src, seg, n):
    out = torch.zeros((n,) + src.shape[1:], dtype=src.dtype)
    return out.index_add_(0, seg, src)

def _pad(x, pw):
    flat = tuple((v for pair in reversed(pw) for v in pair))
    return torch.nn.functional.pad(x, flat)
kernel_name = 'parallel_sum__memory_aug_recurrent_mem_tr__glu_gated_glu__prompt'

def setup_inputs():

    _w = lambda a: (lambda t: t.to(torch.bfloat16) if t.is_floating_point() else t)(torch.as_tensor(a))

    def _A_setup():
        B, S, Dm = (1, 2048, 640)
        H, Dh = (32, 192)
        M, seg = (8, 32)
        seg = min(seg, S)
        S = S // seg * seg
        return {'x': _w((lambda *s: torch.randn(*s, dtype=torch.bfloat16) * 0.05)(B, S, Dm)), 'mem0': _w((lambda *s: torch.randn(*s, dtype=torch.bfloat16) * 1.6)(B, M, Dm)), 'Wq': _w((lambda *s: torch.randn(*s, dtype=torch.bfloat16) * 0.8)(Dm, H, Dh) * Dm ** (-0.5)), 'Wk': _w((lambda *s: torch.randn(*s, dtype=torch.bfloat16) * 0.8)(Dm, H, Dh) * Dm ** (-0.5)), 'Wv': _w((lambda *s: torch.randn(*s, dtype=torch.bfloat16) * 1.6)(Dm, H, Dh) * Dm ** (-0.5)), 'Wo': _w((lambda *s: torch.randn(*s, dtype=torch.bfloat16) * 1.6)(H, Dh, Dm) * (H * Dh) ** (-0.5)), 'seg_len': seg}
    _A_in = _A_setup()

    def _B_setup():
        B, S, D, F = (1, 2048, 640, 1536)
        return {'x': _w((lambda *s: torch.randn(*s, dtype=torch.bfloat16) * 0.05)(B, S, D)), 'w_gate': _w((lambda *s: torch.randn(*s, dtype=torch.bfloat16) * 0.05)(D, F)), 'w_up': _w((lambda *s: torch.randn(*s, dtype=torch.bfloat16) * 0.05)(D, F)), 'w_down': _w((lambda *s: torch.randn(*s, dtype=torch.bfloat16) * 0.05)(F, D))}
    _B_in = _B_setup()
    return {'A_x': _A_in['x'], 'A_mem0': _A_in['mem0'], 'A_Wq': _A_in['Wq'], 'A_Wk': _A_in['Wk'], 'A_Wv': _A_in['Wv'], 'A_Wo': _A_in['Wo'], 'A_seg_len': _A_in['seg_len'], 'B_x': _B_in['x'], 'B_w_gate': _B_in['w_gate'], 'B_w_up': _B_in['w_up'], 'B_w_down': _B_in['w_down']}

def reference(A_x, A_mem0, A_Wq, A_Wk, A_Wv, A_Wo, A_seg_len, B_x, B_w_gate, B_w_up, B_w_down):

    def _A_ref(x, mem0, Wq, Wk, Wv, Wo, seg_len):
        B, S, Dm = x.shape
        H, Dh = (Wq.shape[1], Wq.shape[2])
        M = mem0.shape[1]
        scale = Dh ** (-0.5)
        n_seg = S // seg_len
        L = M + seg_len
        idx = torch.arange(L)
        mask = (idx[:, None] < M) | (idx[:, None] >= idx[None, :])
        mem = mem0
        outs = []
        for s in range(n_seg):
            xs = x[:, s * seg_len:(s + 1) * seg_len, :].clone()
            h = torch.concatenate([mem, xs], axis=1)
            q = torch.einsum('btd,dhe->bhte', h, Wq)
            k = torch.einsum('btd,dhe->bhte', h, Wk)
            v = torch.einsum('btd,dhe->bhte', h, Wv)
            scores = torch.einsum('bhqe,bhke->bhqk', q, k) * scale
            scores = torch.where(mask[None, None], scores, -1000000000.0)
            p = _softmax(scores, axis=-1)
            o = torch.einsum('bhqk,bhke->bhqe', p, v)
            o = torch.einsum('bhte,hed->btd', o, Wo)
            mem = o[:, :M, :].clone()
            outs.append(o[:, M:, :])
        return torch.concatenate(outs, axis=1)

    def _B_ref(x, w_gate, w_up, w_down):
        g = torch.einsum('bsd,df->bsf', x, w_gate)
        u = torch.einsum('bsd,df->bsf', x, w_up)
        h = _sigmoid(g) * u
        return torch.einsum('bsf,fd->bsd', h, w_down)
    x = A_x
    xn = _layernorm(x, axis=-1)
    return x + _A_ref(xn, A_mem0, A_Wq, A_Wk, A_Wv, A_Wo, A_seg_len) + _B_ref(xn, B_w_gate, B_w_up, B_w_down)
```

```asm
; @launch grid=(256,1,1) block=(256,1,1) lds=163840
.amdgcn_target "amdgcn-amd-amdhsa--gfx950"
.text
.globl parallel_sum__memory_aug_recurrent_mem_tr__glu_gated_glu__prompt_kernel
.p2align 8
.type parallel_sum__memory_aug_recurrent_mem_tr__glu_gated_glu__prompt_kernel,@function
parallel_sum__memory_aug_recurrent_mem_tr__glu_gated_glu__prompt_kernel:
  s_cmp_ge_u32 s2, 256
  s_cbranch_scc1 L_end
  s_load_dwordx16 s[32:47], s[0:1], 0
  s_load_dwordx8 s[48:55], s[0:1], 64
  s_load_dwordx4 s[56:59], s[0:1], 96
  v_lshrrev_b32 v1, 6, v0
  v_and_b32 v0, 63, v0
  v_readfirstlane_b32 s3, v1
  s_getreg_b32 s4, hwreg(HW_REG_XCC_ID, 0, 4)
  s_and_b32 s4, s4, 7
  s_waitcnt lgkmcnt(0)
  s_mov_b32 s8, s58
  s_and_b32 s9, s59, 0xffff
  s_mov_b32 s10, 268435456
  s_mov_b32 s11, 0x20000
  s_mov_b32 s59, 0x400000
  s_mov_b32 s12, s32
  s_and_b32 s13, s33, 0xffff
  s_mov_b32 s14, 2621440
  s_mov_b32 s15, 0x20000
  s_mov_b32 s24, s54
  s_and_b32 s25, s55, 0xffff
  s_mov_b32 s26, 2621440
  s_mov_b32 s27, 0x20000
  s_mov_b32 s28, s56
  s_and_b32 s29, s57, 0xffff
  s_mov_b32 s30, 256
  s_mov_b32 s31, 0x20000
  s_cmp_lg_u32 s3, 0
  s_cbranch_scc1 L_p1done
  s_lshl_b32 s5, s4, 4
  v_mov_b32 v80, 1
  s_mov_b64 exec, 1
  buffer_atomic_add v80, off, s[28:31], s5 sc0
  s_mov_b64 exec, -1
L_p1done:
  s_cmp_ge_u32 s3, 2
  s_cbranch_scc1 L_clear
  v_lshrrev_b32 v2, 4, v0
  v_and_b32 v3, 15, v0
  s_lshl_b32 s5, s2, 3
  s_lshl_b32 s6, s3, 2
  s_add_u32 s5, s5, s6
  v_add_u32 v2, s5, v2
  v_mul_u32_u24 v4, 1280, v2
  v_lshl_add_u32 v4, v3, 4, v4
  buffer_load_dwordx4 v[8:11], v4, s[12:15], 0 offen offset:0
  buffer_load_dwordx4 v[12:15], v4, s[12:15], 0 offen offset:256
  buffer_load_dwordx4 v[16:19], v4, s[12:15], 0 offen offset:512
  buffer_load_dwordx4 v[20:23], v4, s[12:15], 0 offen offset:768
  buffer_load_dwordx4 v[24:27], v4, s[12:15], 0 offen offset:1024
  v_lshrrev_b32 v5, 4, v2
  v_mul_u32_u24 v5, 20480, v5
  v_lshrrev_b32 v6, 2, v3
  v_lshl_add_u32 v5, v6, 10, v5
  v_and_b32 v6, 3, v3
  v_lshl_add_u32 v5, v6, 8, v5
  v_and_b32 v6, 15, v2
  v_lshl_add_u32 v5, v6, 4, v5
  s_waitcnt vmcnt(0)
  v_lshlrev_b32 v32, 16, v8
  v_and_b32 v33, 0xffff0000, v8
  v_lshlrev_b32 v34, 16, v9
  v_and_b32 v35, 0xffff0000, v9
  v_lshlrev_b32 v36, 16, v10
  v_and_b32 v37, 0xffff0000, v10
  v_lshlrev_b32 v38, 16, v11
  v_and_b32 v39, 0xffff0000, v11
  v_lshlrev_b32 v40, 16, v12
  v_and_b32 v41, 0xffff0000, v12
  v_lshlrev_b32 v42, 16, v13
  v_and_b32 v43, 0xffff0000, v13
  v_lshlrev_b32 v44, 16, v14
  v_and_b32 v45, 0xffff0000, v14
  v_lshlrev_b32 v46, 16, v15
  v_and_b32 v47, 0xffff0000, v15
  v_lshlrev_b32 v48, 16, v16
  v_and_b32 v49, 0xffff0000, v16
  v_lshlrev_b32 v50, 16, v17
  v_and_b32 v51, 0xffff0000, v17
  v_lshlrev_b32 v52, 16, v18
  v_and_b32 v53, 0xffff0000, v18
  v_lshlrev_b32 v54, 16, v19
  v_and_b32 v55, 0xffff0000, v19
  v_lshlrev_b32 v56, 16, v20
  v_and_b32 v57, 0xffff0000, v20
  v_lshlrev_b32 v58, 16, v21
  v_and_b32 v59, 0xffff0000, v21
  v_lshlrev_b32 v60, 16, v22
  v_and_b32 v61, 0xffff0000, v22
  v_lshlrev_b32 v62, 16, v23
  v_and_b32 v63, 0xffff0000, v23
  v_lshlrev_b32 v64, 16, v24
  v_and_b32 v65, 0xffff0000, v24
  v_lshlrev_b32 v66, 16, v25
  v_and_b32 v67, 0xffff0000, v25
  v_lshlrev_b32 v68, 16, v26
  v_and_b32 v69, 0xffff0000, v26
  v_lshlrev_b32 v70, 16, v27
  v_and_b32 v71, 0xffff0000, v27
  v_add_f32 v6, v32, v33
  v_add_f32 v6, v6, v34
  v_add_f32 v6, v6, v35
  v_add_f32 v6, v6, v36
  v_add_f32 v6, v6, v37
  v_add_f32 v6, v6, v38
  v_add_f32 v6, v6, v39
  v_add_f32 v6, v6, v40
  v_add_f32 v6, v6, v41
  v_add_f32 v6, v6, v42
  v_add_f32 v6, v6, v43
  v_add_f32 v6, v6, v44
  v_add_f32 v6, v6, v45
  v_add_f32 v6, v6, v46
  v_add_f32 v6, v6, v47
  v_add_f32 v6, v6, v48
  v_add_f32 v6, v6, v49
  v_add_f32 v6, v6, v50
  v_add_f32 v6, v6, v51
  v_add_f32 v6, v6, v52
  v_add_f32 v6, v6, v53
  v_add_f32 v6, v6, v54
  v_add_f32 v6, v6, v55
  v_add_f32 v6, v6, v56
  v_add_f32 v6, v6, v57
  v_add_f32 v6, v6, v58
  v_add_f32 v6, v6, v59
  v_add_f32 v6, v6, v60
  v_add_f32 v6, v6, v61
  v_add_f32 v6, v6, v62
  v_add_f32 v6, v6, v63
  v_add_f32 v6, v6, v64
  v_add_f32 v6, v6, v65
  v_add_f32 v6, v6, v66
  v_add_f32 v6, v6, v67
  v_add_f32 v6, v6, v68
  v_add_f32 v6, v6, v69
  v_add_f32 v6, v6, v70
  v_add_f32 v6, v6, v71
  s_nop 1
  v_add_f32_dpp v6, v6, v6 row_ror:1 row_mask:0xf bank_mask:0xf
  s_nop 1
  v_add_f32_dpp v6, v6, v6 row_ror:2 row_mask:0xf bank_mask:0xf
  s_nop 1
  v_add_f32_dpp v6, v6, v6 row_ror:4 row_mask:0xf bank_mask:0xf
  s_nop 1
  v_add_f32_dpp v6, v6, v6 row_ror:8 row_mask:0xf bank_mask:0xf
  v_mul_f32 v6, 0.0015625, v6
  v_sub_f32 v7, v32, v6
  v_mul_f32 v72, v7, v7
  v_sub_f32 v7, v33, v6
  v_fmac_f32 v72, v7, v7
  v_sub_f32 v7, v34, v6
  v_fmac_f32 v72, v7, v7
  v_sub_f32 v7, v35, v6
  v_fmac_f32 v72, v7, v7
  v_sub_f32 v7, v36, v6
  v_fmac_f32 v72, v7, v7
  v_sub_f32 v7, v37, v6
  v_fmac_f32 v72, v7, v7
  v_sub_f32 v7, v38, v6
  v_fmac_f32 v72, v7, v7
  v_sub_f32 v7, v39, v6
  v_fmac_f32 v72, v7, v7
  v_sub_f32 v7, v40, v6
  v_fmac_f32 v72, v7, v7
  v_sub_f32 v7, v41, v6
  v_fmac_f32 v72, v7, v7
  v_sub_f32 v7, v42, v6
  v_fmac_f32 v72, v7, v7
  v_sub_f32 v7, v43, v6
  v_fmac_f32 v72, v7, v7
  v_sub_f32 v7, v44, v6
  v_fmac_f32 v72, v7, v7
  v_sub_f32 v7, v45, v6
  v_fmac_f32 v72, v7, v7
  v_sub_f32 v7, v46, v6
  v_fmac_f32 v72, v7, v7
  v_sub_f32 v7, v47, v6
  v_fmac_f32 v72, v7, v7
  v_sub_f32 v7, v48, v6
  v_fmac_f32 v72, v7, v7
  v_sub_f32 v7, v49, v6
  v_fmac_f32 v72, v7, v7
  v_sub_f32 v7, v50, v6
  v_fmac_f32 v72, v7, v7
  v_sub_f32 v7, v51, v6
  v_fmac_f32 v72, v7, v7
  v_sub_f32 v7, v52, v6
  v_fmac_f32 v72, v7, v7
  v_sub_f32 v7, v53, v6
  v_fmac_f32 v72, v7, v7
  v_sub_f32 v7, v54, v6
  v_fmac_f32 v72, v7, v7
  v_sub_f32 v7, v55, v6
  v_fmac_f32 v72, v7, v7
  v_sub_f32 v7, v56, v6
  v_fmac_f32 v72, v7, v7
  v_sub_f32 v7, v57, v6
  v_fmac_f32 v72, v7, v7
  v_sub_f32 v7, v58, v6
  v_fmac_f32 v72, v7, v7
  v_sub_f32 v7, v59, v6
  v_fmac_f32 v72, v7, v7
  v_sub_f32 v7, v60, v6
  v_fmac_f32 v72, v7, v7
  v_sub_f32 v7, v61, v6
  v_fmac_f32 v72, v7, v7
  v_sub_f32 v7, v62, v6
  v_fmac_f32 v72, v7, v7
  v_sub_f32 v7, v63, v6
  v_fmac_f32 v72, v7, v7
  v_sub_f32 v7, v64, v6
  v_fmac_f32 v72, v7, v7
  v_sub_f32 v7, v65, v6
  v_fmac_f32 v72, v7, v7
  v_sub_f32 v7, v66, v6
  v_fmac_f32 v72, v7, v7
  v_sub_f32 v7, v67, v6
  v_fmac_f32 v72, v7, v7
  v_sub_f32 v7, v68, v6
  v_fmac_f32 v72, v7, v7
  v_sub_f32 v7, v69, v6
  v_fmac_f32 v72, v7, v7
  v_sub_f32 v7, v70, v6
  v_fmac_f32 v72, v7, v7
  v_sub_f32 v7, v71, v6
  v_fmac_f32 v72, v7, v7
  s_nop 1
  v_add_f32_dpp v72, v72, v72 row_ror:1 row_mask:0xf bank_mask:0xf
  s_nop 1
  v_add_f32_dpp v72, v72, v72 row_ror:2 row_mask:0xf bank_mask:0xf
  s_nop 1
  v_add_f32_dpp v72, v72, v72 row_ror:4 row_mask:0xf bank_mask:0xf
  s_nop 1
  v_add_f32_dpp v72, v72, v72 row_ror:8 row_mask:0xf bank_mask:0xf
  v_mul_f32 v72, 0.0015625, v72
  v_cvt_pk_bf16_f32 v6, v6, v6
  v_lshlrev_b32 v6, 16, v6
  v_cvt_pk_bf16_f32 v72, v72, v72
  v_lshlrev_b32 v72, 16, v72
  v_add_f32 v72, 0x3727c5ac, v72
  v_cvt_pk_bf16_f32 v72, v72, v72
  v_lshlrev_b32 v72, 16, v72
  v_sqrt_f32 v72, v72
  s_nop 0
  v_cvt_pk_bf16_f32 v72, v72, v72
  v_lshlrev_b32 v72, 16, v72
  v_rcp_f32 v72, v72
  v_sub_f32 v32, v32, v6
  v_sub_f32 v33, v33, v6
  v_cvt_pk_bf16_f32 v7, v32, v33
  v_lshlrev_b32 v32, 16, v7
  v_and_b32 v33, 0xffff0000, v7
  v_mul_f32 v32, v32, v72
  v_mul_f32 v33, v33, v72
  v_cvt_pk_bf16_f32 v8, v32, v33
  v_sub_f32 v34, v34, v6
  v_sub_f32 v35, v35, v6
  v_cvt_pk_bf16_f32 v7, v34, v35
  v_lshlrev_b32 v34, 16, v7
  v_and_b32 v35, 0xffff0000, v7
  v_mul_f32 v34, v34, v72
  v_mul_f32 v35, v35, v72
  v_cvt_pk_bf16_f32 v9, v34, v35
  v_sub_f32 v36, v36, v6
  v_sub_f32 v37, v37, v6
  v_cvt_pk_bf16_f32 v7, v36, v37
  v_lshlrev_b32 v36, 16, v7
  v_and_b32 v37, 0xffff0000, v7
  v_mul_f32 v36, v36, v72
  v_mul_f32 v37, v37, v72
  v_cvt_pk_bf16_f32 v10, v36, v37
  v_sub_f32 v38, v38, v6
  v_sub_f32 v39, v39, v6
  v_cvt_pk_bf16_f32 v7, v38, v39
  v_lshlrev_b32 v38, 16, v7
  v_and_b32 v39, 0xffff0000, v7
  v_mul_f32 v38, v38, v72
  v_mul_f32 v39, v39, v72
  v_cvt_pk_bf16_f32 v11, v38, v39
  v_sub_f32 v40, v40, v6
  v_sub_f32 v41, v41, v6
  v_cvt_pk_bf16_f32 v7, v40, v41
  v_lshlrev_b32 v40, 16, v7
  v_and_b32 v41, 0xffff0000, v7
  v_mul_f32 v40, v40, v72
  v_mul_f32 v41, v41, v72
  v_cvt_pk_bf16_f32 v12, v40, v41
  v_sub_f32 v42, v42, v6
  v_sub_f32 v43, v43, v6
  v_cvt_pk_bf16_f32 v7, v42, v43
  v_lshlrev_b32 v42, 16, v7
  v_and_b32 v43, 0xffff0000, v7
  v_mul_f32 v42, v42, v72
  v_mul_f32 v43, v43, v72
  v_cvt_pk_bf16_f32 v13, v42, v43
  v_sub_f32 v44, v44, v6
  v_sub_f32 v45, v45, v6
  v_cvt_pk_bf16_f32 v7, v44, v45
  v_lshlrev_b32 v44, 16, v7
  v_and_b32 v45, 0xffff0000, v7
  v_mul_f32 v44, v44, v72
  v_mul_f32 v45, v45, v72
  v_cvt_pk_bf16_f32 v14, v44, v45
  v_sub_f32 v46, v46, v6
  v_sub_f32 v47, v47, v6
  v_cvt_pk_bf16_f32 v7, v46, v47
  v_lshlrev_b32 v46, 16, v7
  v_and_b32 v47, 0xffff0000, v7
  v_mul_f32 v46, v46, v72
  v_mul_f32 v47, v47, v72
  v_cvt_pk_bf16_f32 v15, v46, v47
  v_sub_f32 v48, v48, v6
  v_sub_f32 v49, v49, v6
  v_cvt_pk_bf16_f32 v7, v48, v49
  v_lshlrev_b32 v48, 16, v7
  v_and_b32 v49, 0xffff0000, v7
  v_mul_f32 v48, v48, v72
  v_mul_f32 v49, v49, v72
  v_cvt_pk_bf16_f32 v16, v48, v49
  v_sub_f32 v50, v50, v6
  v_sub_f32 v51, v51, v6
  v_cvt_pk_bf16_f32 v7, v50, v51
  v_lshlrev_b32 v50, 16, v7
  v_and_b32 v51, 0xffff0000, v7
  v_mul_f32 v50, v50, v72
  v_mul_f32 v51, v51, v72
  v_cvt_pk_bf16_f32 v17, v50, v51
  v_sub_f32 v52, v52, v6
  v_sub_f32 v53, v53, v6
  v_cvt_pk_bf16_f32 v7, v52, v53
  v_lshlrev_b32 v52, 16, v7
  v_and_b32 v53, 0xffff0000, v7
  v_mul_f32 v52, v52, v72
  v_mul_f32 v53, v53, v72
  v_cvt_pk_bf16_f32 v18, v52, v53
  v_sub_f32 v54, v54, v6
  v_sub_f32 v55, v55, v6
  v_cvt_pk_bf16_f32 v7, v54, v55
  v_lshlrev_b32 v54, 16, v7
  v_and_b32 v55, 0xffff0000, v7
  v_mul_f32 v54, v54, v72
  v_mul_f32 v55, v55, v72
  v_cvt_pk_bf16_f32 v19, v54, v55
  v_sub_f32 v56, v56, v6
  v_sub_f32 v57, v57, v6
  v_cvt_pk_bf16_f32 v7, v56, v57
  v_lshlrev_b32 v56, 16, v7
  v_and_b32 v57, 0xffff0000, v7
  v_mul_f32 v56, v56, v72
  v_mul_f32 v57, v57, v72
  v_cvt_pk_bf16_f32 v20, v56, v57
  v_sub_f32 v58, v58, v6
  v_sub_f32 v59, v59, v6
  v_cvt_pk_bf16_f32 v7, v58, v59
  v_lshlrev_b32 v58, 16, v7
  v_and_b32 v59, 0xffff0000, v7
  v_mul_f32 v58, v58, v72
  v_mul_f32 v59, v59, v72
  v_cvt_pk_bf16_f32 v21, v58, v59
  v_sub_f32 v60, v60, v6
  v_sub_f32 v61, v61, v6
  v_cvt_pk_bf16_f32 v7, v60, v61
  v_lshlrev_b32 v60, 16, v7
  v_and_b32 v61, 0xffff0000, v7
  v_mul_f32 v60, v60, v72
  v_mul_f32 v61, v61, v72
  v_cvt_pk_bf16_f32 v22, v60, v61
  v_sub_f32 v62, v62, v6
  v_sub_f32 v63, v63, v6
  v_cvt_pk_bf16_f32 v7, v62, v63
  v_lshlrev_b32 v62, 16, v7
  v_and_b32 v63, 0xffff0000, v7
  v_mul_f32 v62, v62, v72
  v_mul_f32 v63, v63, v72
  v_cvt_pk_bf16_f32 v23, v62, v63
  v_sub_f32 v64, v64, v6
  v_sub_f32 v65, v65, v6
  v_cvt_pk_bf16_f32 v7, v64, v65
  v_lshlrev_b32 v64, 16, v7
  v_and_b32 v65, 0xffff0000, v7
  v_mul_f32 v64, v64, v72
  v_mul_f32 v65, v65, v72
  v_cvt_pk_bf16_f32 v24, v64, v65
  v_sub_f32 v66, v66, v6
  v_sub_f32 v67, v67, v6
  v_cvt_pk_bf16_f32 v7, v66, v67
  v_lshlrev_b32 v66, 16, v7
  v_and_b32 v67, 0xffff0000, v7
  v_mul_f32 v66, v66, v72
  v_mul_f32 v67, v67, v72
  v_cvt_pk_bf16_f32 v25, v66, v67
  v_sub_f32 v68, v68, v6
  v_sub_f32 v69, v69, v6
  v_cvt_pk_bf16_f32 v7, v68, v69
  v_lshlrev_b32 v68, 16, v7
  v_and_b32 v69, 0xffff0000, v7
  v_mul_f32 v68, v68, v72
  v_mul_f32 v69, v69, v72
  v_cvt_pk_bf16_f32 v26, v68, v69
  v_sub_f32 v70, v70, v6
  v_sub_f32 v71, v71, v6
  v_cvt_pk_bf16_f32 v7, v70, v71
  v_lshlrev_b32 v70, 16, v7
  v_and_b32 v71, 0xffff0000, v7
  v_mul_f32 v70, v70, v72
  v_mul_f32 v71, v71, v72
  v_cvt_pk_bf16_f32 v27, v70, v71
  s_mov_b32 s5, 2097152
  buffer_store_dwordx4 v[8:11], v5, s[8:11], s5 offen sc1
  s_mov_b32 s5, 2101248
  buffer_store_dwordx4 v[12:15], v5, s[8:11], s5 offen sc1
  s_mov_b32 s5, 2105344
  buffer_store_dwordx4 v[16:19], v5, s[8:11], s5 offen sc1
  s_mov_b32 s5, 2109440
  buffer_store_dwordx4 v[20:23], v5, s[8:11], s5 offen sc1
  s_mov_b32 s5, 2113536
  buffer_store_dwordx4 v[24:27], v5, s[8:11], s5 offen sc1
  s_branch L_p2
L_clear:
  v_lshlrev_b32 v2, 4, v0
  s_mul_i32 s5, s2, 3072
  s_add_u32 s5, s5, 0x140000
  s_lshl_b32 s6, s2, 13
  s_add_u32 s6, s6, 205520896
  s_add_u32 s7, s6, 4096
  v_mov_b32 v8, 0
  v_mov_b32 v9, 0
  v_mov_b32 v10, 0
  v_mov_b32 v11, 0
  s_cmp_eq_u32 s3, 2
  s_cbranch_scc1 L_clear2
  buffer_store_dwordx4 v[8:11], v2, s[8:11], s5 offen offset:0 sc1
  buffer_store_dwordx4 v[8:11], v2, s[8:11], s5 offen offset:1024 sc1
  buffer_store_dwordx4 v[8:11], v2, s[8:11], s5 offen offset:2048 sc1
  buffer_store_dwordx4 v[8:11], v2, s[8:11], s7 offen offset:0 sc1
  buffer_store_dwordx4 v[8:11], v2, s[8:11], s7 offen offset:1024 sc1
  buffer_store_dwordx4 v[8:11], v2, s[8:11], s7 offen offset:2048 sc1
  s_branch L_p2
L_clear2:
  buffer_store_dwordx4 v[8:11], v2, s[8:11], s7 offen offset:3072 sc1
  buffer_store_dwordx4 v[8:11], v2, s[8:11], s6 offen offset:0 sc1
  buffer_store_dwordx4 v[8:11], v2, s[8:11], s6 offen offset:1024 sc1
  buffer_store_dwordx4 v[8:11], v2, s[8:11], s6 offen offset:2048 sc1
  buffer_store_dwordx4 v[8:11], v2, s[8:11], s6 offen offset:3072 sc1
L_p2:
  s_cmp_lg_u32 s3, 0
  s_cbranch_scc1 L_p2a
  v_mov_b32 v2, 0
  s_mov_b64 exec, 1
  ds_write_b32 v2, v80
  s_mov_b64 exec, -1
  s_waitcnt lgkmcnt(0)
L_p2a:
  s_barrier
  v_mov_b32 v2, 0
  ds_read_b32 v3, v2
  s_lshl_b32 s58, s4, 4
  s_waitcnt lgkmcnt(0)
  v_readfirstlane_b32 s74, v3
  s_barrier
  s_cmp_lt_u32 s74, 32
  s_cbranch_scc1 L_slot
  v_mbcnt_lo_u32_b32 v2, -1, 0
  v_mbcnt_hi_u32_b32 v2, -1, v2
  v_and_b32 v2, 7, v2
  v_lshlrev_b32 v2, 4, v2
L_census_1:
  s_sub_u32 s59, s59, 1
  s_cbranch_scc1 L_end
  buffer_load_dword v3, v2, s[28:31], 0 offen sc1
  s_waitcnt vmcnt(0)
  v_readlane_b32 s66, v3, 0
  v_readlane_b32 s67, v3, 1
  v_readlane_b32 s68, v3, 2
  v_readlane_b32 s69, v3, 3
  v_readlane_b32 s70, v3, 4
  v_readlane_b32 s71, v3, 5
  v_readlane_b32 s72, v3, 6
  v_readlane_b32 s73, v3, 7
  s_mov_b32 s5, s66
  s_add_u32 s5, s5, s67
  s_add_u32 s5, s5, s68
  s_add_u32 s5, s5, s69
  s_add_u32 s5, s5, s70
  s_add_u32 s5, s5, s71
  s_add_u32 s5, s5, s72
  s_add_u32 s5, s5, s73
  s_cmp_lt_u32 s5, 256
  s_cbranch_scc1 L_census_1
  s_sub_u32 s74, s74, 32
  s_max_u32 s5, s66, 32
  s_sub_u32 s5, s5, 32
  s_cmp_gt_u32 s4, 0
  s_cselect_b32 s5, s5, 0
  s_add_u32 s74, s74, s5
  s_max_u32 s5, s67, 32
  s_sub_u32 s5, s5, 32
  s_cmp_gt_u32 s4, 1
  s_cselect_b32 s5, s5, 0
  s_add_u32 s74, s74, s5
  s_max_u32 s5, s68, 32
  s_sub_u32 s5, s5, 32
  s_cmp_gt_u32 s4, 2
  s_cselect_b32 s5, s5, 0
  s_add_u32 s74, s74, s5
  s_max_u32 s5, s69, 32
  s_sub_u32 s5, s5, 32
  s_cmp_gt_u32 s4, 3
  s_cselect_b32 s5, s5, 0
  s_add_u32 s74, s74, s5
  s_max_u32 s5, s70, 32
  s_sub_u32 s5, s5, 32
  s_cmp_gt_u32 s4, 4
  s_cselect_b32 s5, s5, 0
  s_add_u32 s74, s74, s5
  s_max_u32 s5, s71, 32
  s_sub_u32 s5, s5, 32
  s_cmp_gt_u32 s4, 5
  s_cselect_b32 s5, s5, 0
  s_add_u32 s74, s74, s5
  s_max_u32 s5, s72, 32
  s_sub_u32 s5, s5, 32
  s_cmp_gt_u32 s4, 6
  s_cselect_b32 s5, s5, 0
  s_add_u32 s74, s74, s5
  s_max_u32 s5, s73, 32
  s_sub_u32 s5, s5, 32
  s_cmp_gt_u32 s4, 7
  s_cselect_b32 s5, s5, 0
  s_add_u32 s74, s74, s5
  s_min_u32 s5, s66, 32
  s_sub_u32 s6, 32, s5
  s_mov_b32 s4, 0
  s_add_u32 s7, s5, s74
  s_cmp_lt_u32 s74, s6
  s_cbranch_scc1 L_took
  s_sub_u32 s74, s74, s6
  s_min_u32 s5, s67, 32
  s_sub_u32 s6, 32, s5
  s_mov_b32 s4, 1
  s_add_u32 s7, s5, s74
  s_cmp_lt_u32 s74, s6
  s_cbranch_scc1 L_took
  s_sub_u32 s74, s74, s6
  s_min_u32 s5, s68, 32
  s_sub_u32 s6, 32, s5
  s_mov_b32 s4, 2
  s_add_u32 s7, s5, s74
  s_cmp_lt_u32 s74, s6
  s_cbranch_scc1 L_took
  s_sub_u32 s74, s74, s6
  s_min_u32 s5, s69, 32
  s_sub_u32 s6, 32, s5
  s_mov_b32 s4, 3
  s_add_u32 s7, s5, s74
  s_cmp_lt_u32 s74, s6
  s_cbranch_scc1 L_took
  s_sub_u32 s74, s74, s6
  s_min_u32 s5, s70, 32
  s_sub_u32 s6, 32, s5
  s_mov_b32 s4, 4
  s_add_u32 s7, s5, s74
  s_cmp_lt_u32 s74, s6
  s_cbranch_scc1 L_took
  s_sub_u32 s74, s74, s6
  s_min_u32 s5, s71, 32
  s_sub_u32 s6, 32, s5
  s_mov_b32 s4, 5
  s_add_u32 s7, s5, s74
  s_cmp_lt_u32 s74, s6
  s_cbranch_scc1 L_took
  s_sub_u32 s74, s74, s6
  s_min_u32 s5, s72, 32
  s_sub_u32 s6, 32, s5
  s_mov_b32 s4, 6
  s_add_u32 s7, s5, s74
  s_cmp_lt_u32 s74, s6
  s_cbranch_scc1 L_took
  s_sub_u32 s74, s74, s6
  s_min_u32 s5, s73, 32
  s_sub_u32 s6, 32, s5
  s_mov_b32 s4, 7
  s_add_u32 s7, s5, s74
  s_cmp_lt_u32 s74, s6
  s_cbranch_scc1 L_took
  s_sub_u32 s74, s74, s6
  s_branch L_end
L_took:
  s_mov_b32 s74, s7
L_slot:
  s_cmp_ge_u32 s4, 4
  s_cbranch_scc1 L_nw
  s_cmp_ge_u32 s74, 24
  s_cbranch_scc1 L_nw2
  s_mov_b32 s63, s4
  s_mov_b32 s60, s74
  s_branch L_chain
L_nw2:
  s_lshl_b32 s5, s4, 3
  s_add_u32 s60, s5, s74
  s_sub_u32 s60, s60, 24
  s_branch L_worker
L_nw:
  s_sub_u32 s5, s4, 3
  s_lshl_b32 s5, s5, 5
  s_add_u32 s60, s5, s74
  s_branch L_worker
L_worker:
  s_cmp_lt_u32 s60, 32
  s_cbranch_scc0 L_wattn
  s_mov_b32 s16, s48
  s_and_b32 s17, s49, 0xffff
  s_mov_b32 s18, 1966080
  s_mov_b32 s19, 0x20000
  s_mov_b32 s20, s50
  s_and_b32 s21, s51, 0xffff
  s_mov_b32 s22, 1966080
  s_mov_b32 s23, 0x20000
  s_lshr_b32 s61, s60, 2
  s_and_b32 s64, s60, 3
  s_add_u32 s65, s61, 32
  s_lshr_b32 s6, s60, 1
  s_mul_i32 s78, s6, 192
  s_and_b32 s79, s60, 1
  s_mov_b32 s80, 32
  s_mov_b32 s91, 2
  s_mov_b32 s83, 196608
  s_mul_i32 s81, s79, 98304
  s_mul_i32 s5, s61, 12288
  s_add_u32 s81, s81, s5
  s_and_b32 s5, s6, 1
  s_mul_i32 s5, s5, 3072
  s_add_u32 s81, s81, s5
  s_mul_i32 s5, s3, 768
  s_add_u32 s81, s81, s5
  s_add_u32 s81, s81, 17301504
  s_lshl_b32 s82, s61, 7
  s_lshl_b32 s5, s64, 2
  s_add_u32 s82, s82, s5
  s_add_u32 s82, s82, 2039808
  s_waitcnt vmcnt(0)
  s_barrier
  s_cmp_lg_u32 s3, 0
  s_cbranch_scc1 L_arr_2
  v_mov_b32 v60, 1
  s_mov_b64 exec, 1
  buffer_atomic_add v60, off, s[28:31], s58 offset:128
  s_mov_b64 exec, -1
L_arr_2:
  s_cmp_lg_u32 s3, 0
  s_cbranch_scc1 L_nocal
  s_getreg_b32 s4, hwreg(HW_REG_XCC_ID, 0, 3)
  v_and_b32 v3, 1, v0
  v_lshlrev_b32 v3, 13, v3
  v_lshrrev_b32 v4, 1, v0
  v_lshl_add_u32 v3, v4, 10, v3
  s_lshr_b32 s32, s60, 3
  s_lshl_b32 s32, s32, 14
  s_and_b32 s33, s60, 7
  s_lshl_b32 s33, s33, 7
  s_add_u32 s32, s32, s33
  s_add_u32 s32, s32, 207486976
  s_mov_b64 exec, 0xffff
  buffer_store_dword v0, v3, s[8:11], s32 offen sc1
  s_mov_b64 exec, 1
  s_mov_b32 s33, -1
  s_mov_b32 s34, -1
  s_waitcnt vmcnt(0)
  s_add_u32 s35, s32, 0
  s_memtime s[36:37]
  s_waitcnt lgkmcnt(0)
  buffer_load_dword v3, off, s[8:11], s35 sc1
  s_waitcnt vmcnt(0)
  s_memtime s[46:47]
  s_waitcnt lgkmcnt(0)
  s_sub_u32 s35, s46, s36
  s_min_u32 s33, s33, s35
  s_add_u32 s35, s32, 8192
  s_memtime s[36:37]
  s_waitcnt lgkmcnt(0)
  buffer_load_dword v3, off, s[8:11], s35 sc1
  s_waitcnt vmcnt(0)
  s_memtime s[46:47]
  s_waitcnt lgkmcnt(0)
  s_sub_u32 s35, s46, s36
  s_min_u32 s34, s34, s35
  s_add_u32 s35, s32, 1024
  s_memtime s[36:37]
  s_waitcnt lgkmcnt(0)
  buffer_load_dword v3, off, s[8:11], s35 sc1
  s_waitcnt vmcnt(0)
  s_memtime s[46:47]
  s_waitcnt lgkmcnt(0)
  s_sub_u32 s35, s46, s36
  s_min_u32 s33, s33, s35
  s_add_u32 s35, s32, 9216
  s_memtime s[36:37]
  s_waitcnt lgkmcnt(0)
  buffer_load_dword v3, off, s[8:11], s35 sc1
  s_waitcnt vmcnt(0)
  s_memtime s[46:47]
  s_waitcnt lgkmcnt(0)
  s_sub_u32 s35, s46, s36
  s_min_u32 s34, s34, s35
  s_add_u32 s35, s32, 2048
  s_memtime s[36:37]
  s_waitcnt lgkmcnt(0)
  buffer_load_dword v3, off, s[8:11], s35 sc1
  s_waitcnt vmcnt(0)
  s_memtime s[46:47]
  s_waitcnt lgkmcnt(0)
  s_sub_u32 s35, s46, s36
  s_min_u32 s33, s33, s35
  s_add_u32 s35, s32, 10240
  s_memtime s[36:37]
  s_waitcnt lgkmcnt(0)
  buffer_load_dword v3, off, s[8:11], s35 sc1
  s_waitcnt vmcnt(0)
  s_memtime s[46:47]
  s_waitcnt lgkmcnt(0)
  s_sub_u32 s35, s46, s36
  s_min_u32 s34, s34, s35
  s_add_u32 s35, s32, 3072
  s_memtime s[36:37]
  s_waitcnt lgkmcnt(0)
  buffer_load_dword v3, off, s[8:11], s35 sc1
  s_waitcnt vmcnt(0)
  s_memtime s[46:47]
  s_waitcnt lgkmcnt(0)
  s_sub_u32 s35, s46, s36
  s_min_u32 s33, s33, s35
  s_add_u32 s35, s32, 11264
  s_memtime s[36:37]
  s_waitcnt lgkmcnt(0)
  buffer_load_dword v3, off, s[8:11], s35 sc1
  s_waitcnt vmcnt(0)
  s_memtime s[46:47]
  s_waitcnt lgkmcnt(0)
  s_sub_u32 s35, s46, s36
  s_min_u32 s34, s34, s35
  s_add_u32 s35, s32, 4096
  s_memtime s[36:37]
  s_waitcnt lgkmcnt(0)
  buffer_load_dword v3, off, s[8:11], s35 sc1
  s_waitcnt vmcnt(0)
  s_memtime s[46:47]
  s_waitcnt lgkmcnt(0)
  s_sub_u32 s35, s46, s36
  s_min_u32 s33, s33, s35
  s_add_u32 s35, s32, 12288
  s_memtime s[36:37]
  s_waitcnt lgkmcnt(0)
  buffer_load_dword v3, off, s[8:11], s35 sc1
  s_waitcnt vmcnt(0)
  s_memtime s[46:47]
  s_waitcnt lgkmcnt(0)
  s_sub_u32 s35, s46, s36
  s_min_u32 s34, s34, s35
  s_add_u32 s35, s32, 5120
  s_memtime s[36:37]
  s_waitcnt lgkmcnt(0)
  buffer_load_dword v3, off, s[8:11], s35 sc1
  s_waitcnt vmcnt(0)
  s_memtime s[46:47]
  s_waitcnt lgkmcnt(0)
  s_sub_u32 s35, s46, s36
  s_min_u32 s33, s33, s35
  s_add_u32 s35, s32, 13312
  s_memtime s[36:37]
  s_waitcnt lgkmcnt(0)
  buffer_load_dword v3, off, s[8:11], s35 sc1
  s_waitcnt vmcnt(0)
  s_memtime s[46:47]
  s_waitcnt lgkmcnt(0)
  s_sub_u32 s35, s46, s36
  s_min_u32 s34, s34, s35
  s_add_u32 s35, s32, 6144
  s_memtime s[36:37]
  s_waitcnt lgkmcnt(0)
  buffer_load_dword v3, off, s[8:11], s35 sc1
  s_waitcnt vmcnt(0)
  s_memtime s[46:47]
  s_waitcnt lgkmcnt(0)
  s_sub_u32 s35, s46, s36
  s_min_u32 s33, s33, s35
  s_add_u32 s35, s32, 14336
  s_memtime s[36:37]
  s_waitcnt lgkmcnt(0)
  buffer_load_dword v3, off, s[8:11], s35 sc1
  s_waitcnt vmcnt(0)
  s_memtime s[46:47]
  s_waitcnt lgkmcnt(0)
  s_sub_u32 s35, s46, s36
  s_min_u32 s34, s34, s35
  s_add_u32 s35, s32, 7168
  s_memtime s[36:37]
  s_waitcnt lgkmcnt(0)
  buffer_load_dword v3, off, s[8:11], s35 sc1
  s_waitcnt vmcnt(0)
  s_memtime s[46:47]
  s_waitcnt lgkmcnt(0)
  s_sub_u32 s35, s46, s36
  s_min_u32 s33, s33, s35
  s_add_u32 s35, s32, 15360
  s_memtime s[36:37]
  s_waitcnt lgkmcnt(0)
  buffer_load_dword v3, off, s[8:11], s35 sc1
  s_waitcnt vmcnt(0)
  s_memtime s[46:47]
  s_waitcnt lgkmcnt(0)
  s_sub_u32 s35, s46, s36
  s_min_u32 s34, s34, s35
  s_sub_i32 s35, s33, s34
  s_sub_i32 s36, s34, s33
  s_cmp_ge_u32 s4, 4
  s_cselect_b32 s35, s36, s35
  s_min_i32 s35, s35, 300
  s_max_i32 s35, s35, -300
  s_add_i32 s35, s35, 300
  s_lshl_b32 s35, s35, 8
  s_add_u32 s35, s35, 1
  v_mov_b32 v3, s35
  buffer_atomic_add v3, off, s[28:31], 0 offset:8
  s_mov_b64 exec, -1
L_nocal:
  s_branch L_gwait_in
L_gwait:
  s_sleep 8
L_gwait_in:
  s_sub_u32 s59, s59, 1
  s_cbranch_scc1 L_end
  buffer_load_dword v1, off, s[28:31], 0 offset:12 sc1
  s_waitcnt vmcnt(0)
  v_readfirstlane_b32 s5, v1
  s_cmp_eq_u32 s5, 0
  s_cbranch_scc1 L_gwait
  s_barrier
  v_mbcnt_lo_u32_b32 v0, -1, 0
  v_mbcnt_hi_u32_b32 v0, -1, v0
  v_add_u32 v1, 0, v0
  v_mul_u32_u24 v2, 5462, v1
  v_lshrrev_b32 v2, 16, v2
  v_mul_u32_u24 v3, 12, v2
  v_sub_u32 v3, v1, v3
  v_mul_u32_u24 v2, 3072, v2
  v_lshl_add_u32 v4, v3, 4, v2
  v_add_u32 v1, 64, v0
  v_mul_u32_u24 v2, 5462, v1
  v_lshrrev_b32 v2, 16, v2
  v_mul_u32_u24 v3, 12, v2
  v_sub_u32 v3, v1, v3
  v_mul_u32_u24 v2, 3072, v2
  v_lshl_add_u32 v5, v3, 4, v2
  v_add_u32 v1, 128, v0
  v_mul_u32_u24 v2, 5462, v1
  v_lshrrev_b32 v2, 16, v2
  v_mul_u32_u24 v3, 12, v2
  v_sub_u32 v3, v1, v3
  v_mul_u32_u24 v2, 3072, v2
  v_lshl_add_u32 v6, v3, 4, v2
  v_lshrrev_b32 v1, 4, v0
  v_bfe_u32 v2, v0, 2, 2
  v_lshl_add_u32 v1, v1, 3, v2
  v_and_b32 v3, 3, v0
  v_mul_u32_u24 v1, 192, v1
  v_lshrrev_b32 v2, 1, v3
  v_lshl_add_u32 v1, v2, 3, v1
  v_and_b32 v3, 1, v3
  v_mul_u32_u24 v3, 24576, v3
  v_add_u32 v1, v1, v3
  s_mul_i32 s5, s3, 48
  v_add_u32 v1, s5, v1
  v_add_u32 v2, 49152, v1
  v_add_u32 v3, 98304, v1
  s_lshl_b32 s5, s3, 1
  s_add_u32 s5, s5, 0
  s_mul_i32 s6, s5, 3072
  s_add_u32 s6, s6, 0
  s_mul_i32 s5, s5, 49152
  s_add_u32 s5, s5, s78
  s_add_u32 s5, s5, 0
  s_add_u32 m0, s6, 0
  s_nop 0
  buffer_load_dwordx4 v4, s[16:19], s5 offen lds
  s_add_u32 m0, s6, 1024
  s_nop 0
  buffer_load_dwordx4 v5, s[16:19], s5 offen lds
  s_add_u32 m0, s6, 2048
  s_nop 0
  buffer_load_dwordx4 v6, s[16:19], s5 offen lds
  s_lshl_b32 s5, s3, 1
  s_add_u32 s5, s5, 1
  s_mul_i32 s6, s5, 3072
  s_add_u32 s6, s6, 0
  s_mul_i32 s5, s5, 49152
  s_add_u32 s5, s5, s78
  s_add_u32 s5, s5, 0
  s_add_u32 m0, s6, 0
  s_nop 0
  buffer_load_dwordx4 v4, s[16:19], s5 offen lds
  s_add_u32 m0, s6, 1024
  s_nop 0
  buffer_load_dwordx4 v5, s[16:19], s5 offen lds
  s_add_u32 m0, s6, 2048
  s_nop 0
  buffer_load_dwordx4 v6, s[16:19], s5 offen lds
  s_lshl_b32 s5, s3, 1
  s_add_u32 s5, s5, 0
  s_mul_i32 s6, s5, 3072
  s_add_u32 s6, s6, 24576
  s_mul_i32 s5, s5, 49152
  s_add_u32 s5, s5, s78
  s_add_u32 s5, s5, 0
  s_add_u32 m0, s6, 0
  s_nop 0
  buffer_load_dwordx4 v4, s[20:23], s5 offen lds
  s_add_u32 m0, s6, 1024
  s_nop 0
  buffer_load_dwordx4 v5, s[20:23], s5 offen lds
  s_add_u32 m0, s6, 2048
  s_nop 0
  buffer_load_dwordx4 v6, s[20:23], s5 offen lds
  s_lshl_b32 s5, s3, 1
  s_add_u32 s5, s5, 1
  s_mul_i32 s6, s5, 3072
  s_add_u32 s6, s6, 24576
  s_mul_i32 s5, s5, 49152
  s_add_u32 s5, s5, s78
  s_add_u32 s5, s5, 0
  s_add_u32 m0, s6, 0
  s_nop 0
  buffer_load_dwordx4 v4, s[20:23], s5 offen lds
  s_add_u32 m0, s6, 1024
  s_nop 0
  buffer_load_dwordx4 v5, s[20:23], s5 offen lds
  s_add_u32 m0, s6, 2048
  s_nop 0
  buffer_load_dwordx4 v6, s[20:23], s5 offen lds
  s_lshl_b32 s5, s3, 1
  s_add_u32 s5, s5, 0
  s_mul_i32 s6, s5, 3072
  s_add_u32 s6, s6, 49152
  s_mul_i32 s5, s5, 49152
  s_add_u32 s5, s5, s78
  s_add_u32 s5, s5, 393216
  s_add_u32 m0, s6, 0
  s_nop 0
  buffer_load_dwordx4 v4, s[16:19], s5 offen lds
  s_add_u32 m0, s6, 1024
  s_nop 0
  buffer_load_dwordx4 v5, s[16:19], s5 offen lds
  s_add_u32 m0, s6, 2048
  s_nop 0
  buffer_load_dwordx4 v6, s[16:19], s5 offen lds
  s_lshl_b32 s5, s3, 1
  s_add_u32 s5, s5, 1
  s_mul_i32 s6, s5, 3072
  s_add_u32 s6, s6, 49152
  s_mul_i32 s5, s5, 49152
  s_add_u32 s5, s5, s78
  s_add_u32 s5, s5, 393216
  s_add_u32 m0, s6, 0
  s_nop 0
  buffer_load_dwordx4 v4, s[16:19], s5 offen lds
  s_add_u32 m0, s6, 1024
  s_nop 0
  buffer_load_dwordx4 v5, s[16:19], s5 offen lds
  s_add_u32 m0, s6, 2048
  s_nop 0
  buffer_load_dwordx4 v6, s[16:19], s5 offen lds
  s_lshl_b32 s5, s3, 1
  s_add_u32 s5, s5, 0
  s_mul_i32 s6, s5, 3072
  s_add_u32 s6, s6, 73728
  s_mul_i32 s5, s5, 49152
  s_add_u32 s5, s5, s78
  s_add_u32 s5, s5, 393216
  s_add_u32 m0, s6, 0
  s_nop 0
  buffer_load_dwordx4 v4, s[20:23], s5 offen lds
  s_add_u32 m0, s6, 1024
  s_nop 0
  buffer_load_dwordx4 v5, s[20:23], s5 offen lds
  s_add_u32 m0, s6, 2048
  s_nop 0
  buffer_load_dwordx4 v6, s[20:23], s5 offen lds
  s_lshl_b32 s5, s3, 1
  s_add_u32 s5, s5, 1
  s_mul_i32 s6, s5, 3072
  s_add_u32 s6, s6, 73728
  s_mul_i32 s5, s5, 49152
  s_add_u32 s5, s5, s78
  s_add_u32 s5, s5, 393216
  s_add_u32 m0, s6, 0
  s_nop 0
  buffer_load_dwordx4 v4, s[20:23], s5 offen lds
  s_add_u32 m0, s6, 1024
  s_nop 0
  buffer_load_dwordx4 v5, s[20:23], s5 offen lds
  s_add_u32 m0, s6, 2048
  s_nop 0
  buffer_load_dwordx4 v6, s[20:23], s5 offen lds
  s_lshl_b32 s5, s3, 1
  s_add_u32 s5, s5, 0
  s_mul_i32 s6, s5, 3072
  s_add_u32 s6, s6, 98304
  s_mul_i32 s5, s5, 49152
  s_add_u32 s5, s5, s78
  s_add_u32 s5, s5, 786432
  s_add_u32 m0, s6, 0
  s_nop 0
  buffer_load_dwordx4 v4, s[16:19], s5 offen lds
  s_add_u32 m0, s6, 1024
  s_nop 0
  buffer_load_dwordx4 v5, s[16:19], s5 offen lds
  s_add_u32 m0, s6, 2048
  s_nop 0
  buffer_load_dwordx4 v6, s[16:19], s5 offen lds
  s_lshl_b32 s5, s3, 1
  s_add_u32 s5, s5, 1
  s_mul_i32 s6, s5, 3072
  s_add_u32 s6, s6, 98304
  s_mul_i32 s5, s5, 49152
  s_add_u32 s5, s5, s78
  s_add_u32 s5, s5, 786432
  s_add_u32 m0, s6, 0
  s_nop 0
  buffer_load_dwordx4 v4, s[16:19], s5 offen lds
  s_add_u32 m0, s6, 1024
  s_nop 0
  buffer_load_dwordx4 v5, s[16:19], s5 offen lds
  s_add_u32 m0, s6, 2048
  s_nop 0
  buffer_load_dwordx4 v6, s[16:19], s5 offen lds
  s_lshl_b32 s5, s3, 1
  s_add_u32 s5, s5, 0
  s_mul_i32 s6, s5, 3072
  s_add_u32 s6, s6, 122880
  s_mul_i32 s5, s5, 49152
  s_add_u32 s5, s5, s78
  s_add_u32 s5, s5, 786432
  s_add_u32 m0, s6, 0
  s_nop 0
  buffer_load_dwordx4 v4, s[20:23], s5 offen lds
  s_add_u32 m0, s6, 1024
  s_nop 0
  buffer_load_dwordx4 v5, s[20:23], s5 offen lds
  s_add_u32 m0, s6, 2048
  s_nop 0
  buffer_load_dwordx4 v6, s[20:23], s5 offen lds
  s_lshl_b32 s5, s3, 1
  s_add_u32 s5, s5, 1
  s_mul_i32 s6, s5, 3072
  s_add_u32 s6, s6, 122880
  s_mul_i32 s5, s5, 49152
  s_add_u32 s5, s5, s78
  s_add_u32 s5, s5, 786432
  s_add_u32 m0, s6, 0
  s_nop 0
  buffer_load_dwordx4 v4, s[20:23], s5 offen lds
  s_add_u32 m0, s6, 1024
  s_nop 0
  buffer_load_dwordx4 v5, s[20:23], s5 offen lds
  s_add_u32 m0, s6, 2048
  s_nop 0
  buffer_load_dwordx4 v6, s[20:23], s5 offen lds
  s_waitcnt vmcnt(24)
  s_barrier
  ds_read_b64_tr_b16 a[0:1], v1 offset:0
  ds_read_b64_tr_b16 a[2:3], v1 offset:768
  ds_read_b64_tr_b16 a[4:5], v1 offset:6144
  ds_read_b64_tr_b16 a[6:7], v1 offset:6912
  ds_read_b64_tr_b16 a[8:9], v1 offset:12288
  ds_read_b64_tr_b16 a[10:11], v1 offset:13056
  ds_read_b64_tr_b16 a[12:13], v1 offset:18432
  ds_read_b64_tr_b16 a[14:15], v1 offset:19200
  ds_read_b64_tr_b16 a[80:81], v1 offset:16
  ds_read_b64_tr_b16 a[82:83], v1 offset:784
  ds_read_b64_tr_b16 a[84:85], v1 offset:6160
  ds_read_b64_tr_b16 a[86:87], v1 offset:6928
  s_waitcnt lgkmcnt(4)
  ds_read_b64_tr_b16 a[88:89], v1 offset:12304
  ds_read_b64_tr_b16 a[90:91], v1 offset:13072
  ds_read_b64_tr_b16 a[92:93], v1 offset:18448
  ds_read_b64_tr_b16 a[94:95], v1 offset:19216
  ds_read_b64_tr_b16 a[160:161], v1 offset:32
  ds_read_b64_tr_b16 a[162:163], v1 offset:800
  ds_read_b64_tr_b16 a[164:165], v1 offset:6176
  ds_read_b64_tr_b16 a[166:167], v1 offset:6944
  ds_read_b64_tr_b16 a[168:169], v1 offset:12320
  ds_read_b64_tr_b16 a[170:171], v1 offset:13088
  ds_read_b64_tr_b16 a[172:173], v1 offset:18464
  ds_read_b64_tr_b16 a[174:175], v1 offset:19232
  s_waitcnt lgkmcnt(0)
  s_barrier
  s_lshl_b32 s5, s3, 1
  s_add_u32 s5, s5, 0
  s_mul_i32 s6, s5, 3072
  s_add_u32 s6, s6, 0
  s_mul_i32 s5, s5, 49152
  s_add_u32 s5, s5, s78
  s_add_u32 s5, s5, 1179648
  s_add_u32 m0, s6, 0
  s_nop 0
  buffer_load_dwordx4 v4, s[16:19], s5 offen lds
  s_add_u32 m0, s6, 1024
  s_nop 0
  buffer_load_dwordx4 v5, s[16:19], s5 offen lds
  s_add_u32 m0, s6, 2048
  s_nop 0
  buffer_load_dwordx4 v6, s[16:19], s5 offen lds
  s_lshl_b32 s5, s3, 1
  s_add_u32 s5, s5, 1
  s_mul_i32 s6, s5, 3072
  s_add_u32 s6, s6, 0
  s_mul_i32 s5, s5, 49152
  s_add_u32 s5, s5, s78
  s_add_u32 s5, s5, 1179648
  s_add_u32 m0, s6, 0
  s_nop 0
  buffer_load_dwordx4 v4, s[16:19], s5 offen lds
  s_add_u32 m0, s6, 1024
  s_nop 0
  buffer_load_dwordx4 v5, s[16:19], s5 offen lds
  s_add_u32 m0, s6, 2048
  s_nop 0
  buffer_load_dwordx4 v6, s[16:19], s5 offen lds
  s_lshl_b32 s5, s3, 1
  s_add_u32 s5, s5, 0
  s_mul_i32 s6, s5, 3072
  s_add_u32 s6, s6, 24576
  s_mul_i32 s5, s5, 49152
  s_add_u32 s5, s5, s78
  s_add_u32 s5, s5, 1179648
  s_add_u32 m0, s6, 0
  s_nop 0
  buffer_load_dwordx4 v4, s[20:23], s5 offen lds
  s_add_u32 m0, s6, 1024
  s_nop 0
  buffer_load_dwordx4 v5, s[20:23], s5 offen lds
  s_add_u32 m0, s6, 2048
  s_nop 0
  buffer_load_dwordx4 v6, s[20:23], s5 offen lds
  s_lshl_b32 s5, s3, 1
  s_add_u32 s5, s5, 1
  s_mul_i32 s6, s5, 3072
  s_add_u32 s6, s6, 24576
  s_mul_i32 s5, s5, 49152
  s_add_u32 s5, s5, s78
  s_add_u32 s5, s5, 1179648
  s_add_u32 m0, s6, 0
  s_nop 0
  buffer_load_dwordx4 v4, s[20:23], s5 offen lds
  s_add_u32 m0, s6, 1024
  s_nop 0
  buffer_load_dwordx4 v5, s[20:23], s5 offen lds
  s_add_u32 m0, s6, 2048
  s_nop 0
  buffer_load_dwordx4 v6, s[20:23], s5 offen lds
  s_waitcnt vmcnt(24)
  s_barrier
  ds_read_b64_tr_b16 a[16:17], v2 offset:0
  ds_read_b64_tr_b16 a[18:19], v2 offset:768
  ds_read_b64_tr_b16 a[20:21], v2 offset:6144
  ds_read_b64_tr_b16 a[22:23], v2 offset:6912
  ds_read_b64_tr_b16 a[24:25], v2 offset:12288
  ds_read_b64_tr_b16 a[26:27], v2 offset:13056
  ds_read_b64_tr_b16 a[28:29], v2 offset:18432
  ds_read_b64_tr_b16 a[30:31], v2 offset:19200
  ds_read_b64_tr_b16 a[96:97], v2 offset:16
  ds_read_b64_tr_b16 a[98:99], v2 offset:784
  ds_read_b64_tr_b16 a[100:101], v2 offset:6160
  ds_read_b64_tr_b16 a[102:103], v2 offset:6928
  s_waitcnt lgkmcnt(4)
  ds_read_b64_tr_b16 a[104:105], v2 offset:12304
  ds_read_b64_tr_b16 a[106:107], v2 offset:13072
  ds_read_b64_tr_b16 a[108:109], v2 offset:18448
  ds_read_b64_tr_b16 a[110:111], v2 offset:19216
  ds_read_b64_tr_b16 a[176:177], v2 offset:32
  ds_read_b64_tr_b16 a[178:179], v2 offset:800
  ds_read_b64_tr_b16 a[180:181], v2 offset:6176
  ds_read_b64_tr_b16 a[182:183], v2 offset:6944
  ds_read_b64_tr_b16 a[184:185], v2 offset:12320
  ds_read_b64_tr_b16 a[186:187], v2 offset:13088
  ds_read_b64_tr_b16 a[188:189], v2 offset:18464
  ds_read_b64_tr_b16 a[190:191], v2 offset:19232
  s_waitcnt lgkmcnt(0)
  s_barrier
  s_lshl_b32 s5, s3, 1
  s_add_u32 s5, s5, 0
  s_mul_i32 s6, s5, 3072
  s_add_u32 s6, s6, 49152
  s_mul_i32 s5, s5, 49152
  s_add_u32 s5, s5, s78
  s_add_u32 s5, s5, 1572864
  s_add_u32 m0, s6, 0
  s_nop 0
  buffer_load_dwordx4 v4, s[16:19], s5 offen lds
  s_add_u32 m0, s6, 1024
  s_nop 0
  buffer_load_dwordx4 v5, s[16:19], s5 offen lds
  s_add_u32 m0, s6, 2048
  s_nop 0
  buffer_load_dwordx4 v6, s[16:19], s5 offen lds
  s_lshl_b32 s5, s3, 1
  s_add_u32 s5, s5, 1
  s_mul_i32 s6, s5, 3072
  s_add_u32 s6, s6, 49152
  s_mul_i32 s5, s5, 49152
  s_add_u32 s5, s5, s78
  s_add_u32 s5, s5, 1572864
  s_add_u32 m0, s6, 0
  s_nop 0
  buffer_load_dwordx4 v4, s[16:19], s5 offen lds
  s_add_u32 m0, s6, 1024
  s_nop 0
  buffer_load_dwordx4 v5, s[16:19], s5 offen lds
  s_add_u32 m0, s6, 2048
  s_nop 0
  buffer_load_dwordx4 v6, s[16:19], s5 offen lds
  s_lshl_b32 s5, s3, 1
  s_add_u32 s5, s5, 0
  s_mul_i32 s6, s5, 3072
  s_add_u32 s6, s6, 73728
  s_mul_i32 s5, s5, 49152
  s_add_u32 s5, s5, s78
  s_add_u32 s5, s5, 1572864
  s_add_u32 m0, s6, 0
  s_nop 0
  buffer_load_dwordx4 v4, s[20:23], s5 offen lds
  s_add_u32 m0, s6, 1024
  s_nop 0
  buffer_load_dwordx4 v5, s[20:23], s5 offen lds
  s_add_u32 m0, s6, 2048
  s_nop 0
  buffer_load_dwordx4 v6, s[20:23], s5 offen lds
  s_lshl_b32 s5, s3, 1
  s_add_u32 s5, s5, 1
  s_mul_i32 s6, s5, 3072
  s_add_u32 s6, s6, 73728
  s_mul_i32 s5, s5, 49152
  s_add_u32 s5, s5, s78
  s_add_u32 s5, s5, 1572864
  s_add_u32 m0, s6, 0
  s_nop 0
  buffer_load_dwordx4 v4, s[20:23], s5 offen lds
  s_add_u32 m0, s6, 1024
  s_nop 0
  buffer_load_dwordx4 v5, s[20:23], s5 offen lds
  s_add_u32 m0, s6, 2048
  s_nop 0
  buffer_load_dwordx4 v6, s[20:23], s5 offen lds
  s_waitcnt vmcnt(24)
  s_barrier
  ds_read_b64_tr_b16 a[32:33], v3 offset:0
  ds_read_b64_tr_b16 a[34:35], v3 offset:768
  ds_read_b64_tr_b16 a[36:37], v3 offset:6144
  ds_read_b64_tr_b16 a[38:39], v3 offset:6912
  ds_read_b64_tr_b16 a[40:41], v3 offset:12288
  ds_read_b64_tr_b16 a[42:43], v3 offset:13056
  ds_read_b64_tr_b16 a[44:45], v3 offset:18432
  ds_read_b64_tr_b16 a[46:47], v3 offset:19200
  ds_read_b64_tr_b16 a[112:113], v3 offset:16
  ds_read_b64_tr_b16 a[114:115], v3 offset:784
  ds_read_b64_tr_b16 a[116:117], v3 offset:6160
  ds_read_b64_tr_b16 a[118:119], v3 offset:6928
  s_waitcnt lgkmcnt(4)
  ds_read_b64_tr_b16 a[120:121], v3 offset:12304
  ds_read_b64_tr_b16 a[122:123], v3 offset:13072
  ds_read_b64_tr_b16 a[124:125], v3 offset:18448
  ds_read_b64_tr_b16 a[126:127], v3 offset:19216
  ds_read_b64_tr_b16 a[192:193], v3 offset:32
  ds_read_b64_tr_b16 a[194:195], v3 offset:800
  ds_read_b64_tr_b16 a[196:197], v3 offset:6176
  ds_read_b64_tr_b16 a[198:199], v3 offset:6944
  ds_read_b64_tr_b16 a[200:201], v3 offset:12320
  ds_read_b64_tr_b16 a[202:203], v3 offset:13088
  ds_read_b64_tr_b16 a[204:205], v3 offset:18464
  ds_read_b64_tr_b16 a[206:207], v3 offset:19232
  s_waitcnt vmcnt(12)
  s_barrier
  ds_read_b64_tr_b16 a[48:49], v1 offset:0
  ds_read_b64_tr_b16 a[50:51], v1 offset:768
  ds_read_b64_tr_b16 a[52:53], v1 offset:6144
  ds_read_b64_tr_b16 a[54:55], v1 offset:6912
  ds_read_b64_tr_b16 a[56:57], v1 offset:12288
  ds_read_b64_tr_b16 a[58:59], v1 offset:13056
  ds_read_b64_tr_b16 a[60:61], v1 offset:18432
  ds_read_b64_tr_b16 a[62:63], v1 offset:19200
  ds_read_b64_tr_b16 a[128:129], v1 offset:16
  ds_read_b64_tr_b16 a[130:131], v1 offset:784
  ds_read_b64_tr_b16 a[132:133], v1 offset:6160
  ds_read_b64_tr_b16 a[134:135], v1 offset:6928
  s_waitcnt lgkmcnt(4)
  ds_read_b64_tr_b16 a[136:137], v1 offset:12304
  ds_read_b64_tr_b16 a[138:139], v1 offset:13072
  ds_read_b64_tr_b16 a[140:141], v1 offset:18448
  ds_read_b64_tr_b16 a[142:143], v1 offset:19216
  ds_read_b64_tr_b16 a[208:209], v1 offset:32
  ds_read_b64_tr_b16 a[210:211], v1 offset:800
  ds_read_b64_tr_b16 a[212:213], v1 offset:6176
  ds_read_b64_tr_b16 a[214:215], v1 offset:6944
  ds_read_b64_tr_b16 a[216:217], v1 offset:12320
  ds_read_b64_tr_b16 a[218:219], v1 offset:13088
  ds_read_b64_tr_b16 a[220:221], v1 offset:18464
  ds_read_b64_tr_b16 a[222:223], v1 offset:19232
  s_waitcnt vmcnt(0)
  s_barrier
  ds_read_b64_tr_b16 a[64:65], v2 offset:0
  ds_read_b64_tr_b16 a[66:67], v2 offset:768
  ds_read_b64_tr_b16 a[68:69], v2 offset:6144
  ds_read_b64_tr_b16 a[70:71], v2 offset:6912
  ds_read_b64_tr_b16 a[72:73], v2 offset:12288
  ds_read_b64_tr_b16 a[74:75], v2 offset:13056
  ds_read_b64_tr_b16 a[76:77], v2 offset:18432
  ds_read_b64_tr_b16 a[78:79], v2 offset:19200
  ds_read_b64_tr_b16 a[144:145], v2 offset:16
  ds_read_b64_tr_b16 a[146:147], v2 offset:784
  ds_read_b64_tr_b16 a[148:149], v2 offset:6160
  ds_read_b64_tr_b16 a[150:151], v2 offset:6928
  s_waitcnt lgkmcnt(4)
  ds_read_b64_tr_b16 a[152:153], v2 offset:12304
  ds_read_b64_tr_b16 a[154:155], v2 offset:13072
  ds_read_b64_tr_b16 a[156:157], v2 offset:18448
  ds_read_b64_tr_b16 a[158:159], v2 offset:19216
  ds_read_b64_tr_b16 a[224:225], v2 offset:32
  ds_read_b64_tr_b16 a[226:227], v2 offset:800
  ds_read_b64_tr_b16 a[228:229], v2 offset:6176
  ds_read_b64_tr_b16 a[230:231], v2 offset:6944
  ds_read_b64_tr_b16 a[232:233], v2 offset:12320
  ds_read_b64_tr_b16 a[234:235], v2 offset:13088
  ds_read_b64_tr_b16 a[236:237], v2 offset:18464
  ds_read_b64_tr_b16 a[238:239], v2 offset:19232
  s_waitcnt lgkmcnt(0)
  s_barrier
  v_mbcnt_lo_u32_b32 v0, -1, 0
  v_mbcnt_hi_u32_b32 v0, -1, v0
  v_lshlrev_b32 v28, 4, v0
  s_cmp_lg_u32 s3, 0
  s_cbranch_scc1 L_poll2d_4
  v_mbcnt_lo_u32_b32 v29, -1, 0
  v_mbcnt_hi_u32_b32 v29, -1, v29
  v_and_b32 v29, 7, v29
  v_lshlrev_b32 v29, 4, v29
L_poll2_3:
  s_sub_u32 s59, s59, 1
  s_cbranch_scc1 L_end
  buffer_load_dword v30, v29, s[28:31], 0 offen offset:128 sc1
  s_waitcnt vmcnt(0)
  v_add_u32_dpp v30, v30, v30 row_ror:1 row_mask:0xf bank_mask:0xf
  s_nop 1
  v_add_u32_dpp v30, v30, v30 row_ror:2 row_mask:0xf bank_mask:0xf
  s_nop 1
  v_add_u32_dpp v30, v30, v30 row_ror:4 row_mask:0xf bank_mask:0xf
  s_nop 0
  v_readfirstlane_b32 s5, v30
  s_cmp_lt_u32 s5, 256
  s_cbranch_scc1 L_poll2_3
L_poll2d_4:
  s_barrier
  s_lshl_b32 s84, s79, 1
  s_lshr_b32 s5, s3, 1
  s_add_u32 s84, s84, s5
  s_mul_i32 s84, s84, 20480
  s_and_b32 s5, s3, 1
  s_mul_i32 s5, s5, 5120
  s_add_u32 s84, s84, s5
  s_add_u32 s84, s84, 2097152
  s_mul_i32 s93, s91, 40960
  s_sub_u32 s93, s93, 10240
  s_mul_i32 s92, s3, 5120
  s_mov_b32 s85, 0
  s_mov_b32 s86, 20480
  s_mov_b32 s87, 40960
  s_mov_b32 s94, 61440
  v_lshrrev_b32 v1, 4, v0
  v_and_b32 v2, 1, v1
  v_mul_u32_u24 v31, 6144, v2
  v_lshrrev_b32 v1, 1, v1
  v_lshl_add_u32 v31, v1, 3, v31
  v_and_b32 v1, 15, v0
  v_lshl_add_u32 v31, v1, 4, v31
  s_add_u32 s88, s85, s92
  s_mov_b32 m0, s88
  s_nop 0
  buffer_load_dwordx4 v28, s[8:11], s84 offen offset:0 lds
  buffer_load_dwordx4 v28, s[8:11], s84 offen offset:1024 lds
  buffer_load_dwordx4 v28, s[8:11], s84 offen offset:2048 lds
  buffer_load_dwordx4 v28, s[8:11], s84 offen offset:3072 lds
  s_add_u32 m0, s88, 4096
  s_add_u32 s89, s84, 4096
  buffer_load_dwordx4 v28, s[8:11], s89 offen offset:0 lds
  s_add_u32 s84, s84, 10240
  s_add_u32 s88, s86, s92
  s_mov_b32 m0, s88
  s_nop 0
  buffer_load_dwordx4 v28, s[8:11], s84 offen offset:0 lds
  buffer_load_dwordx4 v28, s[8:11], s84 offen offset:1024 lds
  buffer_load_dwordx4 v28, s[8:11], s84 offen offset:2048 lds
  buffer_load_dwordx4 v28, s[8:11], s84 offen offset:3072 lds
  s_add_u32 m0, s88, 4096
  s_add_u32 s89, s84, 4096
  buffer_load_dwordx4 v28, s[8:11], s89 offen offset:0 lds
  s_add_u32 s84, s84, s93
  s_add_u32 s88, s87, s92
  s_mov_b32 m0, s88
  s_nop 0
  buffer_load_dwordx4 v28, s[8:11], s84 offen offset:0 lds
  buffer_load_dwordx4 v28, s[8:11], s84 offen offset:1024 lds
  buffer_load_dwordx4 v28, s[8:11], s84 offen offset:2048 lds
  buffer_load_dwordx4 v28, s[8:11], s84 offen offset:3072 lds
  s_add_u32 m0, s88, 4096
  s_add_u32 s89, s84, 4096
  buffer_load_dwordx4 v28, s[8:11], s89 offen offset:0 lds
  s_add_u32 s84, s84, 10240
  s_waitcnt vmcnt(5)
  s_barrier
  s_mov_b32 s90, 0
  v_add_u32 v26, s85, v28
  v_add_u32 v27, s86, v28
  ds_read_b128 v[64:67], v26 offset:0
  ds_read_b128 v[68:71], v26 offset:10240
  ds_read_b128 v[72:75], v26 offset:1024
  ds_read_b128 v[76:79], v26 offset:11264
L_w1_5:
  ds_read_b128 v[80:83], v26 offset:2048
  ds_read_b128 v[84:87], v26 offset:12288
  s_waitcnt lgkmcnt(4)
  v_mfma_f32_16x16x32_bf16 v[32:35], a[0:3], v[64:67], 0
  v_mfma_f32_16x16x32_bf16 v[44:47], a[0:3], v[68:71], 0
  v_mfma_f32_16x16x32_bf16 v[36:39], a[80:83], v[64:67], 0
  v_mfma_f32_16x16x32_bf16 v[48:51], a[80:83], v[68:71], 0
  v_mfma_f32_16x16x32_bf16 v[40:43], a[160:163], v[64:67], 0
  v_mfma_f32_16x16x32_bf16 v[52:55], a[160:163], v[68:71], 0
  ds_read_b128 v[88:91], v26 offset:3072
  ds_read_b128 v[92:95], v26 offset:13312
  s_waitcnt lgkmcnt(4)
  v_mfma_f32_16x16x32_bf16 v[32:35], a[4:7], v[72:75], v[32:35]
  v_mfma_f32_16x16x32_bf16 v[44:47], a[4:7], v[76:79], v[44:47]
  v_mfma_f32_16x16x32_bf16 v[36:39], a[84:87], v[72:75], v[36:39]
  v_mfma_f32_16x16x32_bf16 v[48:51], a[84:87], v[76:79], v[48:51]
  v_mfma_f32_16x16x32_bf16 v[40:43], a[164:167], v[72:75], v[40:43]
  v_mfma_f32_16x16x32_bf16 v[52:55], a[164:167], v[76:79], v[52:55]
  ds_read_b128 v[64:67], v26 offset:4096
  ds_read_b128 v[68:71], v26 offset:14336
  s_waitcnt lgkmcnt(4)
  v_mfma_f32_16x16x32_bf16 v[32:35], a[8:11], v[80:83], v[32:35]
  v_mfma_f32_16x16x32_bf16 v[44:47], a[8:11], v[84:87], v[44:47]
  v_mfma_f32_16x16x32_bf16 v[36:39], a[88:91], v[80:83], v[36:39]
  v_mfma_f32_16x16x32_bf16 v[48:51], a[88:91], v[84:87], v[48:51]
  v_mfma_f32_16x16x32_bf16 v[40:43], a[168:171], v[80:83], v[40:43]
  v_mfma_f32_16x16x32_bf16 v[52:55], a[168:171], v[84:87], v[52:55]
  ds_read_b128 v[72:75], v26 offset:5120
  ds_read_b128 v[76:79], v26 offset:15360
  s_waitcnt lgkmcnt(4)
  v_mfma_f32_16x16x32_bf16 v[32:35], a[12:15], v[88:91], v[32:35]
  v_mfma_f32_16x16x32_bf16 v[44:47], a[12:15], v[92:95], v[44:47]
  v_mfma_f32_16x16x32_bf16 v[36:39], a[92:95], v[88:91], v[36:39]
  v_mfma_f32_16x16x32_bf16 v[48:51], a[92:95], v[92:95], v[48:51]
  v_mfma_f32_16x16x32_bf16 v[40:43], a[172:175], v[88:91], v[40:43]
  v_mfma_f32_16x16x32_bf16 v[52:55], a[172:175], v[92:95], v[52:55]
  ds_read_b128 v[80:83], v26 offset:6144
  ds_read_b128 v[84:87], v26 offset:16384
  s_waitcnt lgkmcnt(4)
  v_mfma_f32_16x16x32_bf16 v[32:35], a[16:19], v[64:67], v[32:35]
  v_mfma_f32_16x16x32_bf16 v[44:47], a[16:19], v[68:71], v[44:47]
  v_mfma_f32_16x16x32_bf16 v[36:39], a[96:99], v[64:67], v[36:39]
  v_mfma_f32_16x16x32_bf16 v[48:51], a[96:99], v[68:71], v[48:51]
  v_mfma_f32_16x16x32_bf16 v[40:43], a[176:179], v[64:67], v[40:43]
  v_mfma_f32_16x16x32_bf16 v[52:55], a[176:179], v[68:71], v[52:55]
  s_waitcnt vmcnt(8)
  s_barrier
  ds_read_b128 v[88:91], v26 offset:7168
  ds_read_b128 v[92:95], v26 offset:17408
  s_waitcnt lgkmcnt(4)
  v_mfma_f32_16x16x32_bf16 v[32:35], a[20:23], v[72:75], v[32:35]
  v_mfma_f32_16x16x32_bf16 v[44:47], a[20:23], v[76:79], v[44:47]
  s_add_u32 s88, s94, s92
  s_mov_b32 m0, s88
  s_nop 0
  buffer_load_dwordx4 v28, s[8:11], s84 offen offset:0 lds
  v_mfma_f32_16x16x32_bf16 v[36:39], a[100:103], v[72:75], v[36:39]
  v_mfma_f32_16x16x32_bf16 v[48:51], a[100:103], v[76:79], v[48:51]
  v_mfma_f32_16x16x32_bf16 v[40:43], a[180:183], v[72:75], v[40:43]
  v_mfma_f32_16x16x32_bf16 v[52:55], a[180:183], v[76:79], v[52:55]
  ds_read_b128 v[64:67], v26 offset:8192
  ds_read_b128 v[68:71], v26 offset:18432
  s_waitcnt lgkmcnt(4)
  v_mfma_f32_16x16x32_bf16 v[32:35], a[24:27], v[80:83], v[32:35]
  v_mfma_f32_16x16x32_bf16 v[44:47], a[24:27], v[84:87], v[44:47]
  buffer_load_dwordx4 v28, s[8:11], s84 offen offset:1024 lds
  v_mfma_f32_16x16x32_bf16 v[36:39], a[104:107], v[80:83], v[36:39]
  v_mfma_f32_16x16x32_bf16 v[48:51], a[104:107], v[84:87], v[48:51]
  v_mfma_f32_16x16x32_bf16 v[40:43], a[184:187], v[80:83], v[40:43]
  v_mfma_f32_16x16x32_bf16 v[52:55], a[184:187], v[84:87], v[52:55]
  ds_read_b128 v[72:75], v26 offset:9216
  ds_read_b128 v[76:79], v26 offset:19456
  s_waitcnt lgkmcnt(4)
  v_mfma_f32_16x16x32_bf16 v[32:35], a[28:31], v[88:91], v[32:35]
  v_mfma_f32_16x16x32_bf16 v[44:47], a[28:31], v[92:95], v[44:47]
  buffer_load_dwordx4 v28, s[8:11], s84 offen offset:2048 lds
  v_mfma_f32_16x16x32_bf16 v[36:39], a[108:111], v[88:91], v[36:39]
  v_mfma_f32_16x16x32_bf16 v[48:51], a[108:111], v[92:95], v[48:51]
  v_mfma_f32_16x16x32_bf16 v[40:43], a[188:191], v[88:91], v[40:43]
  v_mfma_f32_16x16x32_bf16 v[52:55], a[188:191], v[92:95], v[52:55]
  ds_read_b128 v[80:83], v27 offset:0
  ds_read_b128 v[84:87], v27 offset:10240
  s_waitcnt lgkmcnt(4)
  v_mfma_f32_16x16x32_bf16 v[32:35], a[32:35], v[64:67], v[32:35]
  v_mfma_f32_16x16x32_bf16 v[44:47], a[32:35], v[68:71], v[44:47]
  buffer_load_dwordx4 v28, s[8:11], s84 offen offset:3072 lds
  v_mfma_f32_16x16x32_bf16 v[36:39], a[112:115], v[64:67], v[36:39]
  v_mfma_f32_16x16x32_bf16 v[48:51], a[112:115], v[68:71], v[48:51]
  v_mfma_f32_16x16x32_bf16 v[40:43], a[192:195], v[64:67], v[40:43]
  v_mfma_f32_16x16x32_bf16 v[52:55], a[192:195], v[68:71], v[52:55]
  ds_read_b128 v[88:91], v27 offset:1024
  ds_read_b128 v[92:95], v27 offset:11264
  s_waitcnt lgkmcnt(4)
  v_mfma_f32_16x16x32_bf16 v[32:35], a[36:39], v[72:75], v[32:35]
  v_mfma_f32_16x16x32_bf16 v[44:47], a[36:39], v[76:79], v[44:47]
  s_add_u32 m0, s88, 4096
  s_add_u32 s89, s84, 4096
  buffer_load_dwordx4 v28, s[8:11], s89 offen offset:0 lds
  v_mfma_f32_16x16x32_bf16 v[36:39], a[116:119], v[72:75], v[36:39]
  v_mfma_f32_16x16x32_bf16 v[48:51], a[116:119], v[76:79], v[48:51]
  v_mfma_f32_16x16x32_bf16 v[40:43], a[196:199], v[72:75], v[40:43]
  v_mfma_f32_16x16x32_bf16 v[52:55], a[196:199], v[76:79], v[52:55]
  s_add_u32 s84, s84, s93
  s_mov_b32 s5, s85
  s_mov_b32 s85, s86
  s_mov_b32 s86, s87
  s_mov_b32 s87, s94
  s_mov_b32 s94, s5
  v_mov_b32 v26, v27
  v_add_u32 v27, s86, v28
  ds_read_b128 v[64:67], v26 offset:2048
  ds_read_b128 v[68:71], v26 offset:12288
  s_waitcnt lgkmcnt(4)
  v_mfma_f32_16x16x32_bf16 v[32:35], a[40:43], v[80:83], v[32:35]
  v_mfma_f32_16x16x32_bf16 v[44:47], a[40:43], v[84:87], v[44:47]
  v_mfma_f32_16x16x32_bf16 v[36:39], a[120:123], v[80:83], v[36:39]
  v_mfma_f32_16x16x32_bf16 v[48:51], a[120:123], v[84:87], v[48:51]
  v_mfma_f32_16x16x32_bf16 v[40:43], a[200:203], v[80:83], v[40:43]
  v_mfma_f32_16x16x32_bf16 v[52:55], a[200:203], v[84:87], v[52:55]
  ds_read_b128 v[72:75], v26 offset:3072
  ds_read_b128 v[76:79], v26 offset:13312
  s_waitcnt lgkmcnt(4)
  v_mfma_f32_16x16x32_bf16 v[32:35], a[44:47], v[88:91], v[32:35]
  v_mfma_f32_16x16x32_bf16 v[44:47], a[44:47], v[92:95], v[44:47]
  v_mfma_f32_16x16x32_bf16 v[36:39], a[124:127], v[88:91], v[36:39]
  v_mfma_f32_16x16x32_bf16 v[48:51], a[124:127], v[92:95], v[48:51]
  v_mfma_f32_16x16x32_bf16 v[40:43], a[204:207], v[88:91], v[40:43]
  v_mfma_f32_16x16x32_bf16 v[52:55], a[204:207], v[92:95], v[52:55]
  ds_read_b128 v[80:83], v26 offset:4096
  ds_read_b128 v[84:87], v26 offset:14336
  s_waitcnt lgkmcnt(4)
  v_mfma_f32_16x16x32_bf16 v[32:35], a[48:51], v[64:67], v[32:35]
  v_mfma_f32_16x16x32_bf16 v[44:47], a[48:51], v[68:71], v[44:47]
  v_mfma_f32_16x16x32_bf16 v[36:39], a[128:131], v[64:67], v[36:39]
  v_mfma_f32_16x16x32_bf16 v[48:51], a[128:131], v[68:71], v[48:51]
  v_mfma_f32_16x16x32_bf16 v[40:43], a[208:211], v[64:67], v[40:43]
  v_mfma_f32_16x16x32_bf16 v[52:55], a[208:211], v[68:71], v[52:55]
  ds_read_b128 v[88:91], v26 offset:5120
  ds_read_b128 v[92:95], v26 offset:15360
  s_waitcnt lgkmcnt(4)
  v_mfma_f32_16x16x32_bf16 v[32:35], a[52:55], v[72:75], v[32:35]
  v_mfma_f32_16x16x32_bf16 v[44:47], a[52:55], v[76:79], v[44:47]
  v_mfma_f32_16x16x32_bf16 v[36:39], a[132:135], v[72:75], v[36:39]
  v_mfma_f32_16x16x32_bf16 v[48:51], a[132:135], v[76:79], v[48:51]
  v_mfma_f32_16x16x32_bf16 v[40:43], a[212:215], v[72:75], v[40:43]
  v_mfma_f32_16x16x32_bf16 v[52:55], a[212:215], v[76:79], v[52:55]
  ds_read_b128 v[64:67], v26 offset:6144
  ds_read_b128 v[68:71], v26 offset:16384
  s_waitcnt lgkmcnt(4)
  v_mfma_f32_16x16x32_bf16 v[32:35], a[56:59], v[80:83], v[32:35]
  v_mfma_f32_16x16x32_bf16 v[44:47], a[56:59], v[84:87], v[44:47]
  v_mfma_f32_16x16x32_bf16 v[36:39], a[136:139], v[80:83], v[36:39]
  v_mfma_f32_16x16x32_bf16 v[48:51], a[136:139], v[84:87], v[48:51]
  v_mfma_f32_16x16x32_bf16 v[40:43], a[216:219], v[80:83], v[40:43]
  v_mfma_f32_16x16x32_bf16 v[52:55], a[216:219], v[84:87], v[52:55]
  s_waitcnt vmcnt(5)
  s_barrier
  s_cmp_eq_u32 s90, 0
  s_cbranch_scc1 L_nf_6
  s_cmp_lg_u32 s3, 0
  s_cbranch_scc1 L_fl_7
  v_mov_b32 v30, s90
  s_mov_b64 exec, 1
  buffer_store_dword v30, off, s[8:11], s82 sc1
  s_mov_b64 exec, -1
L_fl_7:
L_nf_6:
  ds_read_b128 v[72:75], v26 offset:7168
  ds_read_b128 v[76:79], v26 offset:17408
  s_waitcnt lgkmcnt(4)
  v_mfma_f32_16x16x32_bf16 v[32:35], a[60:63], v[88:91], v[32:35]
  v_mfma_f32_16x16x32_bf16 v[44:47], a[60:63], v[92:95], v[44:47]
  s_add_u32 s88, s94, s92
  s_mov_b32 m0, s88
  s_nop 0
  buffer_load_dwordx4 v28, s[8:11], s84 offen offset:0 lds
  v_mfma_f32_16x16x32_bf16 v[36:39], a[140:143], v[88:91], v[36:39]
  v_mfma_f32_16x16x32_bf16 v[48:51], a[140:143], v[92:95], v[48:51]
  v_mfma_f32_16x16x32_bf16 v[40:43], a[220:223], v[88:91], v[40:43]
  v_mfma_f32_16x16x32_bf16 v[52:55], a[220:223], v[92:95], v[52:55]
  ds_read_b128 v[80:83], v26 offset:8192
  ds_read_b128 v[84:87], v26 offset:18432
  s_waitcnt lgkmcnt(4)
  v_mfma_f32_16x16x32_bf16 v[32:35], a[64:67], v[64:67], v[32:35]
  v_mfma_f32_16x16x32_bf16 v[44:47], a[64:67], v[68:71], v[44:47]
  buffer_load_dwordx4 v28, s[8:11], s84 offen offset:1024 lds
  v_mfma_f32_16x16x32_bf16 v[36:39], a[144:147], v[64:67], v[36:39]
  v_mfma_f32_16x16x32_bf16 v[48:51], a[144:147], v[68:71], v[48:51]
  v_mfma_f32_16x16x32_bf16 v[40:43], a[224:227], v[64:67], v[40:43]
  v_mfma_f32_16x16x32_bf16 v[52:55], a[224:227], v[68:71], v[52:55]
  ds_read_b128 v[88:91], v26 offset:9216
  ds_read_b128 v[92:95], v26 offset:19456
  s_waitcnt lgkmcnt(4)
  v_mfma_f32_16x16x32_bf16 v[32:35], a[68:71], v[72:75], v[32:35]
  v_mfma_f32_16x16x32_bf16 v[44:47], a[68:71], v[76:79], v[44:47]
  buffer_load_dwordx4 v28, s[8:11], s84 offen offset:2048 lds
  v_mfma_f32_16x16x32_bf16 v[36:39], a[148:151], v[72:75], v[36:39]
  v_mfma_f32_16x16x32_bf16 v[48:51], a[148:151], v[76:79], v[48:51]
  v_mfma_f32_16x16x32_bf16 v[40:43], a[228:231], v[72:75], v[40:43]
  v_mfma_f32_16x16x32_bf16 v[52:55], a[228:231], v[76:79], v[52:55]
  ds_read_b128 v[64:67], v27 offset:0
  ds_read_b128 v[68:71], v27 offset:10240
  s_waitcnt lgkmcnt(4)
  v_mfma_f32_16x16x32_bf16 v[32:35], a[72:75], v[80:83], v[32:35]
  v_mfma_f32_16x16x32_bf16 v[44:47], a[72:75], v[84:87], v[44:47]
  buffer_load_dwordx4 v28, s[8:11], s84 offen offset:3072 lds
  v_mfma_f32_16x16x32_bf16 v[36:39], a[152:155], v[80:83], v[36:39]
  v_mfma_f32_16x16x32_bf16 v[48:51], a[152:155], v[84:87], v[48:51]
  v_mfma_f32_16x16x32_bf16 v[40:43], a[232:235], v[80:83], v[40:43]
  v_mfma_f32_16x16x32_bf16 v[52:55], a[232:235], v[84:87], v[52:55]
  ds_read_b128 v[72:75], v27 offset:1024
  ds_read_b128 v[76:79], v27 offset:11264
  s_waitcnt lgkmcnt(4)
  v_mfma_f32_16x16x32_bf16 v[32:35], a[76:79], v[88:91], v[32:35]
  v_mfma_f32_16x16x32_bf16 v[44:47], a[76:79], v[92:95], v[44:47]
  s_add_u32 m0, s88, 4096
  s_add_u32 s89, s84, 4096
  buffer_load_dwordx4 v28, s[8:11], s89 offen offset:0 lds
  v_mfma_f32_16x16x32_bf16 v[36:39], a[156:159], v[88:91], v[36:39]
  v_mfma_f32_16x16x32_bf16 v[48:51], a[156:159], v[92:95], v[48:51]
  v_mfma_f32_16x16x32_bf16 v[40:43], a[236:239], v[88:91], v[40:43]
  v_mfma_f32_16x16x32_bf16 v[52:55], a[236:239], v[92:95], v[52:55]
  s_add_u32 s84, s84, 10240
  s_mov_b32 s5, s85
  s_mov_b32 s85, s86
  s_mov_b32 s86, s87
  s_mov_b32 s87, s94
  s_mov_b32 s94, s5
  v_mov_b32 v26, v27
  v_add_u32 v27, s86, v28
  v_permlane16_swap_b32 v32, v44
  v_permlane16_swap_b32 v33, v45
  v_permlane16_swap_b32 v34, v46
  v_permlane16_swap_b32 v35, v47
  v_mul_f32 v32, 0xbfb8aa3b, v32
  v_mul_f32 v33, 0xbfb8aa3b, v33
  v_mul_f32 v34, 0xbfb8aa3b, v34
  v_mul_f32 v35, 0xbfb8aa3b, v35
  v_exp_f32 v32, v32
  v_exp_f32 v33, v33
  v_exp_f32 v34, v34
  v_exp_f32 v35, v35
  v_add_f32 v32, 1.0, v32
  v_add_f32 v33, 1.0, v33
  v_add_f32 v34, 1.0, v34
  v_add_f32 v35, 1.0, v35
  v_rcp_f32 v32, v32
  v_rcp_f32 v33, v33
  v_rcp_f32 v34, v34
  v_rcp_f32 v35, v35
  v_mul_f32 v32, v32, v44
  v_mul_f32 v33, v33, v45
  v_mul_f32 v34, v34, v46
  v_mul_f32 v35, v35, v47
  v_cvt_pk_bf16_f32 v96, v32, v33
  v_cvt_pk_bf16_f32 v97, v34, v35
  buffer_store_dwordx2 v[96:97], v31, s[8:11], s81 offen offset:0 sc1
  v_permlane16_swap_b32 v36, v48
  v_permlane16_swap_b32 v37, v49
  v_permlane16_swap_b32 v38, v50
  v_permlane16_swap_b32 v39, v51
  v_mul_f32 v36, 0xbfb8aa3b, v36
  v_mul_f32 v37, 0xbfb8aa3b, v37
  v_mul_f32 v38, 0xbfb8aa3b, v38
  v_mul_f32 v39, 0xbfb8aa3b, v39
  v_exp_f32 v36, v36
  v_exp_f32 v37, v37
  v_exp_f32 v38, v38
  v_exp_f32 v39, v39
  v_add_f32 v36, 1.0, v36
  v_add_f32 v37, 1.0, v37
  v_add_f32 v38, 1.0, v38
  v_add_f32 v39, 1.0, v39
  v_rcp_f32 v36, v36
  v_rcp_f32 v37, v37
  v_rcp_f32 v38, v38
  v_rcp_f32 v39, v39
  v_mul_f32 v36, v36, v48
  v_mul_f32 v37, v37, v49
  v_mul_f32 v38, v38, v50
  v_mul_f32 v39, v39, v51
  v_cvt_pk_bf16_f32 v100, v36, v37
  v_cvt_pk_bf16_f32 v101, v38, v39
  buffer_store_dwordx2 v[100:101], v31, s[8:11], s81 offen offset:256 sc1
  v_permlane16_swap_b32 v40, v52
  v_permlane16_swap_b32 v41, v53
  v_permlane16_swap_b32 v42, v54
  v_permlane16_swap_b32 v43, v55
  v_mul_f32 v40, 0xbfb8aa3b, v40
  v_mul_f32 v41, 0xbfb8aa3b, v41
  v_mul_f32 v42, 0xbfb8aa3b, v42
  v_mul_f32 v43, 0xbfb8aa3b, v43
  v_exp_f32 v40, v40
  v_exp_f32 v41, v41
  v_exp_f32 v42, v42
  v_exp_f32 v43, v43
  v_add_f32 v40, 1.0, v40
  v_add_f32 v41, 1.0, v41
  v_add_f32 v42, 1.0, v42
  v_add_f32 v43, 1.0, v43
  v_rcp_f32 v40, v40
  v_rcp_f32 v41, v41
  v_rcp_f32 v42, v42
  v_rcp_f32 v43, v43
  v_mul_f32 v40, v40, v52
  v_mul_f32 v41, v41, v53
  v_mul_f32 v42, v42, v54
  v_mul_f32 v43, v43, v55
  v_cvt_pk_bf16_f32 v104, v40, v41
  v_cvt_pk_bf16_f32 v105, v42, v43
  buffer_store_dwordx2 v[104:105], v31, s[8:11], s81 offen offset:512 sc1
  s_add_u32 s81, s81, s83
  s_add_u32 s90, s90, 1
  s_cmp_lt_u32 s90, s80
  s_cbranch_scc1 L_w1_5
  s_waitcnt vmcnt(0) lgkmcnt(0)
  s_barrier
  s_cmp_lg_u32 s3, 0
  s_cbranch_scc1 L_fl_8
  v_mov_b32 v30, s90
  s_mov_b64 exec, 1
  buffer_store_dword v30, off, s[8:11], s82 sc1
  s_mov_b64 exec, -1
L_fl_8:
  s_branch L_w2g
L_wattn:
  s_sub_u32 s5, s60, 32
  s_lshr_b32 s61, s5, 2
  s_and_b32 s64, s5, 3
  s_mov_b32 s65, s61
  s_and_b32 s79, s64, 1
  s_mov_b32 s80, 32
  s_mov_b32 s91, 2
  s_cmp_ge_u32 s64, 2
  s_cbranch_scc1 L_wv
  s_mov_b32 s16, s38
  s_and_b32 s17, s39, 0xffff
  s_mov_b32 s18, 7864320
  s_mov_b32 s19, 0x20000
  s_mul_i32 s78, s61, 384
  s_mul_i32 s83, s91, 393216
  s_mul_i32 s81, s79, 393216
  s_mul_i32 s5, s61, 12288
  s_add_u32 s81, s81, s5
  s_mul_i32 s5, s3, 3072
  s_add_u32 s81, s81, s5
  s_add_u32 s81, s81, 23592960
  s_lshl_b32 s82, s61, 8
  s_lshl_b32 s5, s64, 2
  s_add_u32 s82, s82, s5
  s_add_u32 s82, s82, 2031616
  v_mbcnt_lo_u32_b32 v0, -1, 0
  v_mbcnt_hi_u32_b32 v0, -1, v0
  v_add_u32 v1, 0, v0
  v_mul_u32_u24 v2, 2731, v1
  v_lshrrev_b32 v2, 16, v2
  v_mul_u32_u24 v3, 24, v2
  v_sub_u32 v3, v1, v3
  v_mul_u32_u24 v2, 12288, v2
  v_lshl_add_u32 v4, v3, 4, v2
  v_add_u32 v1, 64, v0
  v_mul_u32_u24 v2, 2731, v1
  v_lshrrev_b32 v2, 16, v2
  v_mul_u32_u24 v3, 24, v2
  v_sub_u32 v3, v1, v3
  v_mul_u32_u24 v2, 12288, v2
  v_lshl_add_u32 v5, v3, 4, v2
  v_add_u32 v1, 128, v0
  v_mul_u32_u24 v2, 2731, v1
  v_lshrrev_b32 v2, 16, v2
  v_mul_u32_u24 v3, 24, v2
  v_sub_u32 v3, v1, v3
  v_mul_u32_u24 v2, 12288, v2
  v_lshl_add_u32 v6, v3, 4, v2
  v_lshrrev_b32 v1, 4, v0
  v_bfe_u32 v2, v0, 2, 2
  v_lshl_add_u32 v1, v1, 3, v2
  v_and_b32 v3, 3, v0
  v_mul_u32_u24 v1, 384, v1
  v_lshl_add_u32 v1, v3, 3, v1
  s_mul_i32 s5, s3, 96
  v_add_u32 v1, s5, v1
  v_add_u32 v2, 49152, v1
  v_add_u32 v3, 98304, v1
  s_lshl_b32 s5, s3, 2
  s_add_u32 s5, s5, 0
  s_mul_i32 s6, s5, 3072
  s_add_u32 s6, s6, 0
  s_mul_i32 s5, s5, 98304
  s_add_u32 s5, s5, s78
  s_add_u32 s5, s5, 0
  s_add_u32 m0, s6, 0
  s_nop 0
  buffer_load_dwordx4 v4, s[16:19], s5 offen lds
  s_add_u32 m0, s6, 1024
  s_nop 0
  buffer_load_dwordx4 v5, s[16:19], s5 offen lds
  s_add_u32 m0, s6, 2048
  s_nop 0
  buffer_load_dwordx4 v6, s[16:19], s5 offen lds
  s_lshl_b32 s5, s3, 2
  s_add_u32 s5, s5, 1
  s_mul_i32 s6, s5, 3072
  s_add_u32 s6, s6, 0
  s_mul_i32 s5, s5, 98304
  s_add_u32 s5, s5, s78
  s_add_u32 s5, s5, 0
  s_add_u32 m0, s6, 0
  s_nop 0
  buffer_load_dwordx4 v4, s[16:19], s5 offen lds
  s_add_u32 m0, s6, 1024
  s_nop 0
  buffer_load_dwordx4 v5, s[16:19], s5 offen lds
  s_add_u32 m0, s6, 2048
  s_nop 0
  buffer_load_dwordx4 v6, s[16:19], s5 offen lds
  s_lshl_b32 s5, s3, 2
  s_add_u32 s5, s5, 2
  s_mul_i32 s6, s5, 3072
  s_add_u32 s6, s6, 0
  s_mul_i32 s5, s5, 98304
  s_add_u32 s5, s5, s78
  s_add_u32 s5, s5, 0
  s_add_u32 m0, s6, 0
  s_nop 0
  buffer_load_dwordx4 v4, s[16:19], s5 offen lds
  s_add_u32 m0, s6, 1024
  s_nop 0
  buffer_load_dwordx4 v5, s[16:19], s5 offen lds
  s_add_u32 m0, s6, 2048
  s_nop 0
  buffer_load_dwordx4 v6, s[16:19], s5 offen lds
  s_lshl_b32 s5, s3, 2
  s_add_u32 s5, s5, 3
  s_mul_i32 s6, s5, 3072
  s_add_u32 s6, s6, 0
  s_mul_i32 s5, s5, 98304
  s_add_u32 s5, s5, s78
  s_add_u32 s5, s5, 0
  s_add_u32 m0, s6, 0
  s_nop 0
  buffer_load_dwordx4 v4, s[16:19], s5 offen lds
  s_add_u32 m0, s6, 1024
  s_nop 0
  buffer_load_dwordx4 v5, s[16:19], s5 offen lds
  s_add_u32 m0, s6, 2048
  s_nop 0
  buffer_load_dwordx4 v6, s[16:19], s5 offen lds
  s_lshl_b32 s5, s3, 2
  s_add_u32 s5, s5, 0
  s_mul_i32 s6, s5, 3072
  s_add_u32 s6, s6, 49152
  s_mul_i32 s5, s5, 98304
  s_add_u32 s5, s5, s78
  s_add_u32 s5, s5, 1572864
  s_add_u32 m0, s6, 0
  s_nop 0
  buffer_load_dwordx4 v4, s[16:19], s5 offen lds
  s_add_u32 m0, s6, 1024
  s_nop 0
  buffer_load_dwordx4 v5, s[16:19], s5 offen lds
  s_add_u32 m0, s6, 2048
  s_nop 0
  buffer_load_dwordx4 v6, s[16:19], s5 offen lds
  s_lshl_b32 s5, s3, 2
  s_add_u32 s5, s5, 1
  s_mul_i32 s6, s5, 3072
  s_add_u32 s6, s6, 49152
  s_mul_i32 s5, s5, 98304
  s_add_u32 s5, s5, s78
  s_add_u32 s5, s5, 1572864
  s_add_u32 m0, s6, 0
  s_nop 0
  buffer_load_dwordx4 v4, s[16:19], s5 offen lds
  s_add_u32 m0, s6, 1024
  s_nop 0
  buffer_load_dwordx4 v5, s[16:19], s5 offen lds
  s_add_u32 m0, s6, 2048
  s_nop 0
  buffer_load_dwordx4 v6, s[16:19], s5 offen lds
  s_lshl_b32 s5, s3, 2
  s_add_u32 s5, s5, 2
  s_mul_i32 s6, s5, 3072
  s_add_u32 s6, s6, 49152
  s_mul_i32 s5, s5, 98304
  s_add_u32 s5, s5, s78
  s_add_u32 s5, s5, 1572864
  s_add_u32 m0, s6, 0
  s_nop 0
  buffer_load_dwordx4 v4, s[16:19], s5 offen lds
  s_add_u32 m0, s6, 1024
  s_nop 0
  buffer_load_dwordx4 v5, s[16:19], s5 offen lds
  s_add_u32 m0, s6, 2048
  s_nop 0
  buffer_load_dwordx4 v6, s[16:19], s5 offen lds
  s_lshl_b32 s5, s3, 2
  s_add_u32 s5, s5, 3
  s_mul_i32 s6, s5, 3072
  s_add_u32 s6, s6, 49152
  s_mul_i32 s5, s5, 98304
  s_add_u32 s5, s5, s78
  s_add_u32 s5, s5, 1572864
  s_add_u32 m0, s6, 0
  s_nop 0
  buffer_load_dwordx4 v4, s[16:19], s5 offen lds
  s_add_u32 m0, s6, 1024
  s_nop 0
  buffer_load_dwordx4 v5, s[16:19], s5 offen lds
  s_add_u32 m0, s6, 2048
  s_nop 0
  buffer_load_dwordx4 v6, s[16:19], s5 offen lds
  s_lshl_b32 s5, s3, 2
  s_add_u32 s5, s5, 0
  s_mul_i32 s6, s5, 3072
  s_add_u32 s6, s6, 98304
  s_mul_i32 s5, s5, 98304
  s_add_u32 s5, s5, s78
  s_add_u32 s5, s5, 3145728
  s_add_u32 m0, s6, 0
  s_nop 0
  buffer_load_dwordx4 v4, s[16:19], s5 offen lds
  s_add_u32 m0, s6, 1024
  s_nop 0
  buffer_load_dwordx4 v5, s[16:19], s5 offen lds
  s_add_u32 m0, s6, 2048
  s_nop 0
  buffer_load_dwordx4 v6, s[16:19], s5 offen lds
  s_lshl_b32 s5, s3, 2
  s_add_u32 s5, s5, 1
  s_mul_i32 s6, s5, 3072
  s_add_u32 s6, s6, 98304
  s_mul_i32 s5, s5, 98304
  s_add_u32 s5, s5, s78
  s_add_u32 s5, s5, 3145728
  s_add_u32 m0, s6, 0
  s_nop 0
  buffer_load_dwordx4 v4, s[16:19], s5 offen lds
  s_add_u32 m0, s6, 1024
  s_nop 0
  buffer_load_dwordx4 v5, s[16:19], s5 offen lds
  s_add_u32 m0, s6, 2048
  s_nop 0
  buffer_load_dwordx4 v6, s[16:19], s5 offen lds
  s_lshl_b32 s5, s3, 2
  s_add_u32 s5, s5, 2
  s_mul_i32 s6, s5, 3072
  s_add_u32 s6, s6, 98304
  s_mul_i32 s5, s5, 98304
  s_add_u32 s5, s5, s78
  s_add_u32 s5, s5, 3145728
  s_add_u32 m0, s6, 0
  s_nop 0
  buffer_load_dwordx4 v4, s[16:19], s5 offen lds
  s_add_u32 m0, s6, 1024
  s_nop 0
  buffer_load_dwordx4 v5, s[16:19], s5 offen lds
  s_add_u32 m0, s6, 2048
  s_nop 0
  buffer_load_dwordx4 v6, s[16:19], s5 offen lds
  s_lshl_b32 s5, s3, 2
  s_add_u32 s5, s5, 3
  s_mul_i32 s6, s5, 3072
  s_add_u32 s6, s6, 98304
  s_mul_i32 s5, s5, 98304
  s_add_u32 s5, s5, s78
  s_add_u32 s5, s5, 3145728
  s_add_u32 m0, s6, 0
  s_nop 0
  buffer_load_dwordx4 v4, s[16:19], s5 offen lds
  s_add_u32 m0, s6, 1024
  s_nop 0
  buffer_load_dwordx4 v5, s[16:19], s5 offen lds
  s_add_u32 m0, s6, 2048
  s_nop 0
  buffer_load_dwordx4 v6, s[16:19], s5 offen lds
  s_waitcnt vmcnt(24)
  s_barrier
  s_cmp_lg_u32 s3, 0
  s_cbranch_scc1 L_arr_9
  v_mov_b32 v60, 1
  s_mov_b64 exec, 1
  buffer_atomic_add v60, off, s[28:31], s58 offset:128
  s_mov_b64 exec, -1
L_arr_9:
  ds_read_b64_tr_b16 a[0:1], v1 offset:0
  ds_read_b64_tr_b16 a[2:3], v1 offset:1536
  ds_read_b64_tr_b16 a[4:5], v1 offset:12288
  ds_read_b64_tr_b16 a[6:7], v1 offset:13824
  ds_read_b64_tr_b16 a[8:9], v1 offset:24576
  ds_read_b64_tr_b16 a[10:11], v1 offset:26112
  ds_read_b64_tr_b16 a[12:13], v1 offset:36864
  ds_read_b64_tr_b16 a[14:15], v1 offset:38400
  ds_read_b64_tr_b16 a[80:81], v1 offset:32
  ds_read_b64_tr_b16 a[82:83], v1 offset:1568
  ds_read_b64_tr_b16 a[84:85], v1 offset:12320
  ds_read_b64_tr_b16 a[86:87], v1 offset:13856
  s_waitcnt lgkmcnt(4)
  ds_read_b64_tr_b16 a[88:89], v1 offset:24608
  ds_read_b64_tr_b16 a[90:91], v1 offset:26144
  ds_read_b64_tr_b16 a[92:93], v1 offset:36896
  ds_read_b64_tr_b16 a[94:95], v1 offset:38432
  ds_read_b64_tr_b16 a[160:161], v1 offset:64
  ds_read_b64_tr_b16 a[162:163], v1 offset:1600
  ds_read_b64_tr_b16 a[164:165], v1 offset:12352
  ds_read_b64_tr_b16 a[166:167], v1 offset:13888
  ds_read_b64_tr_b16 a[168:169], v1 offset:24640
  ds_read_b64_tr_b16 a[170:171], v1 offset:26176
  ds_read_b64_tr_b16 a[172:173], v1 offset:36928
  ds_read_b64_tr_b16 a[174:175], v1 offset:38464
  s_waitcnt lgkmcnt(0)
  s_barrier
  s_lshl_b32 s5, s3, 2
  s_add_u32 s5, s5, 0
  s_mul_i32 s6, s5, 3072
  s_add_u32 s6, s6, 0
  s_mul_i32 s5, s5, 98304
  s_add_u32 s5, s5, s78
  s_add_u32 s5, s5, 4718592
  s_add_u32 m0, s6, 0
  s_nop 0
  buffer_load_dwordx4 v4, s[16:19], s5 offen lds
  s_add_u32 m0, s6, 1024
  s_nop 0
  buffer_load_dwordx4 v5, s[16:19], s5 offen lds
  s_add_u32 m0, s6, 2048
  s_nop 0
  buffer_load_dwordx4 v6, s[16:19], s5 offen lds
  s_lshl_b32 s5, s3, 2
  s_add_u32 s5, s5, 1
  s_mul_i32 s6, s5, 3072
  s_add_u32 s6, s6, 0
  s_mul_i32 s5, s5, 98304
  s_add_u32 s5, s5, s78
  s_add_u32 s5, s5, 4718592
  s_add_u32 m0, s6, 0
  s_nop 0
  buffer_load_dwordx4 v4, s[16:19], s5 offen lds
  s_add_u32 m0, s6, 1024
  s_nop 0
  buffer_load_dwordx4 v5, s[16:19], s5 offen lds
  s_add_u32 m0, s6, 2048
  s_nop 0
  buffer_load_dwordx4 v6, s[16:19], s5 offen lds
  s_lshl_b32 s5, s3, 2
  s_add_u32 s5, s5, 2
  s_mul_i32 s6, s5, 3072
  s_add_u32 s6, s6, 0
  s_mul_i32 s5, s5, 98304
  s_add_u32 s5, s5, s78
  s_add_u32 s5, s5, 4718592
  s_add_u32 m0, s6, 0
  s_nop 0
  buffer_load_dwordx4 v4, s[16:19], s5 offen lds
  s_add_u32 m0, s6, 1024
  s_nop 0
  buffer_load_dwordx4 v5, s[16:19], s5 offen lds
  s_add_u32 m0, s6, 2048
  s_nop 0
  buffer_load_dwordx4 v6, s[16:19], s5 offen lds
  s_lshl_b32 s5, s3, 2
  s_add_u32 s5, s5, 3
  s_mul_i32 s6, s5, 3072
  s_add_u32 s6, s6, 0
  s_mul_i32 s5, s5, 98304
  s_add_u32 s5, s5, s78
  s_add_u32 s5, s5, 4718592
  s_add_u32 m0, s6, 0
  s_nop 0
  buffer_load_dwordx4 v4, s[16:19], s5 offen lds
  s_add_u32 m0, s6, 1024
  s_nop 0
  buffer_load_dwordx4 v5, s[16:19], s5 offen lds
  s_add_u32 m0, s6, 2048
  s_nop 0
  buffer_load_dwordx4 v6, s[16:19], s5 offen lds
  s_waitcnt vmcnt(24)
  s_barrier
  ds_read_b64_tr_b16 a[16:17], v2 offset:0
  ds_read_b64_tr_b16 a[18:19], v2 offset:1536
  ds_read_b64_tr_b16 a[20:21], v2 offset:12288
  ds_read_b64_tr_b16 a[22:23], v2 offset:13824
  ds_read_b64_tr_b16 a[24:25], v2 offset:24576
  ds_read_b64_tr_b16 a[26:27], v2 offset:26112
  ds_read_b64_tr_b16 a[28:29], v2 offset:36864
  ds_read_b64_tr_b16 a[30:31], v2 offset:38400
  ds_read_b64_tr_b16 a[96:97], v2 offset:32
  ds_read_b64_tr_b16 a[98:99], v2 offset:1568
  ds_read_b64_tr_b16 a[100:101], v2 offset:12320
  ds_read_b64_tr_b16 a[102:103], v2 offset:13856
  s_waitcnt lgkmcnt(4)
  ds_read_b64_tr_b16 a[104:105], v2 offset:24608
  ds_read_b64_tr_b16 a[106:107], v2 offset:26144
  ds_read_b64_tr_b16 a[108:109], v2 offset:36896
  ds_read_b64_tr_b16 a[110:111], v2 offset:38432
  ds_read_b64_tr_b16 a[176:177], v2 offset:64
  ds_read_b64_tr_b16 a[178:179], v2 offset:1600
  ds_read_b64_tr_b16 a[180:181], v2 offset:12352
  ds_read_b64_tr_b16 a[182:183], v2 offset:13888
  ds_read_b64_tr_b16 a[184:185], v2 offset:24640
  ds_read_b64_tr_b16 a[186:187], v2 offset:26176
  ds_read_b64_tr_b16 a[188:189], v2 offset:36928
  ds_read_b64_tr_b16 a[190:191], v2 offset:38464
  s_waitcnt lgkmcnt(0)
  s_barrier
  s_lshl_b32 s5, s3, 2
  s_add_u32 s5, s5, 0
  s_mul_i32 s6, s5, 3072
  s_add_u32 s6, s6, 49152
  s_mul_i32 s5, s5, 98304
  s_add_u32 s5, s5, s78
  s_add_u32 s5, s5, 6291456
  s_add_u32 m0, s6, 0
  s_nop 0
  buffer_load_dwordx4 v4, s[16:19], s5 offen lds
  s_add_u32 m0, s6, 1024
  s_nop 0
  buffer_load_dwordx4 v5, s[16:19], s5 offen lds
  s_add_u32 m0, s6, 2048
  s_nop 0
  buffer_load_dwordx4 v6, s[16:19], s5 offen lds
  s_lshl_b32 s5, s3, 2
  s_add_u32 s5, s5, 1
  s_mul_i32 s6, s5, 3072
  s_add_u32 s6, s6, 49152
  s_mul_i32 s5, s5, 98304
  s_add_u32 s5, s5, s78
  s_add_u32 s5, s5, 6291456
  s_add_u32 m0, s6, 0
  s_nop 0
  buffer_load_dwordx4 v4, s[16:19], s5 offen lds
  s_add_u32 m0, s6, 1024
  s_nop 0
  buffer_load_dwordx4 v5, s[16:19], s5 offen lds
  s_add_u32 m0, s6, 2048
  s_nop 0
  buffer_load_dwordx4 v6, s[16:19], s5 offen lds
  s_lshl_b32 s5, s3, 2
  s_add_u32 s5, s5, 2
  s_mul_i32 s6, s5, 3072
  s_add_u32 s6, s6, 49152
  s_mul_i32 s5, s5, 98304
  s_add_u32 s5, s5, s78
  s_add_u32 s5, s5, 6291456
  s_add_u32 m0, s6, 0
  s_nop 0
  buffer_load_dwordx4 v4, s[16:19], s5 offen lds
  s_add_u32 m0, s6, 1024
  s_nop 0
  buffer_load_dwordx4 v5, s[16:19], s5 offen lds
  s_add_u32 m0, s6, 2048
  s_nop 0
  buffer_load_dwordx4 v6, s[16:19], s5 offen lds
  s_lshl_b32 s5, s3, 2
  s_add_u32 s5, s5, 3
  s_mul_i32 s6, s5, 3072
  s_add_u32 s6, s6, 49152
  s_mul_i32 s5, s5, 98304
  s_add_u32 s5, s5, s78
  s_add_u32 s5, s5, 6291456
  s_add_u32 m0, s6, 0
  s_nop 0
  buffer_load_dwordx4 v4, s[16:19], s5 offen lds
  s_add_u32 m0, s6, 1024
  s_nop 0
  buffer_load_dwordx4 v5, s[16:19], s5 offen lds
  s_add_u32 m0, s6, 2048
  s_nop 0
  buffer_load_dwordx4 v6, s[16:19], s5 offen lds
  s_waitcnt vmcnt(24)
  s_barrier
  ds_read_b64_tr_b16 a[32:33], v3 offset:0
  ds_read_b64_tr_b16 a[34:35], v3 offset:1536
  ds_read_b64_tr_b16 a[36:37], v3 offset:12288
  ds_read_b64_tr_b16 a[38:39], v3 offset:13824
  ds_read_b64_tr_b16 a[40:41], v3 offset:24576
  ds_read_b64_tr_b16 a[42:43], v3 offset:26112
  ds_read_b64_tr_b16 a[44:45], v3 offset:36864
  ds_read_b64_tr_b16 a[46:47], v3 offset:38400
  ds_read_b64_tr_b16 a[112:113], v3 offset:32
  ds_read_b64_tr_b16 a[114:115], v3 offset:1568
  ds_read_b64_tr_b16 a[116:117], v3 offset:12320
  ds_read_b64_tr_b16 a[118:119], v3 offset:13856
  s_waitcnt lgkmcnt(4)
  ds_read_b64_tr_b16 a[120:121], v3 offset:24608
  ds_read_b64_tr_b16 a[122:123], v3 offset:26144
  ds_read_b64_tr_b16 a[124:125], v3 offset:36896
  ds_read_b64_tr_b16 a[126:127], v3 offset:38432
  ds_read_b64_tr_b16 a[192:193], v3 offset:64
  ds_read_b64_tr_b16 a[194:195], v3 offset:1600
  ds_read_b64_tr_b16 a[196:197], v3 offset:12352
  ds_read_b64_tr_b16 a[198:199], v3 offset:13888
  ds_read_b64_tr_b16 a[200:201], v3 offset:24640
  ds_read_b64_tr_b16 a[202:203], v3 offset:26176
  ds_read_b64_tr_b16 a[204:205], v3 offset:36928
  ds_read_b64_tr_b16 a[206:207], v3 offset:38464
  s_waitcnt vmcnt(12)
  s_barrier
  ds_read_b64_tr_b16 a[48:49], v1 offset:0
  ds_read_b64_tr_b16 a[50:51], v1 offset:1536
  ds_read_b64_tr_b16 a[52:53], v1 offset:12288
  ds_read_b64_tr_b16 a[54:55], v1 offset:13824
  ds_read_b64_tr_b16 a[56:57], v1 offset:24576
  ds_read_b64_tr_b16 a[58:59], v1 offset:26112
  ds_read_b64_tr_b16 a[60:61], v1 offset:36864
  ds_read_b64_tr_b16 a[62:63], v1 offset:38400
  ds_read_b64_tr_b16 a[128:129], v1 offset:32
  ds_read_b64_tr_b16 a[130:131], v1 offset:1568
  ds_read_b64_tr_b16 a[132:133], v1 offset:12320
  ds_read_b64_tr_b16 a[134:135], v1 offset:13856
  s_waitcnt lgkmcnt(4)
  ds_read_b64_tr_b16 a[136:137], v1 offset:24608
  ds_read_b64_tr_b16 a[138:139], v1 offset:26144
  ds_read_b64_tr_b16 a[140:141], v1 offset:36896
  ds_read_b64_tr_b16 a[142:143], v1 offset:38432
  ds_read_b64_tr_b16 a[208:209], v1 offset:64
  ds_read_b64_tr_b16 a[210:211], v1 offset:1600
  ds_read_b64_tr_b16 a[212:213], v1 offset:12352
  ds_read_b64_tr_b16 a[214:215], v1 offset:13888
  ds_read_b64_tr_b16 a[216:217], v1 offset:24640
  ds_read_b64_tr_b16 a[218:219], v1 offset:26176
  ds_read_b64_tr_b16 a[220:221], v1 offset:36928
  ds_read_b64_tr_b16 a[222:223], v1 offset:38464
  s_waitcnt vmcnt(0)
  s_barrier
  ds_read_b64_tr_b16 a[64:65], v2 offset:0
  ds_read_b64_tr_b16 a[66:67], v2 offset:1536
  ds_read_b64_tr_b16 a[68:69], v2 offset:12288
  ds_read_b64_tr_b16 a[70:71], v2 offset:13824
  ds_read_b64_tr_b16 a[72:73], v2 offset:24576
  ds_read_b64_tr_b16 a[74:75], v2 offset:26112
  ds_read_b64_tr_b16 a[76:77], v2 offset:36864
  ds_read_b64_tr_b16 a[78:79], v2 offset:38400
  ds_read_b64_tr_b16 a[144:145], v2 offset:32
  ds_read_b64_tr_b16 a[146:147], v2 offset:1568
  ds_read_b64_tr_b16 a[148:149], v2 offset:12320
  ds_read_b64_tr_b16 a[150:151], v2 offset:13856
  s_waitcnt lgkmcnt(4)
  ds_read_b64_tr_b16 a[152:153], v2 offset:24608
  ds_read_b64_tr_b16 a[154:155], v2 offset:26144
  ds_read_b64_tr_b16 a[156:157], v2 offset:36896
  ds_read_b64_tr_b16 a[158:159], v2 offset:38432
  ds_read_b64_tr_b16 a[224:225], v2 offset:64
  ds_read_b64_tr_b16 a[226:227], v2 offset:1600
  ds_read_b64_tr_b16 a[228:229], v2 offset:12352
  ds_read_b64_tr_b16 a[230:231], v2 offset:13888
  ds_read_b64_tr_b16 a[232:233], v2 offset:24640
  ds_read_b64_tr_b16 a[234:235], v2 offset:26176
  ds_read_b64_tr_b16 a[236:237], v2 offset:36928
  ds_read_b64_tr_b16 a[238:239], v2 offset:38464
  s_waitcnt lgkmcnt(0)
  s_barrier
  v_mbcnt_lo_u32_b32 v0, -1, 0
  v_mbcnt_hi_u32_b32 v0, -1, v0
  v_lshlrev_b32 v28, 4, v0
  s_cmp_lg_u32 s3, 0
  s_cbranch_scc1 L_poll2d_11
  v_mbcnt_lo_u32_b32 v29, -1, 0
  v_mbcnt_hi_u32_b32 v29, -1, v29
  v_and_b32 v29, 7, v29
  v_lshlrev_b32 v29, 4, v29
L_poll2_10:
  s_sub_u32 s59, s59, 1
  s_cbranch_scc1 L_end
  buffer_load_dword v30, v29, s[28:31], 0 offen offset:128 sc1
  s_waitcnt vmcnt(0)
  v_add_u32_dpp v30, v30, v30 row_ror:1 row_mask:0xf bank_mask:0xf
  s_nop 1
  v_add_u32_dpp v30, v30, v30 row_ror:2 row_mask:0xf bank_mask:0xf
  s_nop 1
  v_add_u32_dpp v30, v30, v30 row_ror:4 row_mask:0xf bank_mask:0xf
  s_nop 0
  v_readfirstlane_b32 s5, v30
  s_cmp_lt_u32 s5, 256
  s_cbranch_scc1 L_poll2_10
L_poll2d_11:
  s_barrier
  s_lshl_b32 s84, s79, 1
  s_lshr_b32 s5, s3, 1
  s_add_u32 s84, s84, s5
  s_mul_i32 s84, s84, 20480
  s_and_b32 s5, s3, 1
  s_mul_i32 s5, s5, 5120
  s_add_u32 s84, s84, s5
  s_add_u32 s84, s84, 2097152
  s_mul_i32 s93, s91, 40960
  s_sub_u32 s93, s93, 10240
  s_mul_i32 s92, s3, 5120
  s_mov_b32 s85, 0
  s_mov_b32 s86, 20480
  s_mov_b32 s87, 40960
  s_mov_b32 s94, 61440
  v_mov_b32 v31, v28
  s_add_u32 s88, s85, s92
  s_mov_b32 m0, s88
  s_nop 0
  buffer_load_dwordx4 v28, s[8:11], s84 offen offset:0 lds
  buffer_load_dwordx4 v28, s[8:11], s84 offen offset:1024 lds
  buffer_load_dwordx4 v28, s[8:11], s84 offen offset:2048 lds
  buffer_load_dwordx4 v28, s[8:11], s84 offen offset:3072 lds
  s_add_u32 m0, s88, 4096
  s_add_u32 s89, s84, 4096
  buffer_load_dwordx4 v28, s[8:11], s89 offen offset:0 lds
  s_add_u32 s84, s84, 10240
  s_add_u32 s88, s86, s92
  s_mov_b32 m0, s88
  s_nop 0
  buffer_load_dwordx4 v28, s[8:11], s84 offen offset:0 lds
  buffer_load_dwordx4 v28, s[8:11], s84 offen offset:1024 lds
  buffer_load_dwordx4 v28, s[8:11], s84 offen offset:2048 lds
  buffer_load_dwordx4 v28, s[8:11], s84 offen offset:3072 lds
  s_add_u32 m0, s88, 4096
  s_add_u32 s89, s84, 4096
  buffer_load_dwordx4 v28, s[8:11], s89 offen offset:0 lds
  s_add_u32 s84, s84, s93
  s_add_u32 s88, s87, s92
  s_mov_b32 m0, s88
  s_nop 0
  buffer_load_dwordx4 v28, s[8:11], s84 offen offset:0 lds
  buffer_load_dwordx4 v28, s[8:11], s84 offen offset:1024 lds
  buffer_load_dwordx4 v28, s[8:11], s84 offen offset:2048 lds
  buffer_load_dwordx4 v28, s[8:11], s84 offen offset:3072 lds
  s_add_u32 m0, s88, 4096
  s_add_u32 s89, s84, 4096
  buffer_load_dwordx4 v28, s[8:11], s89 offen offset:0 lds
  s_add_u32 s84, s84, 10240
  s_waitcnt vmcnt(5)
  s_barrier
  s_mov_b32 s90, 0
  v_add_u32 v26, s85, v28
  v_add_u32 v27, s86, v28
  ds_read_b128 v[64:67], v26 offset:0
  ds_read_b128 v[68:71], v26 offset:10240
  ds_read_b128 v[72:75], v26 offset:1024
  ds_read_b128 v[76:79], v26 offset:11264
L_w1_12:
  ds_read_b128 v[80:83], v26 offset:2048
  ds_read_b128 v[84:87], v26 offset:12288
  s_waitcnt lgkmcnt(4)
  v_mfma_f32_16x16x32_bf16 v[32:35], a[0:3], v[64:67], 0
  v_mfma_f32_16x16x32_bf16 v[44:47], a[0:3], v[68:71], 0
  v_mfma_f32_16x16x32_bf16 v[36:39], a[80:83], v[64:67], 0
  v_mfma_f32_16x16x32_bf16 v[48:51], a[80:83], v[68:71], 0
  v_mfma_f32_16x16x32_bf16 v[40:43], a[160:163], v[64:67], 0
  v_mfma_f32_16x16x32_bf16 v[52:55], a[160:163], v[68:71], 0
  ds_read_b128 v[88:91], v26 offset:3072
  ds_read_b128 v[92:95], v26 offset:13312
  s_waitcnt lgkmcnt(4)
  v_mfma_f32_16x16x32_bf16 v[32:35], a[4:7], v[72:75], v[32:35]
  v_mfma_f32_16x16x32_bf16 v[44:47], a[4:7], v[76:79], v[44:47]
  v_mfma_f32_16x16x32_bf16 v[36:39], a[84:87], v[72:75], v[36:39]
  v_mfma_f32_16x16x32_bf16 v[48:51], a[84:87], v[76:79], v[48:51]
  v_mfma_f32_16x16x32_bf16 v[40:43], a[164:167], v[72:75], v[40:43]
  v_mfma_f32_16x16x32_bf16 v[52:55], a[164:167], v[76:79], v[52:55]
  ds_read_b128 v[64:67], v26 offset:4096
  ds_read_b128 v[68:71], v26 offset:14336
  s_waitcnt lgkmcnt(4)
  v_mfma_f32_16x16x32_bf16 v[32:35], a[8:11], v[80:83], v[32:35]
  v_mfma_f32_16x16x32_bf16 v[44:47], a[8:11], v[84:87], v[44:47]
  v_mfma_f32_16x16x32_bf16 v[36:39], a[88:91], v[80:83], v[36:39]
  v_mfma_f32_16x16x32_bf16 v[48:51], a[88:91], v[84:87], v[48:51]
  v_mfma_f32_16x16x32_bf16 v[40:43], a[168:171], v[80:83], v[40:43]
  v_mfma_f32_16x16x32_bf16 v[52:55], a[168:171], v[84:87], v[52:55]
  ds_read_b128 v[72:75], v26 offset:5120
  ds_read_b128 v[76:79], v26 offset:15360
  s_waitcnt lgkmcnt(4)
  v_mfma_f32_16x16x32_bf16 v[32:35], a[12:15], v[88:91], v[32:35]
  v_mfma_f32_16x16x32_bf16 v[44:47], a[12:15], v[92:95], v[44:47]
  v_mfma_f32_16x16x32_bf16 v[36:39], a[92:95], v[88:91], v[36:39]
  v_mfma_f32_16x16x32_bf16 v[48:51], a[92:95], v[92:95], v[48:51]
  v_mfma_f32_16x16x32_bf16 v[40:43], a[172:175], v[88:91], v[40:43]
  v_mfma_f32_16x16x32_bf16 v[52:55], a[172:175], v[92:95], v[52:55]
  ds_read_b128 v[80:83], v26 offset:6144
  ds_read_b128 v[84:87], v26 offset:16384
  s_waitcnt lgkmcnt(4)
  v_mfma_f32_16x16x32_bf16 v[32:35], a[16:19], v[64:67], v[32:35]
  v_mfma_f32_16x16x32_bf16 v[44:47], a[16:19], v[68:71], v[44:47]
  v_mfma_f32_16x16x32_bf16 v[36:39], a[96:99], v[64:67], v[36:39]
  v_mfma_f32_16x16x32_bf16 v[48:51], a[96:99], v[68:71], v[48:51]
  v_mfma_f32_16x16x32_bf16 v[40:43], a[176:179], v[64:67], v[40:43]
  v_mfma_f32_16x16x32_bf16 v[52:55], a[176:179], v[68:71], v[52:55]
  s_waitcnt vmcnt(8)
  s_barrier
  ds_read_b128 v[88:91], v26 offset:7168
  ds_read_b128 v[92:95], v26 offset:17408
  s_waitcnt lgkmcnt(4)
  v_mfma_f32_16x16x32_bf16 v[32:35], a[20:23], v[72:75], v[32:35]
  v_mfma_f32_16x16x32_bf16 v[44:47], a[20:23], v[76:79], v[44:47]
  s_add_u32 s88, s94, s92
  s_mov_b32 m0, s88
  s_nop 0
  buffer_load_dwordx4 v28, s[8:11], s84 offen offset:0 lds
  v_mfma_f32_16x16x32_bf16 v[36:39], a[100:103], v[72:75], v[36:39]
  v_mfma_f32_16x16x32_bf16 v[48:51], a[100:103], v[76:79], v[48:51]
  v_mfma_f32_16x16x32_bf16 v[40:43], a[180:183], v[72:75], v[40:43]
  v_mfma_f32_16x16x32_bf16 v[52:55], a[180:183], v[76:79], v[52:55]
  ds_read_b128 v[64:67], v26 offset:8192
  ds_read_b128 v[68:71], v26 offset:18432
  s_waitcnt lgkmcnt(4)
  v_mfma_f32_16x16x32_bf16 v[32:35], a[24:27], v[80:83], v[32:35]
  v_mfma_f32_16x16x32_bf16 v[44:47], a[24:27], v[84:87], v[44:47]
  buffer_load_dwordx4 v28, s[8:11], s84 offen offset:1024 lds
  v_mfma_f32_16x16x32_bf16 v[36:39], a[104:107], v[80:83], v[36:39]
  v_mfma_f32_16x16x32_bf16 v[48:51], a[104:107], v[84:87], v[48:51]
  v_mfma_f32_16x16x32_bf16 v[40:43], a[184:187], v[80:83], v[40:43]
  v_mfma_f32_16x16x32_bf16 v[52:55], a[184:187], v[84:87], v[52:55]
  ds_read_b128 v[72:75], v26 offset:9216
  ds_read_b128 v[76:79], v26 offset:19456
  s_waitcnt lgkmcnt(4)
  v_mfma_f32_16x16x32_bf16 v[32:35], a[28:31], v[88:91], v[32:35]
  v_mfma_f32_16x16x32_bf16 v[44:47], a[28:31], v[92:95], v[44:47]
  buffer_load_dwordx4 v28, s[8:11], s84 offen offset:2048 lds
  v_mfma_f32_16x16x32_bf16 v[36:39], a[108:111], v[88:91], v[36:39]
  v_mfma_f32_16x16x32_bf16 v[48:51], a[108:111], v[92:95], v[48:51]
  v_mfma_f32_16x16x32_bf16 v[40:43], a[188:191], v[88:91], v[40:43]
  v_mfma_f32_16x16x32_bf16 v[52:55], a[188:191], v[92:95], v[52:55]
  ds_read_b128 v[80:83], v27 offset:0
  ds_read_b128 v[84:87], v27 offset:10240
  s_waitcnt lgkmcnt(4)
  v_mfma_f32_16x16x32_bf16 v[32:35], a[32:35], v[64:67], v[32:35]
  v_mfma_f32_16x16x32_bf16 v[44:47], a[32:35], v[68:71], v[44:47]
  buffer_load_dwordx4 v28, s[8:11], s84 offen offset:3072 lds
  v_mfma_f32_16x16x32_bf16 v[36:39], a[112:115], v[64:67], v[36:39]
  v_mfma_f32_16x16x32_bf16 v[48:51], a[112:115], v[68:71], v[48:51]
  v_mfma_f32_16x16x32_bf16 v[40:43], a[192:195], v[64:67], v[40:43]
  v_mfma_f32_16x16x32_bf16 v[52:55], a[192:195], v[68:71], v[52:55]
  ds_read_b128 v[88:91], v27 offset:1024
  ds_read_b128 v[92:95], v27 offset:11264
  s_waitcnt lgkmcnt(4)
  v_mfma_f32_16x16x32_bf16 v[32:35], a[36:39], v[72:75], v[32:35]
  v_mfma_f32_16x16x32_bf16 v[44:47], a[36:39], v[76:79], v[44:47]
  s_add_u32 m0, s88, 4096
  s_add_u32 s89, s84, 4096
  buffer_load_dwordx4 v28, s[8:11], s89 offen offset:0 lds
  v_mfma_f32_16x16x32_bf16 v[36:39], a[116:119], v[72:75], v[36:39]
  v_mfma_f32_16x16x32_bf16 v[48:51], a[116:119], v[76:79], v[48:51]
  v_mfma_f32_16x16x32_bf16 v[40:43], a[196:199], v[72:75], v[40:43]
  v_mfma_f32_16x16x32_bf16 v[52:55], a[196:199], v[76:79], v[52:55]
  s_add_u32 s84, s84, s93
  s_mov_b32 s5, s85
  s_mov_b32 s85, s86
  s_mov_b32 s86, s87
  s_mov_b32 s87, s94
  s_mov_b32 s94, s5
  v_mov_b32 v26, v27
  v_add_u32 v27, s86, v28
  ds_read_b128 v[64:67], v26 offset:2048
  ds_read_b128 v[68:71], v26 offset:12288
  s_waitcnt lgkmcnt(4)
  v_mfma_f32_16x16x32_bf16 v[32:35], a[40:43], v[80:83], v[32:35]
  v_mfma_f32_16x16x32_bf16 v[44:47], a[40:43], v[84:87], v[44:47]
  v_mfma_f32_16x16x32_bf16 v[36:39], a[120:123], v[80:83], v[36:39]
  v_mfma_f32_16x16x32_bf16 v[48:51], a[120:123], v[84:87], v[48:51]
  v_mfma_f32_16x16x32_bf16 v[40:43], a[200:203], v[80:83], v[40:43]
  v_mfma_f32_16x16x32_bf16 v[52:55], a[200:203], v[84:87], v[52:55]
  ds_read_b128 v[72:75], v26 offset:3072
  ds_read_b128 v[76:79], v26 offset:13312
  s_waitcnt lgkmcnt(4)
  v_mfma_f32_16x16x32_bf16 v[32:35], a[44:47], v[88:91], v[32:35]
  v_mfma_f32_16x16x32_bf16 v[44:47], a[44:47], v[92:95], v[44:47]
  v_mfma_f32_16x16x32_bf16 v[36:39], a[124:127], v[88:91], v[36:39]
  v_mfma_f32_16x16x32_bf16 v[48:51], a[124:127], v[92:95], v[48:51]
  v_mfma_f32_16x16x32_bf16 v[40:43], a[204:207], v[88:91], v[40:43]
  v_mfma_f32_16x16x32_bf16 v[52:55], a[204:207], v[92:95], v[52:55]
  ds_read_b128 v[80:83], v26 offset:4096
  ds_read_b128 v[84:87], v26 offset:14336
  s_waitcnt lgkmcnt(4)
  v_mfma_f32_16x16x32_bf16 v[32:35], a[48:51], v[64:67], v[32:35]
  v_mfma_f32_16x16x32_bf16 v[44:47], a[48:51], v[68:71], v[44:47]
  v_mfma_f32_16x16x32_bf16 v[36:39], a[128:131], v[64:67], v[36:39]
  v_mfma_f32_16x16x32_bf16 v[48:51], a[128:131], v[68:71], v[48:51]
  v_mfma_f32_16x16x32_bf16 v[40:43], a[208:211], v[64:67], v[40:43]
  v_mfma_f32_16x16x32_bf16 v[52:55], a[208:211], v[68:71], v[52:55]
  ds_read_b128 v[88:91], v26 offset:5120
  ds_read_b128 v[92:95], v26 offset:15360
  s_waitcnt lgkmcnt(4)
  v_mfma_f32_16x16x32_bf16 v[32:35], a[52:55], v[72:75], v[32:35]
  v_mfma_f32_16x16x32_bf16 v[44:47], a[52:55], v[76:79], v[44:47]
  v_mfma_f32_16x16x32_bf16 v[36:39], a[132:135], v[72:75], v[36:39]
  v_mfma_f32_16x16x32_bf16 v[48:51], a[132:135], v[76:79], v[48:51]
  v_mfma_f32_16x16x32_bf16 v[40:43], a[212:215], v[72:75], v[40:43]
  v_mfma_f32_16x16x32_bf16 v[52:55], a[212:215], v[76:79], v[52:55]
  ds_read_b128 v[64:67], v26 offset:6144
  ds_read_b128 v[68:71], v26 offset:16384
  s_waitcnt lgkmcnt(4)
  v_mfma_f32_16x16x32_bf16 v[32:35], a[56:59], v[80:83], v[32:35]
  v_mfma_f32_16x16x32_bf16 v[44:47], a[56:59], v[84:87], v[44:47]
  v_mfma_f32_16x16x32_bf16 v[36:39], a[136:139], v[80:83], v[36:39]
  v_mfma_f32_16x16x32_bf16 v[48:51], a[136:139], v[84:87], v[48:51]
  v_mfma_f32_16x16x32_bf16 v[40:43], a[216:219], v[80:83], v[40:43]
  v_mfma_f32_16x16x32_bf16 v[52:55], a[216:219], v[84:87], v[52:55]
  s_waitcnt vmcnt(5)
  s_barrier
  s_cmp_eq_u32 s90, 0
  s_cbranch_scc1 L_nf_13
  s_cmp_lg_u32 s3, 0
  s_cbranch_scc1 L_fl_14
  v_mov_b32 v30, s90
  s_mov_b64 exec, 1
  buffer_store_dword v30, off, s[8:11], s82 sc1
  s_mov_b64 exec, -1
L_fl_14:
L_nf_13:
  ds_read_b128 v[72:75], v26 offset:7168
  ds_read_b128 v[76:79], v26 offset:17408
  s_waitcnt lgkmcnt(4)
  v_mfma_f32_16x16x32_bf16 v[32:35], a[60:63], v[88:91], v[32:35]
  v_mfma_f32_16x16x32_bf16 v[44:47], a[60:63], v[92:95], v[44:47]
  s_add_u32 s88, s94, s92
  s_mov_b32 m0, s88
  s_nop 0
  buffer_load_dwordx4 v28, s[8:11], s84 offen offset:0 lds
  v_mfma_f32_16x16x32_bf16 v[36:39], a[140:143], v[88:91], v[36:39]
  v_mfma_f32_16x16x32_bf16 v[48:51], a[140:143], v[92:95], v[48:51]
  v_mfma_f32_16x16x32_bf16 v[40:43], a[220:223], v[88:91], v[40:43]
  v_mfma_f32_16x16x32_bf16 v[52:55], a[220:223], v[92:95], v[52:55]
  ds_read_b128 v[80:83], v26 offset:8192
  ds_read_b128 v[84:87], v26 offset:18432
  s_waitcnt lgkmcnt(4)
  v_mfma_f32_16x16x32_bf16 v[32:35], a[64:67], v[64:67], v[32:35]
  v_mfma_f32_16x16x32_bf16 v[44:47], a[64:67], v[68:71], v[44:47]
  buffer_load_dwordx4 v28, s[8:11], s84 offen offset:1024 lds
  v_mfma_f32_16x16x32_bf16 v[36:39], a[144:147], v[64:67], v[36:39]
  v_mfma_f32_16x16x32_bf16 v[48:51], a[144:147], v[68:71], v[48:51]
  v_mfma_f32_16x16x32_bf16 v[40:43], a[224:227], v[64:67], v[40:43]
  v_mfma_f32_16x16x32_bf16 v[52:55], a[224:227], v[68:71], v[52:55]
  ds_read_b128 v[88:91], v26 offset:9216
  ds_read_b128 v[92:95], v26 offset:19456
  s_waitcnt lgkmcnt(4)
  v_mfma_f32_16x16x32_bf16 v[32:35], a[68:71], v[72:75], v[32:35]
  v_mfma_f32_16x16x32_bf16 v[44:47], a[68:71], v[76:79], v[44:47]
  buffer_load_dwordx4 v28, s[8:11], s84 offen offset:2048 lds
  v_mfma_f32_16x16x32_bf16 v[36:39], a[148:151], v[72:75], v[36:39]
  v_mfma_f32_16x16x32_bf16 v[48:51], a[148:151], v[76:79], v[48:51]
  v_mfma_f32_16x16x32_bf16 v[40:43], a[228:231], v[72:75], v[40:43]
  v_mfma_f32_16x16x32_bf16 v[52:55], a[228:231], v[76:79], v[52:55]
  ds_read_b128 v[64:67], v27 offset:0
  ds_read_b128 v[68:71], v27 offset:10240
  s_waitcnt lgkmcnt(4)
  v_mfma_f32_16x16x32_bf16 v[32:35], a[72:75], v[80:83], v[32:35]
  v_mfma_f32_16x16x32_bf16 v[44:47], a[72:75], v[84:87], v[44:47]
  buffer_load_dwordx4 v28, s[8:11], s84 offen offset:3072 lds
  v_mfma_f32_16x16x32_bf16 v[36:39], a[152:155], v[80:83], v[36:39]
  v_mfma_f32_16x16x32_bf16 v[48:51], a[152:155], v[84:87], v[48:51]
  v_mfma_f32_16x16x32_bf16 v[40:43], a[232:235], v[80:83], v[40:43]
  v_mfma_f32_16x16x32_bf16 v[52:55], a[232:235], v[84:87], v[52:55]
  ds_read_b128 v[72:75], v27 offset:1024
  ds_read_b128 v[76:79], v27 offset:11264
  s_waitcnt lgkmcnt(4)
  v_mfma_f32_16x16x32_bf16 v[32:35], a[76:79], v[88:91], v[32:35]
  v_mfma_f32_16x16x32_bf16 v[44:47], a[76:79], v[92:95], v[44:47]
  s_add_u32 m0, s88, 4096
  s_add_u32 s89, s84, 4096
  buffer_load_dwordx4 v28, s[8:11], s89 offen offset:0 lds
  v_mfma_f32_16x16x32_bf16 v[36:39], a[156:159], v[88:91], v[36:39]
  v_mfma_f32_16x16x32_bf16 v[48:51], a[156:159], v[92:95], v[48:51]
  v_mfma_f32_16x16x32_bf16 v[40:43], a[236:239], v[88:91], v[40:43]
  v_mfma_f32_16x16x32_bf16 v[52:55], a[236:239], v[92:95], v[52:55]
  s_add_u32 s84, s84, 10240
  s_mov_b32 s5, s85
  s_mov_b32 s85, s86
  s_mov_b32 s86, s87
  s_mov_b32 s87, s94
  s_mov_b32 s94, s5
  v_mov_b32 v26, v27
  v_add_u32 v27, s86, v28
  v_cvt_pk_bf16_f32 v96, v32, v33
  v_cvt_pk_bf16_f32 v97, v34, v35
  v_cvt_pk_bf16_f32 v98, v44, v45
  v_cvt_pk_bf16_f32 v99, v46, v47
  buffer_store_dwordx4 v[96:99], v31, s[8:11], s81 offen offset:0 sc1
  v_cvt_pk_bf16_f32 v100, v36, v37
  v_cvt_pk_bf16_f32 v101, v38, v39
  v_cvt_pk_bf16_f32 v102, v48, v49
  v_cvt_pk_bf16_f32 v103, v50, v51
  buffer_store_dwordx4 v[100:103], v31, s[8:11], s81 offen offset:1024 sc1
  v_cvt_pk_bf16_f32 v104, v40, v41
  v_cvt_pk_bf16_f32 v105, v42, v43
  v_cvt_pk_bf16_f32 v106, v52, v53
  v_cvt_pk_bf16_f32 v107, v54, v55
  buffer_store_dwordx4 v[104:107], v31, s[8:11], s81 offen offset:2048 sc1
  s_add_u32 s81, s81, s83
  s_add_u32 s90, s90, 1
  s_cmp_lg_u32 s90, 1
  s_cbranch_scc1 L_nq_15
  s_waitcnt vmcnt(0)
  s_barrier
  s_cmp_lg_u32 s3, 0
  s_cbranch_scc1 L_fl_16
  v_mov_b32 v30, s90
  s_mov_b64 exec, 1
  buffer_store_dword v30, off, s[8:11], s82 sc1
  s_mov_b64 exec, -1
L_fl_16:
L_nq_15:
  s_cmp_lt_u32 s90, s80
  s_cbranch_scc1 L_w1_12
  s_waitcnt vmcnt(0) lgkmcnt(0)
  s_barrier
  s_cmp_lg_u32 s3, 0
  s_cbranch_scc1 L_fl_17
  v_mov_b32 v30, s90
  s_mov_b64 exec, 1
  buffer_store_dword v30, off, s[8:11], s82 sc1
  s_mov_b64 exec, -1
L_fl_17:
  s_branch L_wq
L_wv:
  s_mov_b32 s16, s40
  s_and_b32 s17, s41, 0xffff
  s_mov_b32 s18, 7864320
  s_mov_b32 s19, 0x20000
  s_mul_i32 s78, s61, 384
  s_mul_i32 s83, s91, 393216
  s_mul_i32 s81, s79, 393216
  s_mul_i32 s5, s61, 12288
  s_add_u32 s81, s81, s5
  s_mul_i32 s5, s3, 3072
  s_add_u32 s81, s81, s5
  s_add_u32 s81, s81, 48758784
  s_lshl_b32 s82, s61, 8
  s_lshl_b32 s5, s64, 2
  s_add_u32 s82, s82, s5
  s_add_u32 s82, s82, 2031616
  v_mbcnt_lo_u32_b32 v0, -1, 0
  v_mbcnt_hi_u32_b32 v0, -1, v0
  v_add_u32 v1, 0, v0
  v_mul_u32_u24 v2, 2731, v1
  v_lshrrev_b32 v2, 16, v2
  v_mul_u32_u24 v3, 24, v2
  v_sub_u32 v3, v1, v3
  v_mul_u32_u24 v2, 12288, v2
  v_lshl_add_u32 v4, v3, 4, v2
  v_add_u32 v1, 64, v0
  v_mul_u32_u24 v2, 2731, v1
  v_lshrrev_b32 v2, 16, v2
  v_mul_u32_u24 v3, 24, v2
  v_sub_u32 v3, v1, v3
  v_mul_u32_u24 v2, 12288, v2
  v_lshl_add_u32 v5, v3, 4, v2
  v_add_u32 v1, 128, v0
  v_mul_u32_u24 v2, 2731, v1
  v_lshrrev_b32 v2, 16, v2
  v_mul_u32_u24 v3, 24, v2
  v_sub_u32 v3, v1, v3
  v_mul_u32_u24 v2, 12288, v2
  v_lshl_add_u32 v6, v3, 4, v2
  v_lshrrev_b32 v1, 4, v0
  v_bfe_u32 v2, v0, 2, 2
  v_lshl_add_u32 v1, v1, 3, v2
  v_and_b32 v3, 3, v0
  v_mul_u32_u24 v1, 384, v1
  v_lshl_add_u32 v1, v3, 3, v1
  s_mul_i32 s5, s3, 96
  v_add_u32 v1, s5, v1
  v_add_u32 v2, 49152, v1
  v_add_u32 v3, 98304, v1
  s_lshl_b32 s5, s3, 2
  s_add_u32 s5, s5, 0
  s_mul_i32 s6, s5, 3072
  s_add_u32 s6, s6, 0
  s_mul_i32 s5, s5, 98304
  s_add_u32 s5, s5, s78
  s_add_u32 s5, s5, 0
  s_add_u32 m0, s6, 0
  s_nop 0
  buffer_load_dwordx4 v4, s[16:19], s5 offen lds
  s_add_u32 m0, s6, 1024
  s_nop 0
  buffer_load_dwordx4 v5, s[16:19], s5 offen lds
  s_add_u32 m0, s6, 2048
  s_nop 0
  buffer_load_dwordx4 v6, s[16:19], s5 offen lds
  s_lshl_b32 s5, s3, 2
  s_add_u32 s5, s5, 1
  s_mul_i32 s6, s5, 3072
  s_add_u32 s6, s6, 0
  s_mul_i32 s5, s5, 98304
  s_add_u32 s5, s5, s78
  s_add_u32 s5, s5, 0
  s_add_u32 m0, s6, 0
  s_nop 0
  buffer_load_dwordx4 v4, s[16:19], s5 offen lds
  s_add_u32 m0, s6, 1024
  s_nop 0
  buffer_load_dwordx4 v5, s[16:19], s5 offen lds
  s_add_u32 m0, s6, 2048
  s_nop 0
  buffer_load_dwordx4 v6, s[16:19], s5 offen lds
  s_lshl_b32 s5, s3, 2
  s_add_u32 s5, s5, 2
  s_mul_i32 s6, s5, 3072
  s_add_u32 s6, s6, 0
  s_mul_i32 s5, s5, 98304
  s_add_u32 s5, s5, s78
  s_add_u32 s5, s5, 0
  s_add_u32 m0, s6, 0
  s_nop 0
  buffer_load_dwordx4 v4, s[16:19], s5 offen lds
  s_add_u32 m0, s6, 1024
  s_nop 0
  buffer_load_dwordx4 v5, s[16:19], s5 offen lds
  s_add_u32 m0, s6, 2048
  s_nop 0
  buffer_load_dwordx4 v6, s[16:19], s5 offen lds
  s_lshl_b32 s5, s3, 2
  s_add_u32 s5, s5, 3
  s_mul_i32 s6, s5, 3072
  s_add_u32 s6, s6, 0
  s_mul_i32 s5, s5, 98304
  s_add_u32 s5, s5, s78
  s_add_u32 s5, s5, 0
  s_add_u32 m0, s6, 0
  s_nop 0
  buffer_load_dwordx4 v4, s[16:19], s5 offen lds
  s_add_u32 m0, s6, 1024
  s_nop 0
  buffer_load_dwordx4 v5, s[16:19], s5 offen lds
  s_add_u32 m0, s6, 2048
  s_nop 0
  buffer_load_dwordx4 v6, s[16:19], s5 offen lds
  s_lshl_b32 s5, s3, 2
  s_add_u32 s5, s5, 0
  s_mul_i32 s6, s5, 3072
  s_add_u32 s6, s6, 49152
  s_mul_i32 s5, s5, 98304
  s_add_u32 s5, s5, s78
  s_add_u32 s5, s5, 1572864
  s_add_u32 m0, s6, 0
  s_nop 0
  buffer_load_dwordx4 v4, s[16:19], s5 offen lds
  s_add_u32 m0, s6, 1024
  s_nop 0
  buffer_load_dwordx4 v5, s[16:19], s5 offen lds
  s_add_u32 m0, s6, 2048
  s_nop 0
  buffer_load_dwordx4 v6, s[16:19], s5 offen lds
  s_lshl_b32 s5, s3, 2
  s_add_u32 s5, s5, 1
  s_mul_i32 s6, s5, 3072
  s_add_u32 s6, s6, 49152
  s_mul_i32 s5, s5, 98304
  s_add_u32 s5, s5, s78
  s_add_u32 s5, s5, 1572864
  s_add_u32 m0, s6, 0
  s_nop 0
  buffer_load_dwordx4 v4, s[16:19], s5 offen lds
  s_add_u32 m0, s6, 1024
  s_nop 0
  buffer_load_dwordx4 v5, s[16:19], s5 offen lds
  s_add_u32 m0, s6, 2048
  s_nop 0
  buffer_load_dwordx4 v6, s[16:19], s5 offen lds
  s_lshl_b32 s5, s3, 2
  s_add_u32 s5, s5, 2
  s_mul_i32 s6, s5, 3072
  s_add_u32 s6, s6, 49152
  s_mul_i32 s5, s5, 98304
  s_add_u32 s5, s5, s78
  s_add_u32 s5, s5, 1572864
  s_add_u32 m0, s6, 0
  s_nop 0
  buffer_load_dwordx4 v4, s[16:19], s5 offen lds
  s_add_u32 m0, s6, 1024
  s_nop 0
  buffer_load_dwordx4 v5, s[16:19], s5 offen lds
  s_add_u32 m0, s6, 2048
  s_nop 0
  buffer_load_dwordx4 v6, s[16:19], s5 offen lds
  s_lshl_b32 s5, s3, 2
  s_add_u32 s5, s5, 3
  s_mul_i32 s6, s5, 3072
  s_add_u32 s6, s6, 49152
  s_mul_i32 s5, s5, 98304
  s_add_u32 s5, s5, s78
  s_add_u32 s5, s5, 1572864
  s_add_u32 m0, s6, 0
  s_nop 0
  buffer_load_dwordx4 v4, s[16:19], s5 offen lds
  s_add_u32 m0, s6, 1024
  s_nop 0
  buffer_load_dwordx4 v5, s[16:19], s5 offen lds
  s_add_u32 m0, s6, 2048
  s_nop 0
  buffer_load_dwordx4 v6, s[16:19], s5 offen lds
  s_lshl_b32 s5, s3, 2
  s_add_u32 s5, s5, 0
  s_mul_i32 s6, s5, 3072
  s_add_u32 s6, s6, 98304
  s_mul_i32 s5, s5, 98304
  s_add_u32 s5, s5, s78
  s_add_u32 s5, s5, 3145728
  s_add_u32 m0, s6, 0
  s_nop 0
  buffer_load_dwordx4 v4, s[16:19], s5 offen lds
  s_add_u32 m0, s6, 1024
  s_nop 0
  buffer_load_dwordx4 v5, s[16:19], s5 offen lds
  s_add_u32 m0, s6, 2048
  s_nop 0
  buffer_load_dwordx4 v6, s[16:19], s5 offen lds
  s_lshl_b32 s5, s3, 2
  s_add_u32 s5, s5, 1
  s_mul_i32 s6, s5, 3072
  s_add_u32 s6, s6, 98304
  s_mul_i32 s5, s5, 98304
  s_add_u32 s5, s5, s78
  s_add_u32 s5, s5, 3145728
  s_add_u32 m0, s6, 0
  s_nop 0
  buffer_load_dwordx4 v4, s[16:19], s5 offen lds
  s_add_u32 m0, s6, 1024
  s_nop 0
  buffer_load_dwordx4 v5, s[16:19], s5 offen lds
  s_add_u32 m0, s6, 2048
  s_nop 0
  buffer_load_dwordx4 v6, s[16:19], s5 offen lds
  s_lshl_b32 s5, s3, 2
  s_add_u32 s5, s5, 2
  s_mul_i32 s6, s5, 3072
  s_add_u32 s6, s6, 98304
  s_mul_i32 s5, s5, 98304
  s_add_u32 s5, s5, s78
  s_add_u32 s5, s5, 3145728
  s_add_u32 m0, s6, 0
  s_nop 0
  buffer_load_dwordx4 v4, s[16:19], s5 offen lds
  s_add_u32 m0, s6, 1024
  s_nop 0
  buffer_load_dwordx4 v5, s[16:19], s5 offen lds
  s_add_u32 m0, s6, 2048
  s_nop 0
  buffer_load_dwordx4 v6, s[16:19], s5 offen lds
  s_lshl_b32 s5, s3, 2
  s_add_u32 s5, s5, 3
  s_mul_i32 s6, s5, 3072
  s_add_u32 s6, s6, 98304
  s_mul_i32 s5, s5, 98304
  s_add_u32 s5, s5, s78
  s_add_u32 s5, s5, 3145728
  s_add_u32 m0, s6, 0
  s_nop 0
  buffer_load_dwordx4 v4, s[16:19], s5 offen lds
  s_add_u32 m0, s6, 1024
  s_nop 0
  buffer_load_dwordx4 v5, s[16:19], s5 offen lds
  s_add_u32 m0, s6, 2048
  s_nop 0
  buffer_load_dwordx4 v6, s[16:19], s5 offen lds
  s_waitcnt vmcnt(24)
  s_barrier
  s_cmp_lg_u32 s3, 0
  s_cbranch_scc1 L_arr_18
  v_mov_b32 v60, 1
  s_mov_b64 exec, 1
  buffer_atomic_add v60, off, s[28:31], s58 offset:128
  s_mov_b64 exec, -1
L_arr_18:
  ds_read_b64_tr_b16 a[0:1], v1 offset:0
  ds_read_b64_tr_b16 a[2:3], v1 offset:1536
  ds_read_b64_tr_b16 a[4:5], v1 offset:12288
  ds_read_b64_tr_b16 a[6:7], v1 offset:13824
  ds_read_b64_tr_b16 a[8:9], v1 offset:24576
  ds_read_b64_tr_b16 a[10:11], v1 offset:26112
  ds_read_b64_tr_b16 a[12:13], v1 offset:36864
  ds_read_b64_tr_b16 a[14:15], v1 offset:38400
  ds_read_b64_tr_b16 a[80:81], v1 offset:32
  ds_read_b64_tr_b16 a[82:83], v1 offset:1568
  ds_read_b64_tr_b16 a[84:85], v1 offset:12320
  ds_read_b64_tr_b16 a[86:87], v1 offset:13856
  s_waitcnt lgkmcnt(4)
  ds_read_b64_tr_b16 a[88:89], v1 offset:24608
  ds_read_b64_tr_b16 a[90:91], v1 offset:26144
  ds_read_b64_tr_b16 a[92:93], v1 offset:36896
  ds_read_b64_tr_b16 a[94:95], v1 offset:38432
  ds_read_b64_tr_b16 a[160:161], v1 offset:64
  ds_read_b64_tr_b16 a[162:163], v1 offset:1600
  ds_read_b64_tr_b16 a[164:165], v1 offset:12352
  ds_read_b64_tr_b16 a[166:167], v1 offset:13888
  ds_read_b64_tr_b16 a[168:169], v1 offset:24640
  ds_read_b64_tr_b16 a[170:171], v1 offset:26176
  ds_read_b64_tr_b16 a[172:173], v1 offset:36928
  ds_read_b64_tr_b16 a[174:175], v1 offset:38464
  s_waitcnt lgkmcnt(0)
  s_barrier
  s_lshl_b32 s5, s3, 2
  s_add_u32 s5, s5, 0
  s_mul_i32 s6, s5, 3072
  s_add_u32 s6, s6, 0
  s_mul_i32 s5, s5, 98304
  s_add_u32 s5, s5, s78
  s_add_u32 s5, s5, 4718592
  s_add_u32 m0, s6, 0
  s_nop 0
  buffer_load_dwordx4 v4, s[16:19], s5 offen lds
  s_add_u32 m0, s6, 1024
  s_nop 0
  buffer_load_dwordx4 v5, s[16:19], s5 offen lds
  s_add_u32 m0, s6, 2048
  s_nop 0
  buffer_load_dwordx4 v6, s[16:19], s5 offen lds
  s_lshl_b32 s5, s3, 2
  s_add_u32 s5, s5, 1
  s_mul_i32 s6, s5, 3072
  s_add_u32 s6, s6, 0
  s_mul_i32 s5, s5, 98304
  s_add_u32 s5, s5, s78
  s_add_u32 s5, s5, 4718592
  s_add_u32 m0, s6, 0
  s_nop 0
  buffer_load_dwordx4 v4, s[16:19], s5 offen lds
  s_add_u32 m0, s6, 1024
  s_nop 0
  buffer_load_dwordx4 v5, s[16:19], s5 offen lds
  s_add_u32 m0, s6, 2048
  s_nop 0
  buffer_load_dwordx4 v6, s[16:19], s5 offen lds
  s_lshl_b32 s5, s3, 2
  s_add_u32 s5, s5, 2
  s_mul_i32 s6, s5, 3072
  s_add_u32 s6, s6, 0
  s_mul_i32 s5, s5, 98304
  s_add_u32 s5, s5, s78
  s_add_u32 s5, s5, 4718592
  s_add_u32 m0, s6, 0
  s_nop 0
  buffer_load_dwordx4 v4, s[16:19], s5 offen lds
  s_add_u32 m0, s6, 1024
  s_nop 0
  buffer_load_dwordx4 v5, s[16:19], s5 offen lds
  s_add_u32 m0, s6, 2048
  s_nop 0
  buffer_load_dwordx4 v6, s[16:19], s5 offen lds
  s_lshl_b32 s5, s3, 2
  s_add_u32 s5, s5, 3
  s_mul_i32 s6, s5, 3072
  s_add_u32 s6, s6, 0
  s_mul_i32 s5, s5, 98304
  s_add_u32 s5, s5, s78
  s_add_u32 s5, s5, 4718592
  s_add_u32 m0, s6, 0
  s_nop 0
  buffer_load_dwordx4 v4, s[16:19], s5 offen lds
  s_add_u32 m0, s6, 1024
  s_nop 0
  buffer_load_dwordx4 v5, s[16:19], s5 offen lds
  s_add_u32 m0, s6, 2048
  s_nop 0
  buffer_load_dwordx4 v6, s[16:19], s5 offen lds
  s_waitcnt vmcnt(24)
  s_barrier
  ds_read_b64_tr_b16 a[16:17], v2 offset:0
  ds_read_b64_tr_b16 a[18:19], v2 offset:1536
  ds_read_b64_tr_b16 a[20:21], v2 offset:12288
  ds_read_b64_tr_b16 a[22:23], v2 offset:13824
  ds_read_b64_tr_b16 a[24:25], v2 offset:24576
  ds_read_b64_tr_b16 a[26:27], v2 offset:26112
  ds_read_b64_tr_b16 a[28:29], v2 offset:36864
  ds_read_b64_tr_b16 a[30:31], v2 offset:38400
  ds_read_b64_tr_b16 a[96:97], v2 offset:32
  ds_read_b64_tr_b16 a[98:99], v2 offset:1568
  ds_read_b64_tr_b16 a[100:101], v2 offset:12320
  ds_read_b64_tr_b16 a[102:103], v2 offset:13856
  s_waitcnt lgkmcnt(4)
  ds_read_b64_tr_b16 a[104:105], v2 offset:24608
  ds_read_b64_tr_b16 a[106:107], v2 offset:26144
  ds_read_b64_tr_b16 a[108:109], v2 offset:36896
  ds_read_b64_tr_b16 a[110:111], v2 offset:38432
  ds_read_b64_tr_b16 a[176:177], v2 offset:64
  ds_read_b64_tr_b16 a[178:179], v2 offset:1600
  ds_read_b64_tr_b16 a[180:181], v2 offset:12352
  ds_read_b64_tr_b16 a[182:183], v2 offset:13888
  ds_read_b64_tr_b16 a[184:185], v2 offset:24640
  ds_read_b64_tr_b16 a[186:187], v2 offset:26176
  ds_read_b64_tr_b16 a[188:189], v2 offset:36928
  ds_read_b64_tr_b16 a[190:191], v2 offset:38464
  s_waitcnt lgkmcnt(0)
  s_barrier
  s_lshl_b32 s5, s3, 2
  s_add_u32 s5, s5, 0
  s_mul_i32 s6, s5, 3072
  s_add_u32 s6, s6, 49152
  s_mul_i32 s5, s5, 98304
  s_add_u32 s5, s5, s78
  s_add_u32 s5, s5, 6291456
  s_add_u32 m0, s6, 0
  s_nop 0
  buffer_load_dwordx4 v4, s[16:19], s5 offen lds
  s_add_u32 m0, s6, 1024
  s_nop 0
  buffer_load_dwordx4 v5, s[16:19], s5 offen lds
  s_add_u32 m0, s6, 2048
  s_nop 0
  buffer_load_dwordx4 v6, s[16:19], s5 offen lds
  s_lshl_b32 s5, s3, 2
  s_add_u32 s5, s5, 1
  s_mul_i32 s6, s5, 3072
  s_add_u32 s6, s6, 49152
  s_mul_i32 s5, s5, 98304
  s_add_u32 s5, s5, s78
  s_add_u32 s5, s5, 6291456
  s_add_u32 m0, s6, 0
  s_nop 0
  buffer_load_dwordx4 v4, s[16:19], s5 offen lds
  s_add_u32 m0, s6, 1024
  s_nop 0
  buffer_load_dwordx4 v5, s[16:19], s5 offen lds
  s_add_u32 m0, s6, 2048
  s_nop 0
  buffer_load_dwordx4 v6, s[16:19], s5 offen lds
  s_lshl_b32 s5, s3, 2
  s_add_u32 s5, s5, 2
  s_mul_i32 s6, s5, 3072
  s_add_u32 s6, s6, 49152
  s_mul_i32 s5, s5, 98304
  s_add_u32 s5, s5, s78
  s_add_u32 s5, s5, 6291456
  s_add_u32 m0, s6, 0
  s_nop 0
  buffer_load_dwordx4 v4, s[16:19], s5 offen lds
  s_add_u32 m0, s6, 1024
  s_nop 0
  buffer_load_dwordx4 v5, s[16:19], s5 offen lds
  s_add_u32 m0, s6, 2048
  s_nop 0
  buffer_load_dwordx4 v6, s[16:19], s5 offen lds
  s_lshl_b32 s5, s3, 2
  s_add_u32 s5, s5, 3
  s_mul_i32 s6, s5, 3072
  s_add_u32 s6, s6, 49152
  s_mul_i32 s5, s5, 98304
  s_add_u32 s5, s5, s78
  s_add_u32 s5, s5, 6291456
  s_add_u32 m0, s6, 0
  s_nop 0
  buffer_load_dwordx4 v4, s[16:19], s5 offen lds
  s_add_u32 m0, s6, 1024
  s_nop 0
  buffer_load_dwordx4 v5, s[16:19], s5 offen lds
  s_add_u32 m0, s6, 2048
  s_nop 0
  buffer_load_dwordx4 v6, s[16:19], s5 offen lds
  s_waitcnt vmcnt(24)
  s_barrier
  ds_read_b64_tr_b16 a[32:33], v3 offset:0
  ds_read_b64_tr_b16 a[34:35], v3 offset:1536
  ds_read_b64_tr_b16 a[36:37], v3 offset:12288
  ds_read_b64_tr_b16 a[38:39], v3 offset:13824
  ds_read_b64_tr_b16 a[40:41], v3 offset:24576
  ds_read_b64_tr_b16 a[42:43], v3 offset:26112
  ds_read_b64_tr_b16 a[44:45], v3 offset:36864
  ds_read_b64_tr_b16 a[46:47], v3 offset:38400
  ds_read_b64_tr_b16 a[112:113], v3 offset:32
  ds_read_b64_tr_b16 a[114:115], v3 offset:1568
  ds_read_b64_tr_b16 a[116:117], v3 offset:12320
  ds_read_b64_tr_b16 a[118:119], v3 offset:13856
  s_waitcnt lgkmcnt(4)
  ds_read_b64_tr_b16 a[120:121], v3 offset:24608
  ds_read_b64_tr_b16 a[122:123], v3 offset:26144
  ds_read_b64_tr_b16 a[124:125], v3 offset:36896
  ds_read_b64_tr_b16 a[126:127], v3 offset:38432
  ds_read_b64_tr_b16 a[192:193], v3 offset:64
  ds_read_b64_tr_b16 a[194:195], v3 offset:1600
  ds_read_b64_tr_b16 a[196:197], v3 offset:12352
  ds_read_b64_tr_b16 a[198:199], v3 offset:13888
  ds_read_b64_tr_b16 a[200:201], v3 offset:24640
  ds_read_b64_tr_b16 a[202:203], v3 offset:26176
  ds_read_b64_tr_b16 a[204:205], v3 offset:36928
  ds_read_b64_tr_b16 a[206:207], v3 offset:38464
  s_waitcnt vmcnt(12)
  s_barrier
  ds_read_b64_tr_b16 a[48:49], v1 offset:0
  ds_read_b64_tr_b16 a[50:51], v1 offset:1536
  ds_read_b64_tr_b16 a[52:53], v1 offset:12288
  ds_read_b64_tr_b16 a[54:55], v1 offset:13824
  ds_read_b64_tr_b16 a[56:57], v1 offset:24576
  ds_read_b64_tr_b16 a[58:59], v1 offset:26112
  ds_read_b64_tr_b16 a[60:61], v1 offset:36864
  ds_read_b64_tr_b16 a[62:63], v1 offset:38400
  ds_read_b64_tr_b16 a[128:129], v1 offset:32
  ds_read_b64_tr_b16 a[130:131], v1 offset:1568
  ds_read_b64_tr_b16 a[132:133], v1 offset:12320
  ds_read_b64_tr_b16 a[134:135], v1 offset:13856
  s_waitcnt lgkmcnt(4)
  ds_read_b64_tr_b16 a[136:137], v1 offset:24608
  ds_read_b64_tr_b16 a[138:139], v1 offset:26144
  ds_read_b64_tr_b16 a[140:141], v1 offset:36896
  ds_read_b64_tr_b16 a[142:143], v1 offset:38432
  ds_read_b64_tr_b16 a[208:209], v1 offset:64
  ds_read_b64_tr_b16 a[210:211], v1 offset:1600
  ds_read_b64_tr_b16 a[212:213], v1 offset:12352
  ds_read_b64_tr_b16 a[214:215], v1 offset:13888
  ds_read_b64_tr_b16 a[216:217], v1 offset:24640
  ds_read_b64_tr_b16 a[218:219], v1 offset:26176
  ds_read_b64_tr_b16 a[220:221], v1 offset:36928
  ds_read_b64_tr_b16 a[222:223], v1 offset:38464
  s_waitcnt vmcnt(0)
  s_barrier
  ds_read_b64_tr_b16 a[64:65], v2 offset:0
  ds_read_b64_tr_b16 a[66:67], v2 offset:1536
  ds_read_b64_tr_b16 a[68:69], v2 offset:12288
  ds_read_b64_tr_b16 a[70:71], v2 offset:13824
  ds_read_b64_tr_b16 a[72:73], v2 offset:24576
  ds_read_b64_tr_b16 a[74:75], v2 offset:26112
  ds_read_b64_tr_b16 a[76:77], v2 offset:36864
  ds_read_b64_tr_b16 a[78:79], v2 offset:38400
  ds_read_b64_tr_b16 a[144:145], v2 offset:32
  ds_read_b64_tr_b16 a[146:147], v2 offset:1568
  ds_read_b64_tr_b16 a[148:149], v2 offset:12320
  ds_read_b64_tr_b16 a[150:151], v2 offset:13856
  s_waitcnt lgkmcnt(4)
  ds_read_b64_tr_b16 a[152:153], v2 offset:24608
  ds_read_b64_tr_b16 a[154:155], v2 offset:26144
  ds_read_b64_tr_b16 a[156:157], v2 offset:36896
  ds_read_b64_tr_b16 a[158:159], v2 offset:38432
  ds_read_b64_tr_b16 a[224:225], v2 offset:64
  ds_read_b64_tr_b16 a[226:227], v2 offset:1600
  ds_read_b64_tr_b16 a[228:229], v2 offset:12352
  ds_read_b64_tr_b16 a[230:231], v2 offset:13888
  ds_read_b64_tr_b16 a[232:233], v2 offset:24640
  ds_read_b64_tr_b16 a[234:235], v2 offset:26176
  ds_read_b64_tr_b16 a[236:237], v2 offset:36928
  ds_read_b64_tr_b16 a[238:239], v2 offset:38464
  s_waitcnt lgkmcnt(0)
  s_barrier
  v_mbcnt_lo_u32_b32 v0, -1, 0
  v_mbcnt_hi_u32_b32 v0, -1, v0
  v_lshlrev_b32 v28, 4, v0
  s_cmp_lg_u32 s3, 0
  s_cbranch_scc1 L_poll2d_20
  v_mbcnt_lo_u32_b32 v29, -1, 0
  v_mbcnt_hi_u32_b32 v29, -1, v29
  v_and_b32 v29, 7, v29
  v_lshlrev_b32 v29, 4, v29
L_poll2_19:
  s_sub_u32 s59, s59, 1
  s_cbranch_scc1 L_end
  buffer_load_dword v30, v29, s[28:31], 0 offen offset:128 sc1
  s_waitcnt vmcnt(0)
  v_add_u32_dpp v30, v30, v30 row_ror:1 row_mask:0xf bank_mask:0xf
  s_nop 1
  v_add_u32_dpp v30, v30, v30 row_ror:2 row_mask:0xf bank_mask:0xf
  s_nop 1
  v_add_u32_dpp v30, v30, v30 row_ror:4 row_mask:0xf bank_mask:0xf
  s_nop 0
  v_readfirstlane_b32 s5, v30
  s_cmp_lt_u32 s5, 256
  s_cbranch_scc1 L_poll2_19
L_poll2d_20:
  s_barrier
  s_lshl_b32 s84, s79, 1
  s_lshr_b32 s5, s3, 1
  s_add_u32 s84, s84, s5
  s_mul_i32 s84, s84, 20480
  s_and_b32 s5, s3, 1
  s_mul_i32 s5, s5, 5120
  s_add_u32 s84, s84, s5
  s_add_u32 s84, s84, 2097152
  s_mul_i32 s93, s91, 40960
  s_sub_u32 s93, s93, 10240
  s_mul_i32 s92, s3, 5120
  s_mov_b32 s85, 0
  s_mov_b32 s86, 20480
  s_mov_b32 s87, 40960
  s_mov_b32 s94, 61440
  v_mov_b32 v31, v28
  s_add_u32 s88, s85, s92
  s_mov_b32 m0, s88
  s_nop 0
  buffer_load_dwordx4 v28, s[8:11], s84 offen offset:0 lds
  buffer_load_dwordx4 v28, s[8:11], s84 offen offset:1024 lds
  buffer_load_dwordx4 v28, s[8:11], s84 offen offset:2048 lds
  buffer_load_dwordx4 v28, s[8:11], s84 offen offset:3072 lds
  s_add_u32 m0, s88, 4096
  s_add_u32 s89, s84, 4096
  buffer_load_dwordx4 v28, s[8:11], s89 offen offset:0 lds
  s_add_u32 s84, s84, 10240
  s_add_u32 s88, s86, s92
  s_mov_b32 m0, s88
  s_nop 0
  buffer_load_dwordx4 v28, s[8:11], s84 offen offset:0 lds
  buffer_load_dwordx4 v28, s[8:11], s84 offen offset:1024 lds
  buffer_load_dwordx4 v28, s[8:11], s84 offen offset:2048 lds
  buffer_load_dwordx4 v28, s[8:11], s84 offen offset:3072 lds
  s_add_u32 m0, s88, 4096
  s_add_u32 s89, s84, 4096
  buffer_load_dwordx4 v28, s[8:11], s89 offen offset:0 lds
  s_add_u32 s84, s84, s93
  s_add_u32 s88, s87, s92
  s_mov_b32 m0, s88
  s_nop 0
  buffer_load_dwordx4 v28, s[8:11], s84 offen offset:0 lds
  buffer_load_dwordx4 v28, s[8:11], s84 offen offset:1024 lds
  buffer_load_dwordx4 v28, s[8:11], s84 offen offset:2048 lds
  buffer_load_dwordx4 v28, s[8:11], s84 offen offset:3072 lds
  s_add_u32 m0, s88, 4096
  s_add_u32 s89, s84, 4096
  buffer_load_dwordx4 v28, s[8:11], s89 offen offset:0 lds
  s_add_u32 s84, s84, 10240
  s_waitcnt vmcnt(5)
  s_barrier
  s_mov_b32 s90, 0
  v_add_u32 v26, s85, v28
  v_add_u32 v27, s86, v28
  ds_read_b128 v[64:67], v26 offset:0
  ds_read_b128 v[68:71], v26 offset:10240
  ds_read_b128 v[72:75], v26 offset:1024
  ds_read_b128 v[76:79], v26 offset:11264
L_w1_21:
  ds_read_b128 v[80:83], v26 offset:2048
  ds_read_b128 v[84:87], v26 offset:12288
  s_waitcnt lgkmcnt(4)
  v_mfma_f32_16x16x32_bf16 v[32:35], v[64:67], a[0:3], 0
  v_mfma_f32_16x16x32_bf16 v[44:47], v[68:71], a[0:3], 0
  v_mfma_f32_16x16x32_bf16 v[36:39], v[64:67], a[80:83], 0
  v_mfma_f32_16x16x32_bf16 v[48:51], v[68:71], a[80:83], 0
  v_mfma_f32_16x16x32_bf16 v[40:43], v[64:67], a[160:163], 0
  v_mfma_f32_16x16x32_bf16 v[52:55], v[68:71], a[160:163], 0
  ds_read_b128 v[88:91], v26 offset:3072
  ds_read_b128 v[92:95], v26 offset:13312
  s_waitcnt lgkmcnt(4)
  v_mfma_f32_16x16x32_bf16 v[32:35], v[72:75], a[4:7], v[32:35]
  v_mfma_f32_16x16x32_bf16 v[44:47], v[76:79], a[4:7], v[44:47]
  v_mfma_f32_16x16x32_bf16 v[36:39], v[72:75], a[84:87], v[36:39]
  v_mfma_f32_16x16x32_bf16 v[48:51], v[76:79], a[84:87], v[48:51]
  v_mfma_f32_16x16x32_bf16 v[40:43], v[72:75], a[164:167], v[40:43]
  v_mfma_f32_16x16x32_bf16 v[52:55], v[76:79], a[164:167], v[52:55]
  ds_read_b128 v[64:67], v26 offset:4096
  ds_read_b128 v[68:71], v26 offset:14336
  s_waitcnt lgkmcnt(4)
  v_mfma_f32_16x16x32_bf16 v[32:35], v[80:83], a[8:11], v[32:35]
  v_mfma_f32_16x16x32_bf16 v[44:47], v[84:87], a[8:11], v[44:47]
  v_mfma_f32_16x16x32_bf16 v[36:39], v[80:83], a[88:91], v[36:39]
  v_mfma_f32_16x16x32_bf16 v[48:51], v[84:87], a[88:91], v[48:51]
  v_mfma_f32_16x16x32_bf16 v[40:43], v[80:83], a[168:171], v[40:43]
  v_mfma_f32_16x16x32_bf16 v[52:55], v[84:87], a[168:171], v[52:55]
  ds_read_b128 v[72:75], v26 offset:5120
  ds_read_b128 v[76:79], v26 offset:15360
  s_waitcnt lgkmcnt(4)
  v_mfma_f32_16x16x32_bf16 v[32:35], v[88:91], a[12:15], v[32:35]
  v_mfma_f32_16x16x32_bf16 v[44:47], v[92:95], a[12:15], v[44:47]
  v_mfma_f32_16x16x32_bf16 v[36:39], v[88:91], a[92:95], v[36:39]
  v_mfma_f32_16x16x32_bf16 v[48:51], v[92:95], a[92:95], v[48:51]
  v_mfma_f32_16x16x32_bf16 v[40:43], v[88:91], a[172:175], v[40:43]
  v_mfma_f32_16x16x32_bf16 v[52:55], v[92:95], a[172:175], v[52:55]
  ds_read_b128 v[80:83], v26 offset:6144
  ds_read_b128 v[84:87], v26 offset:16384
  s_waitcnt lgkmcnt(4)
  v_mfma_f32_16x16x32_bf16 v[32:35], v[64:67], a[16:19], v[32:35]
  v_mfma_f32_16x16x32_bf16 v[44:47], v[68:71], a[16:19], v[44:47]
  v_mfma_f32_16x16x32_bf16 v[36:39], v[64:67], a[96:99], v[36:39]
  v_mfma_f32_16x16x32_bf16 v[48:51], v[68:71], a[96:99], v[48:51]
  v_mfma_f32_16x16x32_bf16 v[40:43], v[64:67], a[176:179], v[40:43]
  v_mfma_f32_16x16x32_bf16 v[52:55], v[68:71], a[176:179], v[52:55]
  s_waitcnt vmcnt(8)
  s_barrier
  ds_read_b128 v[88:91], v26 offset:7168
  ds_read_b128 v[92:95], v26 offset:17408
  s_waitcnt lgkmcnt(4)
  v_mfma_f32_16x16x32_bf16 v[32:35], v[72:75], a[20:23], v[32:35]
  v_mfma_f32_16x16x32_bf16 v[44:47], v[76:79], a[20:23], v[44:47]
  s_add_u32 s88, s94, s92
  s_mov_b32 m0, s88
  s_nop 0
  buffer_load_dwordx4 v28, s[8:11], s84 offen offset:0 lds
  v_mfma_f32_16x16x32_bf16 v[36:39], v[72:75], a[100:103], v[36:39]
  v_mfma_f32_16x16x32_bf16 v[48:51], v[76:79], a[100:103], v[48:51]
  v_mfma_f32_16x16x32_bf16 v[40:43], v[72:75], a[180:183], v[40:43]
  v_mfma_f32_16x16x32_bf16 v[52:55], v[76:79], a[180:183], v[52:55]
  ds_read_b128 v[64:67], v26 offset:8192
  ds_read_b128 v[68:71], v26 offset:18432
  s_waitcnt lgkmcnt(4)
  v_mfma_f32_16x16x32_bf16 v[32:35], v[80:83], a[24:27], v[32:35]
  v_mfma_f32_16x16x32_bf16 v[44:47], v[84:87], a[24:27], v[44:47]
  buffer_load_dwordx4 v28, s[8:11], s84 offen offset:1024 lds
  v_mfma_f32_16x16x32_bf16 v[36:39], v[80:83], a[104:107], v[36:39]
  v_mfma_f32_16x16x32_bf16 v[48:51], v[84:87], a[104:107], v[48:51]
  v_mfma_f32_16x16x32_bf16 v[40:43], v[80:83], a[184:187], v[40:43]
  v_mfma_f32_16x16x32_bf16 v[52:55], v[84:87], a[184:187], v[52:55]
  ds_read_b128 v[72:75], v26 offset:9216
  ds_read_b128 v[76:79], v26 offset:19456
  s_waitcnt lgkmcnt(4)
  v_mfma_f32_16x16x32_bf16 v[32:35], v[88:91], a[28:31], v[32:35]
  v_mfma_f32_16x16x32_bf16 v[44:47], v[92:95], a[28:31], v[44:47]
  buffer_load_dwordx4 v28, s[8:11], s84 offen offset:2048 lds
  v_mfma_f32_16x16x32_bf16 v[36:39], v[88:91], a[108:111], v[36:39]
  v_mfma_f32_16x16x32_bf16 v[48:51], v[92:95], a[108:111], v[48:51]
  v_mfma_f32_16x16x32_bf16 v[40:43], v[88:91], a[188:191], v[40:43]
  v_mfma_f32_16x16x32_bf16 v[52:55], v[92:95], a[188:191], v[52:55]
  ds_read_b128 v[80:83], v27 offset:0
  ds_read_b128 v[84:87], v27 offset:10240
  s_waitcnt lgkmcnt(4)
  v_mfma_f32_16x16x32_bf16 v[32:35], v[64:67], a[32:35], v[32:35]
  v_mfma_f32_16x16x32_bf16 v[44:47], v[68:71], a[32:35], v[44:47]
  buffer_load_dwordx4 v28, s[8:11], s84 offen offset:3072 lds
  v_mfma_f32_16x16x32_bf16 v[36:39], v[64:67], a[112:115], v[36:39]
  v_mfma_f32_16x16x32_bf16 v[48:51], v[68:71], a[112:115], v[48:51]
  v_mfma_f32_16x16x32_bf16 v[40:43], v[64:67], a[192:195], v[40:43]
  v_mfma_f32_16x16x32_bf16 v[52:55], v[68:71], a[192:195], v[52:55]
  ds_read_b128 v[88:91], v27 offset:1024
  ds_read_b128 v[92:95], v27 offset:11264
  s_waitcnt lgkmcnt(4)
  v_mfma_f32_16x16x32_bf16 v[32:35], v[72:75], a[36:39], v[32:35]
  v_mfma_f32_16x16x32_bf16 v[44:47], v[76:79], a[36:39], v[44:47]
  s_add_u32 m0, s88, 4096
  s_add_u32 s89, s84, 4096
  buffer_load_dwordx4 v28, s[8:11], s89 offen offset:0 lds
  v_mfma_f32_16x16x32_bf16 v[36:39], v[72:75], a[116:119], v[36:39]
  v_mfma_f32_16x16x32_bf16 v[48:51], v[76:79], a[116:119], v[48:51]
  v_mfma_f32_16x16x32_bf16 v[40:43], v[72:75], a[196:199], v[40:43]
  v_mfma_f32_16x16x32_bf16 v[52:55], v[76:79], a[196:199], v[52:55]
  s_add_u32 s84, s84, s93
  s_mov_b32 s5, s85
  s_mov_b32 s85, s86
  s_mov_b32 s86, s87
  s_mov_b32 s87, s94
  s_mov_b32 s94, s5
  v_mov_b32 v26, v27
  v_add_u32 v27, s86, v28
  ds_read_b128 v[64:67], v26 offset:2048
  ds_read_b128 v[68:71], v26 offset:12288
  s_waitcnt lgkmcnt(4)
  v_mfma_f32_16x16x32_bf16 v[32:35], v[80:83], a[40:43], v[32:35]
  v_mfma_f32_16x16x32_bf16 v[44:47], v[84:87], a[40:43], v[44:47]
  v_mfma_f32_16x16x32_bf16 v[36:39], v[80:83], a[120:123], v[36:39]
  v_mfma_f32_16x16x32_bf16 v[48:51], v[84:87], a[120:123], v[48:51]
  v_mfma_f32_16x16x32_bf16 v[40:43], v[80:83], a[200:203], v[40:43]
  v_mfma_f32_16x16x32_bf16 v[52:55], v[84:87], a[200:203], v[52:55]
  ds_read_b128 v[72:75], v26 offset:3072
  ds_read_b128 v[76:79], v26 offset:13312
  s_waitcnt lgkmcnt(4)
  v_mfma_f32_16x16x32_bf16 v[32:35], v[88:91], a[44:47], v[32:35]
  v_mfma_f32_16x16x32_bf16 v[44:47], v[92:95], a[44:47], v[44:47]
  v_mfma_f32_16x16x32_bf16 v[36:39], v[88:91], a[124:127], v[36:39]
  v_mfma_f32_16x16x32_bf16 v[48:51], v[92:95], a[124:127], v[48:51]
  v_mfma_f32_16x16x32_bf16 v[40:43], v[88:91], a[204:207], v[40:43]
  v_mfma_f32_16x16x32_bf16 v[52:55], v[92:95], a[204:207], v[52:55]
  ds_read_b128 v[80:83], v26 offset:4096
  ds_read_b128 v[84:87], v26 offset:14336
  s_waitcnt lgkmcnt(4)
  v_mfma_f32_16x16x32_bf16 v[32:35], v[64:67], a[48:51], v[32:35]
  v_mfma_f32_16x16x32_bf16 v[44:47], v[68:71], a[48:51], v[44:47]
  v_mfma_f32_16x16x32_bf16 v[36:39], v[64:67], a[128:131], v[36:39]
  v_mfma_f32_16x16x32_bf16 v[48:51], v[68:71], a[128:131], v[48:51]
  v_mfma_f32_16x16x32_bf16 v[40:43], v[64:67], a[208:211], v[40:43]
  v_mfma_f32_16x16x32_bf16 v[52:55], v[68:71], a[208:211], v[52:55]
  ds_read_b128 v[88:91], v26 offset:5120
  ds_read_b128 v[92:95], v26 offset:15360
  s_waitcnt lgkmcnt(4)
  v_mfma_f32_16x16x32_bf16 v[32:35], v[72:75], a[52:55], v[32:35]
  v_mfma_f32_16x16x32_bf16 v[44:47], v[76:79], a[52:55], v[44:47]
  v_mfma_f32_16x16x32_bf16 v[36:39], v[72:75], a[132:135], v[36:39]
  v_mfma_f32_16x16x32_bf16 v[48:51], v[76:79], a[132:135], v[48:51]
  v_mfma_f32_16x16x32_bf16 v[40:43], v[72:75], a[212:215], v[40:43]
  v_mfma_f32_16x16x32_bf16 v[52:55], v[76:79], a[212:215], v[52:55]
  ds_read_b128 v[64:67], v26 offset:6144
  ds_read_b128 v[68:71], v26 offset:16384
  s_waitcnt lgkmcnt(4)
  v_mfma_f32_16x16x32_bf16 v[32:35], v[80:83], a[56:59], v[32:35]
  v_mfma_f32_16x16x32_bf16 v[44:47], v[84:87], a[56:59], v[44:47]
  v_mfma_f32_16x16x32_bf16 v[36:39], v[80:83], a[136:139], v[36:39]
  v_mfma_f32_16x16x32_bf16 v[48:51], v[84:87], a[136:139], v[48:51]
  v_mfma_f32_16x16x32_bf16 v[40:43], v[80:83], a[216:219], v[40:43]
  v_mfma_f32_16x16x32_bf16 v[52:55], v[84:87], a[216:219], v[52:55]
  s_waitcnt vmcnt(5)
  s_barrier
  s_cmp_eq_u32 s90, 0
  s_cbranch_scc1 L_nf_22
  s_cmp_lg_u32 s3, 0
  s_cbranch_scc1 L_fl_23
  v_mov_b32 v30, s90
  s_mov_b64 exec, 1
  buffer_store_dword v30, off, s[8:11], s82 sc1
  s_mov_b64 exec, -1
L_fl_23:
L_nf_22:
  ds_read_b128 v[72:75], v26 offset:7168
  ds_read_b128 v[76:79], v26 offset:17408
  s_waitcnt lgkmcnt(4)
  v_mfma_f32_16x16x32_bf16 v[32:35], v[88:91], a[60:63], v[32:35]
  v_mfma_f32_16x16x32_bf16 v[44:47], v[92:95], a[60:63], v[44:47]
  s_add_u32 s88, s94, s92
  s_mov_b32 m0, s88
  s_nop 0
  buffer_load_dwordx4 v28, s[8:11], s84 offen offset:0 lds
  v_mfma_f32_16x16x32_bf16 v[36:39], v[88:91], a[140:143], v[36:39]
  v_mfma_f32_16x16x32_bf16 v[48:51], v[92:95], a[140:143], v[48:51]
  v_mfma_f32_16x16x32_bf16 v[40:43], v[88:91], a[220:223], v[40:43]
  v_mfma_f32_16x16x32_bf16 v[52:55], v[92:95], a[220:223], v[52:55]
  ds_read_b128 v[80:83], v26 offset:8192
  ds_read_b128 v[84:87], v26 offset:18432
  s_waitcnt lgkmcnt(4)
  v_mfma_f32_16x16x32_bf16 v[32:35], v[64:67], a[64:67], v[32:35]
  v_mfma_f32_16x16x32_bf16 v[44:47], v[68:71], a[64:67], v[44:47]
  buffer_load_dwordx4 v28, s[8:11], s84 offen offset:1024 lds
  v_mfma_f32_16x16x32_bf16 v[36:39], v[64:67], a[144:147], v[36:39]
  v_mfma_f32_16x16x32_bf16 v[48:51], v[68:71], a[144:147], v[48:51]
  v_mfma_f32_16x16x32_bf16 v[40:43], v[64:67], a[224:227], v[40:43]
  v_mfma_f32_16x16x32_bf16 v[52:55], v[68:71], a[224:227], v[52:55]
  ds_read_b128 v[88:91], v26 offset:9216
  ds_read_b128 v[92:95], v26 offset:19456
  s_waitcnt lgkmcnt(4)
  v_mfma_f32_16x16x32_bf16 v[32:35], v[72:75], a[68:71], v[32:35]
  v_mfma_f32_16x16x32_bf16 v[44:47], v[76:79], a[68:71], v[44:47]
  buffer_load_dwordx4 v28, s[8:11], s84 offen offset:2048 lds
  v_mfma_f32_16x16x32_bf16 v[36:39], v[72:75], a[148:151], v[36:39]
  v_mfma_f32_16x16x32_bf16 v[48:51], v[76:79], a[148:151], v[48:51]
  v_mfma_f32_16x16x32_bf16 v[40:43], v[72:75], a[228:231], v[40:43]
  v_mfma_f32_16x16x32_bf16 v[52:55], v[76:79], a[228:231], v[52:55]
  ds_read_b128 v[64:67], v27 offset:0
  ds_read_b128 v[68:71], v27 offset:10240
  s_waitcnt lgkmcnt(4)
  v_mfma_f32_16x16x32_bf16 v[32:35], v[80:83], a[72:75], v[32:35]
  v_mfma_f32_16x16x32_bf16 v[44:47], v[84:87], a[72:75], v[44:47]
  buffer_load_dwordx4 v28, s[8:11], s84 offen offset:3072 lds
  v_mfma_f32_16x16x32_bf16 v[36:39], v[80:83], a[152:155], v[36:39]
  v_mfma_f32_16x16x32_bf16 v[48:51], v[84:87], a[152:155], v[48:51]
  v_mfma_f32_16x16x32_bf16 v[40:43], v[80:83], a[232:235], v[40:43]
  v_mfma_f32_16x16x32_bf16 v[52:55], v[84:87], a[232:235], v[52:55]
  ds_read_b128 v[72:75], v27 offset:1024
  ds_read_b128 v[76:79], v27 offset:11264
  s_waitcnt lgkmcnt(4)
  v_mfma_f32_16x16x32_bf16 v[32:35], v[88:91], a[76:79], v[32:35]
  v_mfma_f32_16x16x32_bf16 v[44:47], v[92:95], a[76:79], v[44:47]
  s_add_u32 m0, s88, 4096
  s_add_u32 s89, s84, 4096
  buffer_load_dwordx4 v28, s[8:11], s89 offen offset:0 lds
  v_mfma_f32_16x16x32_bf16 v[36:39], v[88:91], a[156:159], v[36:39]
  v_mfma_f32_16x16x32_bf16 v[48:51], v[92:95], a[156:159], v[48:51]
  v_mfma_f32_16x16x32_bf16 v[40:43], v[88:91], a[236:239], v[40:43]
  v_mfma_f32_16x16x32_bf16 v[52:55], v[92:95], a[236:239], v[52:55]
  s_add_u32 s84, s84, 10240
  s_mov_b32 s5, s85
  s_mov_b32 s85, s86
  s_mov_b32 s86, s87
  s_mov_b32 s87, s94
  s_mov_b32 s94, s5
  v_mov_b32 v26, v27
  v_add_u32 v27, s86, v28
  v_cvt_pk_bf16_f32 v96, v32, v33
  v_cvt_pk_bf16_f32 v97, v44, v45
  v_cvt_pk_bf16_f32 v98, v34, v35
  v_cvt_pk_bf16_f32 v99, v46, v47
  buffer_store_dwordx4 v[96:99], v31, s[8:11], s81 offen offset:0 sc1
  v_cvt_pk_bf16_f32 v100, v36, v37
  v_cvt_pk_bf16_f32 v101, v48, v49
  v_cvt_pk_bf16_f32 v102, v38, v39
  v_cvt_pk_bf16_f32 v103, v50, v51
  buffer_store_dwordx4 v[100:103], v31, s[8:11], s81 offen offset:1024 sc1
  v_cvt_pk_bf16_f32 v104, v40, v41
  v_cvt_pk_bf16_f32 v105, v52, v53
  v_cvt_pk_bf16_f32 v106, v42, v43
  v_cvt_pk_bf16_f32 v107, v54, v55
  buffer_store_dwordx4 v[104:107], v31, s[8:11], s81 offen offset:2048 sc1
  s_add_u32 s81, s81, s83
  s_add_u32 s90, s90, 1
  s_cmp_lg_u32 s90, 1
  s_cbranch_scc1 L_nq_24
  s_waitcnt vmcnt(0)
  s_barrier
  s_cmp_lg_u32 s3, 0
  s_cbranch_scc1 L_fl_25
  v_mov_b32 v30, s90
  s_mov_b64 exec, 1
  buffer_store_dword v30, off, s[8:11], s82 sc1
  s_mov_b64 exec, -1
L_fl_25:
L_nq_24:
  s_cmp_lt_u32 s90, s80
  s_cbranch_scc1 L_w1_21
  s_waitcnt vmcnt(0) lgkmcnt(0)
  s_barrier
  s_cmp_lg_u32 s3, 0
  s_cbranch_scc1 L_fl_26
  v_mov_b32 v30, s90
  s_mov_b64 exec, 1
  buffer_store_dword v30, off, s[8:11], s82 sc1
  s_mov_b64 exec, -1
L_fl_26:
L_wq:
  s_mov_b32 s79, s64
  s_mov_b32 s80, 16
  s_mov_b32 s91, 4
  s_mov_b32 s16, s36
  s_and_b32 s17, s37, 0xffff
  s_mov_b32 s18, 7864320
  s_mov_b32 s19, 0x20000
  s_mul_i32 s78, s61, 384
  s_mul_i32 s83, s91, 393216
  s_mul_i32 s81, s79, 393216
  s_mul_i32 s5, s61, 12288
  s_add_u32 s81, s81, s5
  s_mul_i32 s5, s3, 3072
  s_add_u32 s81, s81, s5
  s_add_u32 s81, s81, 73924608
  s_lshl_b32 s82, s61, 8
  s_lshl_b32 s5, s64, 2
  s_add_u32 s82, s82, s5
  s_add_u32 s82, s82, 2031616
  v_mbcnt_lo_u32_b32 v0, -1, 0
  v_mbcnt_hi_u32_b32 v0, -1, v0
  v_add_u32 v1, 0, v0
  v_mul_u32_u24 v2, 2731, v1
  v_lshrrev_b32 v2, 16, v2
  v_mul_u32_u24 v3, 24, v2
  v_sub_u32 v3, v1, v3
  v_mul_u32_u24 v2, 12288, v2
  v_lshl_add_u32 v4, v3, 4, v2
  v_add_u32 v1, 64, v0
  v_mul_u32_u24 v2, 2731, v1
  v_lshrrev_b32 v2, 16, v2
  v_mul_u32_u24 v3, 24, v2
  v_sub_u32 v3, v1, v3
  v_mul_u32_u24 v2, 12288, v2
  v_lshl_add_u32 v5, v3, 4, v2
  v_add_u32 v1, 128, v0
  v_mul_u32_u24 v2, 2731, v1
  v_lshrrev_b32 v2, 16, v2
  v_mul_u32_u24 v3, 24, v2
  v_sub_u32 v3, v1, v3
  v_mul_u32_u24 v2, 12288, v2
  v_lshl_add_u32 v6, v3, 4, v2
  v_lshrrev_b32 v1, 4, v0
  v_bfe_u32 v2, v0, 2, 2
  v_lshl_add_u32 v1, v1, 3, v2
  v_and_b32 v3, 3, v0
  v_mul_u32_u24 v1, 384, v1
  v_lshl_add_u32 v1, v3, 3, v1
  s_mul_i32 s5, s3, 96
  v_add_u32 v1, s5, v1
  v_add_u32 v2, 49152, v1
  v_add_u32 v3, 98304, v1
  s_lshl_b32 s5, s3, 2
  s_add_u32 s5, s5, 0
  s_mul_i32 s6, s5, 3072
  s_add_u32 s6, s6, 0
  s_mul_i32 s5, s5, 98304
  s_add_u32 s5, s5, s78
  s_add_u32 s5, s5, 0
  s_add_u32 m0, s6, 0
  s_nop 0
  buffer_load_dwordx4 v4, s[16:19], s5 offen lds
  s_add_u32 m0, s6, 1024
  s_nop 0
  buffer_load_dwordx4 v5, s[16:19], s5 offen lds
  s_add_u32 m0, s6, 2048
  s_nop 0
  buffer_load_dwordx4 v6, s[16:19], s5 offen lds
  s_lshl_b32 s5, s3, 2
  s_add_u32 s5, s5, 1
  s_mul_i32 s6, s5, 3072
  s_add_u32 s6, s6, 0
  s_mul_i32 s5, s5, 98304
  s_add_u32 s5, s5, s78
  s_add_u32 s5, s5, 0
  s_add_u32 m0, s6, 0
  s_nop 0
  buffer_load_dwordx4 v4, s[16:19], s5 offen lds
  s_add_u32 m0, s6, 1024
  s_nop 0
  buffer_load_dwordx4 v5, s[16:19], s5 offen lds
  s_add_u32 m0, s6, 2048
  s_nop 0
  buffer_load_dwordx4 v6, s[16:19], s5 offen lds
  s_lshl_b32 s5, s3, 2
  s_add_u32 s5, s5, 2
  s_mul_i32 s6, s5, 3072
  s_add_u32 s6, s6, 0
  s_mul_i32 s5, s5, 98304
  s_add_u32 s5, s5, s78
  s_add_u32 s5, s5, 0
  s_add_u32 m0, s6, 0
  s_nop 0
  buffer_load_dwordx4 v4, s[16:19], s5 offen lds
  s_add_u32 m0, s6, 1024
  s_nop 0
  buffer_load_dwordx4 v5, s[16:19], s5 offen lds
  s_add_u32 m0, s6, 2048
  s_nop 0
  buffer_load_dwordx4 v6, s[16:19], s5 offen lds
  s_lshl_b32 s5, s3, 2
  s_add_u32 s5, s5, 3
  s_mul_i32 s6, s5, 3072
  s_add_u32 s6, s6, 0
  s_mul_i32 s5, s5, 98304
  s_add_u32 s5, s5, s78
  s_add_u32 s5, s5, 0
  s_add_u32 m0, s6, 0
  s_nop 0
  buffer_load_dwordx4 v4, s[16:19], s5 offen lds
  s_add_u32 m0, s6, 1024
  s_nop 0
  buffer_load_dwordx4 v5, s[16:19], s5 offen lds
  s_add_u32 m0, s6, 2048
  s_nop 0
  buffer_load_dwordx4 v6, s[16:19], s5 offen lds
  s_lshl_b32 s5, s3, 2
  s_add_u32 s5, s5, 0
  s_mul_i32 s6, s5, 3072
  s_add_u32 s6, s6, 49152
  s_mul_i32 s5, s5, 98304
  s_add_u32 s5, s5, s78
  s_add_u32 s5, s5, 1572864
  s_add_u32 m0, s6, 0
  s_nop 0
  buffer_load_dwordx4 v4, s[16:19], s5 offen lds
  s_add_u32 m0, s6, 1024
  s_nop 0
  buffer_load_dwordx4 v5, s[16:19], s5 offen lds
  s_add_u32 m0, s6, 2048
  s_nop 0
  buffer_load_dwordx4 v6, s[16:19], s5 offen lds
  s_lshl_b32 s5, s3, 2
  s_add_u32 s5, s5, 1
  s_mul_i32 s6, s5, 3072
  s_add_u32 s6, s6, 49152
  s_mul_i32 s5, s5, 98304
  s_add_u32 s5, s5, s78
  s_add_u32 s5, s5, 1572864
  s_add_u32 m0, s6, 0
  s_nop 0
  buffer_load_dwordx4 v4, s[16:19], s5 offen lds
  s_add_u32 m0, s6, 1024
  s_nop 0
  buffer_load_dwordx4 v5, s[16:19], s5 offen lds
  s_add_u32 m0, s6, 2048
  s_nop 0
  buffer_load_dwordx4 v6, s[16:19], s5 offen lds
  s_lshl_b32 s5, s3, 2
  s_add_u32 s5, s5, 2
  s_mul_i32 s6, s5, 3072
  s_add_u32 s6, s6, 49152
  s_mul_i32 s5, s5, 98304
  s_add_u32 s5, s5, s78
  s_add_u32 s5, s5, 1572864
  s_add_u32 m0, s6, 0
  s_nop 0
  buffer_load_dwordx4 v4, s[16:19], s5 offen lds
  s_add_u32 m0, s6, 1024
  s_nop 0
  buffer_load_dwordx4 v5, s[16:19], s5 offen lds
  s_add_u32 m0, s6, 2048
  s_nop 0
  buffer_load_dwordx4 v6, s[16:19], s5 offen lds
  s_lshl_b32 s5, s3, 2
  s_add_u32 s5, s5, 3
  s_mul_i32 s6, s5, 3072
  s_add_u32 s6, s6, 49152
  s_mul_i32 s5, s5, 98304
  s_add_u32 s5, s5, s78
  s_add_u32 s5, s5, 1572864
  s_add_u32 m0, s6, 0
  s_nop 0
  buffer_load_dwordx4 v4, s[16:19], s5 offen lds
  s_add_u32 m0, s6, 1024
  s_nop 0
  buffer_load_dwordx4 v5, s[16:19], s5 offen lds
  s_add_u32 m0, s6, 2048
  s_nop 0
  buffer_load_dwordx4 v6, s[16:19], s5 offen lds
  s_lshl_b32 s5, s3, 2
  s_add_u32 s5, s5, 0
  s_mul_i32 s6, s5, 3072
  s_add_u32 s6, s6, 98304
  s_mul_i32 s5, s5, 98304
  s_add_u32 s5, s5, s78
  s_add_u32 s5, s5, 3145728
  s_add_u32 m0, s6, 0
  s_nop 0
  buffer_load_dwordx4 v4, s[16:19], s5 offen lds
  s_add_u32 m0, s6, 1024
  s_nop 0
  buffer_load_dwordx4 v5, s[16:19], s5 offen lds
  s_add_u32 m0, s6, 2048
  s_nop 0
  buffer_load_dwordx4 v6, s[16:19], s5 offen lds
  s_lshl_b32 s5, s3, 2
  s_add_u32 s5, s5, 1
  s_mul_i32 s6, s5, 3072
  s_add_u32 s6, s6, 98304
  s_mul_i32 s5, s5, 98304
  s_add_u32 s5, s5, s78
  s_add_u32 s5, s5, 3145728
  s_add_u32 m0, s6, 0
  s_nop 0
  buffer_load_dwordx4 v4, s[16:19], s5 offen lds
  s_add_u32 m0, s6, 1024
  s_nop 0
  buffer_load_dwordx4 v5, s[16:19], s5 offen lds
  s_add_u32 m0, s6, 2048
  s_nop 0
  buffer_load_dwordx4 v6, s[16:19], s5 offen lds
  s_lshl_b32 s5, s3, 2
  s_add_u32 s5, s5, 2
  s_mul_i32 s6, s5, 3072
  s_add_u32 s6, s6, 98304
  s_mul_i32 s5, s5, 98304
  s_add_u32 s5, s5, s78
  s_add_u32 s5, s5, 3145728
  s_add_u32 m0, s6, 0
  s_nop 0
  buffer_load_dwordx4 v4, s[16:19], s5 offen lds
  s_add_u32 m0, s6, 1024
  s_nop 0
  buffer_load_dwordx4 v5, s[16:19], s5 offen lds
  s_add_u32 m0, s6, 2048
  s_nop 0
  buffer_load_dwordx4 v6, s[16:19], s5 offen lds
  s_lshl_b32 s5, s3, 2
  s_add_u32 s5, s5, 3
  s_mul_i32 s6, s5, 3072
  s_add_u32 s6, s6, 98304
  s_mul_i32 s5, s5, 98304
  s_add_u32 s5, s5, s78
  s_add_u32 s5, s5, 3145728
  s_add_u32 m0, s6, 0
  s_nop 0
  buffer_load_dwordx4 v4, s[16:19], s5 offen lds
  s_add_u32 m0, s6, 1024
  s_nop 0
  buffer_load_dwordx4 v5, s[16:19], s5 offen lds
  s_add_u32 m0, s6, 2048
  s_nop 0
  buffer_load_dwordx4 v6, s[16:19], s5 offen lds
  s_waitcnt vmcnt(24)
  s_barrier
  ds_read_b64_tr_b16 a[0:1], v1 offset:0
  ds_read_b64_tr_b16 a[2:3], v1 offset:1536
  ds_read_b64_tr_b16 a[4:5], v1 offset:12288
  ds_read_b64_tr_b16 a[6:7], v1 offset:13824
  ds_read_b64_tr_b16 a[8:9], v1 offset:24576
  ds_read_b64_tr_b16 a[10:11], v1 offset:26112
  ds_read_b64_tr_b16 a[12:13], v1 offset:36864
  ds_read_b64_tr_b16 a[14:15], v1 offset:38400
  ds_read_b64_tr_b16 a[80:81], v1 offset:32
  ds_read_b64_tr_b16 a[82:83], v1 offset:1568
  ds_read_b64_tr_b16 a[84:85], v1 offset:12320
  ds_read_b64_tr_b16 a[86:87], v1 offset:13856
  s_waitcnt lgkmcnt(4)
  ds_read_b64_tr_b16 a[88:89], v1 offset:24608
  ds_read_b64_tr_b16 a[90:91], v1 offset:26144
  ds_read_b64_tr_b16 a[92:93], v1 offset:36896
  ds_read_b64_tr_b16 a[94:95], v1 offset:38432
  ds_read_b64_tr_b16 a[160:161], v1 offset:64
  ds_read_b64_tr_b16 a[162:163], v1 offset:1600
  ds_read_b64_tr_b16 a[164:165], v1 offset:12352
  ds_read_b64_tr_b16 a[166:167], v1 offset:13888
  ds_read_b64_tr_b16 a[168:169], v1 offset:24640
  ds_read_b64_tr_b16 a[170:171], v1 offset:26176
  ds_read_b64_tr_b16 a[172:173], v1 offset:36928
  ds_read_b64_tr_b16 a[174:175], v1 offset:38464
  s_waitcnt lgkmcnt(0)
  s_barrier
  s_lshl_b32 s5, s3, 2
  s_add_u32 s5, s5, 0
  s_mul_i32 s6, s5, 3072
  s_add_u32 s6, s6, 0
  s_mul_i32 s5, s5, 98304
  s_add_u32 s5, s5, s78
  s_add_u32 s5, s5, 4718592
  s_add_u32 m0, s6, 0
  s_nop 0
  buffer_load_dwordx4 v4, s[16:19], s5 offen lds
  s_add_u32 m0, s6, 1024
  s_nop 0
  buffer_load_dwordx4 v5, s[16:19], s5 offen lds
  s_add_u32 m0, s6, 2048
  s_nop 0
  buffer_load_dwordx4 v6, s[16:19], s5 offen lds
  s_lshl_b32 s5, s3, 2
  s_add_u32 s5, s5, 1
  s_mul_i32 s6, s5, 3072
  s_add_u32 s6, s6, 0
  s_mul_i32 s5, s5, 98304
  s_add_u32 s5, s5, s78
  s_add_u32 s5, s5, 4718592
  s_add_u32 m0, s6, 0
  s_nop 0
  buffer_load_dwordx4 v4, s[16:19], s5 offen lds
  s_add_u32 m0, s6, 1024
  s_nop 0
  buffer_load_dwordx4 v5, s[16:19], s5 offen lds
  s_add_u32 m0, s6, 2048
  s_nop 0
  buffer_load_dwordx4 v6, s[16:19], s5 offen lds
  s_lshl_b32 s5, s3, 2
  s_add_u32 s5, s5, 2
  s_mul_i32 s6, s5, 3072
  s_add_u32 s6, s6, 0
  s_mul_i32 s5, s5, 98304
  s_add_u32 s5, s5, s78
  s_add_u32 s5, s5, 4718592
  s_add_u32 m0, s6, 0
  s_nop 0
  buffer_load_dwordx4 v4, s[16:19], s5 offen lds
  s_add_u32 m0, s6, 1024
  s_nop 0
  buffer_load_dwordx4 v5, s[16:19], s5 offen lds
  s_add_u32 m0, s6, 2048
  s_nop 0
  buffer_load_dwordx4 v6, s[16:19], s5 offen lds
  s_lshl_b32 s5, s3, 2
  s_add_u32 s5, s5, 3
  s_mul_i32 s6, s5, 3072
  s_add_u32 s6, s6, 0
  s_mul_i32 s5, s5, 98304
  s_add_u32 s5, s5, s78
  s_add_u32 s5, s5, 4718592
  s_add_u32 m0, s6, 0
  s_nop 0
  buffer_load_dwordx4 v4, s[16:19], s5 offen lds
  s_add_u32 m0, s6, 1024
  s_nop 0
  buffer_load_dwordx4 v5, s[16:19], s5 offen lds
  s_add_u32 m0, s6, 2048
  s_nop 0
  buffer_load_dwordx4 v6, s[16:19], s5 offen lds
  s_waitcnt vmcnt(24)
  s_barrier
  ds_read_b64_tr_b16 a[16:17], v2 offset:0
  ds_read_b64_tr_b16 a[18:19], v2 offset:1536
  ds_read_b64_tr_b16 a[20:21], v2 offset:12288
  ds_read_b64_tr_b16 a[22:23], v2 offset:13824
  ds_read_b64_tr_b16 a[24:25], v2 offset:24576
  ds_read_b64_tr_b16 a[26:27], v2 offset:26112
  ds_read_b64_tr_b16 a[28:29], v2 offset:36864
  ds_read_b64_tr_b16 a[30:31], v2 offset:38400
  ds_read_b64_tr_b16 a[96:97], v2 offset:32
  ds_read_b64_tr_b16 a[98:99], v2 offset:1568
  ds_read_b64_tr_b16 a[100:101], v2 offset:12320
  ds_read_b64_tr_b16 a[102:103], v2 offset:13856
  s_waitcnt lgkmcnt(4)
  ds_read_b64_tr_b16 a[104:105], v2 offset:24608
  ds_read_b64_tr_b16 a[106:107], v2 offset:26144
  ds_read_b64_tr_b16 a[108:109], v2 offset:36896
  ds_read_b64_tr_b16 a[110:111], v2 offset:38432
  ds_read_b64_tr_b16 a[176:177], v2 offset:64
  ds_read_b64_tr_b16 a[178:179], v2 offset:1600
  ds_read_b64_tr_b16 a[180:181], v2 offset:12352
  ds_read_b64_tr_b16 a[182:183], v2 offset:13888
  ds_read_b64_tr_b16 a[184:185], v2 offset:24640
  ds_read_b64_tr_b16 a[186:187], v2 offset:26176
  ds_read_b64_tr_b16 a[188:189], v2 offset:36928
  ds_read_b64_tr_b16 a[190:191], v2 offset:38464
  s_waitcnt lgkmcnt(0)
  s_barrier
  s_lshl_b32 s5, s3, 2
  s_add_u32 s5, s5, 0
  s_mul_i32 s6, s5, 3072
  s_add_u32 s6, s6, 49152
  s_mul_i32 s5, s5, 98304
  s_add_u32 s5, s5, s78
  s_add_u32 s5, s5, 6291456
  s_add_u32 m0, s6, 0
  s_nop 0
  buffer_load_dwordx4 v4, s[16:19], s5 offen lds
  s_add_u32 m0, s6, 1024
  s_nop 0
  buffer_load_dwordx4 v5, s[16:19], s5 offen lds
  s_add_u32 m0, s6, 2048
  s_nop 0
  buffer_load_dwordx4 v6, s[16:19], s5 offen lds
  s_lshl_b32 s5, s3, 2
  s_add_u32 s5, s5, 1
  s_mul_i32 s6, s5, 3072
  s_add_u32 s6, s6, 49152
  s_mul_i32 s5, s5, 98304
  s_add_u32 s5, s5, s78
  s_add_u32 s5, s5, 6291456
  s_add_u32 m0, s6, 0
  s_nop 0
  buffer_load_dwordx4 v4, s[16:19], s5 offen lds
  s_add_u32 m0, s6, 1024
  s_nop 0
  buffer_load_dwordx4 v5, s[16:19], s5 offen lds
  s_add_u32 m0, s6, 2048
  s_nop 0
  buffer_load_dwordx4 v6, s[16:19], s5 offen lds
  s_lshl_b32 s5, s3, 2
  s_add_u32 s5, s5, 2
  s_mul_i32 s6, s5, 3072
  s_add_u32 s6, s6, 49152
  s_mul_i32 s5, s5, 98304
  s_add_u32 s5, s5, s78
  s_add_u32 s5, s5, 6291456
  s_add_u32 m0, s6, 0
  s_nop 0
  buffer_load_dwordx4 v4, s[16:19], s5 offen lds
  s_add_u32 m0, s6, 1024
  s_nop 0
  buffer_load_dwordx4 v5, s[16:19], s5 offen lds
  s_add_u32 m0, s6, 2048
  s_nop 0
  buffer_load_dwordx4 v6, s[16:19], s5 offen lds
  s_lshl_b32 s5, s3, 2
  s_add_u32 s5, s5, 3
  s_mul_i32 s6, s5, 3072
  s_add_u32 s6, s6, 49152
  s_mul_i32 s5, s5, 98304
  s_add_u32 s5, s5, s78
  s_add_u32 s5, s5, 6291456
  s_add_u32 m0, s6, 0
  s_nop 0
  buffer_load_dwordx4 v4, s[16:19], s5 offen lds
  s_add_u32 m0, s6, 1024
  s_nop 0
  buffer_load_dwordx4 v5, s[16:19], s5 offen lds
  s_add_u32 m0, s6, 2048
  s_nop 0
  buffer_load_dwordx4 v6, s[16:19], s5 offen lds
  s_waitcnt vmcnt(24)
  s_barrier
  ds_read_b64_tr_b16 a[32:33], v3 offset:0
  ds_read_b64_tr_b16 a[34:35], v3 offset:1536
  ds_read_b64_tr_b16 a[36:37], v3 offset:12288
  ds_read_b64_tr_b16 a[38:39], v3 offset:13824
  ds_read_b64_tr_b16 a[40:41], v3 offset:24576
  ds_read_b64_tr_b16 a[42:43], v3 offset:26112
  ds_read_b64_tr_b16 a[44:45], v3 offset:36864
  ds_read_b64_tr_b16 a[46:47], v3 offset:38400
  ds_read_b64_tr_b16 a[112:113], v3 offset:32
  ds_read_b64_tr_b16 a[114:115], v3 offset:1568
  ds_read_b64_tr_b16 a[116:117], v3 offset:12320
  ds_read_b64_tr_b16 a[118:119], v3 offset:13856
  s_waitcnt lgkmcnt(4)
  ds_read_b64_tr_b16 a[120:121], v3 offset:24608
  ds_read_b64_tr_b16 a[122:123], v3 offset:26144
  ds_read_b64_tr_b16 a[124:125], v3 offset:36896
  ds_read_b64_tr_b16 a[126:127], v3 offset:38432
  ds_read_b64_tr_b16 a[192:193], v3 offset:64
  ds_read_b64_tr_b16 a[194:195], v3 offset:1600
  ds_read_b64_tr_b16 a[196:197], v3 offset:12352
  ds_read_b64_tr_b16 a[198:199], v3 offset:13888
  ds_read_b64_tr_b16 a[200:201], v3 offset:24640
  ds_read_b64_tr_b16 a[202:203], v3 offset:26176
  ds_read_b64_tr_b16 a[204:205], v3 offset:36928
  ds_read_b64_tr_b16 a[206:207], v3 offset:38464
  s_waitcnt vmcnt(12)
  s_barrier
  ds_read_b64_tr_b16 a[48:49], v1 offset:0
  ds_read_b64_tr_b16 a[50:51], v1 offset:1536
  ds_read_b64_tr_b16 a[52:53], v1 offset:12288
  ds_read_b64_tr_b16 a[54:55], v1 offset:13824
  ds_read_b64_tr_b16 a[56:57], v1 offset:24576
  ds_read_b64_tr_b16 a[58:59], v1 offset:26112
  ds_read_b64_tr_b16 a[60:61], v1 offset:36864
  ds_read_b64_tr_b16 a[62:63], v1 offset:38400
  ds_read_b64_tr_b16 a[128:129], v1 offset:32
  ds_read_b64_tr_b16 a[130:131], v1 offset:1568
  ds_read_b64_tr_b16 a[132:133], v1 offset:12320
  ds_read_b64_tr_b16 a[134:135], v1 offset:13856
  s_waitcnt lgkmcnt(4)
  ds_read_b64_tr_b16 a[136:137], v1 offset:24608
  ds_read_b64_tr_b16 a[138:139], v1 offset:26144
  ds_read_b64_tr_b16 a[140:141], v1 offset:36896
  ds_read_b64_tr_b16 a[142:143], v1 offset:38432
  ds_read_b64_tr_b16 a[208:209], v1 offset:64
  ds_read_b64_tr_b16 a[210:211], v1 offset:1600
  ds_read_b64_tr_b16 a[212:213], v1 offset:12352
  ds_read_b64_tr_b16 a[214:215], v1 offset:13888
  ds_read_b64_tr_b16 a[216:217], v1 offset:24640
  ds_read_b64_tr_b16 a[218:219], v1 offset:26176
  ds_read_b64_tr_b16 a[220:221], v1 offset:36928
  ds_read_b64_tr_b16 a[222:223], v1 offset:38464
  s_waitcnt vmcnt(0)
  s_barrier
  ds_read_b64_tr_b16 a[64:65], v2 offset:0
  ds_read_b64_tr_b16 a[66:67], v2 offset:1536
  ds_read_b64_tr_b16 a[68:69], v2 offset:12288
  ds_read_b64_tr_b16 a[70:71], v2 offset:13824
  ds_read_b64_tr_b16 a[72:73], v2 offset:24576
  ds_read_b64_tr_b16 a[74:75], v2 offset:26112
  ds_read_b64_tr_b16 a[76:77], v2 offset:36864
  ds_read_b64_tr_b16 a[78:79], v2 offset:38400
  ds_read_b64_tr_b16 a[144:145], v2 offset:32
  ds_read_b64_tr_b16 a[146:147], v2 offset:1568
  ds_read_b64_tr_b16 a[148:149], v2 offset:12320
  ds_read_b64_tr_b16 a[150:151], v2 offset:13856
  s_waitcnt lgkmcnt(4)
  ds_read_b64_tr_b16 a[152:153], v2 offset:24608
  ds_read_b64_tr_b16 a[154:155], v2 offset:26144
  ds_read_b64_tr_b16 a[156:157], v2 offset:36896
  ds_read_b64_tr_b16 a[158:159], v2 offset:38432
  ds_read_b64_tr_b16 a[224:225], v2 offset:64
  ds_read_b64_tr_b16 a[226:227], v2 offset:1600
  ds_read_b64_tr_b16 a[228:229], v2 offset:12352
  ds_read_b64_tr_b16 a[230:231], v2 offset:13888
  ds_read_b64_tr_b16 a[232:233], v2 offset:24640
  ds_read_b64_tr_b16 a[234:235], v2 offset:26176
  ds_read_b64_tr_b16 a[236:237], v2 offset:36928
  ds_read_b64_tr_b16 a[238:239], v2 offset:38464
  s_waitcnt lgkmcnt(0)
  s_barrier
  v_mbcnt_lo_u32_b32 v0, -1, 0
  v_mbcnt_hi_u32_b32 v0, -1, v0
  v_lshlrev_b32 v28, 4, v0
  s_lshl_b32 s84, s79, 1
  s_lshr_b32 s5, s3, 1
  s_add_u32 s84, s84, s5
  s_mul_i32 s84, s84, 20480
  s_and_b32 s5, s3, 1
  s_mul_i32 s5, s5, 5120
  s_add_u32 s84, s84, s5
  s_add_u32 s84, s84, 2097152
  s_mul_i32 s93, s91, 40960
  s_sub_u32 s93, s93, 10240
  s_mul_i32 s92, s3, 5120
  s_mov_b32 s85, 0
  s_mov_b32 s86, 20480
  s_mov_b32 s87, 40960
  s_mov_b32 s94, 61440
  v_mov_b32 v31, v28
  s_add_u32 s88, s85, s92
  s_mov_b32 m0, s88
  s_nop 0
  buffer_load_dwordx4 v28, s[8:11], s84 offen offset:0 lds
  buffer_load_dwordx4 v28, s[8:11], s84 offen offset:1024 lds
  buffer_load_dwordx4 v28, s[8:11], s84 offen offset:2048 lds
  buffer_load_dwordx4 v28, s[8:11], s84 offen offset:3072 lds
  s_add_u32 m0, s88, 4096
  s_add_u32 s89, s84, 4096
  buffer_load_dwordx4 v28, s[8:11], s89 offen offset:0 lds
  s_add_u32 s84, s84, 10240
  s_add_u32 s88, s86, s92
  s_mov_b32 m0, s88
  s_nop 0
  buffer_load_dwordx4 v28, s[8:11], s84 offen offset:0 lds
  buffer_load_dwordx4 v28, s[8:11], s84 offen offset:1024 lds
  buffer_load_dwordx4 v28, s[8:11], s84 offen offset:2048 lds
  buffer_load_dwordx4 v28, s[8:11], s84 offen offset:3072 lds
  s_add_u32 m0, s88, 4096
  s_add_u32 s89, s84, 4096
  buffer_load_dwordx4 v28, s[8:11], s89 offen offset:0 lds
  s_add_u32 s84, s84, s93
  s_add_u32 s88, s87, s92
  s_mov_b32 m0, s88
  s_nop 0
  buffer_load_dwordx4 v28, s[8:11], s84 offen offset:0 lds
  buffer_load_dwordx4 v28, s[8:11], s84 offen offset:1024 lds
  buffer_load_dwordx4 v28, s[8:11], s84 offen offset:2048 lds
  buffer_load_dwordx4 v28, s[8:11], s84 offen offset:3072 lds
  s_add_u32 m0, s88, 4096
  s_add_u32 s89, s84, 4096
  buffer_load_dwordx4 v28, s[8:11], s89 offen offset:0 lds
  s_add_u32 s84, s84, 10240
  s_waitcnt vmcnt(5)
  s_barrier
  s_mov_b32 s90, 0
  v_add_u32 v26, s85, v28
  v_add_u32 v27, s86, v28
  ds_read_b128 v[64:67], v26 offset:0
  ds_read_b128 v[68:71], v26 offset:10240
  ds_read_b128 v[72:75], v26 offset:1024
  ds_read_b128 v[76:79], v26 offset:11264
L_w1_27:
  ds_read_b128 v[80:83], v26 offset:2048
  ds_read_b128 v[84:87], v26 offset:12288
  s_waitcnt lgkmcnt(4)
  v_mfma_f32_16x16x32_bf16 v[32:35], a[0:3], v[64:67], 0
  v_mfma_f32_16x16x32_bf16 v[44:47], a[0:3], v[68:71], 0
  v_mfma_f32_16x16x32_bf16 v[36:39], a[80:83], v[64:67], 0
  v_mfma_f32_16x16x32_bf16 v[48:51], a[80:83], v[68:71], 0
  v_mfma_f32_16x16x32_bf16 v[40:43], a[160:163], v[64:67], 0
  v_mfma_f32_16x16x32_bf16 v[52:55], a[160:163], v[68:71], 0
  ds_read_b128 v[88:91], v26 offset:3072
  ds_read_b128 v[92:95], v26 offset:13312
  s_waitcnt lgkmcnt(4)
  v_mfma_f32_16x16x32_bf16 v[32:35], a[4:7], v[72:75], v[32:35]
  v_mfma_f32_16x16x32_bf16 v[44:47], a[4:7], v[76:79], v[44:47]
  v_mfma_f32_16x16x32_bf16 v[36:39], a[84:87], v[72:75], v[36:39]
  v_mfma_f32_16x16x32_bf16 v[48:51], a[84:87], v[76:79], v[48:51]
  v_mfma_f32_16x16x32_bf16 v[40:43], a[164:167], v[72:75], v[40:43]
  v_mfma_f32_16x16x32_bf16 v[52:55], a[164:167], v[76:79], v[52:55]
  ds_read_b128 v[64:67], v26 offset:4096
  ds_read_b128 v[68:71], v26 offset:14336
  s_waitcnt lgkmcnt(4)
  v_mfma_f32_16x16x32_bf16 v[32:35], a[8:11], v[80:83], v[32:35]
  v_mfma_f32_16x16x32_bf16 v[44:47], a[8:11], v[84:87], v[44:47]
  v_mfma_f32_16x16x32_bf16 v[36:39], a[88:91], v[80:83], v[36:39]
  v_mfma_f32_16x16x32_bf16 v[48:51], a[88:91], v[84:87], v[48:51]
  v_mfma_f32_16x16x32_bf16 v[40:43], a[168:171], v[80:83], v[40:43]
  v_mfma_f32_16x16x32_bf16 v[52:55], a[168:171], v[84:87], v[52:55]
  ds_read_b128 v[72:75], v26 offset:5120
  ds_read_b128 v[76:79], v26 offset:15360
  s_waitcnt lgkmcnt(4)
  v_mfma_f32_16x16x32_bf16 v[32:35], a[12:15], v[88:91], v[32:35]
  v_mfma_f32_16x16x32_bf16 v[44:47], a[12:15], v[92:95], v[44:47]
  v_mfma_f32_16x16x32_bf16 v[36:39], a[92:95], v[88:91], v[36:39]
  v_mfma_f32_16x16x32_bf16 v[48:51], a[92:95], v[92:95], v[48:51]
  v_mfma_f32_16x16x32_bf16 v[40:43], a[172:175], v[88:91], v[40:43]
  v_mfma_f32_16x16x32_bf16 v[52:55], a[172:175], v[92:95], v[52:55]
  ds_read_b128 v[80:83], v26 offset:6144
  ds_read_b128 v[84:87], v26 offset:16384
  s_waitcnt lgkmcnt(4)
  v_mfma_f32_16x16x32_bf16 v[32:35], a[16:19], v[64:67], v[32:35]
  v_mfma_f32_16x16x32_bf16 v[44:47], a[16:19], v[68:71], v[44:47]
  v_mfma_f32_16x16x32_bf16 v[36:39], a[96:99], v[64:67], v[36:39]
  v_mfma_f32_16x16x32_bf16 v[48:51], a[96:99], v[68:71], v[48:51]
  v_mfma_f32_16x16x32_bf16 v[40:43], a[176:179], v[64:67], v[40:43]
  v_mfma_f32_16x16x32_bf16 v[52:55], a[176:179], v[68:71], v[52:55]
  s_waitcnt vmcnt(8)
  s_barrier
  ds_read_b128 v[88:91], v26 offset:7168
  ds_read_b128 v[92:95], v26 offset:17408
  s_waitcnt lgkmcnt(4)
  v_mfma_f32_16x16x32_bf16 v[32:35], a[20:23], v[72:75], v[32:35]
  v_mfma_f32_16x16x32_bf16 v[44:47], a[20:23], v[76:79], v[44:47]
  s_add_u32 s88, s94, s92
  s_mov_b32 m0, s88
  s_nop 0
  buffer_load_dwordx4 v28, s[8:11], s84 offen offset:0 lds
  v_mfma_f32_16x16x32_bf16 v[36:39], a[100:103], v[72:75], v[36:39]
  v_mfma_f32_16x16x32_bf16 v[48:51], a[100:103], v[76:79], v[48:51]
  v_mfma_f32_16x16x32_bf16 v[40:43], a[180:183], v[72:75], v[40:43]
  v_mfma_f32_16x16x32_bf16 v[52:55], a[180:183], v[76:79], v[52:55]
  ds_read_b128 v[64:67], v26 offset:8192
  ds_read_b128 v[68:71], v26 offset:18432
  s_waitcnt lgkmcnt(4)
  v_mfma_f32_16x16x32_bf16 v[32:35], a[24:27], v[80:83], v[32:35]
  v_mfma_f32_16x16x32_bf16 v[44:47], a[24:27], v[84:87], v[44:47]
  buffer_load_dwordx4 v28, s[8:11], s84 offen offset:1024 lds
  v_mfma_f32_16x16x32_bf16 v[36:39], a[104:107], v[80:83], v[36:39]
  v_mfma_f32_16x16x32_bf16 v[48:51], a[104:107], v[84:87], v[48:51]
  v_mfma_f32_16x16x32_bf16 v[40:43], a[184:187], v[80:83], v[40:43]
  v_mfma_f32_16x16x32_bf16 v[52:55], a[184:187], v[84:87], v[52:55]
  ds_read_b128 v[72:75], v26 offset:9216
  ds_read_b128 v[76:79], v26 offset:19456
  s_waitcnt lgkmcnt(4)
  v_mfma_f32_16x16x32_bf16 v[32:35], a[28:31], v[88:91], v[32:35]
  v_mfma_f32_16x16x32_bf16 v[44:47], a[28:31], v[92:95], v[44:47]
  buffer_load_dwordx4 v28, s[8:11], s84 offen offset:2048 lds
  v_mfma_f32_16x16x32_bf16 v[36:39], a[108:111], v[88:91], v[36:39]
  v_mfma_f32_16x16x32_bf16 v[48:51], a[108:111], v[92:95], v[48:51]
  v_mfma_f32_16x16x32_bf16 v[40:43], a[188:191], v[88:91], v[40:43]
  v_mfma_f32_16x16x32_bf16 v[52:55], a[188:191], v[92:95], v[52:55]
  ds_read_b128 v[80:83], v27 offset:0
  ds_read_b128 v[84:87], v27 offset:10240
  s_waitcnt lgkmcnt(4)
  v_mfma_f32_16x16x32_bf16 v[32:35], a[32:35], v[64:67], v[32:35]
  v_mfma_f32_16x16x32_bf16 v[44:47], a[32:35], v[68:71], v[44:47]
  buffer_load_dwordx4 v28, s[8:11], s84 offen offset:3072 lds
  v_mfma_f32_16x16x32_bf16 v[36:39], a[112:115], v[64:67], v[36:39]
  v_mfma_f32_16x16x32_bf16 v[48:51], a[112:115], v[68:71], v[48:51]
  v_mfma_f32_16x16x32_bf16 v[40:43], a[192:195], v[64:67], v[40:43]
  v_mfma_f32_16x16x32_bf16 v[52:55], a[192:195], v[68:71], v[52:55]
  ds_read_b128 v[88:91], v27 offset:1024
  ds_read_b128 v[92:95], v27 offset:11264
  s_waitcnt lgkmcnt(4)
  v_mfma_f32_16x16x32_bf16 v[32:35], a[36:39], v[72:75], v[32:35]
  v_mfma_f32_16x16x32_bf16 v[44:47], a[36:39], v[76:79], v[44:47]
  s_add_u32 m0, s88, 4096
  s_add_u32 s89, s84, 4096
  buffer_load_dwordx4 v28, s[8:11], s89 offen offset:0 lds
  v_mfma_f32_16x16x32_bf16 v[36:39], a[116:119], v[72:75], v[36:39]
  v_mfma_f32_16x16x32_bf16 v[48:51], a[116:119], v[76:79], v[48:51]
  v_mfma_f32_16x16x32_bf16 v[40:43], a[196:199], v[72:75], v[40:43]
  v_mfma_f32_16x16x32_bf16 v[52:55], a[196:199], v[76:79], v[52:55]
  s_add_u32 s84, s84, s93
  s_mov_b32 s5, s85
  s_mov_b32 s85, s86
  s_mov_b32 s86, s87
  s_mov_b32 s87, s94
  s_mov_b32 s94, s5
  v_mov_b32 v26, v27
  v_add_u32 v27, s86, v28
  ds_read_b128 v[64:67], v26 offset:2048
  ds_read_b128 v[68:71], v26 offset:12288
  s_waitcnt lgkmcnt(4)
  v_mfma_f32_16x16x32_bf16 v[32:35], a[40:43], v[80:83], v[32:35]
  v_mfma_f32_16x16x32_bf16 v[44:47], a[40:43], v[84:87], v[44:47]
  v_mfma_f32_16x16x32_bf16 v[36:39], a[120:123], v[80:83], v[36:39]
  v_mfma_f32_16x16x32_bf16 v[48:51], a[120:123], v[84:87], v[48:51]
  v_mfma_f32_16x16x32_bf16 v[40:43], a[200:203], v[80:83], v[40:43]
  v_mfma_f32_16x16x32_bf16 v[52:55], a[200:203], v[84:87], v[52:55]
  ds_read_b128 v[72:75], v26 offset:3072
  ds_read_b128 v[76:79], v26 offset:13312
  s_waitcnt lgkmcnt(4)
  v_mfma_f32_16x16x32_bf16 v[32:35], a[44:47], v[88:91], v[32:35]
  v_mfma_f32_16x16x32_bf16 v[44:47], a[44:47], v[92:95], v[44:47]
  v_mfma_f32_16x16x32_bf16 v[36:39], a[124:127], v[88:91], v[36:39]
  v_mfma_f32_16x16x32_bf16 v[48:51], a[124:127], v[92:95], v[48:51]
  v_mfma_f32_16x16x32_bf16 v[40:43], a[204:207], v[88:91], v[40:43]
  v_mfma_f32_16x16x32_bf16 v[52:55], a[204:207], v[92:95], v[52:55]
  ds_read_b128 v[80:83], v26 offset:4096
  ds_read_b128 v[84:87], v26 offset:14336
  s_waitcnt lgkmcnt(4)
  v_mfma_f32_16x16x32_bf16 v[32:35], a[48:51], v[64:67], v[32:35]
  v_mfma_f32_16x16x32_bf16 v[44:47], a[48:51], v[68:71], v[44:47]
  v_mfma_f32_16x16x32_bf16 v[36:39], a[128:131], v[64:67], v[36:39]
  v_mfma_f32_16x16x32_bf16 v[48:51], a[128:131], v[68:71], v[48:51]
  v_mfma_f32_16x16x32_bf16 v[40:43], a[208:211], v[64:67], v[40:43]
  v_mfma_f32_16x16x32_bf16 v[52:55], a[208:211], v[68:71], v[52:55]
  ds_read_b128 v[88:91], v26 offset:5120
  ds_read_b128 v[92:95], v26 offset:15360
  s_waitcnt lgkmcnt(4)
  v_mfma_f32_16x16x32_bf16 v[32:35], a[52:55], v[72:75], v[32:35]
  v_mfma_f32_16x16x32_bf16 v[44:47], a[52:55], v[76:79], v[44:47]
  v_mfma_f32_16x16x32_bf16 v[36:39], a[132:135], v[72:75], v[36:39]
  v_mfma_f32_16x16x32_bf16 v[48:51], a[132:135], v[76:79], v[48:51]
  v_mfma_f32_16x16x32_bf16 v[40:43], a[212:215], v[72:75], v[40:43]
  v_mfma_f32_16x16x32_bf16 v[52:55], a[212:215], v[76:79], v[52:55]
  ds_read_b128 v[64:67], v26 offset:6144
  ds_read_b128 v[68:71], v26 offset:16384
  s_waitcnt lgkmcnt(4)
  v_mfma_f32_16x16x32_bf16 v[32:35], a[56:59], v[80:83], v[32:35]
  v_mfma_f32_16x16x32_bf16 v[44:47], a[56:59], v[84:87], v[44:47]
  v_mfma_f32_16x16x32_bf16 v[36:39], a[136:139], v[80:83], v[36:39]
  v_mfma_f32_16x16x32_bf16 v[48:51], a[136:139], v[84:87], v[48:51]
  v_mfma_f32_16x16x32_bf16 v[40:43], a[216:219], v[80:83], v[40:43]
  v_mfma_f32_16x16x32_bf16 v[52:55], a[216:219], v[84:87], v[52:55]
  s_waitcnt vmcnt(5)
  s_barrier
  ds_read_b128 v[72:75], v26 offset:7168
  ds_read_b128 v[76:79], v26 offset:17408
  s_waitcnt lgkmcnt(4)
  v_mfma_f32_16x16x32_bf16 v[32:35], a[60:63], v[88:91], v[32:35]
  v_mfma_f32_16x16x32_bf16 v[44:47], a[60:63], v[92:95], v[44:47]
  s_add_u32 s88, s94, s92
  s_mov_b32 m0, s88
  s_nop 0
  buffer_load_dwordx4 v28, s[8:11], s84 offen offset:0 lds
  v_mfma_f32_16x16x32_bf16 v[36:39], a[140:143], v[88:91], v[36:39]
  v_mfma_f32_16x16x32_bf16 v[48:51], a[140:143], v[92:95], v[48:51]
  v_mfma_f32_16x16x32_bf16 v[40:43], a[220:223], v[88:91], v[40:43]
  v_mfma_f32_16x16x32_bf16 v[52:55], a[220:223], v[92:95], v[52:55]
  ds_read_b128 v[80:83], v26 offset:8192
  ds_read_b128 v[84:87], v26 offset:18432
  s_waitcnt lgkmcnt(4)
  v_mfma_f32_16x16x32_bf16 v[32:35], a[64:67], v[64:67], v[32:35]
  v_mfma_f32_16x16x32_bf16 v[44:47], a[64:67], v[68:71], v[44:47]
  buffer_load_dwordx4 v28, s[8:11], s84 offen offset:1024 lds
  v_mfma_f32_16x16x32_bf16 v[36:39], a[144:147], v[64:67], v[36:39]
  v_mfma_f32_16x16x32_bf16 v[48:51], a[144:147], v[68:71], v[48:51]
  v_mfma_f32_16x16x32_bf16 v[40:43], a[224:227], v[64:67], v[40:43]
  v_mfma_f32_16x16x32_bf16 v[52:55], a[224:227], v[68:71], v[52:55]
  ds_read_b128 v[88:91], v26 offset:9216
  ds_read_b128 v[92:95], v26 offset:19456
  s_waitcnt lgkmcnt(4)
  v_mfma_f32_16x16x32_bf16 v[32:35], a[68:71], v[72:75], v[32:35]
  v_mfma_f32_16x16x32_bf16 v[44:47], a[68:71], v[76:79], v[44:47]
  buffer_load_dwordx4 v28, s[8:11], s84 offen offset:2048 lds
  v_mfma_f32_16x16x32_bf16 v[36:39], a[148:151], v[72:75], v[36:39]
  v_mfma_f32_16x16x32_bf16 v[48:51], a[148:151], v[76:79], v[48:51]
  v_mfma_f32_16x16x32_bf16 v[40:43], a[228:231], v[72:75], v[40:43]
  v_mfma_f32_16x16x32_bf16 v[52:55], a[228:231], v[76:79], v[52:55]
  ds_read_b128 v[64:67], v27 offset:0
  ds_read_b128 v[68:71], v27 offset:10240
  s_waitcnt lgkmcnt(4)
  v_mfma_f32_16x16x32_bf16 v[32:35], a[72:75], v[80:83], v[32:35]
  v_mfma_f32_16x16x32_bf16 v[44:47], a[72:75], v[84:87], v[44:47]
  buffer_load_dwordx4 v28, s[8:11], s84 offen offset:3072 lds
  v_mfma_f32_16x16x32_bf16 v[36:39], a[152:155], v[80:83], v[36:39]
  v_mfma_f32_16x16x32_bf16 v[48:51], a[152:155], v[84:87], v[48:51]
  v_mfma_f32_16x16x32_bf16 v[40:43], a[232:235], v[80:83], v[40:43]
  v_mfma_f32_16x16x32_bf16 v[52:55], a[232:235], v[84:87], v[52:55]
  ds_read_b128 v[72:75], v27 offset:1024
  ds_read_b128 v[76:79], v27 offset:11264
  s_waitcnt lgkmcnt(4)
  v_mfma_f32_16x16x32_bf16 v[32:35], a[76:79], v[88:91], v[32:35]
  v_mfma_f32_16x16x32_bf16 v[44:47], a[76:79], v[92:95], v[44:47]
  s_add_u32 m0, s88, 4096
  s_add_u32 s89, s84, 4096
  buffer_load_dwordx4 v28, s[8:11], s89 offen offset:0 lds
  v_mfma_f32_16x16x32_bf16 v[36:39], a[156:159], v[88:91], v[36:39]
  v_mfma_f32_16x16x32_bf16 v[48:51], a[156:159], v[92:95], v[48:51]
  v_mfma_f32_16x16x32_bf16 v[40:43], a[236:239], v[88:91], v[40:43]
  v_mfma_f32_16x16x32_bf16 v[52:55], a[236:239], v[92:95], v[52:55]
  s_add_u32 s84, s84, 10240
  s_mov_b32 s5, s85
  s_mov_b32 s85, s86
  s_mov_b32 s86, s87
  s_mov_b32 s87, s94
  s_mov_b32 s94, s5
  v_mov_b32 v26, v27
  v_add_u32 v27, s86, v28
  v_cvt_pk_bf16_f32 v96, v32, v33
  v_cvt_pk_bf16_f32 v97, v34, v35
  v_cvt_pk_bf16_f32 v98, v44, v45
  v_cvt_pk_bf16_f32 v99, v46, v47
  buffer_store_dwordx4 v[96:99], v31, s[8:11], s81 offen offset:0
  v_cvt_pk_bf16_f32 v100, v36, v37
  v_cvt_pk_bf16_f32 v101, v38, v39
  v_cvt_pk_bf16_f32 v102, v48, v49
  v_cvt_pk_bf16_f32 v103, v50, v51
  buffer_store_dwordx4 v[100:103], v31, s[8:11], s81 offen offset:1024
  v_cvt_pk_bf16_f32 v104, v40, v41
  v_cvt_pk_bf16_f32 v105, v42, v43
  v_cvt_pk_bf16_f32 v106, v52, v53
  v_cvt_pk_bf16_f32 v107, v54, v55
  buffer_store_dwordx4 v[104:107], v31, s[8:11], s81 offen offset:2048
  s_add_u32 s81, s81, s83
  s_add_u32 s90, s90, 1
  s_cmp_lt_u32 s90, s80
  s_cbranch_scc1 L_w1_27
  s_waitcnt vmcnt(0) lgkmcnt(0)
  s_barrier
  s_branch L_w2a
L_w2g:
  v_mbcnt_lo_u32_b32 v0, -1, 0
  v_mbcnt_hi_u32_b32 v0, -1, v0
  s_mov_b32 s16, s52
  s_and_b32 s17, s53, 0xffff
  s_mov_b32 s18, 1966080
  s_mov_b32 s19, 0x20000
  v_lshlrev_b32 v240, 4, v0
  v_lshrrev_b32 v2, 4, v0
  v_bfe_u32 v3, v0, 2, 2
  v_and_b32 v4, 3, v0
  v_and_b32 v5, 15, v0
  v_lshl_add_u32 v1, v2, 3, v3
  v_mul_u32_u24 v1, 1280, v1
  v_lshl_add_u32 v1, v4, 3, v1
  s_mul_i32 s5, s3, 320
  v_add_u32 v6, s5, v1
  v_add_u32 v7, 40960, v6
  v_add_u32 v8, 81920, v6
  s_mul_i32 s82, s61, 245760
  s_mul_i32 s83, s3, 10240
  s_add_u32 s82, s82, s83
  s_add_u32 m0, s83, 0
  s_add_u32 s5, s82, 0
  buffer_load_dwordx4 v240, s[16:19], s5 offen offset:0 lds
  buffer_load_dwordx4 v240, s[16:19], s5 offen offset:1024 lds
  buffer_load_dwordx4 v240, s[16:19], s5 offen offset:2048 lds
  buffer_load_dwordx4 v240, s[16:19], s5 offen offset:3072 lds
  s_add_u32 m0, s83, 4096
  s_add_u32 s5, s82, 4096
  buffer_load_dwordx4 v240, s[16:19], s5 offen offset:0 lds
  buffer_load_dwordx4 v240, s[16:19], s5 offen offset:1024 lds
  buffer_load_dwordx4 v240, s[16:19], s5 offen offset:2048 lds
  buffer_load_dwordx4 v240, s[16:19], s5 offen offset:3072 lds
  s_add_u32 m0, s83, 8192
  s_add_u32 s5, s82, 8192
  buffer_load_dwordx4 v240, s[16:19], s5 offen offset:0 lds
  buffer_load_dwordx4 v240, s[16:19], s5 offen offset:1024 lds
  s_add_u32 m0, s83, 40960
  s_add_u32 s5, s82, 40960
  buffer_load_dwordx4 v240, s[16:19], s5 offen offset:0 lds
  buffer_load_dwordx4 v240, s[16:19], s5 offen offset:1024 lds
  buffer_load_dwordx4 v240, s[16:19], s5 offen offset:2048 lds
  buffer_load_dwordx4 v240, s[16:19], s5 offen offset:3072 lds
  s_add_u32 m0, s83, 45056
  s_add_u32 s5, s82, 45056
  buffer_load_dwordx4 v240, s[16:19], s5 offen offset:0 lds
  buffer_load_dwordx4 v240, s[16:19], s5 offen offset:1024 lds
  buffer_load_dwordx4 v240, s[16:19], s5 offen offset:2048 lds
  buffer_load_dwordx4 v240, s[16:19], s5 offen offset:3072 lds
  s_add_u32 m0, s83, 49152
  s_add_u32 s5, s82, 49152
  buffer_load_dwordx4 v240, s[16:19], s5 offen offset:0 lds
  buffer_load_dwordx4 v240, s[16:19], s5 offen offset:1024 lds
  s_add_u32 m0, s83, 81920
  s_add_u32 s5, s82, 81920
  buffer_load_dwordx4 v240, s[16:19], s5 offen offset:0 lds
  buffer_load_dwordx4 v240, s[16:19], s5 offen offset:1024 lds
  buffer_load_dwordx4 v240, s[16:19], s5 offen offset:2048 lds
  buffer_load_dwordx4 v240, s[16:19], s5 offen offset:3072 lds
  s_add_u32 m0, s83, 86016
  s_add_u32 s5, s82, 86016
  buffer_load_dwordx4 v240, s[16:19], s5 offen offset:0 lds
  buffer_load_dwordx4 v240, s[16:19], s5 offen offset:1024 lds
  buffer_load_dwordx4 v240, s[16:19], s5 offen offset:2048 lds
  buffer_load_dwordx4 v240, s[16:19], s5 offen offset:3072 lds
  s_add_u32 m0, s83, 90112
  s_add_u32 s5, s82, 90112
  buffer_load_dwordx4 v240, s[16:19], s5 offen offset:0 lds
  buffer_load_dwordx4 v240, s[16:19], s5 offen offset:1024 lds
  s_waitcnt vmcnt(20)
  s_barrier
  ds_read_b64_tr_b16 a[0:1], v6 offset:0
  ds_read_b64_tr_b16 a[2:3], v6 offset:5120
  ds_read_b64_tr_b16 a[24:25], v6 offset:32
  ds_read_b64_tr_b16 a[26:27], v6 offset:5152
  ds_read_b64_tr_b16 a[48:49], v6 offset:64
  ds_read_b64_tr_b16 a[50:51], v6 offset:5184
  ds_read_b64_tr_b16 a[72:73], v6 offset:96
  ds_read_b64_tr_b16 a[74:75], v6 offset:5216
  ds_read_b64_tr_b16 a[96:97], v6 offset:128
  ds_read_b64_tr_b16 a[98:99], v6 offset:5248
  ds_read_b64_tr_b16 a[120:121], v6 offset:160
  ds_read_b64_tr_b16 a[122:123], v6 offset:5280
  s_waitcnt lgkmcnt(4)
  ds_read_b64_tr_b16 a[144:145], v6 offset:192
  ds_read_b64_tr_b16 a[146:147], v6 offset:5312
  ds_read_b64_tr_b16 a[168:169], v6 offset:224
  ds_read_b64_tr_b16 a[170:171], v6 offset:5344
  ds_read_b64_tr_b16 a[192:193], v6 offset:256
  ds_read_b64_tr_b16 a[194:195], v6 offset:5376
  ds_read_b64_tr_b16 a[216:217], v6 offset:288
  ds_read_b64_tr_b16 a[218:219], v6 offset:5408
  s_waitcnt lgkmcnt(0)
  s_barrier
  s_add_u32 m0, s83, 0
  s_add_u32 s5, s82, 122880
  buffer_load_dwordx4 v240, s[16:19], s5 offen offset:0 lds
  buffer_load_dwordx4 v240, s[16:19], s5 offen offset:1024 lds
  buffer_load_dwordx4 v240, s[16:19], s5 offen offset:2048 lds
  buffer_load_dwordx4 v240, s[16:19], s5 offen offset:3072 lds
  s_add_u32 m0, s83, 4096
  s_add_u32 s5, s82, 126976
  buffer_load_dwordx4 v240, s[16:19], s5 offen offset:0 lds
  buffer_load_dwordx4 v240, s[16:19], s5 offen offset:1024 lds
  buffer_load_dwordx4 v240, s[16:19], s5 offen offset:2048 lds
  buffer_load_dwordx4 v240, s[16:19], s5 offen offset:3072 lds
  s_add_u32 m0, s83, 8192
  s_add_u32 s5, s82, 131072
  buffer_load_dwordx4 v240, s[16:19], s5 offen offset:0 lds
  buffer_load_dwordx4 v240, s[16:19], s5 offen offset:1024 lds
  s_waitcnt vmcnt(20)
  s_barrier
  ds_read_b64_tr_b16 a[4:5], v7 offset:0
  ds_read_b64_tr_b16 a[6:7], v7 offset:5120
  ds_read_b64_tr_b16 a[28:29], v7 offset:32
  ds_read_b64_tr_b16 a[30:31], v7 offset:5152
  ds_read_b64_tr_b16 a[52:53], v7 offset:64
  ds_read_b64_tr_b16 a[54:55], v7 offset:5184
  ds_read_b64_tr_b16 a[76:77], v7 offset:96
  ds_read_b64_tr_b16 a[78:79], v7 offset:5216
  ds_read_b64_tr_b16 a[100:101], v7 offset:128
  ds_read_b64_tr_b16 a[102:103], v7 offset:5248
  ds_read_b64_tr_b16 a[124:125], v7 offset:160
  ds_read_b64_tr_b16 a[126:127], v7 offset:5280
  s_waitcnt lgkmcnt(4)
  ds_read_b64_tr_b16 a[148:149], v7 offset:192
  ds_read_b64_tr_b16 a[150:151], v7 offset:5312
  ds_read_b64_tr_b16 a[172:173], v7 offset:224
  ds_read_b64_tr_b16 a[174:175], v7 offset:5344
  ds_read_b64_tr_b16 a[196:197], v7 offset:256
  ds_read_b64_tr_b16 a[198:199], v7 offset:5376
  ds_read_b64_tr_b16 a[220:221], v7 offset:288
  ds_read_b64_tr_b16 a[222:223], v7 offset:5408
  s_waitcnt lgkmcnt(0)
  s_barrier
  s_add_u32 m0, s83, 40960
  s_add_u32 s5, s82, 163840
  buffer_load_dwordx4 v240, s[16:19], s5 offen offset:0 lds
  buffer_load_dwordx4 v240, s[16:19], s5 offen offset:1024 lds
  buffer_load_dwordx4 v240, s[16:19], s5 offen offset:2048 lds
  buffer_load_dwordx4 v240, s[16:19], s5 offen offset:3072 lds
  s_add_u32 m0, s83, 45056
  s_add_u32 s5, s82, 167936
  buffer_load_dwordx4 v240, s[16:19], s5 offen offset:0 lds
  buffer_load_dwordx4 v240, s[16:19], s5 offen offset:1024 lds
  buffer_load_dwordx4 v240, s[16:19], s5 offen offset:2048 lds
  buffer_load_dwordx4 v240, s[16:19], s5 offen offset:3072 lds
  s_add_u32 m0, s83, 49152
  s_add_u32 s5, s82, 172032
  buffer_load_dwordx4 v240, s[16:19], s5 offen offset:0 lds
  buffer_load_dwordx4 v240, s[16:19], s5 offen offset:1024 lds
  s_waitcnt vmcnt(20)
  s_barrier
  ds_read_b64_tr_b16 a[8:9], v8 offset:0
  ds_read_b64_tr_b16 a[10:11], v8 offset:5120
  ds_read_b64_tr_b16 a[32:33], v8 offset:32
  ds_read_b64_tr_b16 a[34:35], v8 offset:5152
  ds_read_b64_tr_b16 a[56:57], v8 offset:64
  ds_read_b64_tr_b16 a[58:59], v8 offset:5184
  ds_read_b64_tr_b16 a[80:81], v8 offset:96
  ds_read_b64_tr_b16 a[82:83], v8 offset:5216
  ds_read_b64_tr_b16 a[104:105], v8 offset:128
  ds_read_b64_tr_b16 a[106:107], v8 offset:5248
  ds_read_b64_tr_b16 a[128:129], v8 offset:160
  ds_read_b64_tr_b16 a[130:131], v8 offset:5280
  s_waitcnt lgkmcnt(4)
  ds_read_b64_tr_b16 a[152:153], v8 offset:192
  ds_read_b64_tr_b16 a[154:155], v8 offset:5312
  ds_read_b64_tr_b16 a[176:177], v8 offset:224
  ds_read_b64_tr_b16 a[178:179], v8 offset:5344
  ds_read_b64_tr_b16 a[200:201], v8 offset:256
  ds_read_b64_tr_b16 a[202:203], v8 offset:5376
  ds_read_b64_tr_b16 a[224:225], v8 offset:288
  ds_read_b64_tr_b16 a[226:227], v8 offset:5408
  s_waitcnt lgkmcnt(0)
  s_barrier
  s_add_u32 m0, s83, 81920
  s_add_u32 s5, s82, 204800
  buffer_load_dwordx4 v240, s[16:19], s5 offen offset:0 lds
  buffer_load_dwordx4 v240, s[16:19], s5 offen offset:1024 lds
  buffer_load_dwordx4 v240, s[16:19], s5 offen offset:2048 lds
  buffer_load_dwordx4 v240, s[16:19], s5 offen offset:3072 lds
  s_add_u32 m0, s83, 86016
  s_add_u32 s5, s82, 208896
  buffer_load_dwordx4 v240, s[16:19], s5 offen offset:0 lds
  buffer_load_dwordx4 v240, s[16:19], s5 offen offset:1024 lds
  buffer_load_dwordx4 v240, s[16:19], s5 offen offset:2048 lds
  buffer_load_dwordx4 v240, s[16:19], s5 offen offset:3072 lds
  s_add_u32 m0, s83, 90112
  s_add_u32 s5, s82, 212992
  buffer_load_dwordx4 v240, s[16:19], s5 offen offset:0 lds
  buffer_load_dwordx4 v240, s[16:19], s5 offen offset:1024 lds
  s_waitcnt vmcnt(20)
  s_barrier
  ds_read_b64_tr_b16 a[12:13], v6 offset:0
  ds_read_b64_tr_b16 a[14:15], v6 offset:5120
  ds_read_b64_tr_b16 a[36:37], v6 offset:32
  ds_read_b64_tr_b16 a[38:39], v6 offset:5152
  ds_read_b64_tr_b16 a[60:61], v6 offset:64
  ds_read_b64_tr_b16 a[62:63], v6 offset:5184
  ds_read_b64_tr_b16 a[84:85], v6 offset:96
  ds_read_b64_tr_b16 a[86:87], v6 offset:5216
  ds_read_b64_tr_b16 a[108:109], v6 offset:128
  ds_read_b64_tr_b16 a[110:111], v6 offset:5248
  ds_read_b64_tr_b16 a[132:133], v6 offset:160
  ds_read_b64_tr_b16 a[134:135], v6 offset:5280
  s_waitcnt lgkmcnt(4)
  ds_read_b64_tr_b16 a[156:157], v6 offset:192
  ds_read_b64_tr_b16 a[158:159], v6 offset:5312
  ds_read_b64_tr_b16 a[180:181], v6 offset:224
  ds_read_b64_tr_b16 a[182:183], v6 offset:5344
  ds_read_b64_tr_b16 a[204:205], v6 offset:256
  ds_read_b64_tr_b16 a[206:207], v6 offset:5376
  ds_read_b64_tr_b16 a[228:229], v6 offset:288
  ds_read_b64_tr_b16 a[230:231], v6 offset:5408
  s_waitcnt vmcnt(10)
  s_barrier
  ds_read_b64_tr_b16 a[16:17], v7 offset:0
  ds_read_b64_tr_b16 a[18:19], v7 offset:5120
  ds_read_b64_tr_b16 a[40:41], v7 offset:32
  ds_read_b64_tr_b16 a[42:43], v7 offset:5152
  ds_read_b64_tr_b16 a[64:65], v7 offset:64
  ds_read_b64_tr_b16 a[66:67], v7 offset:5184
  ds_read_b64_tr_b16 a[88:89], v7 offset:96
  ds_read_b64_tr_b16 a[90:91], v7 offset:5216
  ds_read_b64_tr_b16 a[112:113], v7 offset:128
  ds_read_b64_tr_b16 a[114:115], v7 offset:5248
  ds_read_b64_tr_b16 a[136:137], v7 offset:160
  ds_read_b64_tr_b16 a[138:139], v7 offset:5280
  s_waitcnt lgkmcnt(4)
  ds_read_b64_tr_b16 a[160:161], v7 offset:192
  ds_read_b64_tr_b16 a[162:163], v7 offset:5312
  ds_read_b64_tr_b16 a[184:185], v7 offset:224
  ds_read_b64_tr_b16 a[186:187], v7 offset:5344
  ds_read_b64_tr_b16 a[208:209], v7 offset:256
  ds_read_b64_tr_b16 a[210:211], v7 offset:5376
  ds_read_b64_tr_b16 a[232:233], v7 offset:288
  ds_read_b64_tr_b16 a[234:235], v7 offset:5408
  s_waitcnt vmcnt(0)
  s_barrier
  ds_read_b64_tr_b16 a[20:21], v8 offset:0
  ds_read_b64_tr_b16 a[22:23], v8 offset:5120
  ds_read_b64_tr_b16 a[44:45], v8 offset:32
  ds_read_b64_tr_b16 a[46:47], v8 offset:5152
  ds_read_b64_tr_b16 a[68:69], v8 offset:64
  ds_read_b64_tr_b16 a[70:71], v8 offset:5184
  ds_read_b64_tr_b16 a[92:93], v8 offset:96
  ds_read_b64_tr_b16 a[94:95], v8 offset:5216
  ds_read_b64_tr_b16 a[116:117], v8 offset:128
  ds_read_b64_tr_b16 a[118:119], v8 offset:5248
  ds_read_b64_tr_b16 a[140:141], v8 offset:160
  ds_read_b64_tr_b16 a[142:143], v8 offset:5280
  s_waitcnt lgkmcnt(4)
  ds_read_b64_tr_b16 a[164:165], v8 offset:192
  ds_read_b64_tr_b16 a[166:167], v8 offset:5312
  ds_read_b64_tr_b16 a[188:189], v8 offset:224
  ds_read_b64_tr_b16 a[190:191], v8 offset:5344
  ds_read_b64_tr_b16 a[212:213], v8 offset:256
  ds_read_b64_tr_b16 a[214:215], v8 offset:5376
  ds_read_b64_tr_b16 a[236:237], v8 offset:288
  ds_read_b64_tr_b16 a[238:239], v8 offset:5408
  s_waitcnt lgkmcnt(0)
  s_barrier
  s_and_b32 s6, s3, 1
  s_lshr_b32 s7, s3, 1
  s_lshl_b32 s5, s6, 3
  v_add_u32 v241, s5, v240
  v_and_b32 v1, 7, v0
  v_lshl_add_u32 v1, v2, 3, v1
  v_lshlrev_b32 v242, 4, v1
  v_and_b32 v1, 1, v2
  v_lshlrev_b32 v1, 3, v1
  v_lshl_add_u32 v1, v5, 4, v1
  s_mul_i32 s5, s7, 1536
  v_add_u32 v243, s5, v1
  s_mul_i32 s5, s6, 6144
  s_mul_i32 s84, s7, 3072
  s_add_u32 s5, s5, s84
  v_add_u32 v247, s5, v240
  s_mul_i32 s84, s7, 6144
  v_lshlrev_b32 v1, 10, v2
  v_lshl_add_u32 v1, v5, 4, v1
  s_lshl_b32 s5, s3, 8
  v_add_u32 v244, s5, v1
  v_lshl_add_u32 v1, v2, 4, v5
  v_mul_u32_u24 v1, 1280, v1
  s_lshl_b32 s5, s65, 5
  s_lshl_b32 s7, s3, 3
  s_add_u32 s5, s5, s7
  v_add_u32 v1, s5, v1
  v_mov_b32 v9, 0x20000000
  v_cmp_gt_u32 vcc, 32, v0
  s_nop 1
  v_cndmask_b32 v245, v9, v1, vcc
  v_mov_b32 v10, 0x4444
  v_mov_b32 v11, 0xeeee
  v_and_b32 v1, 2, v0
  v_cmp_eq_u32 vcc, 0, v1
  s_nop 1
  v_cndmask_b32 v246, v11, v10, vcc
  v_and_b32 v1, 1, v0
  v_cmp_eq_u32 vcc, 0, v1
  v_mov_b32 v10, 0x3f80
  v_mov_b32 v11, 1.0
  v_cndmask_b32 v10, v11, v10, vcc
  v_cmp_eq_u32 vcc, 0, v3
  s_nop 1
  v_cndmask_b32 v11, 0, v10, vcc
  v_cmp_eq_u32 vcc, 1, v3
  s_nop 1
  v_cndmask_b32 v12, 0, v10, vcc
  v_accvgpr_write_b32 a240, v11
  v_accvgpr_write_b32 a241, v12
  v_accvgpr_write_b32 a242, v11
  v_accvgpr_write_b32 a243, v12
  v_and_b32 v1, 3, v0
  v_lshlrev_b32 v248, 2, v1
  v_min_u32 v1, 39, v0
  v_lshlrev_b32 v249, 2, v1
  s_lshl_b32 s80, s64, 8
  s_add_u32 s80, s80, 2043904
  s_mov_b32 s76, 0
  s_mov_b32 s77, 0
  s_mov_b32 s78, s64
  s_mov_b32 s93, 0x3dd53b95
  s_lshl_b32 s79, s61, 7
  s_add_u32 s79, s79, 2039808
  s_branch L_wt_28_in
L_wt_28:
  s_sleep 8
L_wt_28_in:
  s_sub_u32 s59, s59, 1
  s_cbranch_scc1 L_end
  buffer_load_dword v250, v248, s[8:11], s79 offen sc1
  s_waitcnt vmcnt(0)
  v_cmp_gt_u32 vcc, 32, v250
  s_cbranch_vccnz L_wt_28
  s_lshl_b32 s5, s78, 3
  s_add_u32 s5, s5, s61
  s_mul_i32 s5, s5, 12288
  s_add_u32 s5, s5, 17301504
  buffer_load_dwordx4 v[0:3], v240, s[8:11], s5 offen offset:0 sc1
  buffer_load_dwordx4 v[4:7], v240, s[8:11], s5 offen offset:1024 sc1
  buffer_load_dwordx4 v[8:11], v240, s[8:11], s5 offen offset:2048 sc1
  buffer_load_dwordx4 v[12:15], v240, s[8:11], s5 offen offset:3072 sc1
  s_add_u32 s5, s5, 4096
  buffer_load_dwordx4 v[16:19], v240, s[8:11], s5 offen offset:0 sc1
  buffer_load_dwordx4 v[20:23], v240, s[8:11], s5 offen offset:1024 sc1
  buffer_load_dwordx4 v[24:27], v240, s[8:11], s5 offen offset:2048 sc1
  buffer_load_dwordx4 v[28:31], v240, s[8:11], s5 offen offset:3072 sc1
  s_add_u32 s5, s5, 4096
  buffer_load_dwordx4 v[32:35], v240, s[8:11], s5 offen offset:0 sc1
  buffer_load_dwordx4 v[36:39], v240, s[8:11], s5 offen offset:1024 sc1
  buffer_load_dwordx4 v[40:43], v240, s[8:11], s5 offen offset:2048 sc1
  buffer_load_dwordx4 v[44:47], v240, s[8:11], s5 offen offset:3072 sc1
  v_mov_b32 v253, 0
L_w2k_29:
  s_waitcnt vmcnt(0)
  v_mov_b32 v176, v0
  v_mov_b32 v177, v1
  v_mov_b32 v178, v2
  v_mov_b32 v179, v3
  v_mov_b32 v184, v4
  v_mov_b32 v185, v5
  v_mov_b32 v186, v6
  v_mov_b32 v187, v7
  v_mov_b32 v192, v8
  v_mov_b32 v193, v9
  v_mov_b32 v194, v10
  v_mov_b32 v195, v11
  v_mov_b32 v200, v12
  v_mov_b32 v201, v13
  v_mov_b32 v202, v14
  v_mov_b32 v203, v15
  v_mov_b32 v208, v16
  v_mov_b32 v209, v17
  v_mov_b32 v210, v18
  v_mov_b32 v211, v19
  v_mov_b32 v216, v20
  v_mov_b32 v217, v21
  v_mov_b32 v218, v22
  v_mov_b32 v219, v23
  v_mov_b32 v180, v24
  v_mov_b32 v181, v25
  v_mov_b32 v182, v26
  v_mov_b32 v183, v27
  v_mov_b32 v188, v28
  v_mov_b32 v189, v29
  v_mov_b32 v190, v30
  v_mov_b32 v191, v31
  v_mov_b32 v196, v32
  v_mov_b32 v197, v33
  v_mov_b32 v198, v34
  v_mov_b32 v199, v35
  v_mov_b32 v204, v36
  v_mov_b32 v205, v37
  v_mov_b32 v206, v38
  v_mov_b32 v207, v39
  v_mov_b32 v212, v40
  v_mov_b32 v213, v41
  v_mov_b32 v214, v42
  v_mov_b32 v215, v43
  v_mov_b32 v220, v44
  v_mov_b32 v221, v45
  v_mov_b32 v222, v46
  v_mov_b32 v223, v47
  s_mul_i32 s81, s78, 40
  s_mul_i32 s5, s3, 10
  s_add_u32 s81, s81, s5
  s_mul_i32 s81, s81, 40
  s_add_u32 s81, s81, s65
  s_lshl_b32 s81, s81, 10
  s_add_u32 s81, s81, 99090432
  s_add_u32 s78, s78, 4
  s_cmp_ge_u32 s78, 64
  s_cbranch_scc1 L_w2n_30
  s_lshl_b32 s5, s78, 3
  s_add_u32 s5, s5, s61
  s_mul_i32 s5, s5, 12288
  s_add_u32 s5, s5, 17301504
  buffer_load_dwordx4 v[0:3], v240, s[8:11], s5 offen offset:0 sc1
  buffer_load_dwordx4 v[4:7], v240, s[8:11], s5 offen offset:1024 sc1
  buffer_load_dwordx4 v[8:11], v240, s[8:11], s5 offen offset:2048 sc1
  buffer_load_dwordx4 v[12:15], v240, s[8:11], s5 offen offset:3072 sc1
  s_add_u32 s5, s5, 4096
  buffer_load_dwordx4 v[16:19], v240, s[8:11], s5 offen offset:0 sc1
  buffer_load_dwordx4 v[20:23], v240, s[8:11], s5 offen offset:1024 sc1
  buffer_load_dwordx4 v[24:27], v240, s[8:11], s5 offen offset:2048 sc1
  buffer_load_dwordx4 v[28:31], v240, s[8:11], s5 offen offset:3072 sc1
  s_add_u32 s5, s5, 4096
  buffer_load_dwordx4 v[32:35], v240, s[8:11], s5 offen offset:0 sc1
  buffer_load_dwordx4 v[36:39], v240, s[8:11], s5 offen offset:1024 sc1
  buffer_load_dwordx4 v[40:43], v240, s[8:11], s5 offen offset:2048 sc1
  buffer_load_dwordx4 v[44:47], v240, s[8:11], s5 offen offset:3072 sc1
L_w2n_30:
  s_waitcnt lgkmcnt(0)
  v_mfma_f32_16x16x32_bf16 v[96:99], a[0:3], v[176:179], 0
  v_mfma_f32_16x16x32_bf16 v[100:103], a[0:3], v[180:183], 0
  v_mfma_f32_16x16x32_bf16 v[96:99], a[4:7], v[184:187], v[96:99]
  v_mfma_f32_16x16x32_bf16 v[100:103], a[4:7], v[188:191], v[100:103]
  v_mfma_f32_16x16x32_bf16 v[96:99], a[8:11], v[192:195], v[96:99]
  v_mfma_f32_16x16x32_bf16 v[100:103], a[8:11], v[196:199], v[100:103]
  v_mfma_f32_16x16x32_bf16 v[96:99], a[12:15], v[200:203], v[96:99]
  v_mfma_f32_16x16x32_bf16 v[100:103], a[12:15], v[204:207], v[100:103]
  v_mfma_f32_16x16x32_bf16 v[96:99], a[16:19], v[208:211], v[96:99]
  v_mfma_f32_16x16x32_bf16 v[100:103], a[16:19], v[212:215], v[100:103]
  v_mfma_f32_16x16x32_bf16 v[96:99], a[20:23], v[216:219], v[96:99]
  v_mfma_f32_16x16x32_bf16 v[100:103], a[20:23], v[220:223], v[100:103]
  v_mfma_f32_16x16x32_bf16 v[104:107], a[24:27], v[176:179], 0
  v_mfma_f32_16x16x32_bf16 v[108:111], a[24:27], v[180:183], 0
  v_mfma_f32_16x16x32_bf16 v[104:107], a[28:31], v[184:187], v[104:107]
  v_mfma_f32_16x16x32_bf16 v[108:111], a[28:31], v[188:191], v[108:111]
  v_mfma_f32_16x16x32_bf16 v[104:107], a[32:35], v[192:195], v[104:107]
  v_mfma_f32_16x16x32_bf16 v[108:111], a[32:35], v[196:199], v[108:111]
  v_mfma_f32_16x16x32_bf16 v[104:107], a[36:39], v[200:203], v[104:107]
  v_mfma_f32_16x16x32_bf16 v[108:111], a[36:39], v[204:207], v[108:111]
  v_mfma_f32_16x16x32_bf16 v[104:107], a[40:43], v[208:211], v[104:107]
  v_mfma_f32_16x16x32_bf16 v[108:111], a[40:43], v[212:215], v[108:111]
  v_cvt_pk_bf16_f32 v228, v96, v97
  v_cvt_pk_bf16_f32 v229, v98, v99
  v_cvt_pk_bf16_f32 v230, v100, v101
  v_cvt_pk_bf16_f32 v231, v102, v103
  buffer_store_dwordx4 v[228:231], v240, s[8:11], s81 offen sc1
  s_add_u32 s81, s81, 40960
  v_mfma_f32_16x16x32_bf16 v[104:107], a[44:47], v[216:219], v[104:107]
  v_mfma_f32_16x16x32_bf16 v[108:111], a[44:47], v[220:223], v[108:111]
  v_mfma_f32_16x16x32_bf16 v[112:115], a[48:51], v[176:179], 0
  v_mfma_f32_16x16x32_bf16 v[116:119], a[48:51], v[180:183], 0
  v_mfma_f32_16x16x32_bf16 v[112:115], a[52:55], v[184:187], v[112:115]
  v_mfma_f32_16x16x32_bf16 v[116:119], a[52:55], v[188:191], v[116:119]
  v_mfma_f32_16x16x32_bf16 v[112:115], a[56:59], v[192:195], v[112:115]
  v_mfma_f32_16x16x32_bf16 v[116:119], a[56:59], v[196:199], v[116:119]
  v_mfma_f32_16x16x32_bf16 v[112:115], a[60:63], v[200:203], v[112:115]
  v_mfma_f32_16x16x32_bf16 v[116:119], a[60:63], v[204:207], v[116:119]
  v_mfma_f32_16x16x32_bf16 v[112:115], a[64:67], v[208:211], v[112:115]
  v_mfma_f32_16x16x32_bf16 v[116:119], a[64:67], v[212:215], v[116:119]
  v_cvt_pk_bf16_f32 v224, v104, v105
  v_cvt_pk_bf16_f32 v225, v106, v107
  v_cvt_pk_bf16_f32 v226, v108, v109
  v_cvt_pk_bf16_f32 v227, v110, v111
  buffer_store_dwordx4 v[224:227], v240, s[8:11], s81 offen sc1
  s_add_u32 s81, s81, 40960
  v_mfma_f32_16x16x32_bf16 v[112:115], a[68:71], v[216:219], v[112:115]
  v_mfma_f32_16x16x32_bf16 v[116:119], a[68:71], v[220:223], v[116:119]
  v_mfma_f32_16x16x32_bf16 v[120:123], a[72:75], v[176:179], 0
  v_mfma_f32_16x16x32_bf16 v[124:127], a[72:75], v[180:183], 0
  v_mfma_f32_16x16x32_bf16 v[120:123], a[76:79], v[184:187], v[120:123]
  v_mfma_f32_16x16x32_bf16 v[124:127], a[76:79], v[188:191], v[124:127]
  v_mfma_f32_16x16x32_bf16 v[120:123], a[80:83], v[192:195], v[120:123]
  v_mfma_f32_16x16x32_bf16 v[124:127], a[80:83], v[196:199], v[124:127]
  v_mfma_f32_16x16x32_bf16 v[120:123], a[84:87], v[200:203], v[120:123]
  v_mfma_f32_16x16x32_bf16 v[124:127], a[84:87], v[204:207], v[124:127]
  v_mfma_f32_16x16x32_bf16 v[120:123], a[88:91], v[208:211], v[120:123]
  v_mfma_f32_16x16x32_bf16 v[124:127], a[88:91], v[212:215], v[124:127]
  v_cvt_pk_bf16_f32 v228, v112, v113
  v_cvt_pk_bf16_f32 v229, v114, v115
  v_cvt_pk_bf16_f32 v230, v116, v117
  v_cvt_pk_bf16_f32 v231, v118, v119
  buffer_store_dwordx4 v[228:231], v240, s[8:11], s81 offen sc1
  s_add_u32 s81, s81, 40960
  v_mfma_f32_16x16x32_bf16 v[120:123], a[92:95], v[216:219], v[120:123]
  v_mfma_f32_16x16x32_bf16 v[124:127], a[92:95], v[220:223], v[124:127]
  v_mfma_f32_16x16x32_bf16 v[128:131], a[96:99], v[176:179], 0
  v_mfma_f32_16x16x32_bf16 v[132:135], a[96:99], v[180:183], 0
  v_mfma_f32_16x16x32_bf16 v[128:131], a[100:103], v[184:187], v[128:131]
  v_mfma_f32_16x16x32_bf16 v[132:135], a[100:103], v[188:191], v[132:135]
  v_mfma_f32_16x16x32_bf16 v[128:131], a[104:107], v[192:195], v[128:131]
  v_mfma_f32_16x16x32_bf16 v[132:135], a[104:107], v[196:199], v[132:135]
  v_mfma_f32_16x16x32_bf16 v[128:131], a[108:111], v[200:203], v[128:131]
  v_mfma_f32_16x16x32_bf16 v[132:135], a[108:111], v[204:207], v[132:135]
  v_mfma_f32_16x16x32_bf16 v[128:131], a[112:115], v[208:211], v[128:131]
  v_mfma_f32_16x16x32_bf16 v[132:135], a[112:115], v[212:215], v[132:135]
  v_cvt_pk_bf16_f32 v224, v120, v121
  v_cvt_pk_bf16_f32 v225, v122, v123
  v_cvt_pk_bf16_f32 v226, v124, v125
  v_cvt_pk_bf16_f32 v227, v126, v127
  buffer_store_dwordx4 v[224:227], v240, s[8:11], s81 offen sc1
  s_add_u32 s81, s81, 40960
  v_mfma_f32_16x16x32_bf16 v[128:131], a[116:119], v[216:219], v[128:131]
  v_mfma_f32_16x16x32_bf16 v[132:135], a[116:119], v[220:223], v[132:135]
  v_mfma_f32_16x16x32_bf16 v[136:139], a[120:123], v[176:179], 0
  v_mfma_f32_16x16x32_bf16 v[140:143], a[120:123], v[180:183], 0
  v_mfma_f32_16x16x32_bf16 v[136:139], a[124:127], v[184:187], v[136:139]
  v_mfma_f32_16x16x32_bf16 v[140:143], a[124:127], v[188:191], v[140:143]
  v_mfma_f32_16x16x32_bf16 v[136:139], a[128:131], v[192:195], v[136:139]
  v_mfma_f32_16x16x32_bf16 v[140:143], a[128:131], v[196:199], v[140:143]
  v_mfma_f32_16x16x32_bf16 v[136:139], a[132:135], v[200:203], v[136:139]
  v_mfma_f32_16x16x32_bf16 v[140:143], a[132:135], v[204:207], v[140:143]
  v_mfma_f32_16x16x32_bf16 v[136:139], a[136:139], v[208:211], v[136:139]
  v_mfma_f32_16x16x32_bf16 v[140:143], a[136:139], v[212:215], v[140:143]
  v_cvt_pk_bf16_f32 v228, v128, v129
  v_cvt_pk_bf16_f32 v229, v130, v131
  v_cvt_pk_bf16_f32 v230, v132, v133
  v_cvt_pk_bf16_f32 v231, v134, v135
  buffer_store_dwordx4 v[228:231], v240, s[8:11], s81 offen sc1
  s_add_u32 s81, s81, 40960
  v_mfma_f32_16x16x32_bf16 v[136:139], a[140:143], v[216:219], v[136:139]
  v_mfma_f32_16x16x32_bf16 v[140:143], a[140:143], v[220:223], v[140:143]
  v_mfma_f32_16x16x32_bf16 v[144:147], a[144:147], v[176:179], 0
  v_mfma_f32_16x16x32_bf16 v[148:151], a[144:147], v[180:183], 0
  v_mfma_f32_16x16x32_bf16 v[144:147], a[148:151], v[184:187], v[144:147]
  v_mfma_f32_16x16x32_bf16 v[148:151], a[148:151], v[188:191], v[148:151]
  v_mfma_f32_16x16x32_bf16 v[144:147], a[152:155], v[192:195], v[144:147]
  v_mfma_f32_16x16x32_bf16 v[148:151], a[152:155], v[196:199], v[148:151]
  v_mfma_f32_16x16x32_bf16 v[144:147], a[156:159], v[200:203], v[144:147]
  v_mfma_f32_16x16x32_bf16 v[148:151], a[156:159], v[204:207], v[148:151]
  v_mfma_f32_16x16x32_bf16 v[144:147], a[160:163], v[208:211], v[144:147]
  v_mfma_f32_16x16x32_bf16 v[148:151], a[160:163], v[212:215], v[148:151]
  v_cvt_pk_bf16_f32 v224, v136, v137
  v_cvt_pk_bf16_f32 v225, v138, v139
  v_cvt_pk_bf16_f32 v226, v140, v141
  v_cvt_pk_bf16_f32 v227, v142, v143
  buffer_store_dwordx4 v[224:227], v240, s[8:11], s81 offen sc1
  s_add_u32 s81, s81, 40960
  v_mfma_f32_16x16x32_bf16 v[144:147], a[164:167], v[216:219], v[144:147]
  v_mfma_f32_16x16x32_bf16 v[148:151], a[164:167], v[220:223], v[148:151]
  v_mfma_f32_16x16x32_bf16 v[152:155], a[168:171], v[176:179], 0
  v_mfma_f32_16x16x32_bf16 v[156:159], a[168:171], v[180:183], 0
  v_mfma_f32_16x16x32_bf16 v[152:155], a[172:175], v[184:187], v[152:155]
  v_mfma_f32_16x16x32_bf16 v[156:159], a[172:175], v[188:191], v[156:159]
  v_mfma_f32_16x16x32_bf16 v[152:155], a[176:179], v[192:195], v[152:155]
  v_mfma_f32_16x16x32_bf16 v[156:159], a[176:179], v[196:199], v[156:159]
  v_mfma_f32_16x16x32_bf16 v[152:155], a[180:183], v[200:203], v[152:155]
  v_mfma_f32_16x16x32_bf16 v[156:159], a[180:183], v[204:207], v[156:159]
  v_mfma_f32_16x16x32_bf16 v[152:155], a[184:187], v[208:211], v[152:155]
  v_mfma_f32_16x16x32_bf16 v[156:159], a[184:187], v[212:215], v[156:159]
  v_cvt_pk_bf16_f32 v228, v144, v145
  v_cvt_pk_bf16_f32 v229, v146, v147
  v_cvt_pk_bf16_f32 v230, v148, v149
  v_cvt_pk_bf16_f32 v231, v150, v151
  buffer_store_dwordx4 v[228:231], v240, s[8:11], s81 offen sc1
  s_add_u32 s81, s81, 40960
  v_mfma_f32_16x16x32_bf16 v[152:155], a[188:191], v[216:219], v[152:155]
  v_mfma_f32_16x16x32_bf16 v[156:159], a[188:191], v[220:223], v[156:159]
  v_mfma_f32_16x16x32_bf16 v[160:163], a[192:195], v[176:179], 0
  v_mfma_f32_16x16x32_bf16 v[164:167], a[192:195], v[180:183], 0
  v_mfma_f32_16x16x32_bf16 v[160:163], a[196:199], v[184:187], v[160:163]
  v_mfma_f32_16x16x32_bf16 v[164:167], a[196:199], v[188:191], v[164:167]
  v_mfma_f32_16x16x32_bf16 v[160:163], a[200:203], v[192:195], v[160:163]
  v_mfma_f32_16x16x32_bf16 v[164:167], a[200:203], v[196:199], v[164:167]
  v_mfma_f32_16x16x32_bf16 v[160:163], a[204:207], v[200:203], v[160:163]
  v_mfma_f32_16x16x32_bf16 v[164:167], a[204:207], v[204:207], v[164:167]
  v_mfma_f32_16x16x32_bf16 v[160:163], a[208:211], v[208:211], v[160:163]
  v_mfma_f32_16x16x32_bf16 v[164:167], a[208:211], v[212:215], v[164:167]
  v_cvt_pk_bf16_f32 v224, v152, v153
  v_cvt_pk_bf16_f32 v225, v154, v155
  v_cvt_pk_bf16_f32 v226, v156, v157
  v_cvt_pk_bf16_f32 v227, v158, v159
  buffer_store_dwordx4 v[224:227], v240, s[8:11], s81 offen sc1
  s_add_u32 s81, s81, 40960
  v_mfma_f32_16x16x32_bf16 v[160:163], a[212:215], v[216:219], v[160:163]
  v_mfma_f32_16x16x32_bf16 v[164:167], a[212:215], v[220:223], v[164:167]
  v_mfma_f32_16x16x32_bf16 v[168:171], a[216:219], v[176:179], 0
  v_mfma_f32_16x16x32_bf16 v[172:175], a[216:219], v[180:183], 0
  v_mfma_f32_16x16x32_bf16 v[168:171], a[220:223], v[184:187], v[168:171]
  v_mfma_f32_16x16x32_bf16 v[172:175], a[220:223], v[188:191], v[172:175]
  v_mfma_f32_16x16x32_bf16 v[168:171], a[224:227], v[192:195], v[168:171]
  v_mfma_f32_16x16x32_bf16 v[172:175], a[224:227], v[196:199], v[172:175]
  v_mfma_f32_16x16x32_bf16 v[168:171], a[228:231], v[200:203], v[168:171]
  v_mfma_f32_16x16x32_bf16 v[172:175], a[228:231], v[204:207], v[172:175]
  v_mfma_f32_16x16x32_bf16 v[168:171], a[232:235], v[208:211], v[168:171]
  v_mfma_f32_16x16x32_bf16 v[172:175], a[232:235], v[212:215], v[172:175]
  v_cvt_pk_bf16_f32 v228, v160, v161
  v_cvt_pk_bf16_f32 v229, v162, v163
  v_cvt_pk_bf16_f32 v230, v164, v165
  v_cvt_pk_bf16_f32 v231, v166, v167
  buffer_store_dwordx4 v[228:231], v240, s[8:11], s81 offen sc1
  s_add_u32 s81, s81, 40960
  v_mfma_f32_16x16x32_bf16 v[168:171], a[236:239], v[216:219], v[168:171]
  v_mfma_f32_16x16x32_bf16 v[172:175], a[236:239], v[220:223], v[172:175]
  s_nop 6
  v_cvt_pk_bf16_f32 v224, v168, v169
  v_cvt_pk_bf16_f32 v225, v170, v171
  v_cvt_pk_bf16_f32 v226, v172, v173
  v_cvt_pk_bf16_f32 v227, v174, v175
  buffer_store_dwordx4 v[224:227], v240, s[8:11], s81 offen sc1
  s_add_u32 s76, s76, 1
  s_add_u32 s5, s77, 1
  s_cmp_ge_u32 s5, s76
  s_cbranch_scc1 L_rno_33
  s_branch L_rf_34_in
L_rf_34:
  s_cmp_ge_u32 s77, 14
  s_cbranch_scc1 L_rf_34_in
  s_sleep 48
L_rf_34_in:
  s_sub_u32 s59, s59, 1
  s_cbranch_scc1 L_end
  buffer_load_dword v250, v249, s[8:11], s80 offen sc1
  s_waitcnt vmcnt(0)
  v_cmp_ge_u32 vcc, s77, v250
  s_cbranch_vccnz L_rf_34
  s_lshl_b32 s5, s77, 2
  s_add_u32 s5, s5, s64
  s_mul_i32 s85, s5, 40960
  s_mul_i32 s5, s5, 40
  s_add_u32 s5, s5, s65
  s_mul_i32 s5, s5, 40960
  s_add_u32 s5, s5, 99090432
  buffer_load_dwordx2 v[232:233], v245, s[12:15], s85 offen
  buffer_load_dwordx4 v[176:179], v244, s[8:11], s5 offen sc1
  s_add_u32 s5, s5, 4096
  buffer_load_dwordx4 v[180:183], v244, s[8:11], s5 offen sc1
  s_add_u32 s5, s5, 4096
  buffer_load_dwordx4 v[184:187], v244, s[8:11], s5 offen sc1
  s_add_u32 s5, s5, 4096
  buffer_load_dwordx4 v[188:191], v244, s[8:11], s5 offen sc1
  s_add_u32 s5, s5, 4096
  buffer_load_dwordx4 v[192:195], v244, s[8:11], s5 offen sc1
  s_add_u32 s5, s5, 4096
  buffer_load_dwordx4 v[196:199], v244, s[8:11], s5 offen sc1
  s_add_u32 s5, s5, 4096
  buffer_load_dwordx4 v[200:203], v244, s[8:11], s5 offen sc1
  s_add_u32 s5, s5, 4096
  buffer_load_dwordx4 v[204:207], v244, s[8:11], s5 offen sc1
  s_add_u32 s5, s5, 4096
  buffer_load_dwordx4 v[208:211], v244, s[8:11], s5 offen sc1
  s_add_u32 s5, s5, 4096
  buffer_load_dwordx4 v[212:215], v244, s[8:11], s5 offen sc1
  s_add_u32 s5, s5, 4096
  s_barrier
  s_lshl_b32 s5, s65, 2
  s_add_u32 s5, s5, s80
  s_cmp_lg_u32 s3, 0
  s_cbranch_scc1 L_fl_35
  v_mov_b32 v250, s76
  s_mov_b64 exec, 1
  buffer_store_dword v250, off, s[8:11], s5 sc1
  s_mov_b64 exec, -1
L_fl_35:
  s_waitcnt vmcnt(10)
  v_lshlrev_b32 v236, 16, v232
  v_and_b32 v237, 0xffff0000, v232
  v_lshlrev_b32 v238, 16, v233
  v_and_b32 v239, 0xffff0000, v233
  s_waitcnt vmcnt(8)
  s_nop 0
  v_smfmac_f32_16x16x64_bf16 v[236:239], a[240:243], v[176:183], v246
  s_waitcnt vmcnt(6)
  v_smfmac_f32_16x16x64_bf16 v[236:239], a[240:243], v[184:191], v246
  s_waitcnt vmcnt(4)
  v_smfmac_f32_16x16x64_bf16 v[236:239], a[240:243], v[192:199], v246
  s_waitcnt vmcnt(2)
  v_smfmac_f32_16x16x64_bf16 v[236:239], a[240:243], v[200:207], v246
  s_waitcnt vmcnt(0)
  v_smfmac_f32_16x16x64_bf16 v[236:239], a[240:243], v[208:215], v246
  s_nop 7
  v_cvt_pk_bf16_f32 v232, v236, v237
  v_cvt_pk_bf16_f32 v233, v238, v239
  buffer_store_dwordx2 v[232:233], v245, s[24:27], s85 offen
  s_add_u32 s77, s77, 1
  s_branch L_r_31
L_rno_33:
  s_waitcnt vmcnt(0)
  s_barrier
  s_lshl_b32 s5, s65, 2
  s_add_u32 s5, s5, s80
  s_cmp_lg_u32 s3, 0
  s_cbranch_scc1 L_fl_36
  v_mov_b32 v250, s76
  s_mov_b64 exec, 1
  buffer_store_dword v250, off, s[8:11], s5 sc1
  s_mov_b64 exec, -1
L_fl_36:
L_r_31:
  s_cmp_le_u32 s76, 12
  s_cbranch_scc1 L_rd_32
  s_branch L_rf_37_in
L_rf_37:
  s_cmp_ge_u32 s77, 14
  s_cbranch_scc1 L_rf_37_in
  s_sleep 48
L_rf_37_in:
  s_sub_u32 s59, s59, 1
  s_cbranch_scc1 L_end
  buffer_load_dword v250, v249, s[8:11], s80 offen sc1
  s_waitcnt vmcnt(0)
  v_cmp_ge_u32 vcc, s77, v250
  s_cbranch_vccnz L_rf_37
  s_lshl_b32 s5, s77, 2
  s_add_u32 s5, s5, s64
  s_mul_i32 s85, s5, 40960
  s_mul_i32 s5, s5, 40
  s_add_u32 s5, s5, s65
  s_mul_i32 s5, s5, 40960
  s_add_u32 s5, s5, 99090432
  buffer_load_dwordx2 v[232:233], v245, s[12:15], s85 offen
  buffer_load_dwordx4 v[176:179], v244, s[8:11], s5 offen sc1
  s_add_u32 s5, s5, 4096
  buffer_load_dwordx4 v[180:183], v244, s[8:11], s5 offen sc1
  s_add_u32 s5, s5, 4096
  buffer_load_dwordx4 v[184:187], v244, s[8:11], s5 offen sc1
  s_add_u32 s5, s5, 4096
  buffer_load_dwordx4 v[188:191], v244, s[8:11], s5 offen sc1
  s_add_u32 s5, s5, 4096
  buffer_load_dwordx4 v[192:195], v244, s[8:11], s5 offen sc1
  s_add_u32 s5, s5, 4096
  buffer_load_dwordx4 v[196:199], v244, s[8:11], s5 offen sc1
  s_add_u32 s5, s5, 4096
  buffer_load_dwordx4 v[200:203], v244, s[8:11], s5 offen sc1
  s_add_u32 s5, s5, 4096
  buffer_load_dwordx4 v[204:207], v244, s[8:11], s5 offen sc1
  s_add_u32 s5, s5, 4096
  buffer_load_dwordx4 v[208:211], v244, s[8:11], s5 offen sc1
  s_add_u32 s5, s5, 4096
  buffer_load_dwordx4 v[212:215], v244, s[8:11], s5 offen sc1
  s_add_u32 s5, s5, 4096
  s_waitcnt vmcnt(10)
  v_lshlrev_b32 v236, 16, v232
  v_and_b32 v237, 0xffff0000, v232
  v_lshlrev_b32 v238, 16, v233
  v_and_b32 v239, 0xffff0000, v233
  s_waitcnt vmcnt(8)
  s_nop 0
  v_smfmac_f32_16x16x64_bf16 v[236:239], a[240:243], v[176:183], v246
  s_waitcnt vmcnt(6)
  v_smfmac_f32_16x16x64_bf16 v[236:239], a[240:243], v[184:191], v246
  s_waitcnt vmcnt(4)
  v_smfmac_f32_16x16x64_bf16 v[236:239], a[240:243], v[192:199], v246
  s_waitcnt vmcnt(2)
  v_smfmac_f32_16x16x64_bf16 v[236:239], a[240:243], v[200:207], v246
  s_waitcnt vmcnt(0)
  v_smfmac_f32_16x16x64_bf16 v[236:239], a[240:243], v[208:215], v246
  s_nop 7
  v_cvt_pk_bf16_f32 v232, v236, v237
  v_cvt_pk_bf16_f32 v233, v238, v239
  buffer_store_dwordx2 v[232:233], v245, s[24:27], s85 offen
  s_add_u32 s77, s77, 1
L_rd_32:
  s_cmp_lt_u32 s76, 16
  s_cbranch_scc1 L_w2k_29
  s_branch L_end
L_w2a:
  v_mbcnt_lo_u32_b32 v0, -1, 0
  v_mbcnt_hi_u32_b32 v0, -1, v0
  s_mov_b32 s16, s42
  s_and_b32 s17, s43, 0xffff
  s_mov_b32 s18, 7864320
  s_mov_b32 s19, 0x20000
  v_lshlrev_b32 v240, 4, v0
  v_lshrrev_b32 v2, 4, v0
  v_bfe_u32 v3, v0, 2, 2
  v_and_b32 v4, 3, v0
  v_and_b32 v5, 15, v0
  v_lshl_add_u32 v1, v2, 2, v3
  v_mul_u32_u24 v1, 1280, v1
  v_lshl_add_u32 v1, v4, 3, v1
  s_mul_i32 s5, s3, 320
  v_add_u32 v6, s5, v1
  v_add_u32 v7, 40960, v6
  v_add_u32 v8, 81920, v6
  s_mul_i32 s82, s61, 245760
  s_mul_i32 s83, s3, 10240
  s_add_u32 s82, s82, s83
  s_add_u32 m0, s83, 0
  s_add_u32 s5, s82, 0
  buffer_load_dwordx4 v240, s[16:19], s5 offen offset:0 lds
  buffer_load_dwordx4 v240, s[16:19], s5 offen offset:1024 lds
  buffer_load_dwordx4 v240, s[16:19], s5 offen offset:2048 lds
  buffer_load_dwordx4 v240, s[16:19], s5 offen offset:3072 lds
  s_add_u32 m0, s83, 4096
  s_add_u32 s5, s82, 4096
  buffer_load_dwordx4 v240, s[16:19], s5 offen offset:0 lds
  buffer_load_dwordx4 v240, s[16:19], s5 offen offset:1024 lds
  buffer_load_dwordx4 v240, s[16:19], s5 offen offset:2048 lds
  buffer_load_dwordx4 v240, s[16:19], s5 offen offset:3072 lds
  s_add_u32 m0, s83, 8192
  s_add_u32 s5, s82, 8192
  buffer_load_dwordx4 v240, s[16:19], s5 offen offset:0 lds
  buffer_load_dwordx4 v240, s[16:19], s5 offen offset:1024 lds
  s_add_u32 m0, s83, 40960
  s_add_u32 s5, s82, 40960
  buffer_load_dwordx4 v240, s[16:19], s5 offen offset:0 lds
  buffer_load_dwordx4 v240, s[16:19], s5 offen offset:1024 lds
  buffer_load_dwordx4 v240, s[16:19], s5 offen offset:2048 lds
  buffer_load_dwordx4 v240, s[16:19], s5 offen offset:3072 lds
  s_add_u32 m0, s83, 45056
  s_add_u32 s5, s82, 45056
  buffer_load_dwordx4 v240, s[16:19], s5 offen offset:0 lds
  buffer_load_dwordx4 v240, s[16:19], s5 offen offset:1024 lds
  buffer_load_dwordx4 v240, s[16:19], s5 offen offset:2048 lds
  buffer_load_dwordx4 v240, s[16:19], s5 offen offset:3072 lds
  s_add_u32 m0, s83, 49152
  s_add_u32 s5, s82, 49152
  buffer_load_dwordx4 v240, s[16:19], s5 offen offset:0 lds
  buffer_load_dwordx4 v240, s[16:19], s5 offen offset:1024 lds
  s_add_u32 m0, s83, 81920
  s_add_u32 s5, s82, 81920
  buffer_load_dwordx4 v240, s[16:19], s5 offen offset:0 lds
  buffer_load_dwordx4 v240, s[16:19], s5 offen offset:1024 lds
  buffer_load_dwordx4 v240, s[16:19], s5 offen offset:2048 lds
  buffer_load_dwordx4 v240, s[16:19], s5 offen offset:3072 lds
  s_add_u32 m0, s83, 86016
  s_add_u32 s5, s82, 86016
  buffer_load_dwordx4 v240, s[16:19], s5 offen offset:0 lds
  buffer_load_dwordx4 v240, s[16:19], s5 offen offset:1024 lds
  buffer_load_dwordx4 v240, s[16:19], s5 offen offset:2048 lds
  buffer_load_dwordx4 v240, s[16:19], s5 offen offset:3072 lds
  s_add_u32 m0, s83, 90112
  s_add_u32 s5, s82, 90112
  buffer_load_dwordx4 v240, s[16:19], s5 offen offset:0 lds
  buffer_load_dwordx4 v240, s[16:19], s5 offen offset:1024 lds
  s_waitcnt vmcnt(20)
  s_barrier
  ds_read_b64_tr_b16 a[0:1], v6 offset:0
  ds_read_b64_tr_b16 a[2:3], v6 offset:20480
  ds_read_b64_tr_b16 a[24:25], v6 offset:32
  ds_read_b64_tr_b16 a[26:27], v6 offset:20512
  ds_read_b64_tr_b16 a[48:49], v6 offset:64
  ds_read_b64_tr_b16 a[50:51], v6 offset:20544
  ds_read_b64_tr_b16 a[72:73], v6 offset:96
  ds_read_b64_tr_b16 a[74:75], v6 offset:20576
  ds_read_b64_tr_b16 a[96:97], v6 offset:128
  ds_read_b64_tr_b16 a[98:99], v6 offset:20608
  ds_read_b64_tr_b16 a[120:121], v6 offset:160
  ds_read_b64_tr_b16 a[122:123], v6 offset:20640
  s_waitcnt lgkmcnt(4)
  ds_read_b64_tr_b16 a[144:145], v6 offset:192
  ds_read_b64_tr_b16 a[146:147], v6 offset:20672
  ds_read_b64_tr_b16 a[168:169], v6 offset:224
  ds_read_b64_tr_b16 a[170:171], v6 offset:20704
  ds_read_b64_tr_b16 a[192:193], v6 offset:256
  ds_read_b64_tr_b16 a[194:195], v6 offset:20736
  ds_read_b64_tr_b16 a[216:217], v6 offset:288
  ds_read_b64_tr_b16 a[218:219], v6 offset:20768
  s_waitcnt lgkmcnt(0)
  s_barrier
  s_add_u32 m0, s83, 0
  s_add_u32 s5, s82, 122880
  buffer_load_dwordx4 v240, s[16:19], s5 offen offset:0 lds
  buffer_load_dwordx4 v240, s[16:19], s5 offen offset:1024 lds
  buffer_load_dwordx4 v240, s[16:19], s5 offen offset:2048 lds
  buffer_load_dwordx4 v240, s[16:19], s5 offen offset:3072 lds
  s_add_u32 m0, s83, 4096
  s_add_u32 s5, s82, 126976
  buffer_load_dwordx4 v240, s[16:19], s5 offen offset:0 lds
  buffer_load_dwordx4 v240, s[16:19], s5 offen offset:1024 lds
  buffer_load_dwordx4 v240, s[16:19], s5 offen offset:2048 lds
  buffer_load_dwordx4 v240, s[16:19], s5 offen offset:3072 lds
  s_add_u32 m0, s83, 8192
  s_add_u32 s5, s82, 131072
  buffer_load_dwordx4 v240, s[16:19], s5 offen offset:0 lds
  buffer_load_dwordx4 v240, s[16:19], s5 offen offset:1024 lds
  s_waitcnt vmcnt(20)
  s_barrier
  ds_read_b64_tr_b16 a[4:5], v7 offset:0
  ds_read_b64_tr_b16 a[6:7], v7 offset:20480
  ds_read_b64_tr_b16 a[28:29], v7 offset:32
  ds_read_b64_tr_b16 a[30:31], v7 offset:20512
  ds_read_b64_tr_b16 a[52:53], v7 offset:64
  ds_read_b64_tr_b16 a[54:55], v7 offset:20544
  ds_read_b64_tr_b16 a[76:77], v7 offset:96
  ds_read_b64_tr_b16 a[78:79], v7 offset:20576
  ds_read_b64_tr_b16 a[100:101], v7 offset:128
  ds_read_b64_tr_b16 a[102:103], v7 offset:20608
  ds_read_b64_tr_b16 a[124:125], v7 offset:160
  ds_read_b64_tr_b16 a[126:127], v7 offset:20640
  s_waitcnt lgkmcnt(4)
  ds_read_b64_tr_b16 a[148:149], v7 offset:192
  ds_read_b64_tr_b16 a[150:151], v7 offset:20672
  ds_read_b64_tr_b16 a[172:173], v7 offset:224
  ds_read_b64_tr_b16 a[174:175], v7 offset:20704
  ds_read_b64_tr_b16 a[196:197], v7 offset:256
  ds_read_b64_tr_b16 a[198:199], v7 offset:20736
  ds_read_b64_tr_b16 a[220:221], v7 offset:288
  ds_read_b64_tr_b16 a[222:223], v7 offset:20768
  s_waitcnt lgkmcnt(0)
  s_barrier
  s_add_u32 m0, s83, 40960
  s_add_u32 s5, s82, 163840
  buffer_load_dwordx4 v240, s[16:19], s5 offen offset:0 lds
  buffer_load_dwordx4 v240, s[16:19], s5 offen offset:1024 lds
  buffer_load_dwordx4 v240, s[16:19], s5 offen offset:2048 lds
  buffer_load_dwordx4 v240, s[16:19], s5 offen offset:3072 lds
  s_add_u32 m0, s83, 45056
  s_add_u32 s5, s82, 167936
  buffer_load_dwordx4 v240, s[16:19], s5 offen offset:0 lds
  buffer_load_dwordx4 v240, s[16:19], s5 offen offset:1024 lds
  buffer_load_dwordx4 v240, s[16:19], s5 offen offset:2048 lds
  buffer_load_dwordx4 v240, s[16:19], s5 offen offset:3072 lds
  s_add_u32 m0, s83, 49152
  s_add_u32 s5, s82, 172032
  buffer_load_dwordx4 v240, s[16:19], s5 offen offset:0 lds
  buffer_load_dwordx4 v240, s[16:19], s5 offen offset:1024 lds
  s_waitcnt vmcnt(20)
  s_barrier
  ds_read_b64_tr_b16 a[8:9], v8 offset:0
  ds_read_b64_tr_b16 a[10:11], v8 offset:20480
  ds_read_b64_tr_b16 a[32:33], v8 offset:32
  ds_read_b64_tr_b16 a[34:35], v8 offset:20512
  ds_read_b64_tr_b16 a[56:57], v8 offset:64
  ds_read_b64_tr_b16 a[58:59], v8 offset:20544
  ds_read_b64_tr_b16 a[80:81], v8 offset:96
  ds_read_b64_tr_b16 a[82:83], v8 offset:20576
  ds_read_b64_tr_b16 a[104:105], v8 offset:128
  ds_read_b64_tr_b16 a[106:107], v8 offset:20608
  ds_read_b64_tr_b16 a[128:129], v8 offset:160
  ds_read_b64_tr_b16 a[130:131], v8 offset:20640
  s_waitcnt lgkmcnt(4)
  ds_read_b64_tr_b16 a[152:153], v8 offset:192
  ds_read_b64_tr_b16 a[154:155], v8 offset:20672
  ds_read_b64_tr_b16 a[176:177], v8 offset:224
  ds_read_b64_tr_b16 a[178:179], v8 offset:20704
  ds_read_b64_tr_b16 a[200:201], v8 offset:256
  ds_read_b64_tr_b16 a[202:203], v8 offset:20736
  ds_read_b64_tr_b16 a[224:225], v8 offset:288
  ds_read_b64_tr_b16 a[226:227], v8 offset:20768
  s_waitcnt lgkmcnt(0)
  s_barrier
  s_add_u32 m0, s83, 81920
  s_add_u32 s5, s82, 204800
  buffer_load_dwordx4 v240, s[16:19], s5 offen offset:0 lds
  buffer_load_dwordx4 v240, s[16:19], s5 offen offset:1024 lds
  buffer_load_dwordx4 v240, s[16:19], s5 offen offset:2048 lds
  buffer_load_dwordx4 v240, s[16:19], s5 offen offset:3072 lds
  s_add_u32 m0, s83, 86016
  s_add_u32 s5, s82, 208896
  buffer_load_dwordx4 v240, s[16:19], s5 offen offset:0 lds
  buffer_load_dwordx4 v240, s[16:19], s5 offen offset:1024 lds
  buffer_load_dwordx4 v240, s[16:19], s5 offen offset:2048 lds
  buffer_load_dwordx4 v240, s[16:19], s5 offen offset:3072 lds
  s_add_u32 m0, s83, 90112
  s_add_u32 s5, s82, 212992
  buffer_load_dwordx4 v240, s[16:19], s5 offen offset:0 lds
  buffer_load_dwordx4 v240, s[16:19], s5 offen offset:1024 lds
  s_waitcnt vmcnt(20)
  s_barrier
  ds_read_b64_tr_b16 a[12:13], v6 offset:0
  ds_read_b64_tr_b16 a[14:15], v6 offset:20480
  ds_read_b64_tr_b16 a[36:37], v6 offset:32
  ds_read_b64_tr_b16 a[38:39], v6 offset:20512
  ds_read_b64_tr_b16 a[60:61], v6 offset:64
  ds_read_b64_tr_b16 a[62:63], v6 offset:20544
  ds_read_b64_tr_b16 a[84:85], v6 offset:96
  ds_read_b64_tr_b16 a[86:87], v6 offset:20576
  ds_read_b64_tr_b16 a[108:109], v6 offset:128
  ds_read_b64_tr_b16 a[110:111], v6 offset:20608
  ds_read_b64_tr_b16 a[132:133], v6 offset:160
  ds_read_b64_tr_b16 a[134:135], v6 offset:20640
  s_waitcnt lgkmcnt(4)
  ds_read_b64_tr_b16 a[156:157], v6 offset:192
  ds_read_b64_tr_b16 a[158:159], v6 offset:20672
  ds_read_b64_tr_b16 a[180:181], v6 offset:224
  ds_read_b64_tr_b16 a[182:183], v6 offset:20704
  ds_read_b64_tr_b16 a[204:205], v6 offset:256
  ds_read_b64_tr_b16 a[206:207], v6 offset:20736
  ds_read_b64_tr_b16 a[228:229], v6 offset:288
  ds_read_b64_tr_b16 a[230:231], v6 offset:20768
  s_waitcnt vmcnt(10)
  s_barrier
  ds_read_b64_tr_b16 a[16:17], v7 offset:0
  ds_read_b64_tr_b16 a[18:19], v7 offset:20480
  ds_read_b64_tr_b16 a[40:41], v7 offset:32
  ds_read_b64_tr_b16 a[42:43], v7 offset:20512
  ds_read_b64_tr_b16 a[64:65], v7 offset:64
  ds_read_b64_tr_b16 a[66:67], v7 offset:20544
  ds_read_b64_tr_b16 a[88:89], v7 offset:96
  ds_read_b64_tr_b16 a[90:91], v7 offset:20576
  ds_read_b64_tr_b16 a[112:113], v7 offset:128
  ds_read_b64_tr_b16 a[114:115], v7 offset:20608
  ds_read_b64_tr_b16 a[136:137], v7 offset:160
  ds_read_b64_tr_b16 a[138:139], v7 offset:20640
  s_waitcnt lgkmcnt(4)
  ds_read_b64_tr_b16 a[160:161], v7 offset:192
  ds_read_b64_tr_b16 a[162:163], v7 offset:20672
  ds_read_b64_tr_b16 a[184:185], v7 offset:224
  ds_read_b64_tr_b16 a[186:187], v7 offset:20704
  ds_read_b64_tr_b16 a[208:209], v7 offset:256
  ds_read_b64_tr_b16 a[210:211], v7 offset:20736
  ds_read_b64_tr_b16 a[232:233], v7 offset:288
  ds_read_b64_tr_b16 a[234:235], v7 offset:20768
  s_waitcnt vmcnt(0)
  s_barrier
  ds_read_b64_tr_b16 a[20:21], v8 offset:0
  ds_read_b64_tr_b16 a[22:23], v8 offset:20480
  ds_read_b64_tr_b16 a[44:45], v8 offset:32
  ds_read_b64_tr_b16 a[46:47], v8 offset:20512
  ds_read_b64_tr_b16 a[68:69], v8 offset:64
  ds_read_b64_tr_b16 a[70:71], v8 offset:20544
  ds_read_b64_tr_b16 a[92:93], v8 offset:96
  ds_read_b64_tr_b16 a[94:95], v8 offset:20576
  ds_read_b64_tr_b16 a[116:117], v8 offset:128
  ds_read_b64_tr_b16 a[118:119], v8 offset:20608
  ds_read_b64_tr_b16 a[140:141], v8 offset:160
  ds_read_b64_tr_b16 a[142:143], v8 offset:20640
  s_waitcnt lgkmcnt(4)
  ds_read_b64_tr_b16 a[164:165], v8 offset:192
  ds_read_b64_tr_b16 a[166:167], v8 offset:20672
  ds_read_b64_tr_b16 a[188:189], v8 offset:224
  ds_read_b64_tr_b16 a[190:191], v8 offset:20704
  ds_read_b64_tr_b16 a[212:213], v8 offset:256
  ds_read_b64_tr_b16 a[214:215], v8 offset:20736
  ds_read_b64_tr_b16 a[236:237], v8 offset:288
  ds_read_b64_tr_b16 a[238:239], v8 offset:20768
  s_waitcnt lgkmcnt(0)
  s_barrier
  s_and_b32 s6, s3, 1
  s_lshr_b32 s7, s3, 1
  s_lshl_b32 s5, s6, 3
  v_add_u32 v241, s5, v240
  v_and_b32 v1, 7, v0
  v_lshl_add_u32 v1, v2, 3, v1
  v_lshlrev_b32 v242, 4, v1
  v_and_b32 v1, 1, v2
  v_lshlrev_b32 v1, 3, v1
  v_lshl_add_u32 v1, v5, 4, v1
  s_mul_i32 s5, s7, 1536
  v_add_u32 v243, s5, v1
  s_mul_i32 s5, s6, 6144
  s_mul_i32 s84, s7, 3072
  s_add_u32 s5, s5, s84
  v_add_u32 v247, s5, v240
  s_mul_i32 s84, s7, 6144
  v_lshlrev_b32 v1, 10, v2
  v_lshl_add_u32 v1, v5, 4, v1
  s_lshl_b32 s5, s3, 8
  v_add_u32 v244, s5, v1
  v_lshl_add_u32 v1, v2, 4, v5
  v_mul_u32_u24 v1, 1280, v1
  s_lshl_b32 s5, s65, 5
  s_lshl_b32 s7, s3, 3
  s_add_u32 s5, s5, s7
  v_add_u32 v1, s5, v1
  v_mov_b32 v9, 0x20000000
  v_cmp_gt_u32 vcc, 32, v0
  s_nop 1
  v_cndmask_b32 v245, v9, v1, vcc
  v_mov_b32 v10, 0x4444
  v_mov_b32 v11, 0xeeee
  v_and_b32 v1, 2, v0
  v_cmp_eq_u32 vcc, 0, v1
  s_nop 1
  v_cndmask_b32 v246, v11, v10, vcc
  v_and_b32 v1, 1, v0
  v_cmp_eq_u32 vcc, 0, v1
  v_mov_b32 v10, 0x3f80
  v_mov_b32 v11, 1.0
  v_cndmask_b32 v10, v11, v10, vcc
  v_cmp_eq_u32 vcc, 0, v3
  s_nop 1
  v_cndmask_b32 v11, 0, v10, vcc
  v_cmp_eq_u32 vcc, 1, v3
  s_nop 1
  v_cndmask_b32 v12, 0, v10, vcc
  v_accvgpr_write_b32 a240, v11
  v_accvgpr_write_b32 a241, v12
  v_accvgpr_write_b32 a242, v11
  v_accvgpr_write_b32 a243, v12
  v_and_b32 v1, 3, v0
  v_lshlrev_b32 v248, 2, v1
  v_min_u32 v1, 39, v0
  v_lshlrev_b32 v249, 2, v1
  s_lshl_b32 s80, s64, 8
  s_add_u32 s80, s80, 2043904
  s_mov_b32 s76, 0
  s_mov_b32 s77, 0
  s_mov_b32 s78, s64
  s_mov_b32 s93, 0x3dd53b95
  s_lshl_b32 s79, s61, 8
  s_add_u32 s79, s79, 2031616
  v_cmp_gt_u32 s[86:87], 32, v0
  v_lshl_add_u32 v1, v2, 2, 0
  v_cmp_le_u32 vcc, v1, v5
  s_cmp_eq_u32 s6, 0
  s_cselect_b64 s[66:67], 0, vcc
  s_cselect_b64 s[32:33], vcc, -1
  v_lshl_add_u32 v1, v2, 2, 1
  v_cmp_le_u32 vcc, v1, v5
  s_cmp_eq_u32 s6, 0
  s_cselect_b64 s[68:69], 0, vcc
  s_cselect_b64 s[34:35], vcc, -1
  v_lshl_add_u32 v1, v2, 2, 2
  v_cmp_le_u32 vcc, v1, v5
  s_cmp_eq_u32 s6, 0
  s_cselect_b64 s[70:71], 0, vcc
  s_cselect_b64 s[36:37], vcc, -1
  v_lshl_add_u32 v1, v2, 2, 3
  v_cmp_le_u32 vcc, v1, v5
  s_cmp_eq_u32 s6, 0
  s_cselect_b64 s[72:73], 0, vcc
  s_cselect_b64 s[38:39], vcc, -1
  s_branch L_wt_38_in
L_wt_38:
  s_sleep 8
L_wt_38_in:
  s_sub_u32 s59, s59, 1
  s_cbranch_scc1 L_end
  buffer_load_dword v250, v248, s[8:11], s79 offen sc1
  s_waitcnt vmcnt(0)
  v_cmp_gt_u32 vcc, 32, v250
  s_cbranch_vccnz L_wt_38
  s_lshl_b32 s7, s78, 5
  s_add_u32 s7, s7, s61
  s_mul_i32 s7, s7, 12288
  s_add_u32 s5, s7, 73924608
  s_add_u32 s6, s7, 23592960
  s_add_u32 s7, s7, 48758784
  s_add_u32 s7, s7, s84
  buffer_load_dwordx2 v[0:1], v241, s[8:11], s5 offen offset:0 sc1
  buffer_load_dwordx4 v[24:27], v240, s[8:11], s6 offen offset:0 sc1
  buffer_load_dwordx2 v[2:3], v241, s[8:11], s5 offen offset:1024 sc1
  buffer_load_dwordx4 v[28:31], v240, s[8:11], s6 offen offset:1024 sc1
  buffer_load_dwordx2 v[4:5], v241, s[8:11], s5 offen offset:2048 sc1
  buffer_load_dwordx4 v[32:35], v240, s[8:11], s6 offen offset:2048 sc1
  buffer_load_dwordx2 v[6:7], v241, s[8:11], s5 offen offset:3072 sc1
  buffer_load_dwordx4 v[36:39], v240, s[8:11], s6 offen offset:3072 sc1
  s_add_u32 s5, s5, 4096
  s_add_u32 s6, s6, 4096
  buffer_load_dwordx2 v[8:9], v241, s[8:11], s5 offen offset:0 sc1
  buffer_load_dwordx4 v[40:43], v240, s[8:11], s6 offen offset:0 sc1
  buffer_load_dwordx2 v[10:11], v241, s[8:11], s5 offen offset:1024 sc1
  buffer_load_dwordx4 v[44:47], v240, s[8:11], s6 offen offset:1024 sc1
  buffer_load_dwordx2 v[12:13], v241, s[8:11], s5 offen offset:2048 sc1
  buffer_load_dwordx4 v[48:51], v240, s[8:11], s6 offen offset:2048 sc1
  buffer_load_dwordx2 v[14:15], v241, s[8:11], s5 offen offset:3072 sc1
  buffer_load_dwordx4 v[52:55], v240, s[8:11], s6 offen offset:3072 sc1
  s_add_u32 s5, s5, 4096
  s_add_u32 s6, s6, 4096
  buffer_load_dwordx2 v[16:17], v241, s[8:11], s5 offen offset:0 sc1
  buffer_load_dwordx4 v[56:59], v240, s[8:11], s6 offen offset:0 sc1
  buffer_load_dwordx2 v[18:19], v241, s[8:11], s5 offen offset:1024 sc1
  buffer_load_dwordx4 v[60:63], v240, s[8:11], s6 offen offset:1024 sc1
  buffer_load_dwordx2 v[20:21], v241, s[8:11], s5 offen offset:2048 sc1
  buffer_load_dwordx4 v[64:67], v240, s[8:11], s6 offen offset:2048 sc1
  buffer_load_dwordx2 v[22:23], v241, s[8:11], s5 offen offset:3072 sc1
  buffer_load_dwordx4 v[68:71], v240, s[8:11], s6 offen offset:3072 sc1
  buffer_load_dwordx4 v[72:75], v240, s[8:11], s7 offen offset:0 sc1
  buffer_load_dwordx4 v[76:79], v240, s[8:11], s7 offen offset:1024 sc1
  buffer_load_dwordx4 v[80:83], v240, s[8:11], s7 offen offset:2048 sc1
  buffer_load_dwordx4 v[84:87], v240, s[8:11], s7 offen offset:3072 sc1
  s_add_u32 s7, s7, 4096
  buffer_load_dwordx4 v[88:91], v240, s[8:11], s7 offen offset:0 sc1
  buffer_load_dwordx4 v[92:95], v240, s[8:11], s7 offen offset:1024 sc1
  v_mov_b32 v253, 0
L_w2k_39:
  s_waitcnt vmcnt(6)
  v_swap_b32 v26, v28
  v_swap_b32 v27, v29
  v_swap_b32 v34, v36
  v_swap_b32 v35, v37
  v_swap_b32 v42, v44
  v_swap_b32 v43, v45
  v_swap_b32 v50, v52
  v_swap_b32 v51, v53
  v_swap_b32 v58, v60
  v_swap_b32 v59, v61
  v_swap_b32 v66, v68
  v_swap_b32 v67, v69
  v_mfma_f32_16x16x32_bf16 v[132:135], v[24:27], v[0:3], 0
  v_mfma_f32_16x16x32_bf16 v[136:139], v[28:31], v[0:3], 0
  v_mfma_f32_16x16x32_bf16 v[132:135], v[32:35], v[4:7], v[132:135]
  v_mfma_f32_16x16x32_bf16 v[136:139], v[36:39], v[4:7], v[136:139]
  v_mfma_f32_16x16x32_bf16 v[132:135], v[40:43], v[8:11], v[132:135]
  v_mfma_f32_16x16x32_bf16 v[136:139], v[44:47], v[8:11], v[136:139]
  v_mfma_f32_16x16x32_bf16 v[132:135], v[48:51], v[12:15], v[132:135]
  v_mfma_f32_16x16x32_bf16 v[136:139], v[52:55], v[12:15], v[136:139]
  v_mfma_f32_16x16x32_bf16 v[132:135], v[56:59], v[16:19], v[132:135]
  v_mfma_f32_16x16x32_bf16 v[136:139], v[60:63], v[16:19], v[136:139]
  v_mfma_f32_16x16x32_bf16 v[132:135], v[64:67], v[20:23], v[132:135]
  v_mfma_f32_16x16x32_bf16 v[136:139], v[68:71], v[20:23], v[136:139]
  s_branch L_wm2_41
  s_branch L_wm_40_in
L_wm_40:
  s_cmp_ge_u32 s76, 14
  s_cbranch_scc1 L_wm_40_in
  s_sleep 48
L_wm_40_in:
  s_sub_u32 s59, s59, 1
  s_cbranch_scc1 L_end
  buffer_load_dword v253, v248, s[8:11], s79 offen offset:128 sc1
  s_waitcnt vmcnt(0)
L_wm2_41:
  v_readlane_b32 s5, v253, 0
  v_readlane_b32 s6, v253, 1
  v_readlane_b32 s7, v253, 2
  s_min_u32 s5, s5, s6
  s_min_u32 s5, s5, s7
  s_cmp_le_u32 s5, s78
  s_cbranch_scc1 L_wm_40
  s_lshl_b32 s5, s78, 5
  s_add_u32 s5, s5, s61
  s_mul_i32 s5, s5, 3072
  s_add_u32 s6, s5, 11010048
  s_add_u32 s5, s5, 4718592
  buffer_load_dwordx4 v[96:99], v242, s[8:11], s5 offen offset:0 sc1
  buffer_load_dwordx4 v[100:103], v242, s[8:11], s5 offen offset:512 sc1
  buffer_load_dwordx4 v[104:107], v242, s[8:11], s5 offen offset:1024 sc1
  buffer_load_dwordx4 v[108:111], v242, s[8:11], s5 offen offset:1536 sc1
  buffer_load_dwordx4 v[112:115], v242, s[8:11], s5 offen offset:2048 sc1
  buffer_load_dwordx4 v[116:119], v242, s[8:11], s5 offen offset:2560 sc1
  buffer_load_dwordx2 v[120:121], v243, s[8:11], s6 offen offset:0 sc1
  buffer_load_dwordx2 v[122:123], v243, s[8:11], s6 offen offset:256 sc1
  buffer_load_dwordx2 v[124:125], v243, s[8:11], s6 offen offset:512 sc1
  buffer_load_dwordx2 v[126:127], v243, s[8:11], s6 offen offset:768 sc1
  buffer_load_dwordx2 v[128:129], v243, s[8:11], s6 offen offset:1024 sc1
  buffer_load_dwordx2 v[130:131], v243, s[8:11], s6 offen offset:1280 sc1
  v_mov_b32 v252, 0xff800000
  v_cndmask_b32 v132, v252, v132, s[32:33]
  v_cndmask_b32 v136, v252, v136, s[66:67]
  v_cndmask_b32 v133, v252, v133, s[34:35]
  v_cndmask_b32 v137, v252, v137, s[68:69]
  v_cndmask_b32 v134, v252, v134, s[36:37]
  v_cndmask_b32 v138, v252, v138, s[70:71]
  v_cndmask_b32 v135, v252, v135, s[38:39]
  v_cndmask_b32 v139, v252, v139, s[72:73]
  s_waitcnt vmcnt(11)
  v_mfma_f32_16x16x32_bf16 v[140:143], v[96:99], v[0:3], 0
  s_waitcnt vmcnt(10)
  v_mfma_f32_16x16x32_bf16 v[140:143], v[100:103], v[4:7], v[140:143]
  s_waitcnt vmcnt(9)
  v_mfma_f32_16x16x32_bf16 v[140:143], v[104:107], v[8:11], v[140:143]
  s_waitcnt vmcnt(8)
  v_mfma_f32_16x16x32_bf16 v[140:143], v[108:111], v[12:15], v[140:143]
  s_waitcnt vmcnt(7)
  v_mfma_f32_16x16x32_bf16 v[140:143], v[112:115], v[16:19], v[140:143]
  s_waitcnt vmcnt(6)
  v_mfma_f32_16x16x32_bf16 v[140:143], v[116:119], v[20:23], v[140:143]
  s_nop 7
  v_cndmask_b32 v140, v252, v140, s[86:87]
  v_cndmask_b32 v141, v252, v141, s[86:87]
  v_cndmask_b32 v142, v252, v142, s[86:87]
  v_cndmask_b32 v143, v252, v143, s[86:87]
  v_max3_f32 v250, v132, v133, v134
  v_max3_f32 v250, v250, v135, v136
  v_max3_f32 v250, v250, v137, v138
  v_max3_f32 v250, v250, v139, v140
  v_max3_f32 v250, v250, v141, v142
  v_max_f32 v250, v250, v143
  v_mov_b32 v251, v250
  s_nop 1
  v_permlane16_swap_b32 v250, v251
  v_max_f32 v250, v250, v251
  v_mov_b32 v251, v250
  s_nop 1
  v_permlane32_swap_b32 v250, v251
  v_max_f32 v250, v250, v251
  v_sub_f32 v132, v132, v250
  v_sub_f32 v133, v133, v250
  v_sub_f32 v134, v134, v250
  v_sub_f32 v135, v135, v250
  v_sub_f32 v136, v136, v250
  v_sub_f32 v137, v137, v250
  v_sub_f32 v138, v138, v250
  v_sub_f32 v139, v139, v250
  v_sub_f32 v140, v140, v250
  v_sub_f32 v141, v141, v250
  v_sub_f32 v142, v142, v250
  v_sub_f32 v143, v143, v250
  v_mul_f32 v132, s93, v132
  v_mul_f32 v133, s93, v133
  v_mul_f32 v134, s93, v134
  v_mul_f32 v135, s93, v135
  v_mul_f32 v136, s93, v136
  v_mul_f32 v137, s93, v137
  v_mul_f32 v138, s93, v138
  v_mul_f32 v139, s93, v139
  v_mul_f32 v140, s93, v140
  v_mul_f32 v141, s93, v141
  v_mul_f32 v142, s93, v142
  v_mul_f32 v143, s93, v143
  v_exp_f32 v132, v132
  v_exp_f32 v133, v133
  v_exp_f32 v134, v134
  v_exp_f32 v135, v135
  v_exp_f32 v136, v136
  v_exp_f32 v137, v137
  v_exp_f32 v138, v138
  v_exp_f32 v139, v139
  v_exp_f32 v140, v140
  v_exp_f32 v141, v141
  v_exp_f32 v142, v142
  v_exp_f32 v143, v143
  v_cvt_pk_bf16_f32 v144, v132, v133
  v_cvt_pk_bf16_f32 v145, v136, v137
  v_cvt_pk_bf16_f32 v146, v134, v135
  v_cvt_pk_bf16_f32 v147, v138, v139
  v_cvt_pk_bf16_f32 v148, v140, v141
  v_cvt_pk_bf16_f32 v149, v142, v143
  v_add_f32 v250, v132, v133
  s_waitcnt vmcnt(0)
  v_mfma_f32_16x16x32_bf16 v[152:155], v[72:75], v[144:147], 0
  v_mfma_f32_16x16x32_bf16 v[156:159], v[76:79], v[144:147], 0
  v_mfma_f32_16x16x32_bf16 v[160:163], v[80:83], v[144:147], 0
  v_mfma_f32_16x16x32_bf16 v[164:167], v[84:87], v[144:147], 0
  v_mfma_f32_16x16x32_bf16 v[168:171], v[88:91], v[144:147], 0
  v_mfma_f32_16x16x32_bf16 v[172:175], v[92:95], v[144:147], 0
  v_add_f32 v250, v250, v134
  v_add_f32 v250, v250, v135
  v_add_f32 v250, v250, v136
  v_add_f32 v250, v250, v137
  v_add_f32 v250, v250, v138
  v_add_f32 v250, v250, v139
  v_add_f32 v250, v250, v140
  v_add_f32 v250, v250, v141
  v_add_f32 v250, v250, v142
  v_add_f32 v250, v250, v143
  v_mfma_f32_16x16x16_bf16 v[152:155], v[120:121], v[148:149], v[152:155]
  v_mfma_f32_16x16x16_bf16 v[156:159], v[122:123], v[148:149], v[156:159]
  v_mfma_f32_16x16x16_bf16 v[160:163], v[124:125], v[148:149], v[160:163]
  v_mfma_f32_16x16x16_bf16 v[164:167], v[126:127], v[148:149], v[164:167]
  v_mfma_f32_16x16x16_bf16 v[168:171], v[128:129], v[148:149], v[168:171]
  v_mfma_f32_16x16x16_bf16 v[172:175], v[130:131], v[148:149], v[172:175]
  v_mov_b32 v251, v250
  s_nop 1
  v_permlane16_swap_b32 v250, v251
  v_add_f32 v250, v250, v251
  v_mov_b32 v251, v250
  s_nop 1
  v_permlane32_swap_b32 v250, v251
  v_add_f32 v250, v250, v251
  v_rcp_f32 v250, v250
  s_nop 0
  v_mul_f32 v152, v152, v250
  v_mul_f32 v153, v153, v250
  v_mul_f32 v154, v154, v250
  v_mul_f32 v155, v155, v250
  v_cvt_pk_bf16_f32 v224, v152, v153
  v_cvt_pk_bf16_f32 v225, v154, v155
  v_mul_f32 v156, v156, v250
  v_mul_f32 v157, v157, v250
  v_mul_f32 v158, v158, v250
  v_mul_f32 v159, v159, v250
  v_cvt_pk_bf16_f32 v226, v156, v157
  v_cvt_pk_bf16_f32 v227, v158, v159
  ds_write_b128 v247, v[224:227] offset:0
  v_mul_f32 v160, v160, v250
  v_mul_f32 v161, v161, v250
  v_mul_f32 v162, v162, v250
  v_mul_f32 v163, v163, v250
  v_cvt_pk_bf16_f32 v228, v160, v161
  v_cvt_pk_bf16_f32 v229, v162, v163
  v_mul_f32 v164, v164, v250
  v_mul_f32 v165, v165, v250
  v_mul_f32 v166, v166, v250
  v_mul_f32 v167, v167, v250
  v_cvt_pk_bf16_f32 v230, v164, v165
  v_cvt_pk_bf16_f32 v231, v166, v167
  ds_write_b128 v247, v[228:231] offset:1024
  v_mul_f32 v168, v168, v250
  v_mul_f32 v169, v169, v250
  v_mul_f32 v170, v170, v250
  v_mul_f32 v171, v171, v250
  v_cvt_pk_bf16_f32 v232, v168, v169
  v_cvt_pk_bf16_f32 v233, v170, v171
  v_mul_f32 v172, v172, v250
  v_mul_f32 v173, v173, v250
  v_mul_f32 v174, v174, v250
  v_mul_f32 v175, v175, v250
  v_cvt_pk_bf16_f32 v234, v172, v173
  v_cvt_pk_bf16_f32 v235, v174, v175
  ds_write_b128 v247, v[232:235] offset:2048
  s_waitcnt lgkmcnt(0)
  s_barrier
  ds_read_b128 v[176:179], v240 offset:0
  ds_read_b128 v[184:187], v240 offset:1024
  ds_read_b128 v[192:195], v240 offset:2048
  ds_read_b128 v[200:203], v240 offset:3072
  ds_read_b128 v[208:211], v240 offset:4096
  ds_read_b128 v[216:219], v240 offset:5120
  ds_read_b128 v[180:183], v240 offset:6144
  ds_read_b128 v[188:191], v240 offset:7168
  ds_read_b128 v[196:199], v240 offset:8192
  ds_read_b128 v[204:207], v240 offset:9216
  ds_read_b128 v[212:215], v240 offset:10240
  ds_read_b128 v[220:223], v240 offset:11264
  s_mul_i32 s81, s78, 40
  s_mul_i32 s5, s3, 10
  s_add_u32 s81, s81, s5
  s_mul_i32 s81, s81, 40
  s_add_u32 s81, s81, s65
  s_lshl_b32 s81, s81, 10
  s_add_u32 s81, s81, 99090432
  s_add_u32 s78, s78, 4
  s_cmp_ge_u32 s78, 64
  s_cbranch_scc1 L_w2n_42
  s_lshl_b32 s7, s78, 5
  s_add_u32 s7, s7, s61
  s_mul_i32 s7, s7, 12288
  s_add_u32 s5, s7, 73924608
  s_add_u32 s6, s7, 23592960
  s_add_u32 s7, s7, 48758784
  s_add_u32 s7, s7, s84
  buffer_load_dwordx2 v[0:1], v241, s[8:11], s5 offen offset:0 sc1
  buffer_load_dwordx4 v[24:27], v240, s[8:11], s6 offen offset:0 sc1
  buffer_load_dwordx2 v[2:3], v241, s[8:11], s5 offen offset:1024 sc1
  buffer_load_dwordx4 v[28:31], v240, s[8:11], s6 offen offset:1024 sc1
  buffer_load_dwordx2 v[4:5], v241, s[8:11], s5 offen offset:2048 sc1
  buffer_load_dwordx4 v[32:35], v240, s[8:11], s6 offen offset:2048 sc1
  buffer_load_dwordx2 v[6:7], v241, s[8:11], s5 offen offset:3072 sc1
  buffer_load_dwordx4 v[36:39], v240, s[8:11], s6 offen offset:3072 sc1
  s_add_u32 s5, s5, 4096
  s_add_u32 s6, s6, 4096
  buffer_load_dwordx2 v[8:9], v241, s[8:11], s5 offen offset:0 sc1
  buffer_load_dwordx4 v[40:43], v240, s[8:11], s6 offen offset:0 sc1
  buffer_load_dwordx2 v[10:11], v241, s[8:11], s5 offen offset:1024 sc1
  buffer_load_dwordx4 v[44:47], v240, s[8:11], s6 offen offset:1024 sc1
  buffer_load_dwordx2 v[12:13], v241, s[8:11], s5 offen offset:2048 sc1
  buffer_load_dwordx4 v[48:51], v240, s[8:11], s6 offen offset:2048 sc1
  buffer_load_dwordx2 v[14:15], v241, s[8:11], s5 offen offset:3072 sc1
  buffer_load_dwordx4 v[52:55], v240, s[8:11], s6 offen offset:3072 sc1
  s_add_u32 s5, s5, 4096
  s_add_u32 s6, s6, 4096
  buffer_load_dwordx2 v[16:17], v241, s[8:11], s5 offen offset:0 sc1
  buffer_load_dwordx4 v[56:59], v240, s[8:11], s6 offen offset:0 sc1
  buffer_load_dwordx2 v[18:19], v241, s[8:11], s5 offen offset:1024 sc1
  buffer_load_dwordx4 v[60:63], v240, s[8:11], s6 offen offset:1024 sc1
  buffer_load_dwordx2 v[20:21], v241, s[8:11], s5 offen offset:2048 sc1
  buffer_load_dwordx4 v[64:67], v240, s[8:11], s6 offen offset:2048 sc1
  buffer_load_dwordx2 v[22:23], v241, s[8:11], s5 offen offset:3072 sc1
  buffer_load_dwordx4 v[68:71], v240, s[8:11], s6 offen offset:3072 sc1
  buffer_load_dwordx4 v[72:75], v240, s[8:11], s7 offen offset:0 sc1
  buffer_load_dwordx4 v[76:79], v240, s[8:11], s7 offen offset:1024 sc1
  buffer_load_dwordx4 v[80:83], v240, s[8:11], s7 offen offset:2048 sc1
  buffer_load_dwordx4 v[84:87], v240, s[8:11], s7 offen offset:3072 sc1
  s_add_u32 s7, s7, 4096
  buffer_load_dwordx4 v[88:91], v240, s[8:11], s7 offen offset:0 sc1
  buffer_load_dwordx4 v[92:95], v240, s[8:11], s7 offen offset:1024 sc1
  buffer_load_dword v253, v248, s[8:11], s79 offen offset:128 sc1
L_w2n_42:
  s_waitcnt lgkmcnt(0)
  v_mfma_f32_16x16x32_bf16 v[96:99], a[0:3], v[176:179], 0
  v_mfma_f32_16x16x32_bf16 v[100:103], a[0:3], v[180:183], 0
  v_mfma_f32_16x16x32_bf16 v[96:99], a[4:7], v[184:187], v[96:99]
  v_mfma_f32_16x16x32_bf16 v[100:103], a[4:7], v[188:191], v[100:103]
  v_mfma_f32_16x16x32_bf16 v[96:99], a[8:11], v[192:195], v[96:99]
  v_mfma_f32_16x16x32_bf16 v[100:103], a[8:11], v[196:199], v[100:103]
  v_mfma_f32_16x16x32_bf16 v[96:99], a[12:15], v[200:203], v[96:99]
  v_mfma_f32_16x16x32_bf16 v[100:103], a[12:15], v[204:207], v[100:103]
  v_mfma_f32_16x16x32_bf16 v[96:99], a[16:19], v[208:211], v[96:99]
  v_mfma_f32_16x16x32_bf16 v[100:103], a[16:19], v[212:215], v[100:103]
  v_mfma_f32_16x16x32_bf16 v[96:99], a[20:23], v[216:219], v[96:99]
  v_mfma_f32_16x16x32_bf16 v[100:103], a[20:23], v[220:223], v[100:103]
  v_mfma_f32_16x16x32_bf16 v[104:107], a[24:27], v[176:179], 0
  v_mfma_f32_16x16x32_bf16 v[108:111], a[24:27], v[180:183], 0
  v_mfma_f32_16x16x32_bf16 v[104:107], a[28:31], v[184:187], v[104:107]
  v_mfma_f32_16x16x32_bf16 v[108:111], a[28:31], v[188:191], v[108:111]
  v_mfma_f32_16x16x32_bf16 v[104:107], a[32:35], v[192:195], v[104:107]
  v_mfma_f32_16x16x32_bf16 v[108:111], a[32:35], v[196:199], v[108:111]
  v_mfma_f32_16x16x32_bf16 v[104:107], a[36:39], v[200:203], v[104:107]
  v_mfma_f32_16x16x32_bf16 v[108:111], a[36:39], v[204:207], v[108:111]
  v_mfma_f32_16x16x32_bf16 v[104:107], a[40:43], v[208:211], v[104:107]
  v_mfma_f32_16x16x32_bf16 v[108:111], a[40:43], v[212:215], v[108:111]
  v_cvt_pk_bf16_f32 v228, v96, v97
  v_cvt_pk_bf16_f32 v229, v98, v99
  v_cvt_pk_bf16_f32 v230, v100, v101
  v_cvt_pk_bf16_f32 v231, v102, v103
  buffer_store_dwordx4 v[228:231], v240, s[8:11], s81 offen sc1
  s_add_u32 s81, s81, 40960
  v_mfma_f32_16x16x32_bf16 v[104:107], a[44:47], v[216:219], v[104:107]
  v_mfma_f32_16x16x32_bf16 v[108:111], a[44:47], v[220:223], v[108:111]
  v_mfma_f32_16x16x32_bf16 v[112:115], a[48:51], v[176:179], 0
  v_mfma_f32_16x16x32_bf16 v[116:119], a[48:51], v[180:183], 0
  v_mfma_f32_16x16x32_bf16 v[112:115], a[52:55], v[184:187], v[112:115]
  v_mfma_f32_16x16x32_bf16 v[116:119], a[52:55], v[188:191], v[116:119]
  v_mfma_f32_16x16x32_bf16 v[112:115], a[56:59], v[192:195], v[112:115]
  v_mfma_f32_16x16x32_bf16 v[116:119], a[56:59], v[196:199], v[116:119]
  v_mfma_f32_16x16x32_bf16 v[112:115], a[60:63], v[200:203], v[112:115]
  v_mfma_f32_16x16x32_bf16 v[116:119], a[60:63], v[204:207], v[116:119]
  v_mfma_f32_16x16x32_bf16 v[112:115], a[64:67], v[208:211], v[112:115]
  v_mfma_f32_16x16x32_bf16 v[116:119], a[64:67], v[212:215], v[116:119]
  v_cvt_pk_bf16_f32 v224, v104, v105
  v_cvt_pk_bf16_f32 v225, v106, v107
  v_cvt_pk_bf16_f32 v226, v108, v109
  v_cvt_pk_bf16_f32 v227, v110, v111
  buffer_store_dwordx4 v[224:227], v240, s[8:11], s81 offen sc1
  s_add_u32 s81, s81, 40960
  v_mfma_f32_16x16x32_bf16 v[112:115], a[68:71], v[216:219], v[112:115]
  v_mfma_f32_16x16x32_bf16 v[116:119], a[68:71], v[220:223], v[116:119]
  v_mfma_f32_16x16x32_bf16 v[120:123], a[72:75], v[176:179], 0
  v_mfma_f32_16x16x32_bf16 v[124:127], a[72:75], v[180:183], 0
  v_mfma_f32_16x16x32_bf16 v[120:123], a[76:79], v[184:187], v[120:123]
  v_mfma_f32_16x16x32_bf16 v[124:127], a[76:79], v[188:191], v[124:127]
  v_mfma_f32_16x16x32_bf16 v[120:123], a[80:83], v[192:195], v[120:123]
  v_mfma_f32_16x16x32_bf16 v[124:127], a[80:83], v[196:199], v[124:127]
  v_mfma_f32_16x16x32_bf16 v[120:123], a[84:87], v[200:203], v[120:123]
  v_mfma_f32_16x16x32_bf16 v[124:127], a[84:87], v[204:207], v[124:127]
  v_mfma_f32_16x16x32_bf16 v[120:123], a[88:91], v[208:211], v[120:123]
  v_mfma_f32_16x16x32_bf16 v[124:127], a[88:91], v[212:215], v[124:127]
  v_cvt_pk_bf16_f32 v228, v112, v113
  v_cvt_pk_bf16_f32 v229, v114, v115
  v_cvt_pk_bf16_f32 v230, v116, v117
  v_cvt_pk_bf16_f32 v231, v118, v119
  buffer_store_dwordx4 v[228:231], v240, s[8:11], s81 offen sc1
  s_add_u32 s81, s81, 40960
  v_mfma_f32_16x16x32_bf16 v[120:123], a[92:95], v[216:219], v[120:123]
  v_mfma_f32_16x16x32_bf16 v[124:127], a[92:95], v[220:223], v[124:127]
  v_mfma_f32_16x16x32_bf16 v[128:131], a[96:99], v[176:179], 0
  v_mfma_f32_16x16x32_bf16 v[132:135], a[96:99], v[180:183], 0
  v_mfma_f32_16x16x32_bf16 v[128:131], a[100:103], v[184:187], v[128:131]
  v_mfma_f32_16x16x32_bf16 v[132:135], a[100:103], v[188:191], v[132:135]
  v_mfma_f32_16x16x32_bf16 v[128:131], a[104:107], v[192:195], v[128:131]
  v_mfma_f32_16x16x32_bf16 v[132:135], a[104:107], v[196:199], v[132:135]
  v_mfma_f32_16x16x32_bf16 v[128:131], a[108:111], v[200:203], v[128:131]
  v_mfma_f32_16x16x32_bf16 v[132:135], a[108:111], v[204:207], v[132:135]
  v_mfma_f32_16x16x32_bf16 v[128:131], a[112:115], v[208:211], v[128:131]
  v_mfma_f32_16x16x32_bf16 v[132:135], a[112:115], v[212:215], v[132:135]
  v_cvt_pk_bf16_f32 v224, v120, v121
  v_cvt_pk_bf16_f32 v225, v122, v123
  v_cvt_pk_bf16_f32 v226, v124, v125
  v_cvt_pk_bf16_f32 v227, v126, v127
  buffer_store_dwordx4 v[224:227], v240, s[8:11], s81 offen sc1
  s_add_u32 s81, s81, 40960
  v_mfma_f32_16x16x32_bf16 v[128:131], a[116:119], v[216:219], v[128:131]
  v_mfma_f32_16x16x32_bf16 v[132:135], a[116:119], v[220:223], v[132:135]
  v_mfma_f32_16x16x32_bf16 v[136:139], a[120:123], v[176:179], 0
  v_mfma_f32_16x16x32_bf16 v[140:143], a[120:123], v[180:183], 0
  v_mfma_f32_16x16x32_bf16 v[136:139], a[124:127], v[184:187], v[136:139]
  v_mfma_f32_16x16x32_bf16 v[140:143], a[124:127], v[188:191], v[140:143]
  v_mfma_f32_16x16x32_bf16 v[136:139], a[128:131], v[192:195], v[136:139]
  v_mfma_f32_16x16x32_bf16 v[140:143], a[128:131], v[196:199], v[140:143]
  v_mfma_f32_16x16x32_bf16 v[136:139], a[132:135], v[200:203], v[136:139]
  v_mfma_f32_16x16x32_bf16 v[140:143], a[132:135], v[204:207], v[140:143]
  v_mfma_f32_16x16x32_bf16 v[136:139], a[136:139], v[208:211], v[136:139]
  v_mfma_f32_16x16x32_bf16 v[140:143], a[136:139], v[212:215], v[140:143]
  v_cvt_pk_bf16_f32 v228, v128, v129
  v_cvt_pk_bf16_f32 v229, v130, v131
  v_cvt_pk_bf16_f32 v230, v132, v133
  v_cvt_pk_bf16_f32 v231, v134, v135
  buffer_store_dwordx4 v[228:231], v240, s[8:11], s81 offen sc1
  s_add_u32 s81, s81, 40960
  v_mfma_f32_16x16x32_bf16 v[136:139], a[140:143], v[216:219], v[136:139]
  v_mfma_f32_16x16x32_bf16 v[140:143], a[140:143], v[220:223], v[140:143]
  v_mfma_f32_16x16x32_bf16 v[144:147], a[144:147], v[176:179], 0
  v_mfma_f32_16x16x32_bf16 v[148:151], a[144:147], v[180:183], 0
  v_mfma_f32_16x16x32_bf16 v[144:147], a[148:151], v[184:187], v[144:147]
  v_mfma_f32_16x16x32_bf16 v[148:151], a[148:151], v[188:191], v[148:151]
  v_mfma_f32_16x16x32_bf16 v[144:147], a[152:155], v[192:195], v[144:147]
  v_mfma_f32_16x16x32_bf16 v[148:151], a[152:155], v[196:199], v[148:151]
  v_mfma_f32_16x16x32_bf16 v[144:147], a[156:159], v[200:203], v[144:147]
  v_mfma_f32_16x16x32_bf16 v[148:151], a[156:159], v[204:207], v[148:151]
  v_mfma_f32_16x16x32_bf16 v[144:147], a[160:163], v[208:211], v[144:147]
  v_mfma_f32_16x16x32_bf16 v[148:151], a[160:163], v[212:215], v[148:151]
  v_cvt_pk_bf16_f32 v224, v136, v137
  v_cvt_pk_bf16_f32 v225, v138, v139
  v_cvt_pk_bf16_f32 v226, v140, v141
  v_cvt_pk_bf16_f32 v227, v142, v143
  buffer_store_dwordx4 v[224:227], v240, s[8:11], s81 offen sc1
  s_add_u32 s81, s81, 40960
  v_mfma_f32_16x16x32_bf16 v[144:147], a[164:167], v[216:219], v[144:147]
  v_mfma_f32_16x16x32_bf16 v[148:151], a[164:167], v[220:223], v[148:151]
  v_mfma_f32_16x16x32_bf16 v[152:155], a[168:171], v[176:179], 0
  v_mfma_f32_16x16x32_bf16 v[156:159], a[168:171], v[180:183], 0
  v_mfma_f32_16x16x32_bf16 v[152:155], a[172:175], v[184:187], v[152:155]
  v_mfma_f32_16x16x32_bf16 v[156:159], a[172:175], v[188:191], v[156:159]
  v_mfma_f32_16x16x32_bf16 v[152:155], a[176:179], v[192:195], v[152:155]
  v_mfma_f32_16x16x32_bf16 v[156:159], a[176:179], v[196:199], v[156:159]
  v_mfma_f32_16x16x32_bf16 v[152:155], a[180:183], v[200:203], v[152:155]
  v_mfma_f32_16x16x32_bf16 v[156:159], a[180:183], v[204:207], v[156:159]
  v_mfma_f32_16x16x32_bf16 v[152:155], a[184:187], v[208:211], v[152:155]
  v_mfma_f32_16x16x32_bf16 v[156:159], a[184:187], v[212:215], v[156:159]
  v_cvt_pk_bf16_f32 v228, v144, v145
  v_cvt_pk_bf16_f32 v229, v146, v147
  v_cvt_pk_bf16_f32 v230, v148, v149
  v_cvt_pk_bf16_f32 v231, v150, v151
  buffer_store_dwordx4 v[228:231], v240, s[8:11], s81 offen sc1
  s_add_u32 s81, s81, 40960
  v_mfma_f32_16x16x32_bf16 v[152:155], a[188:191], v[216:219], v[152:155]
  v_mfma_f32_16x16x32_bf16 v[156:159], a[188:191], v[220:223], v[156:159]
  v_mfma_f32_16x16x32_bf16 v[160:163], a[192:195], v[176:179], 0
  v_mfma_f32_16x16x32_bf16 v[164:167], a[192:195], v[180:183], 0
  v_mfma_f32_16x16x32_bf16 v[160:163], a[196:199], v[184:187], v[160:163]
  v_mfma_f32_16x16x32_bf16 v[164:167], a[196:199], v[188:191], v[164:167]
  v_mfma_f32_16x16x32_bf16 v[160:163], a[200:203], v[192:195], v[160:163]
  v_mfma_f32_16x16x32_bf16 v[164:167], a[200:203], v[196:199], v[164:167]
  v_mfma_f32_16x16x32_bf16 v[160:163], a[204:207], v[200:203], v[160:163]
  v_mfma_f32_16x16x32_bf16 v[164:167], a[204:207], v[204:207], v[164:167]
  v_mfma_f32_16x16x32_bf16 v[160:163], a[208:211], v[208:211], v[160:163]
  v_mfma_f32_16x16x32_bf16 v[164:167], a[208:211], v[212:215], v[164:167]
  v_cvt_pk_bf16_f32 v224, v152, v153
  v_cvt_pk_bf16_f32 v225, v154, v155
  v_cvt_pk_bf16_f32 v226, v156, v157
  v_cvt_pk_bf16_f32 v227, v158, v159
  buffer_store_dwordx4 v[224:227], v240, s[8:11], s81 offen sc1
  s_add_u32 s81, s81, 40960
  v_mfma_f32_16x16x32_bf16 v[160:163], a[212:215], v[216:219], v[160:163]
  v_mfma_f32_16x16x32_bf16 v[164:167], a[212:215], v[220:223], v[164:167]
  v_mfma_f32_16x16x32_bf16 v[168:171], a[216:219], v[176:179], 0
  v_mfma_f32_16x16x32_bf16 v[172:175], a[216:219], v[180:183], 0
  v_mfma_f32_16x16x32_bf16 v[168:171], a[220:223], v[184:187], v[168:171]
  v_mfma_f32_16x16x32_bf16 v[172:175], a[220:223], v[188:191], v[172:175]
  v_mfma_f32_16x16x32_bf16 v[168:171], a[224:227], v[192:195], v[168:171]
  v_mfma_f32_16x16x32_bf16 v[172:175], a[224:227], v[196:199], v[172:175]
  v_mfma_f32_16x16x32_bf16 v[168:171], a[228:231], v[200:203], v[168:171]
  v_mfma_f32_16x16x32_bf16 v[172:175], a[228:231], v[204:207], v[172:175]
  v_mfma_f32_16x16x32_bf16 v[168:171], a[232:235], v[208:211], v[168:171]
  v_mfma_f32_16x16x32_bf16 v[172:175], a[232:235], v[212:215], v[172:175]
  v_cvt_pk_bf16_f32 v228, v160, v161
  v_cvt_pk_bf16_f32 v229, v162, v163
  v_cvt_pk_bf16_f32 v230, v164, v165
  v_cvt_pk_bf16_f32 v231, v166, v167
  buffer_store_dwordx4 v[228:231], v240, s[8:11], s81 offen sc1
  s_add_u32 s81, s81, 40960
  v_mfma_f32_16x16x32_bf16 v[168:171], a[236:239], v[216:219], v[168:171]
  v_mfma_f32_16x16x32_bf16 v[172:175], a[236:239], v[220:223], v[172:175]
  s_nop 6
  v_cvt_pk_bf16_f32 v224, v168, v169
  v_cvt_pk_bf16_f32 v225, v170, v171
  v_cvt_pk_bf16_f32 v226, v172, v173
  v_cvt_pk_bf16_f32 v227, v174, v175
  buffer_store_dwordx4 v[224:227], v240, s[8:11], s81 offen sc1
  s_add_u32 s76, s76, 1
  s_add_u32 s5, s77, 1
  s_cmp_ge_u32 s5, s76
  s_cbranch_scc1 L_rno_45
  s_branch L_rf_46_in
L_rf_46:
  s_cmp_ge_u32 s77, 14
  s_cbranch_scc1 L_rf_46_in
  s_sleep 48
L_rf_46_in:
  s_sub_u32 s59, s59, 1
  s_cbranch_scc1 L_end
  buffer_load_dword v250, v249, s[8:11], s80 offen sc1
  s_waitcnt vmcnt(0)
  v_cmp_ge_u32 vcc, s77, v250
  s_cbranch_vccnz L_rf_46
  s_lshl_b32 s5, s77, 2
  s_add_u32 s5, s5, s64
  s_mul_i32 s85, s5, 40960
  s_mul_i32 s5, s5, 40
  s_add_u32 s5, s5, s65
  s_mul_i32 s5, s5, 40960
  s_add_u32 s5, s5, 99090432
  buffer_load_dwordx2 v[232:233], v245, s[12:15], s85 offen
  buffer_load_dwordx4 v[176:179], v244, s[8:11], s5 offen sc1
  s_add_u32 s5, s5, 4096
  buffer_load_dwordx4 v[180:183], v244, s[8:11], s5 offen sc1
  s_add_u32 s5, s5, 4096
  buffer_load_dwordx4 v[184:187], v244, s[8:11], s5 offen sc1
  s_add_u32 s5, s5, 4096
  buffer_load_dwordx4 v[188:191], v244, s[8:11], s5 offen sc1
  s_add_u32 s5, s5, 4096
  buffer_load_dwordx4 v[192:195], v244, s[8:11], s5 offen sc1
  s_add_u32 s5, s5, 4096
  buffer_load_dwordx4 v[196:199], v244, s[8:11], s5 offen sc1
  s_add_u32 s5, s5, 4096
  buffer_load_dwordx4 v[200:203], v244, s[8:11], s5 offen sc1
  s_add_u32 s5, s5, 4096
  buffer_load_dwordx4 v[204:207], v244, s[8:11], s5 offen sc1
  s_add_u32 s5, s5, 4096
  buffer_load_dwordx4 v[208:211], v244, s[8:11], s5 offen sc1
  s_add_u32 s5, s5, 4096
  buffer_load_dwordx4 v[212:215], v244, s[8:11], s5 offen sc1
  s_add_u32 s5, s5, 4096
  s_barrier
  s_lshl_b32 s5, s65, 2
  s_add_u32 s5, s5, s80
  s_cmp_lg_u32 s3, 0
  s_cbranch_scc1 L_fl_47
  v_mov_b32 v250, s76
  s_mov_b64 exec, 1
  buffer_store_dword v250, off, s[8:11], s5 sc1
  s_mov_b64 exec, -1
L_fl_47:
  s_waitcnt vmcnt(10)
  v_lshlrev_b32 v236, 16, v232
  v_and_b32 v237, 0xffff0000, v232
  v_lshlrev_b32 v238, 16, v233
  v_and_b32 v239, 0xffff0000, v233
  s_waitcnt vmcnt(8)
  s_nop 0
  v_smfmac_f32_16x16x64_bf16 v[236:239], a[240:243], v[176:183], v246
  s_waitcnt vmcnt(6)
  v_smfmac_f32_16x16x64_bf16 v[236:239], a[240:243], v[184:191], v246
  s_waitcnt vmcnt(4)
  v_smfmac_f32_16x16x64_bf16 v[236:239], a[240:243], v[192:199], v246
  s_waitcnt vmcnt(2)
  v_smfmac_f32_16x16x64_bf16 v[236:239], a[240:243], v[200:207], v246
  s_waitcnt vmcnt(0)
  v_smfmac_f32_16x16x64_bf16 v[236:239], a[240:243], v[208:215], v246
  s_nop 7
  v_cvt_pk_bf16_f32 v232, v236, v237
  v_cvt_pk_bf16_f32 v233, v238, v239
  buffer_store_dwordx2 v[232:233], v245, s[24:27], s85 offen
  s_add_u32 s77, s77, 1
  s_branch L_r_43
L_rno_45:
  s_waitcnt vmcnt(0)
  s_barrier
  s_lshl_b32 s5, s65, 2
  s_add_u32 s5, s5, s80
  s_cmp_lg_u32 s3, 0
  s_cbranch_scc1 L_fl_48
  v_mov_b32 v250, s76
  s_mov_b64 exec, 1
  buffer_store_dword v250, off, s[8:11], s5 sc1
  s_mov_b64 exec, -1
L_fl_48:
L_r_43:
  s_cmp_le_u32 s76, 12
  s_cbranch_scc1 L_rd_44
  s_branch L_rf_49_in
L_rf_49:
  s_cmp_ge_u32 s77, 14
  s_cbranch_scc1 L_rf_49_in
  s_sleep 48
L_rf_49_in:
  s_sub_u32 s59, s59, 1
  s_cbranch_scc1 L_end
  buffer_load_dword v250, v249, s[8:11], s80 offen sc1
  s_waitcnt vmcnt(0)
  v_cmp_ge_u32 vcc, s77, v250
  s_cbranch_vccnz L_rf_49
  s_lshl_b32 s5, s77, 2
  s_add_u32 s5, s5, s64
  s_mul_i32 s85, s5, 40960
  s_mul_i32 s5, s5, 40
  s_add_u32 s5, s5, s65
  s_mul_i32 s5, s5, 40960
  s_add_u32 s5, s5, 99090432
  buffer_load_dwordx2 v[232:233], v245, s[12:15], s85 offen
  buffer_load_dwordx4 v[176:179], v244, s[8:11], s5 offen sc1
  s_add_u32 s5, s5, 4096
  buffer_load_dwordx4 v[180:183], v244, s[8:11], s5 offen sc1
  s_add_u32 s5, s5, 4096
  buffer_load_dwordx4 v[184:187], v244, s[8:11], s5 offen sc1
  s_add_u32 s5, s5, 4096
  buffer_load_dwordx4 v[188:191], v244, s[8:11], s5 offen sc1
  s_add_u32 s5, s5, 4096
  buffer_load_dwordx4 v[192:195], v244, s[8:11], s5 offen sc1
  s_add_u32 s5, s5, 4096
  buffer_load_dwordx4 v[196:199], v244, s[8:11], s5 offen sc1
  s_add_u32 s5, s5, 4096
  buffer_load_dwordx4 v[200:203], v244, s[8:11], s5 offen sc1
  s_add_u32 s5, s5, 4096
  buffer_load_dwordx4 v[204:207], v244, s[8:11], s5 offen sc1
  s_add_u32 s5, s5, 4096
  buffer_load_dwordx4 v[208:211], v244, s[8:11], s5 offen sc1
  s_add_u32 s5, s5, 4096
  buffer_load_dwordx4 v[212:215], v244, s[8:11], s5 offen sc1
  s_add_u32 s5, s5, 4096
  s_waitcnt vmcnt(10)
  v_lshlrev_b32 v236, 16, v232
  v_and_b32 v237, 0xffff0000, v232
  v_lshlrev_b32 v238, 16, v233
  v_and_b32 v239, 0xffff0000, v233
  s_waitcnt vmcnt(8)
  s_nop 0
  v_smfmac_f32_16x16x64_bf16 v[236:239], a[240:243], v[176:183], v246
  s_waitcnt vmcnt(6)
  v_smfmac_f32_16x16x64_bf16 v[236:239], a[240:243], v[184:191], v246
  s_waitcnt vmcnt(4)
  v_smfmac_f32_16x16x64_bf16 v[236:239], a[240:243], v[192:199], v246
  s_waitcnt vmcnt(2)
  v_smfmac_f32_16x16x64_bf16 v[236:239], a[240:243], v[200:207], v246
  s_waitcnt vmcnt(0)
  v_smfmac_f32_16x16x64_bf16 v[236:239], a[240:243], v[208:215], v246
  s_nop 7
  v_cvt_pk_bf16_f32 v232, v236, v237
  v_cvt_pk_bf16_f32 v233, v238, v239
  buffer_store_dwordx2 v[232:233], v245, s[24:27], s85 offen
  s_add_u32 s77, s77, 1
L_rd_44:
  s_cmp_lt_u32 s76, 16
  s_cbranch_scc1 L_w2k_39
  s_branch L_end
L_chain:
  s_setprio 3
  s_mul_i32 s5, s60, 21846
  s_lshr_b32 s5, s5, 16
  s_mul_i32 s6, s5, 3
  s_sub_u32 s62, s60, s6
  s_lshl_b32 s61, s63, 3
  s_add_u32 s61, s61, s5
  v_mbcnt_lo_u32_b32 v0, -1, 0
  v_mbcnt_hi_u32_b32 v0, -1, v0
  v_lshrrev_b32 v1, 3, v0
  v_and_b32 v2, 7, v0
  v_mul_u32_u24 v4, 12288, v1
  v_lshl_add_u32 v4, v2, 4, v4
  v_lshrrev_b32 v1, 4, v0
  v_and_b32 v2, 15, v0
  v_mul_u32_u24 v5, 1280, v1
  v_lshl_add_u32 v5, v2, 4, v5
  v_lshrrev_b32 v2, 1, v1
  v_xor_b32 v3, v1, v2
  v_and_b32 v3, 1, v3
  v_lshlrev_b32 v3, 2, v3
  v_lshl_add_u32 v3, v2, 3, v3
  v_bfe_u32 v2, v0, 2, 1
  v_add_u32 v3, v3, v2
  v_bfe_u32 v2, v0, 3, 1
  v_lshl_add_u32 v3, v2, 4, v3
  v_and_b32 v2, 3, v0
  v_lshlrev_b32 v2, 3, v2
  v_lshl_add_u32 v1, v3, 7, v2
  v_lshl_add_u32 v22, v3, 8, v2
  s_lshl_b32 s5, s3, 5
  s_add_u32 s5, s5, 16384
  v_add_u32 v1, s5, v1
  v_add_u32 v2, 49152, v1
  v_add_u32 v3, 98304, v1
  s_lshl_b32 s5, s3, 6
  s_add_u32 s5, s5, 16384
  v_add_u32 v22, s5, v22
  v_add_u32 v23, 98304, v22
  s_mul_i32 s78, s61, 384
  s_lshl_b32 s5, s62, 7
  s_add_u32 s78, s78, s5
  s_mul_i32 s79, s61, 245760
  s_lshl_b32 s5, s62, 8
  s_add_u32 s79, s79, s5
  s_mov_b32 s20, s34
  s_and_b32 s21, s35, 0xffff
  s_mov_b32 s22, 10240
  s_mov_b32 s23, 0x20000
  s_mul_i32 s5, s3, 2560
  v_lshlrev_b32 v6, 2, v0
  buffer_load_dword v8, v6, s[20:23], s5 offen offset:0
  buffer_load_dword v9, v6, s[20:23], s5 offen offset:1280
  buffer_load_dword v10, v6, s[20:23], s5 offen offset:256
  buffer_load_dword v11, v6, s[20:23], s5 offen offset:1536
  buffer_load_dword v12, v6, s[20:23], s5 offen offset:512
  buffer_load_dword v13, v6, s[20:23], s5 offen offset:1792
  buffer_load_dword v14, v6, s[20:23], s5 offen offset:768
  buffer_load_dword v15, v6, s[20:23], s5 offen offset:2048
  buffer_load_dword v16, v6, s[20:23], s5 offen offset:1024
  buffer_load_dword v17, v6, s[20:23], s5 offen offset:2304
  s_mov_b32 s16, s36
  s_and_b32 s17, s37, 0xffff
  s_mov_b32 s18, 7864320
  s_mov_b32 s19, 0x20000
  s_mul_i32 s5, s3, 983040
  s_add_u32 s5, s5, s78
  s_add_u32 s5, s5, 0
  s_mul_i32 s6, s3, 10240
  s_add_u32 s6, s6, 16384
  s_add_u32 m0, s6, 0
  s_add_u32 s7, s5, 0
  buffer_load_dwordx4 v4, s[16:19], s7 offen lds
  s_add_u32 m0, s6, 1024
  s_add_u32 s7, s5, 98304
  buffer_load_dwordx4 v4, s[16:19], s7 offen lds
  s_add_u32 m0, s6, 2048
  s_add_u32 s7, s5, 196608
  buffer_load_dwordx4 v4, s[16:19], s7 offen lds
  s_add_u32 m0, s6, 3072
  s_add_u32 s7, s5, 294912
  buffer_load_dwordx4 v4, s[16:19], s7 offen lds
  s_add_u32 m0, s6, 4096
  s_add_u32 s7, s5, 393216
  buffer_load_dwordx4 v4, s[16:19], s7 offen lds
  s_add_u32 m0, s6, 5120
  s_add_u32 s7, s5, 491520
  buffer_load_dwordx4 v4, s[16:19], s7 offen lds
  s_add_u32 m0, s6, 6144
  s_add_u32 s7, s5, 589824
  buffer_load_dwordx4 v4, s[16:19], s7 offen lds
  s_add_u32 m0, s6, 7168
  s_add_u32 s7, s5, 688128
  buffer_load_dwordx4 v4, s[16:19], s7 offen lds
  s_add_u32 m0, s6, 8192
  s_add_u32 s7, s5, 786432
  buffer_load_dwordx4 v4, s[16:19], s7 offen lds
  s_add_u32 m0, s6, 9216
  s_add_u32 s7, s5, 884736
  buffer_load_dwordx4 v4, s[16:19], s7 offen lds
  s_mov_b32 s16, s36
  s_and_b32 s17, s37, 0xffff
  s_mov_b32 s18, 7864320
  s_mov_b32 s19, 0x20000
  s_mul_i32 s5, s3, 983040
  s_add_u32 s5, s5, s78
  s_add_u32 s5, s5, 3932160
  s_mul_i32 s6, s3, 10240
  s_add_u32 s6, s6, 65536
  s_add_u32 m0, s6, 0
  s_add_u32 s7, s5, 0
  buffer_load_dwordx4 v4, s[16:19], s7 offen lds
  s_add_u32 m0, s6, 1024
  s_add_u32 s7, s5, 98304
  buffer_load_dwordx4 v4, s[16:19], s7 offen lds
  s_add_u32 m0, s6, 2048
  s_add_u32 s7, s5, 196608
  buffer_load_dwordx4 v4, s[16:19], s7 offen lds
  s_add_u32 m0, s6, 3072
  s_add_u32 s7, s5, 294912
  buffer_load_dwordx4 v4, s[16:19], s7 offen lds
  s_add_u32 m0, s6, 4096
  s_add_u32 s7, s5, 393216
  buffer_load_dwordx4 v4, s[16:19], s7 offen lds
  s_add_u32 m0, s6, 5120
  s_add_u32 s7, s5, 491520
  buffer_load_dwordx4 v4, s[16:19], s7 offen lds
  s_add_u32 m0, s6, 6144
  s_add_u32 s7, s5, 589824
  buffer_load_dwordx4 v4, s[16:19], s7 offen lds
  s_add_u32 m0, s6, 7168
  s_add_u32 s7, s5, 688128
  buffer_load_dwordx4 v4, s[16:19], s7 offen lds
  s_add_u32 m0, s6, 8192
  s_add_u32 s7, s5, 786432
  buffer_load_dwordx4 v4, s[16:19], s7 offen lds
  s_add_u32 m0, s6, 9216
  s_add_u32 s7, s5, 884736
  buffer_load_dwordx4 v4, s[16:19], s7 offen lds
  s_mov_b32 s16, s42
  s_and_b32 s17, s43, 0xffff
  s_mov_b32 s18, 7864320
  s_mov_b32 s19, 0x20000
  s_mul_i32 s5, s3, 61440
  s_add_u32 s5, s5, s79
  s_mul_i32 s6, s3, 12288
  s_add_u32 s6, s6, 114688
  s_add_u32 m0, s6, 0
  s_add_u32 s7, s5, 0
  buffer_load_dwordx4 v5, s[16:19], s7 offen lds
  s_add_u32 m0, s6, 1024
  s_add_u32 s7, s5, 5120
  buffer_load_dwordx4 v5, s[16:19], s7 offen lds
  s_add_u32 m0, s6, 2048
  s_add_u32 s7, s5, 10240
  buffer_load_dwordx4 v5, s[16:19], s7 offen lds
  s_add_u32 m0, s6, 3072
  s_add_u32 s7, s5, 15360
  buffer_load_dwordx4 v5, s[16:19], s7 offen lds
  s_add_u32 m0, s6, 4096
  s_add_u32 s7, s5, 20480
  buffer_load_dwordx4 v5, s[16:19], s7 offen lds
  s_add_u32 m0, s6, 5120
  s_add_u32 s7, s5, 25600
  buffer_load_dwordx4 v5, s[16:19], s7 offen lds
  s_add_u32 m0, s6, 6144
  s_add_u32 s7, s5, 30720
  buffer_load_dwordx4 v5, s[16:19], s7 offen lds
  s_add_u32 m0, s6, 7168
  s_add_u32 s7, s5, 35840
  buffer_load_dwordx4 v5, s[16:19], s7 offen lds
  s_add_u32 m0, s6, 8192
  s_add_u32 s7, s5, 40960
  buffer_load_dwordx4 v5, s[16:19], s7 offen lds
  s_add_u32 m0, s6, 9216
  s_add_u32 s7, s5, 46080
  buffer_load_dwordx4 v5, s[16:19], s7 offen lds
  s_add_u32 m0, s6, 10240
  s_add_u32 s7, s5, 51200
  buffer_load_dwordx4 v5, s[16:19], s7 offen lds
  s_add_u32 m0, s6, 11264
  s_add_u32 s7, s5, 56320
  buffer_load_dwordx4 v5, s[16:19], s7 offen lds
  s_waitcnt vmcnt(32)
  s_mov_b32 s5, 0x05040100
  s_mov_b32 s6, 0x07060302
  v_lshrrev_b32 v7, 4, v0
  v_lshlrev_b32 v7, 9, v7
  v_bfe_u32 v20, v0, 3, 1
  v_lshl_add_u32 v7, v20, 2, v7
  v_and_b32 v20, 7, v0
  v_lshlrev_b32 v20, 4, v20
  s_lshr_b32 s7, s3, 1
  s_lshl_b32 s7, s7, 6
  v_xor_b32 v20, s7, v20
  v_add_u32 v7, v7, v20
  s_lshl_b32 s7, s3, 7
  v_add_u32 v7, s7, v7
  v_perm_b32 v20, v9, v8, s5
  v_perm_b32 v21, v9, v8, s6
  ds_write_b32 v7, v20 offset:0
  ds_write_b32 v7, v21 offset:8
  v_perm_b32 v20, v11, v10, s5
  v_perm_b32 v21, v11, v10, s6
  ds_write_b32 v7, v20 offset:2048
  ds_write_b32 v7, v21 offset:2056
  v_perm_b32 v20, v13, v12, s5
  v_perm_b32 v21, v13, v12, s6
  ds_write_b32 v7, v20 offset:4096
  ds_write_b32 v7, v21 offset:4104
  v_perm_b32 v20, v15, v14, s5
  v_perm_b32 v21, v15, v14, s6
  ds_write_b32 v7, v20 offset:6144
  ds_write_b32 v7, v21 offset:6152
  v_perm_b32 v20, v17, v16, s5
  v_perm_b32 v21, v17, v16, s6
  ds_write_b32 v7, v20 offset:8192
  ds_write_b32 v7, v21 offset:8200
  s_waitcnt vmcnt(22)
  s_barrier
  s_cmp_lg_u32 s3, 0
  s_cbranch_scc1 L_arr_50
  v_mov_b32 v60, 1
  s_mov_b64 exec, 1
  buffer_atomic_add v60, off, s[28:31], s58 offset:128
  s_mov_b64 exec, -1
L_arr_50:
  ds_read_b64_tr_b16 a[0:1], v1 offset:0
  ds_read_b64_tr_b16 a[2:3], v1 offset:256
  ds_read_b64_tr_b16 a[4:5], v1 offset:4096
  ds_read_b64_tr_b16 a[6:7], v1 offset:4352
  ds_read_b64_tr_b16 a[8:9], v1 offset:8192
  ds_read_b64_tr_b16 a[10:11], v1 offset:8448
  ds_read_b64_tr_b16 a[12:13], v1 offset:12288
  ds_read_b64_tr_b16 a[14:15], v1 offset:12544
  ds_read_b64_tr_b16 a[16:17], v1 offset:16384
  ds_read_b64_tr_b16 a[18:19], v1 offset:16640
  ds_read_b64_tr_b16 a[20:21], v1 offset:20480
  ds_read_b64_tr_b16 a[22:23], v1 offset:20736
  s_waitcnt lgkmcnt(4)
  ds_read_b64_tr_b16 a[24:25], v1 offset:24576
  ds_read_b64_tr_b16 a[26:27], v1 offset:24832
  ds_read_b64_tr_b16 a[28:29], v1 offset:28672
  ds_read_b64_tr_b16 a[30:31], v1 offset:28928
  ds_read_b64_tr_b16 a[32:33], v1 offset:32768
  ds_read_b64_tr_b16 a[34:35], v1 offset:33024
  ds_read_b64_tr_b16 a[36:37], v1 offset:36864
  ds_read_b64_tr_b16 a[38:39], v1 offset:37120
  s_waitcnt lgkmcnt(0)
  s_barrier
  s_mov_b32 s16, s42
  s_and_b32 s17, s43, 0xffff
  s_mov_b32 s18, 7864320
  s_mov_b32 s19, 0x20000
  s_mul_i32 s5, s3, 61440
  s_add_u32 s5, s5, s79
  s_mul_i32 s6, s3, 12288
  s_add_u32 s6, s6, 16384
  s_cmp_eq_u32 s62, 2
  s_cselect_b32 s5, 536870912, s5
  s_add_u32 m0, s6, 0
  s_add_u32 s7, s5, 768
  buffer_load_dwordx4 v5, s[16:19], s7 offen lds
  s_add_u32 m0, s6, 1024
  s_add_u32 s7, s5, 5888
  buffer_load_dwordx4 v5, s[16:19], s7 offen lds
  s_add_u32 m0, s6, 2048
  s_add_u32 s7, s5, 11008
  buffer_load_dwordx4 v5, s[16:19], s7 offen lds
  s_add_u32 m0, s6, 3072
  s_add_u32 s7, s5, 16128
  buffer_load_dwordx4 v5, s[16:19], s7 offen lds
  s_add_u32 m0, s6, 4096
  s_add_u32 s7, s5, 21248
  buffer_load_dwordx4 v5, s[16:19], s7 offen lds
  s_add_u32 m0, s6, 5120
  s_add_u32 s7, s5, 26368
  buffer_load_dwordx4 v5, s[16:19], s7 offen lds
  s_add_u32 m0, s6, 6144
  s_add_u32 s7, s5, 31488
  buffer_load_dwordx4 v5, s[16:19], s7 offen lds
  s_add_u32 m0, s6, 7168
  s_add_u32 s7, s5, 36608
  buffer_load_dwordx4 v5, s[16:19], s7 offen lds
  s_add_u32 m0, s6, 8192
  s_add_u32 s7, s5, 41728
  buffer_load_dwordx4 v5, s[16:19], s7 offen lds
  s_add_u32 m0, s6, 9216
  s_add_u32 s7, s5, 46848
  buffer_load_dwordx4 v5, s[16:19], s7 offen lds
  s_add_u32 m0, s6, 10240
  s_add_u32 s7, s5, 51968
  buffer_load_dwordx4 v5, s[16:19], s7 offen lds
  s_add_u32 m0, s6, 11264
  s_add_u32 s7, s5, 57088
  buffer_load_dwordx4 v5, s[16:19], s7 offen lds
  s_waitcnt vmcnt(24)
  s_barrier
  ds_read_b64_tr_b16 a[40:41], v2 offset:0
  ds_read_b64_tr_b16 a[42:43], v2 offset:256
  ds_read_b64_tr_b16 a[44:45], v2 offset:4096
  ds_read_b64_tr_b16 a[46:47], v2 offset:4352
  ds_read_b64_tr_b16 a[48:49], v2 offset:8192
  ds_read_b64_tr_b16 a[50:51], v2 offset:8448
  ds_read_b64_tr_b16 a[52:53], v2 offset:12288
  ds_read_b64_tr_b16 a[54:55], v2 offset:12544
  ds_read_b64_tr_b16 a[56:57], v2 offset:16384
  ds_read_b64_tr_b16 a[58:59], v2 offset:16640
  ds_read_b64_tr_b16 a[60:61], v2 offset:20480
  ds_read_b64_tr_b16 a[62:63], v2 offset:20736
  s_waitcnt lgkmcnt(4)
  ds_read_b64_tr_b16 a[64:65], v2 offset:24576
  ds_read_b64_tr_b16 a[66:67], v2 offset:24832
  ds_read_b64_tr_b16 a[68:69], v2 offset:28672
  ds_read_b64_tr_b16 a[70:71], v2 offset:28928
  ds_read_b64_tr_b16 a[72:73], v2 offset:32768
  ds_read_b64_tr_b16 a[74:75], v2 offset:33024
  ds_read_b64_tr_b16 a[76:77], v2 offset:36864
  ds_read_b64_tr_b16 a[78:79], v2 offset:37120
  s_waitcnt lgkmcnt(0)
  s_barrier
  s_mov_b32 s16, s38
  s_and_b32 s17, s39, 0xffff
  s_mov_b32 s18, 7864320
  s_mov_b32 s19, 0x20000
  s_mul_i32 s5, s3, 983040
  s_add_u32 s5, s5, s78
  s_add_u32 s5, s5, 0
  s_mul_i32 s6, s3, 10240
  s_add_u32 s6, s6, 65536
  s_add_u32 m0, s6, 0
  s_add_u32 s7, s5, 0
  buffer_load_dwordx4 v4, s[16:19], s7 offen lds
  s_add_u32 m0, s6, 1024
  s_add_u32 s7, s5, 98304
  buffer_load_dwordx4 v4, s[16:19], s7 offen lds
  s_add_u32 m0, s6, 2048
  s_add_u32 s7, s5, 196608
  buffer_load_dwordx4 v4, s[16:19], s7 offen lds
  s_add_u32 m0, s6, 3072
  s_add_u32 s7, s5, 294912
  buffer_load_dwordx4 v4, s[16:19], s7 offen lds
  s_add_u32 m0, s6, 4096
  s_add_u32 s7, s5, 393216
  buffer_load_dwordx4 v4, s[16:19], s7 offen lds
  s_add_u32 m0, s6, 5120
  s_add_u32 s7, s5, 491520
  buffer_load_dwordx4 v4, s[16:19], s7 offen lds
  s_add_u32 m0, s6, 6144
  s_add_u32 s7, s5, 589824
  buffer_load_dwordx4 v4, s[16:19], s7 offen lds
  s_add_u32 m0, s6, 7168
  s_add_u32 s7, s5, 688128
  buffer_load_dwordx4 v4, s[16:19], s7 offen lds
  s_add_u32 m0, s6, 8192
  s_add_u32 s7, s5, 786432
  buffer_load_dwordx4 v4, s[16:19], s7 offen lds
  s_add_u32 m0, s6, 9216
  s_add_u32 s7, s5, 884736
  buffer_load_dwordx4 v4, s[16:19], s7 offen lds
  s_waitcnt vmcnt(22)
  s_barrier
  ds_read_b64_tr_b16 v[160:161], v23 offset:0
  ds_read_b64_tr_b16 v[162:163], v23 offset:512
  ds_read_b64_tr_b16 v[164:165], v23 offset:8192
  ds_read_b64_tr_b16 v[166:167], v23 offset:8704
  ds_read_b64_tr_b16 v[168:169], v23 offset:16384
  ds_read_b64_tr_b16 v[170:171], v23 offset:16896
  ds_read_b64_tr_b16 v[172:173], v23 offset:24576
  ds_read_b64_tr_b16 v[174:175], v23 offset:25088
  ds_read_b64_tr_b16 v[176:177], v23 offset:32768
  ds_read_b64_tr_b16 v[178:179], v23 offset:33280
  ds_read_b64_tr_b16 v[180:181], v23 offset:40960
  ds_read_b64_tr_b16 v[182:183], v23 offset:41472
  s_waitcnt lgkmcnt(4)
  ds_read_b64_tr_b16 v[184:185], v23 offset:32
  ds_read_b64_tr_b16 v[186:187], v23 offset:544
  ds_read_b64_tr_b16 v[188:189], v23 offset:8224
  ds_read_b64_tr_b16 v[190:191], v23 offset:8736
  ds_read_b64_tr_b16 v[192:193], v23 offset:16416
  ds_read_b64_tr_b16 v[194:195], v23 offset:16928
  ds_read_b64_tr_b16 v[196:197], v23 offset:24608
  ds_read_b64_tr_b16 v[198:199], v23 offset:25120
  ds_read_b64_tr_b16 v[200:201], v23 offset:32800
  ds_read_b64_tr_b16 v[202:203], v23 offset:33312
  ds_read_b64_tr_b16 v[204:205], v23 offset:40992
  ds_read_b64_tr_b16 v[206:207], v23 offset:41504
  s_waitcnt lgkmcnt(0)
  s_barrier
  s_mov_b32 s16, s38
  s_and_b32 s17, s39, 0xffff
  s_mov_b32 s18, 7864320
  s_mov_b32 s19, 0x20000
  s_mul_i32 s5, s3, 983040
  s_add_u32 s5, s5, s78
  s_add_u32 s5, s5, 3932160
  s_mul_i32 s6, s3, 10240
  s_add_u32 s6, s6, 114688
  s_add_u32 m0, s6, 0
  s_add_u32 s7, s5, 0
  buffer_load_dwordx4 v4, s[16:19], s7 offen lds
  s_add_u32 m0, s6, 1024
  s_add_u32 s7, s5, 98304
  buffer_load_dwordx4 v4, s[16:19], s7 offen lds
  s_add_u32 m0, s6, 2048
  s_add_u32 s7, s5, 196608
  buffer_load_dwordx4 v4, s[16:19], s7 offen lds
  s_add_u32 m0, s6, 3072
  s_add_u32 s7, s5, 294912
  buffer_load_dwordx4 v4, s[16:19], s7 offen lds
  s_add_u32 m0, s6, 4096
  s_add_u32 s7, s5, 393216
  buffer_load_dwordx4 v4, s[16:19], s7 offen lds
  s_add_u32 m0, s6, 5120
  s_add_u32 s7, s5, 491520
  buffer_load_dwordx4 v4, s[16:19], s7 offen lds
  s_add_u32 m0, s6, 6144
  s_add_u32 s7, s5, 589824
  buffer_load_dwordx4 v4, s[16:19], s7 offen lds
  s_add_u32 m0, s6, 7168
  s_add_u32 s7, s5, 688128
  buffer_load_dwordx4 v4, s[16:19], s7 offen lds
  s_add_u32 m0, s6, 8192
  s_add_u32 s7, s5, 786432
  buffer_load_dwordx4 v4, s[16:19], s7 offen lds
  s_add_u32 m0, s6, 9216
  s_add_u32 s7, s5, 884736
  buffer_load_dwordx4 v4, s[16:19], s7 offen lds
  s_waitcnt vmcnt(20)
  s_barrier
  ds_read_b64_tr_b16 v[208:209], v22 offset:0
  ds_read_b64_tr_b16 v[210:211], v22 offset:512
  ds_read_b64_tr_b16 v[212:213], v22 offset:8192
  ds_read_b64_tr_b16 v[214:215], v22 offset:8704
  ds_read_b64_tr_b16 v[216:217], v22 offset:16384
  ds_read_b64_tr_b16 v[218:219], v22 offset:16896
  ds_read_b64_tr_b16 v[220:221], v22 offset:24576
  ds_read_b64_tr_b16 v[222:223], v22 offset:25088
  ds_read_b64_tr_b16 v[224:225], v22 offset:32768
  ds_read_b64_tr_b16 v[226:227], v22 offset:33280
  ds_read_b64_tr_b16 v[228:229], v22 offset:40960
  ds_read_b64_tr_b16 v[230:231], v22 offset:41472
  s_waitcnt lgkmcnt(4)
  ds_read_b64_tr_b16 v[232:233], v22 offset:32
  ds_read_b64_tr_b16 v[234:235], v22 offset:544
  ds_read_b64_tr_b16 v[236:237], v22 offset:8224
  ds_read_b64_tr_b16 v[238:239], v22 offset:8736
  ds_read_b64_tr_b16 v[240:241], v22 offset:16416
  ds_read_b64_tr_b16 v[242:243], v22 offset:16928
  ds_read_b64_tr_b16 v[244:245], v22 offset:24608
  ds_read_b64_tr_b16 v[246:247], v22 offset:25120
  ds_read_b64_tr_b16 v[248:249], v22 offset:32800
  ds_read_b64_tr_b16 v[250:251], v22 offset:33312
  ds_read_b64_tr_b16 v[252:253], v22 offset:40992
  ds_read_b64_tr_b16 v[254:255], v22 offset:41504
  s_waitcnt lgkmcnt(0)
  s_barrier
  s_mov_b32 s16, s40
  s_and_b32 s17, s41, 0xffff
  s_mov_b32 s18, 7864320
  s_mov_b32 s19, 0x20000
  s_mul_i32 s5, s3, 983040
  s_add_u32 s5, s5, s78
  s_add_u32 s5, s5, 0
  s_mul_i32 s6, s3, 10240
  s_add_u32 s6, s6, 16384
  s_add_u32 m0, s6, 0
  s_add_u32 s7, s5, 0
  buffer_load_dwordx4 v4, s[16:19], s7 offen lds
  s_add_u32 m0, s6, 1024
  s_add_u32 s7, s5, 98304
  buffer_load_dwordx4 v4, s[16:19], s7 offen lds
  s_add_u32 m0, s6, 2048
  s_add_u32 s7, s5, 196608
  buffer_load_dwordx4 v4, s[16:19], s7 offen lds
  s_add_u32 m0, s6, 3072
  s_add_u32 s7, s5, 294912
  buffer_load_dwordx4 v4, s[16:19], s7 offen lds
  s_add_u32 m0, s6, 4096
  s_add_u32 s7, s5, 393216
  buffer_load_dwordx4 v4, s[16:19], s7 offen lds
  s_add_u32 m0, s6, 5120
  s_add_u32 s7, s5, 491520
  buffer_load_dwordx4 v4, s[16:19], s7 offen lds
  s_add_u32 m0, s6, 6144
  s_add_u32 s7, s5, 589824
  buffer_load_dwordx4 v4, s[16:19], s7 offen lds
  s_add_u32 m0, s6, 7168
  s_add_u32 s7, s5, 688128
  buffer_load_dwordx4 v4, s[16:19], s7 offen lds
  s_add_u32 m0, s6, 8192
  s_add_u32 s7, s5, 786432
  buffer_load_dwordx4 v4, s[16:19], s7 offen lds
  s_add_u32 m0, s6, 9216
  s_add_u32 s7, s5, 884736
  buffer_load_dwordx4 v4, s[16:19], s7 offen lds
  s_waitcnt vmcnt(20)
  s_barrier
  ds_read_b64_tr_b16 a[80:81], v2 offset:0
  ds_read_b64_tr_b16 a[82:83], v2 offset:256
  ds_read_b64_tr_b16 a[84:85], v2 offset:4096
  ds_read_b64_tr_b16 a[86:87], v2 offset:4352
  ds_read_b64_tr_b16 a[88:89], v2 offset:8192
  ds_read_b64_tr_b16 a[90:91], v2 offset:8448
  ds_read_b64_tr_b16 a[92:93], v2 offset:12288
  ds_read_b64_tr_b16 a[94:95], v2 offset:12544
  ds_read_b64_tr_b16 a[96:97], v2 offset:16384
  ds_read_b64_tr_b16 a[98:99], v2 offset:16640
  ds_read_b64_tr_b16 a[100:101], v2 offset:20480
  ds_read_b64_tr_b16 a[102:103], v2 offset:20736
  s_waitcnt lgkmcnt(4)
  ds_read_b64_tr_b16 a[104:105], v2 offset:24576
  ds_read_b64_tr_b16 a[106:107], v2 offset:24832
  ds_read_b64_tr_b16 a[108:109], v2 offset:28672
  ds_read_b64_tr_b16 a[110:111], v2 offset:28928
  ds_read_b64_tr_b16 a[112:113], v2 offset:32768
  ds_read_b64_tr_b16 a[114:115], v2 offset:33024
  ds_read_b64_tr_b16 a[116:117], v2 offset:36864
  ds_read_b64_tr_b16 a[118:119], v2 offset:37120
  s_waitcnt lgkmcnt(0)
  s_barrier
  s_mov_b32 s16, s40
  s_and_b32 s17, s41, 0xffff
  s_mov_b32 s18, 7864320
  s_mov_b32 s19, 0x20000
  s_mul_i32 s5, s3, 983040
  s_add_u32 s5, s5, s78
  s_add_u32 s5, s5, 3932160
  s_mul_i32 s6, s3, 10240
  s_add_u32 s6, s6, 65536
  s_add_u32 m0, s6, 0
  s_add_u32 s7, s5, 0
  buffer_load_dwordx4 v4, s[16:19], s7 offen lds
  s_add_u32 m0, s6, 1024
  s_add_u32 s7, s5, 98304
  buffer_load_dwordx4 v4, s[16:19], s7 offen lds
  s_add_u32 m0, s6, 2048
  s_add_u32 s7, s5, 196608
  buffer_load_dwordx4 v4, s[16:19], s7 offen lds
  s_add_u32 m0, s6, 3072
  s_add_u32 s7, s5, 294912
  buffer_load_dwordx4 v4, s[16:19], s7 offen lds
  s_add_u32 m0, s6, 4096
  s_add_u32 s7, s5, 393216
  buffer_load_dwordx4 v4, s[16:19], s7 offen lds
  s_add_u32 m0, s6, 5120
  s_add_u32 s7, s5, 491520
  buffer_load_dwordx4 v4, s[16:19], s7 offen lds
  s_add_u32 m0, s6, 6144
  s_add_u32 s7, s5, 589824
  buffer_load_dwordx4 v4, s[16:19], s7 offen lds
  s_add_u32 m0, s6, 7168
  s_add_u32 s7, s5, 688128
  buffer_load_dwordx4 v4, s[16:19], s7 offen lds
  s_add_u32 m0, s6, 8192
  s_add_u32 s7, s5, 786432
  buffer_load_dwordx4 v4, s[16:19], s7 offen lds
  s_add_u32 m0, s6, 9216
  s_add_u32 s7, s5, 884736
  buffer_load_dwordx4 v4, s[16:19], s7 offen lds
  v_mbcnt_lo_u32_b32 v34, -1, 0
  v_mbcnt_hi_u32_b32 v34, -1, v34
  v_and_b32 v34, 7, v34
  v_lshlrev_b32 v34, 4, v34
L_census_51:
  s_sub_u32 s59, s59, 1
  s_cbranch_scc1 L_end
  buffer_load_dword v35, v34, s[28:31], 0 offen sc1
  s_waitcnt vmcnt(0)
  v_readlane_b32 s66, v35, 0
  v_readlane_b32 s67, v35, 1
  v_readlane_b32 s68, v35, 2
  v_readlane_b32 s69, v35, 3
  v_readlane_b32 s70, v35, 4
  v_readlane_b32 s71, v35, 5
  v_readlane_b32 s72, v35, 6
  v_readlane_b32 s73, v35, 7
  s_mov_b32 s5, s66
  s_add_u32 s5, s5, s67
  s_add_u32 s5, s5, s68
  s_add_u32 s5, s5, s69
  s_add_u32 s5, s5, s70
  s_add_u32 s5, s5, s71
  s_add_u32 s5, s5, s72
  s_add_u32 s5, s5, s73
  s_cmp_lt_u32 s5, 256
  s_cbranch_scc1 L_census_51
L_vote:
  s_sub_u32 s59, s59, 1
  s_cbranch_scc1 L_end
  buffer_load_dword v35, off, s[28:31], 0 offset:8 sc1
  s_waitcnt vmcnt(0)
  v_readfirstlane_b32 s57, v35
  s_and_b32 s5, s57, 0xff
  s_cmp_lt_u32 s5, 32
  s_cbranch_scc1 L_vote
  s_cmp_gt_u32 s57, 2457855
  s_cselect_b32 s57, 0x2000, 0
  s_min_u32 s5, s66, s67
  s_min_u32 s6, s68, s69
  s_min_u32 s75, s5, s6
  v_and_b32 v25, 15, v0
  v_lshrrev_b32 v26, 4, v0
  v_bfe_u32 v27, v0, 2, 2
  v_and_b32 v28, 3, v0
  v_and_b32 v29, 1, v26
  v_lshrrev_b32 v30, 1, v26
  v_and_b32 v40, 1, v0
  v_lshl_add_u32 v40, v27, 1, v40
  v_bfe_u32 v41, v0, 1, 1
  v_mov_b32 v31, 0x4444
  v_mov_b32 v32, 0xeeee
  v_mov_b32 v33, 536870912
  v_cmp_eq_u32 vcc, 0, v41
  s_nop 1
  v_cndmask_b32 v132, v32, v31, vcc
  v_lshlrev_b32 v144, 4, v0
  v_mul_u32_u24 v34, 12, v29
  v_add_u32 v34, v34, v27
  v_lshlrev_b32 v34, 3, v34
  v_lshlrev_b32 v35, 6, v41
  v_xor_b32 v34, v34, v35
  v_lshl_add_u32 v34, v30, 9, v34
  v_lshl_add_u32 v133, v28, 7, v34
  v_xor_b32 v134, 32, v133
  v_lshlrev_b32 v36, 5, v25
  v_lshl_add_u32 v36, v26, 3, v36
  s_lshl_b32 s5, s3, 9
  s_add_u32 s5, s5, 10240
  v_add_u32 v135, s5, v36
  v_lshlrev_b32 v36, 3, v25
  v_lshlrev_b32 v35, 6, v30
  v_xor_b32 v36, v36, v35
  v_lshl_add_u32 v36, v26, 7, v36
  v_mov_b32 v146, v36
  v_lshl_add_u32 v34, v26, 2, v27
  v_lshlrev_b32 v34, 5, v34
  v_lshl_add_u32 v34, v28, 3, v34
  v_add_u32 v136, 10240, v34
  s_mul_i32 s5, s3, 3
  s_add_u32 s5, s5, 0
  s_and_b32 s6, s5, 1
  s_lshl_b32 s6, s6, 2
  s_lshr_b32 s5, s5, 1
  s_lshl_b32 s5, s5, 9
  s_add_u32 s5, s5, s6
  s_add_u32 s5, s5, 12288
  v_add_u32 v137, s5, v36
  s_mul_i32 s5, s3, 3
  s_add_u32 s5, s5, 1
  s_and_b32 s6, s5, 1
  s_lshl_b32 s6, s6, 2
  s_lshr_b32 s5, s5, 1
  s_lshl_b32 s5, s5, 9
  s_add_u32 s5, s5, s6
  s_add_u32 s5, s5, 12288
  v_add_u32 v147, s5, v36
  s_mul_i32 s5, s3, 3
  s_add_u32 s5, s5, 2
  s_and_b32 s6, s5, 1
  s_lshl_b32 s6, s6, 2
  s_lshr_b32 s5, s5, 1
  s_lshl_b32 s5, s5, 9
  s_add_u32 s5, s5, s6
  s_add_u32 s5, s5, 12288
  v_add_u32 v138, s5, v36
  v_lshlrev_b32 v34, 4, v25
  v_lshl_add_u32 v35, v26, 2, v34
  s_lshl_b32 s5, s62, 10
  s_lshl_b32 s6, s3, 8
  s_add_u32 s5, s5, s6
  v_add_u32 v143, s5, v35
  v_lshl_add_u32 v34, v29, 3, v34
  v_cmp_eq_u32 vcc, 0, v30
  s_nop 1
  v_cndmask_b32 v150, v33, v34, vcc
  s_lshl_b32 s5, s5, 1
  v_lshlrev_b32 v34, 5, v25
  v_lshl_add_u32 v35, v26, 3, v34
  v_add_u32 v141, s5, v35
  v_lshl_add_u32 v34, v29, 4, v34
  s_mul_i32 s5, s3, 1536
  v_add_u32 v142, s5, v34
  v_lshlrev_b32 v35, 9, v26
  v_lshl_add_u32 v148, v25, 4, v35
  v_cmp_eq_u32 vcc, s63, v26
  s_xor_b32 s5, s57, 0x2000
  v_mov_b32 v34, s57
  v_mov_b32 v35, s5
  v_cndmask_b32 v34, v34, v35, vcc
  v_lshl_add_u32 v34, v26, 8, v34
  v_lshl_add_u32 v149, v25, 4, v34
  s_and_b32 s5, s3, 1
  s_lshl_b32 s6, s5, 3
  v_add_u32 v145, s6, v144
  s_mul_i32 s6, s3, 2560
  v_lshlrev_b32 v34, 4, v25
  v_lshl_add_u32 v34, v29, 3, v34
  v_lshl_add_u32 v34, v30, 8, v34
  v_add_u32 v151, s6, v34
  v_lshl_add_u32 v34, v26, 1, v41
  v_lshlrev_b32 v34, 7, v34
  v_lshl_add_u32 v34, v40, 4, v34
  v_add_u32 v91, 15360, v34
  v_mul_u32_u24 v34, 160, v40
  v_lshl_add_u32 v35, v26, 4, v34
  s_lshl_b32 s5, s5, 6
  v_add_u32 v35, s5, v35
  s_cmp_lg_u32 s3, 2
  s_cbranch_scc1 L_c1
  v_lshl_add_u32 v35, v26, 3, v34
  v_add_u32 v35, 128, v35
L_c1:
  v_cmp_eq_u32 vcc, 0, v41
  s_nop 1
  v_cndmask_b32 v139, v33, v35, vcc
  s_cmp_lg_u32 s3, 3
  s_cbranch_scc1 L_c2
  v_lshl_add_u32 v35, v26, 3, v40
  v_lshlrev_b32 v35, 4, v35
  s_lshl_b32 s5, s62, 10
  v_add_u32 v35, s5, v35
  v_cndmask_b32 v139, v35, v33, vcc
L_c2:
  s_lshl_b32 s5, s3, 1
  v_add_u32 v34, s5, v29
  v_mul_u32_u24 v35, 160, v34
  v_min_u32 v36, 9, v25
  v_lshl_add_u32 v35, v36, 4, v35
  v_add_u32 v154, 2560, v35
  v_mul_u32_u24 v36, 1280, v30
  v_add_u32 v140, v35, v36
  v_cmp_eq_u32 vcc, 0, v30
  s_nop 1
  v_cndmask_b32 v155, 0, 1.0, vcc
  v_bfe_u32 v35, v25, 1, 1
  v_lshlrev_b32 v35, 1, v35
  v_bfe_u32 v36, v25, 2, 1
  v_add_u32 v35, v35, v36
  v_cmp_lt_u32 vcc, 7, v25
  s_nop 1
  v_cndmask_b32 v35, v35, 4, vcc
  v_lshlrev_b32 v35, 7, v35
  v_lshl_add_u32 v35, v34, 4, v35
  v_and_b32 v36, 1, v25
  v_lshl_add_u32 v35, v36, 3, v35
  v_lshl_add_u32 v35, v30, 2, v35
  v_add_u32 v35, 15360, v35
  v_lshlrev_b32 v36, 2, v0
  v_add_u32 v36, 16384, v36
  v_cmp_gt_u32 vcc, 10, v25
  s_nop 1
  v_cndmask_b32 v156, v36, v35, vcc
  v_mov_b32 v36, 0
  v_mov_b32 v37, 0
  v_mov_b32 v38, 0
  v_mov_b32 v39, 0
  ds_write_b128 v144, v[36:39] offset:15360
  v_mov_b32 v34, 0x3f803f80
  v_accvgpr_write_b32 a240, v34
  v_accvgpr_write_b32 a241, v34
  v_accvgpr_write_b32 a242, v34
  v_accvgpr_write_b32 a243, v34
  v_accvgpr_write_b32 a244, v34
  v_accvgpr_write_b32 a245, v34
  v_accvgpr_write_b32 a246, v34
  v_accvgpr_write_b32 a247, v34
  v_and_b32 v34, 1, v0
  v_cmp_eq_u32 vcc, 0, v34
  v_mov_b32 v35, 0x3f80
  v_mov_b32 v36, 1.0
  v_cndmask_b32 v35, v36, v35, vcc
  v_cmp_eq_u32 vcc, 0, v27
  s_nop 1
  v_cndmask_b32 v36, 0, v35, vcc
  v_cmp_eq_u32 vcc, 1, v27
  s_nop 1
  v_cndmask_b32 v37, 0, v35, vcc
  v_accvgpr_write_b32 a248, v36
  v_accvgpr_write_b32 a249, v37
  v_accvgpr_write_b32 a250, v36
  v_accvgpr_write_b32 a251, v37
  v_lshrrev_b32 v36, 1, v27
  v_cmp_eq_u32 vcc, v36, v30
  s_nop 1
  v_cndmask_b32 v35, 0, v35, vcc
  v_and_b32 v36, 1, v27
  v_cmp_eq_u32 vcc, 0, v36
  s_nop 1
  v_cndmask_b32 v120, 0, v35, vcc
  v_cndmask_b32 v121, v35, 0, vcc
  v_mov_b32 v122, v120
  v_mov_b32 v123, v121
  s_mov_b32 s92, 0
  s_mov_b32 s7, s60
  s_cmp_eq_u32 s3, 3
  s_cselect_b32 s92, 1, 0
  s_cmp_lg_u32 s3, 2
  s_cbranch_scc1 L_c3
  s_add_u32 s7, s60, 24
  s_cmp_lt_u32 s60, 16
  s_cselect_b32 s92, 1, 0
L_c3:
  s_mul_i32 s5, s61, 3840
  s_add_u32 s76, s5, 1310720
  s_mul_i32 s5, s61, 6144
  s_add_u32 s78, s5, 1556480
  s_lshl_b32 s5, s62, 2
  s_add_u32 s5, s5, s3
  s_lshl_b32 s5, s5, 14
  s_lshl_b32 s6, s61, 9
  s_add_u32 s5, s5, s6
  s_add_u32 s80, s5, 205520896
  s_add_u32 s5, s80, 196608
  s_cmp_lt_u32 s62, 2
  s_cselect_b32 s66, s5, 536870912
  s_lshr_b32 s5, s7, 1
  s_lshl_b32 s5, s5, 14
  s_and_b32 s6, s7, 1
  s_lshl_b32 s6, s6, 8
  s_add_u32 s5, s5, s6
  s_lshl_b32 s6, s63, 12
  s_add_u32 s5, s5, s6
  s_add_u32 s82, s5, 205520896
  s_lshl_b32 s5, s3, 14
  s_add_u32 s86, s5, 206176256
  s_lshl_b32 s5, s3, 11
  s_add_u32 s84, s5, 206241792
  s_mul_i32 s5, s7, 6554
  s_lshr_b32 s5, s5, 16
  s_mul_i32 s6, s5, 10
  s_sub_u32 s6, s7, s6
  s_lshl_b32 s71, s5, 4
  s_add_u32 s71, s71, s6
  s_lshl_b32 s5, s5, 1
  s_add_u32 s5, s5, s6
  s_add_u32 s5, s5, 56
  s_cmp_lt_u32 s6, 8
  s_cselect_b32 s5, s71, s5
  s_lshl_b32 s5, s5, 10
  s_lshl_b32 s6, s63, 8
  s_add_u32 s5, s5, s6
  s_add_u32 s5, s5, s57
  s_add_u32 s69, s5, 206176256
  s_mul_i32 s5, s61, 3840
  s_add_u32 s77, s5, 1433600
  s_mul_i32 s5, s61, 6144
  s_add_u32 s79, s5, 1753088
  s_lshl_b32 s5, s62, 2
  s_add_u32 s5, s5, s3
  s_lshl_b32 s5, s5, 14
  s_lshl_b32 s6, s61, 9
  s_add_u32 s5, s5, s6
  s_add_u32 s81, s5, 205848576
  s_add_u32 s5, s81, 196608
  s_cmp_lt_u32 s62, 2
  s_cselect_b32 s67, s5, 536870912
  s_lshr_b32 s5, s7, 1
  s_lshl_b32 s5, s5, 14
  s_and_b32 s6, s7, 1
  s_lshl_b32 s6, s6, 8
  s_add_u32 s5, s5, s6
  s_lshl_b32 s6, s63, 12
  s_add_u32 s5, s5, s6
  s_add_u32 s83, s5, 205848576
  s_lshl_b32 s5, s3, 14
  s_add_u32 s87, s5, 206258176
  s_lshl_b32 s5, s3, 11
  s_add_u32 s85, s5, 206323712
  s_mul_i32 s5, s7, 6554
  s_lshr_b32 s5, s5, 16
  s_mul_i32 s6, s5, 10
  s_sub_u32 s6, s7, s6
  s_lshl_b32 s71, s5, 4
  s_add_u32 s71, s71, s6
  s_lshl_b32 s5, s5, 1
  s_add_u32 s5, s5, s6
  s_add_u32 s5, s5, 56
  s_cmp_lt_u32 s6, 8
  s_cselect_b32 s5, s71, s5
  s_lshl_b32 s5, s5, 10
  s_lshl_b32 s6, s63, 8
  s_add_u32 s5, s5, s6
  s_add_u32 s5, s5, s57
  s_add_u32 s70, s5, 206258176
  s_lshl_b32 s5, s62, 2
  s_add_u32 s5, s5, s3
  s_lshl_b32 s5, s5, 15
  s_lshr_b32 s6, s61, 4
  s_lshl_b32 s6, s6, 14
  s_add_u32 s5, s5, s6
  s_and_b32 s6, s61, 15
  s_lshl_b32 s6, s6, 9
  s_add_u32 s5, s5, s6
  s_add_u32 s5, s5, s57
  s_add_u32 s80, s5, 205520896
  s_add_u32 s5, s80, 393216
  s_cmp_lt_u32 s62, 2
  s_cselect_b32 s66, s5, 536870912
  s_lshr_b32 s5, s7, 1
  s_lshl_b32 s5, s5, 15
  s_and_b32 s6, s7, 1
  s_lshl_b32 s6, s6, 8
  s_add_u32 s5, s5, s6
  s_add_u32 s5, s5, s57
  s_add_u32 s82, s5, 205520896
  s_mul_i32 s5, s63, 10240
  s_add_u32 s86, s5, 1949696
  s_lshl_b32 s5, s7, 8
  s_add_u32 s84, s86, s5
  s_lshl_b32 s5, s62, 2
  s_add_u32 s5, s5, s3
  s_lshl_b32 s5, s5, 14
  s_lshl_b32 s6, s61, 9
  s_add_u32 s5, s5, s6
  s_add_u32 s32, s5, 206831616
  s_add_u32 s5, s32, 196608
  s_cmp_lt_u32 s62, 2
  s_cselect_b32 s34, s5, 536870912
  s_lshr_b32 s5, s7, 1
  s_lshl_b32 s5, s5, 14
  s_and_b32 s6, s7, 1
  s_lshl_b32 s6, s6, 8
  s_add_u32 s5, s5, s6
  s_lshl_b32 s6, s63, 12
  s_add_u32 s5, s5, s6
  s_add_u32 s36, s5, 206831616
  s_lshl_b32 s5, s62, 2
  s_add_u32 s5, s5, s3
  s_lshl_b32 s5, s5, 15
  s_lshr_b32 s6, s61, 4
  s_lshl_b32 s6, s6, 14
  s_add_u32 s5, s5, s6
  s_and_b32 s6, s61, 15
  s_lshl_b32 s6, s6, 9
  s_add_u32 s5, s5, s6
  s_add_u32 s5, s5, s57
  s_add_u32 s81, s5, 206176256
  s_add_u32 s5, s81, 393216
  s_cmp_lt_u32 s62, 2
  s_cselect_b32 s67, s5, 536870912
  s_lshr_b32 s5, s7, 1
  s_lshl_b32 s5, s5, 15
  s_and_b32 s6, s7, 1
  s_lshl_b32 s6, s6, 8
  s_add_u32 s5, s5, s6
  s_add_u32 s5, s5, s57
  s_add_u32 s83, s5, 206176256
  s_mul_i32 s5, s63, 10240
  s_add_u32 s87, s5, 1990656
  s_lshl_b32 s5, s7, 8
  s_add_u32 s85, s87, s5
  s_lshl_b32 s5, s62, 2
  s_add_u32 s5, s5, s3
  s_lshl_b32 s5, s5, 14
  s_lshl_b32 s6, s61, 9
  s_add_u32 s5, s5, s6
  s_add_u32 s33, s5, 207159296
  s_add_u32 s5, s33, 196608
  s_cmp_lt_u32 s62, 2
  s_cselect_b32 s35, s5, 536870912
  s_lshr_b32 s5, s7, 1
  s_lshl_b32 s5, s5, 14
  s_and_b32 s6, s7, 1
  s_lshl_b32 s6, s6, 8
  s_add_u32 s5, s5, s6
  s_lshl_b32 s6, s63, 12
  s_add_u32 s5, s5, s6
  s_add_u32 s37, s5, 207159296
  s_lshl_b32 s6, s3, 11
  v_add_u32 v151, s6, v144
  s_lshl_b32 s5, s3, 10
  s_add_u32 s5, s5, 8192
  v_add_u32 v157, s5, v144
  v_mov_b32 v89, v157
  s_cmp_lt_u32 s3, 2
  s_cbranch_scc1 L_c0
  v_add_u32 v157, 18432, v144
  v_mov_b32 v89, s6
L_c0:
  s_mul_i32 s88, s61, 3072
  s_add_u32 s88, s88, 4718592
  s_mul_i32 s89, s61, 12288
  s_lshl_b32 s90, s61, 8
  s_add_u32 s90, s90, 2031616
  s_mov_b32 s91, 0
  s_cmp_lg_u32 s3, 0
  s_cbranch_scc1 L_poll2d_53
  v_mbcnt_lo_u32_b32 v34, -1, 0
  v_mbcnt_hi_u32_b32 v34, -1, v34
  v_and_b32 v34, 7, v34
  v_lshlrev_b32 v34, 4, v34
L_poll2_52:
  s_sub_u32 s59, s59, 1
  s_cbranch_scc1 L_end
  buffer_load_dword v35, v34, s[28:31], 0 offen offset:128 sc1
  s_waitcnt vmcnt(0)
  v_add_u32_dpp v35, v35, v35 row_ror:1 row_mask:0xf bank_mask:0xf
  s_nop 1
  v_add_u32_dpp v35, v35, v35 row_ror:2 row_mask:0xf bank_mask:0xf
  s_nop 1
  v_add_u32_dpp v35, v35, v35 row_ror:4 row_mask:0xf bank_mask:0xf
  s_nop 0
  v_readfirstlane_b32 s5, v35
  s_cmp_lt_u32 s5, 256
  s_cbranch_scc1 L_poll2_52
L_poll2d_53:
  s_barrier
  v_mov_b32 v40, 0
  v_mov_b32 v41, 0
  v_mov_b32 v42, 0
  v_mov_b32 v43, 0
  v_mov_b32 v44, 0
  v_mov_b32 v45, 0
  v_mov_b32 v46, 0
  v_mov_b32 v47, 0
  v_mov_b32 v48, 0
  v_mov_b32 v49, 0
  v_mov_b32 v50, 0
  v_mov_b32 v51, 0
  v_mov_b32 v69, 0
  v_mov_b32 v71, 0
  v_mov_b32 v77, 0
  v_mov_b32 v79, 0
  v_mov_b32 v85, 0
  v_mov_b32 v87, 0
  v_mov_b32 v153, 0
  v_lshrrev_b32 v159, 2, v144
  v_and_b32 v159, 12, v159
  s_waitcnt vmcnt(20)
  s_barrier
  ds_read_b64_tr_b16 a[120:121], v3 offset:0
  ds_read_b64_tr_b16 a[122:123], v3 offset:256
  ds_read_b64_tr_b16 a[124:125], v3 offset:4096
  ds_read_b64_tr_b16 a[126:127], v3 offset:4352
  ds_read_b64_tr_b16 a[128:129], v3 offset:8192
  ds_read_b64_tr_b16 a[130:131], v3 offset:8448
  ds_read_b64_tr_b16 a[132:133], v3 offset:12288
  ds_read_b64_tr_b16 a[134:135], v3 offset:12544
  ds_read_b64_tr_b16 a[136:137], v3 offset:16384
  ds_read_b64_tr_b16 a[138:139], v3 offset:16640
  ds_read_b64_tr_b16 a[140:141], v3 offset:20480
  ds_read_b64_tr_b16 a[142:143], v3 offset:20736
  s_waitcnt lgkmcnt(4)
  ds_read_b64_tr_b16 a[144:145], v3 offset:24576
  ds_read_b64_tr_b16 a[146:147], v3 offset:24832
  ds_read_b64_tr_b16 a[148:149], v3 offset:28672
  ds_read_b64_tr_b16 a[150:151], v3 offset:28928
  ds_read_b64_tr_b16 a[152:153], v3 offset:32768
  ds_read_b64_tr_b16 a[154:155], v3 offset:33024
  ds_read_b64_tr_b16 a[156:157], v3 offset:36864
  ds_read_b64_tr_b16 a[158:159], v3 offset:37120
  s_waitcnt vmcnt(10)
  s_barrier
  ds_read_b64_tr_b16 a[160:161], v1 offset:0
  ds_read_b64_tr_b16 a[162:163], v1 offset:256
  ds_read_b64_tr_b16 a[164:165], v1 offset:4096
  ds_read_b64_tr_b16 a[166:167], v1 offset:4352
  ds_read_b64_tr_b16 a[168:169], v1 offset:8192
  ds_read_b64_tr_b16 a[170:171], v1 offset:8448
  ds_read_b64_tr_b16 a[172:173], v1 offset:12288
  ds_read_b64_tr_b16 a[174:175], v1 offset:12544
  ds_read_b64_tr_b16 a[176:177], v1 offset:16384
  ds_read_b64_tr_b16 a[178:179], v1 offset:16640
  ds_read_b64_tr_b16 a[180:181], v1 offset:20480
  ds_read_b64_tr_b16 a[182:183], v1 offset:20736
  s_waitcnt lgkmcnt(4)
  ds_read_b64_tr_b16 a[184:185], v1 offset:24576
  ds_read_b64_tr_b16 a[186:187], v1 offset:24832
  ds_read_b64_tr_b16 a[188:189], v1 offset:28672
  ds_read_b64_tr_b16 a[190:191], v1 offset:28928
  ds_read_b64_tr_b16 a[192:193], v1 offset:32768
  ds_read_b64_tr_b16 a[194:195], v1 offset:33024
  ds_read_b64_tr_b16 a[196:197], v1 offset:36864
  ds_read_b64_tr_b16 a[198:199], v1 offset:37120
  s_waitcnt vmcnt(0)
  s_barrier
  ds_read_b64_tr_b16 a[200:201], v2 offset:0
  ds_read_b64_tr_b16 a[202:203], v2 offset:256
  ds_read_b64_tr_b16 a[204:205], v2 offset:4096
  ds_read_b64_tr_b16 a[206:207], v2 offset:4352
  ds_read_b64_tr_b16 a[208:209], v2 offset:8192
  ds_read_b64_tr_b16 a[210:211], v2 offset:8448
  ds_read_b64_tr_b16 a[212:213], v2 offset:12288
  ds_read_b64_tr_b16 a[214:215], v2 offset:12544
  ds_read_b64_tr_b16 a[216:217], v2 offset:16384
  ds_read_b64_tr_b16 a[218:219], v2 offset:16640
  ds_read_b64_tr_b16 a[220:221], v2 offset:20480
  ds_read_b64_tr_b16 a[222:223], v2 offset:20736
  s_waitcnt lgkmcnt(4)
  ds_read_b64_tr_b16 a[224:225], v2 offset:24576
  ds_read_b64_tr_b16 a[226:227], v2 offset:24832
  ds_read_b64_tr_b16 a[228:229], v2 offset:28672
  ds_read_b64_tr_b16 a[230:231], v2 offset:28928
  ds_read_b64_tr_b16 a[232:233], v2 offset:32768
  ds_read_b64_tr_b16 a[234:235], v2 offset:33024
  ds_read_b64_tr_b16 a[236:237], v2 offset:36864
  ds_read_b64_tr_b16 a[238:239], v2 offset:37120
  s_waitcnt lgkmcnt(0)
  s_barrier
  s_or_b32 s5, s60, s3
  s_or_b32 s5, s5, s63
  s_cmp_lg_u32 s5, 0
  s_cbranch_scc1 L_nogo
  v_mov_b32 v10, 1
  s_mov_b64 exec, 1
  buffer_store_dword v10, off, s[28:31], 0 offset:12 sc1
  s_mov_b64 exec, -1
L_nogo:
  ds_write_b128 v144, v[40:43] offset:17408
  s_cmp_ge_u32 s91, 63
  s_cbranch_scc1 L_pfok_55
  s_add_u32 s7, s91, 0
  s_add_u32 s71, s7, 1
  s_lshr_b32 s7, s7, 1
  s_lshr_b32 s71, s71, 1
L_pf_54:
  s_sub_u32 s59, s59, 1
  s_cbranch_scc1 L_end
  v_readlane_b32 s5, v153, 1
  v_readlane_b32 s6, v153, 2
  s_cmp_gt_u32 s5, s71
  s_cselect_b32 s6, s6, 0
  s_cmp_gt_u32 s6, s7
  s_cbranch_scc1 L_pfok_55
  buffer_load_dword v153, v159, s[8:11], s90 offen sc1
  s_waitcnt vmcnt(0)
  s_branch L_pf_54
L_pfok_55:
  s_mul_i32 s72, s3, 3072
  s_add_u32 s72, s72, s89
  s_add_u32 s72, s72, 48758784
  s_lshl_b32 s73, s62, 12
  s_add_u32 s73, s73, s89
  s_add_u32 s73, s73, 23986176
L_k0:
  s_sub_u32 s59, s59, 1
  s_cbranch_scc1 L_end
  buffer_load_dword v153, v159, s[8:11], s90 offen sc1
  s_waitcnt vmcnt(0)
  v_readlane_b32 s5, v153, 0
  s_cmp_eq_u32 s5, 0
  s_cbranch_scc1 L_k0
  s_sub_u32 s5, s73, 393216
  s_nop 1
  buffer_load_dwordx2 v[104:105], v145, s[8:11], s5 offen offset:0 sc1
  buffer_load_dwordx2 v[106:107], v145, s[8:11], s5 offen offset:1024 sc1
  buffer_load_dwordx2 v[108:109], v145, s[8:11], s5 offen offset:2048 sc1
  buffer_load_dwordx2 v[110:111], v145, s[8:11], s5 offen offset:3072 sc1
  buffer_load_dwordx4 v[64:67], v144, s[8:11], s72 offen offset:0 sc1
  buffer_load_dwordx4 v[72:75], v144, s[8:11], s72 offen offset:1024 sc1
  buffer_load_dwordx4 v[80:83], v144, s[8:11], s72 offen offset:2048 sc1
  s_waitcnt vmcnt(0) lgkmcnt(0)
  s_barrier
  s_mov_b32 s93, 0x3dd53b95
  s_cmp_lt_u32 s75, 24
  s_cbranch_scc1 L_slow
L_fast:
  ds_read_b64_tr_b16 v[0:1], v133 offset:0
  ds_read_b64_tr_b16 v[2:3], v134 offset:0
  ds_read_b64_tr_b16 v[4:5], v133 offset:1024
  ds_read_b64_tr_b16 v[6:7], v134 offset:1024
  ds_read_b64_tr_b16 v[8:9], v133 offset:2048
  ds_read_b64_tr_b16 v[10:11], v134 offset:2048
  ds_read_b64_tr_b16 v[12:13], v133 offset:3072
  ds_read_b64_tr_b16 v[14:15], v134 offset:3072
  ds_read_b64_tr_b16 v[16:17], v133 offset:4096
  ds_read_b64_tr_b16 v[18:19], v134 offset:4096
  ds_read_b64_tr_b16 v[20:21], v133 offset:5120
  ds_read_b64_tr_b16 v[22:23], v134 offset:5120
  s_cmp_ge_u32 s3, 2
  s_cbranch_scc1 L_s1a_60
  ds_read_b64_tr_b16 v[24:25], v133 offset:6144
  ds_read_b64_tr_b16 v[26:27], v134 offset:6144
  s_waitcnt lgkmcnt(12)
  v_smfmac_f32_16x16x64_bf16 v[40:43], v[0:3], a[0:7], v132
  v_smfmac_f32_16x16x64_bf16 v[44:47], v[0:3], a[80:87], v132
  buffer_load_dwordx4 v[64:67], v144, s[8:11], s72 offen offset:0 sc1
  ds_read_b64_tr_b16 v[28:29], v133 offset:7168
  ds_read_b64_tr_b16 v[30:31], v134 offset:7168
  s_waitcnt lgkmcnt(12)
  v_smfmac_f32_16x16x64_bf16 v[40:43], v[4:7], a[8:15], v132
  v_smfmac_f32_16x16x64_bf16 v[44:47], v[4:7], a[88:95], v132
  buffer_load_dwordx4 v[72:75], v144, s[8:11], s72 offen offset:1024 sc1
  ds_read_b64_tr_b16 v[32:33], v133 offset:8192
  ds_read_b64_tr_b16 v[34:35], v134 offset:8192
  s_waitcnt lgkmcnt(12)
  v_smfmac_f32_16x16x64_bf16 v[40:43], v[8:11], a[16:23], v132
  v_smfmac_f32_16x16x64_bf16 v[44:47], v[8:11], a[96:103], v132
  buffer_load_dwordx4 v[80:83], v144, s[8:11], s72 offen offset:2048 sc1
  ds_read_b64_tr_b16 v[36:37], v133 offset:9216
  ds_read_b64_tr_b16 v[38:39], v134 offset:9216
  s_waitcnt lgkmcnt(12)
  v_smfmac_f32_16x16x64_bf16 v[40:43], v[12:15], a[24:31], v132
  v_smfmac_f32_16x16x64_bf16 v[44:47], v[12:15], a[104:111], v132
  buffer_load_dwordx2 v[112:113], v145, s[8:11], s73 offen offset:0 sc1
  s_waitcnt lgkmcnt(10)
  v_smfmac_f32_16x16x64_bf16 v[40:43], v[16:19], a[32:39], v132
  v_smfmac_f32_16x16x64_bf16 v[44:47], v[16:19], a[112:119], v132
  buffer_load_dwordx2 v[114:115], v145, s[8:11], s73 offen offset:1024 sc1
  s_waitcnt lgkmcnt(8)
  v_smfmac_f32_16x16x64_bf16 v[40:43], v[20:23], a[40:47], v132
  v_smfmac_f32_16x16x64_bf16 v[44:47], v[20:23], a[120:127], v132
  buffer_load_dwordx2 v[116:117], v145, s[8:11], s73 offen offset:2048 sc1
  s_waitcnt lgkmcnt(6)
  v_smfmac_f32_16x16x64_bf16 v[40:43], v[24:27], a[48:55], v132
  v_smfmac_f32_16x16x64_bf16 v[44:47], v[24:27], a[128:135], v132
  buffer_load_dwordx2 v[118:119], v145, s[8:11], s73 offen offset:3072 sc1
  s_waitcnt lgkmcnt(4)
  v_smfmac_f32_16x16x64_bf16 v[40:43], v[28:31], a[56:63], v132
  v_smfmac_f32_16x16x64_bf16 v[44:47], v[28:31], a[136:143], v132
  buffer_load_dword v153, v159, s[8:11], s90 offen sc1
  s_waitcnt lgkmcnt(2)
  v_smfmac_f32_16x16x64_bf16 v[40:43], v[32:35], a[64:71], v132
  v_smfmac_f32_16x16x64_bf16 v[44:47], v[32:35], a[144:151], v132
  s_waitcnt lgkmcnt(0)
  v_smfmac_f32_16x16x64_bf16 v[40:43], v[36:39], a[72:79], v132
  v_smfmac_f32_16x16x64_bf16 v[44:47], v[36:39], a[152:159], v132
  s_branch L_s1b_61
L_s1a_60:
  ds_read_b64_tr_b16 v[24:25], v133 offset:6144
  ds_read_b64_tr_b16 v[26:27], v134 offset:6144
  s_waitcnt lgkmcnt(12)
  v_smfmac_f32_16x16x64_bf16 v[40:43], v[0:3], a[0:7], v132
  v_smfmac_f32_16x16x64_bf16 v[44:47], v[0:3], a[80:87], v132
  buffer_load_dwordx4 v[64:67], v144, s[8:11], s72 offen offset:0 sc1
  ds_read_b64_tr_b16 v[28:29], v133 offset:7168
  ds_read_b64_tr_b16 v[30:31], v134 offset:7168
  s_waitcnt lgkmcnt(12)
  v_smfmac_f32_16x16x64_bf16 v[40:43], v[4:7], a[8:15], v132
  v_smfmac_f32_16x16x64_bf16 v[44:47], v[4:7], a[88:95], v132
  buffer_load_dwordx4 v[72:75], v144, s[8:11], s72 offen offset:1024 sc1
  ds_read_b64_tr_b16 v[32:33], v133 offset:8192
  ds_read_b64_tr_b16 v[34:35], v134 offset:8192
  s_waitcnt lgkmcnt(12)
  v_smfmac_f32_16x16x64_bf16 v[40:43], v[8:11], a[16:23], v132
  v_smfmac_f32_16x16x64_bf16 v[44:47], v[8:11], a[96:103], v132
  buffer_load_dwordx4 v[80:83], v144, s[8:11], s72 offen offset:2048 sc1
  ds_read_b64_tr_b16 v[36:37], v133 offset:9216
  ds_read_b64_tr_b16 v[38:39], v134 offset:9216
  s_waitcnt lgkmcnt(12)
  v_smfmac_f32_16x16x64_bf16 v[40:43], v[12:15], a[24:31], v132
  v_smfmac_f32_16x16x64_bf16 v[44:47], v[12:15], a[104:111], v132
  s_waitcnt lgkmcnt(10)
  v_smfmac_f32_16x16x64_bf16 v[40:43], v[16:19], a[32:39], v132
  v_smfmac_f32_16x16x64_bf16 v[44:47], v[16:19], a[112:119], v132
  s_waitcnt lgkmcnt(8)
  v_smfmac_f32_16x16x64_bf16 v[40:43], v[20:23], a[40:47], v132
  v_smfmac_f32_16x16x64_bf16 v[44:47], v[20:23], a[120:127], v132
  s_waitcnt lgkmcnt(6)
  v_smfmac_f32_16x16x64_bf16 v[40:43], v[24:27], a[48:55], v132
  v_smfmac_f32_16x16x64_bf16 v[44:47], v[24:27], a[128:135], v132
  s_waitcnt lgkmcnt(4)
  v_smfmac_f32_16x16x64_bf16 v[40:43], v[28:31], a[56:63], v132
  v_smfmac_f32_16x16x64_bf16 v[44:47], v[28:31], a[136:143], v132
  s_waitcnt lgkmcnt(2)
  v_smfmac_f32_16x16x64_bf16 v[40:43], v[32:35], a[64:71], v132
  v_smfmac_f32_16x16x64_bf16 v[44:47], v[32:35], a[144:151], v132
  s_waitcnt lgkmcnt(0)
  v_smfmac_f32_16x16x64_bf16 v[40:43], v[36:39], a[72:79], v132
  v_smfmac_f32_16x16x64_bf16 v[44:47], v[36:39], a[152:159], v132
L_s1b_61:
  v_smfmac_f32_16x16x64_bf16 v[48:51], v[0:3], a[160:167], v132
  s_mul_i32 s5, s62, 1280
  s_add_u32 s5, s5, s76
  s_nop 3
  v_add_f32 v40, v40, v42
  v_add_f32 v41, v41, v43
  v_add_f32 v44, v44, v46
  v_add_f32 v45, v45, v47
  v_cvt_pk_bf16_f32 v128, v40, v41
  v_cvt_pk_bf16_f32 v129, v44, v45
  ds_write_b64 v135, v[128:129]
  v_smfmac_f32_16x16x64_bf16 v[48:51], v[4:7], a[168:175], v132
  v_smfmac_f32_16x16x64_bf16 v[48:51], v[8:11], a[176:183], v132
  v_smfmac_f32_16x16x64_bf16 v[48:51], v[12:15], a[184:191], v132
  s_waitcnt lgkmcnt(0)
  s_barrier
  ds_read_b64_tr_b16 v[52:53], v136 offset:0
  ds_read_b64_tr_b16 v[54:55], v136 offset:512
  ds_read_b64_tr_b16 v[56:57], v136 offset:1024
  ds_read_b64_tr_b16 v[58:59], v136 offset:1536
  v_smfmac_f32_16x16x64_bf16 v[48:51], v[16:19], a[192:199], v132
  v_smfmac_f32_16x16x64_bf16 v[48:51], v[20:23], a[200:207], v132
  v_smfmac_f32_16x16x64_bf16 v[48:51], v[24:27], a[208:215], v132
  v_smfmac_f32_16x16x64_bf16 v[48:51], v[28:31], a[216:223], v132
  s_cmp_ge_u32 s3, 2
  s_cbranch_scc1 L_s0_62
  s_waitcnt lgkmcnt(2)
  v_mfma_f32_16x16x32_bf16 v[100:103], v[104:107], v[52:55], 0
  s_waitcnt lgkmcnt(0)
  v_mfma_f32_16x16x32_bf16 v[100:103], v[108:111], v[56:59], v[100:103]
  v_smfmac_f32_16x16x64_bf16 v[48:51], v[32:35], a[224:231], v132
  s_nop 6
  v_or_b32 v100, 1, v100
  v_or_b32 v102, 1, v102
  buffer_store_dwordx4 v[100:103], v139, s[8:11], s5 offen
  s_branch L_sj_63
L_s0_62:
  s_waitcnt lgkmcnt(2)
  v_mfma_f32_16x16x32_bf16 v[100:103], v[52:55], v[52:55], 0
  s_waitcnt lgkmcnt(0)
  v_mfma_f32_16x16x32_bf16 v[100:103], v[56:59], v[56:59], v[100:103]
  v_smfmac_f32_16x16x64_bf16 v[48:51], v[32:35], a[224:231], v132
  s_cmp_eq_u32 s3, 3
  s_cbranch_scc1 L_s3_64
  s_nop 4
  v_or_b32 v102, 1, v102
  buffer_store_dwordx2 v[102:103], v139, s[8:11], s5 offen
L_sj_63:
  v_smfmac_f32_16x16x64_bf16 v[48:51], v[36:39], a[232:239], v132
  v_mov_b32 v12, 0
  v_mov_b32 v13, 0
  v_mov_b32 v14, 0
  v_mov_b32 v15, 0
  v_mov_b32 v16, 0
  v_mov_b32 v17, 0
  v_mov_b32 v18, 0
  v_mov_b32 v19, 0
  v_add_f32 v48, v48, v50
  v_add_f32 v49, v49, v51
  v_cvt_pk_bf16_f32 v152, v48, v49
  v_or_b32 v128, 1, v152
  buffer_store_dword v128, v141, s[8:11], s78 offen
  s_cmp_lg_u32 s3, 0
  s_cbranch_scc1 L_w0_68
  s_cmp_ge_u32 s91, 62
  s_cbranch_scc1 L_pfok_70
  s_add_u32 s7, s91, 1
  s_add_u32 s71, s7, 1
  s_lshr_b32 s7, s7, 1
  s_lshr_b32 s71, s71, 1
L_pf_69:
  s_sub_u32 s59, s59, 1
  s_cbranch_scc1 L_end
  v_readlane_b32 s5, v153, 0
  v_readlane_b32 s6, v153, 3
  s_cmp_gt_u32 s5, s71
  s_cselect_b32 s6, s6, 0
  s_cmp_gt_u32 s6, s7
  s_cbranch_scc1 L_pfok_70
  buffer_load_dword v153, v159, s[8:11], s90 offen sc1
  s_waitcnt vmcnt(0)
  s_branch L_pf_69
L_pfok_70:
L_w0_68:
  v_mov_b32 v20, 0
  v_mov_b32 v21, 0
  v_mov_b32 v22, 0
  v_mov_b32 v23, 0
  v_mov_b32 v24, 0
  v_mov_b32 v25, 0
  v_mov_b32 v26, 0
  v_mov_b32 v27, 0
  v_mov_b32 v28, 0
  v_mov_b32 v29, 0
  v_mov_b32 v30, 0
  v_mov_b32 v31, 0
  v_mov_b32 v32, 0
  v_mov_b32 v33, 0
  v_mov_b32 v34, 0
  v_mov_b32 v35, 0
  v_mov_b32 v36, 0
  v_mov_b32 v37, 0
  v_mov_b32 v38, 0
  v_mov_b32 v39, 0
  v_mov_b32 v40, 0
  v_mov_b32 v41, 0
  v_mov_b32 v42, 0
  v_mov_b32 v43, 0
  buffer_load_dwordx4 v[92:95], v140, s[8:11], s76 offen sc1
  buffer_load_dwordx4 v[96:99], v154, s[8:11], s76 offen sc1
L_pl_65:
  s_sub_u32 s59, s59, 1
  s_cbranch_scc1 L_end
  s_waitcnt vmcnt(0)
  v_bitop3_b32 v90, v92, v94, v96 bitop3:0x80
  v_bitop3_b32 v90, v90, v98, v98 bitop3:0x80
  v_and_b32 v90, 1, v90
  v_cmp_ne_u32 vcc, 1, v90
  s_cbranch_vccz L_pd_67
  buffer_load_dwordx4 v[92:95], v140, s[8:11], s76 offen sc1
  buffer_load_dwordx4 v[96:99], v154, s[8:11], s76 offen sc1
  s_branch L_pl_65
L_pd_67:
  v_fma_f32 v100, v155, v96, v92
  v_fma_f32 v101, v155, v97, v93
  v_fma_f32 v102, v155, v98, v94
  v_fma_f32 v103, v155, v99, v95
L_pj_66:
  buffer_load_dwordx4 v[68:71], v142, s[8:11], s78 offen offset:0 sc1
  v_permlane32_swap_b32 v100, v102
  v_permlane32_swap_b32 v101, v103
  v_add_f32 v100, v100, v102
  v_add_f32 v101, v101, v103
  v_max_f32 v128, v100, v101
  buffer_load_dwordx4 v[76:79], v142, s[8:11], s78 offen offset:512 sc1
  s_nop 0
  v_max_f32_dpp v128, v128, v128 row_ror:1 row_mask:0xf bank_mask:0xf
  buffer_load_dwordx4 v[84:87], v142, s[8:11], s78 offen offset:1024 sc1
  s_nop 0
  v_max_f32_dpp v128, v128, v128 row_ror:2 row_mask:0xf bank_mask:0xf
  s_nop 1
  v_max_f32_dpp v128, v128, v128 row_ror:4 row_mask:0xf bank_mask:0xf
  s_nop 1
  v_max_f32_dpp v128, v128, v128 row_ror:8 row_mask:0xf bank_mask:0xf
  v_mov_b32 v129, v128
  s_nop 1
  v_permlane32_swap_b32 v128, v129
  v_max_f32 v128, v128, v129
  v_sub_f32 v100, v100, v128
  v_sub_f32 v101, v101, v128
  v_mul_f32 v100, s93, v100
  v_mul_f32 v101, s93, v101
  v_exp_f32 v100, v100
  v_exp_f32 v101, v101
  s_nop 0
  v_cvt_pk_bf16_f32 v128, v100, v101
  ds_write_b32 v156, v128
  s_waitcnt lgkmcnt(0)
  s_barrier
  ds_read_b128 v[124:127], v91
L_hv2_72:
  s_waitcnt vmcnt(0)
  v_bitop3_b32 v128, v68, v70, v76 bitop3:0x80
  v_bitop3_b32 v128, v128, v78, v84 bitop3:0x80
  v_bitop3_b32 v128, v128, v86, v86 bitop3:0x80
  v_and_b32 v128, 1, v128
  v_cmp_ne_u32 vcc, 1, v128
  s_cbranch_vccnz L_hv_71
  s_waitcnt lgkmcnt(0)
  v_smfmac_f32_16x16x64_bf16 v[12:15], v[124:127], v[64:71], v132
  v_smfmac_f32_16x16x64_bf16 v[16:19], v[124:127], v[72:79], v132
  v_smfmac_f32_16x16x64_bf16 v[20:23], v[124:127], v[80:87], v132
  v_smfmac_f32_16x16x64_bf16 v[24:27], v[124:127], a[240:247], v132
  s_nop 4
  v_add_f32 v12, v12, v14
  v_add_f32 v13, v13, v15
  v_cvt_pk_bf16_f32 v128, v12, v13
  ds_write_b32 v137, v128
  v_add_f32 v16, v16, v18
  v_add_f32 v17, v17, v19
  v_cvt_pk_bf16_f32 v129, v16, v17
  ds_write_b32 v147, v129
  v_add_f32 v20, v20, v22
  v_add_f32 v21, v21, v23
  v_cvt_pk_bf16_f32 v130, v20, v21
  ds_write_b32 v138, v130
  v_add_f32 v24, v24, v26
  v_add_f32 v25, v25, v27
  v_rcp_f32 v12, v24
  v_rcp_f32 v13, v25
  s_waitcnt lgkmcnt(0)
  s_barrier
  ds_read_b64_tr_b16 v[0:1], v133 offset:12288
  ds_read_b64_tr_b16 v[2:3], v134 offset:12288
  ds_read_b64_tr_b16 v[4:5], v133 offset:13312
  ds_read_b64_tr_b16 v[6:7], v134 offset:13312
  ds_read_b64_tr_b16 v[8:9], v133 offset:14336
  ds_read_b64_tr_b16 v[10:11], v134 offset:14336
  s_add_u32 s5, s88, 6291456
  buffer_store_dword v152, v143, s[8:11], s5 offen sc1
  s_cmp_lg_u32 s3, 3
  s_cbranch_scc1 L_km_73
  s_sub_u32 s5, s88, 0
  buffer_store_dwordx4 v[52:55], v139, s[8:11], s5 offen sc1
  buffer_store_dwordx4 v[56:59], v139, s[8:11], s5 offen offset:512 sc1
L_km_73:
  s_waitcnt lgkmcnt(4)
  v_smfmac_f32_16x16x64_bf16 v[28:31], v[0:3], v[160:167], v132
  v_smfmac_f32_16x16x64_bf16 v[32:35], v[0:3], v[184:191], v132
  s_waitcnt lgkmcnt(2)
  v_smfmac_f32_16x16x64_bf16 v[28:31], v[4:7], v[168:175], v132
  v_smfmac_f32_16x16x64_bf16 v[32:35], v[4:7], v[192:199], v132
  s_waitcnt lgkmcnt(0)
  v_smfmac_f32_16x16x64_bf16 v[28:31], v[8:11], v[176:183], v132
  v_smfmac_f32_16x16x64_bf16 v[32:35], v[8:11], v[200:207], v132
  v_smfmac_f32_16x16x64_bf16 v[36:39], v[0:3], v[208:215], v132
  v_smfmac_f32_16x16x64_bf16 v[40:43], v[0:3], v[232:239], v132
  v_smfmac_f32_16x16x64_bf16 v[36:39], v[4:7], v[216:223], v132
  v_smfmac_f32_16x16x64_bf16 v[40:43], v[4:7], v[240:247], v132
  v_smfmac_f32_16x16x64_bf16 v[36:39], v[8:11], v[224:231], v132
  s_nop 1
  v_add_f32 v28, v28, v30
  v_add_f32 v29, v29, v31
  v_smfmac_f32_16x16x64_bf16 v[40:43], v[8:11], v[248:255], v132
  v_mul_f32 v28, v28, v12
  v_mul_f32 v29, v29, v13
  v_cvt_pk_bf16_f32 v128, v28, v29
  v_or_b32 v128, 1, v128
  v_add_f32 v32, v32, v34
  v_add_f32 v33, v33, v35
  v_mul_f32 v32, v32, v12
  v_mul_f32 v33, v33, v13
  v_cvt_pk_bf16_f32 v129, v32, v33
  buffer_store_dwordx2 v[128:129], v146, s[8:11], s80 offen sc1
  v_add_f32 v36, v36, v38
  v_add_f32 v37, v37, v39
  v_mul_f32 v36, v36, v12
  v_mul_f32 v37, v37, v13
  v_cvt_pk_bf16_f32 v130, v36, v37
  v_or_b32 v130, 1, v130
  v_add_f32 v40, v40, v42
  v_add_f32 v41, v41, v43
  v_mul_f32 v40, v40, v12
  v_mul_f32 v41, v41, v13
  v_cvt_pk_bf16_f32 v131, v40, v41
  buffer_store_dwordx2 v[130:131], v146, s[8:11], s66 offen sc1
  buffer_store_dwordx2 v[128:129], v146, s[8:11], s32 offen
  buffer_store_dwordx2 v[130:131], v146, s[8:11], s34 offen
  s_cmp_eq_u32 s92, 0
  s_cbranch_scc1 L_nr_74
  v_mov_b32 v124, 0
  v_mov_b32 v125, 0
  v_mov_b32 v126, 0
  v_mov_b32 v127, 0
  s_add_u32 s91, s91, 1
  s_add_u32 s88, s88, 98304
  s_add_u32 s89, s89, 393216
  v_mov_b32 v40, 0
  v_mov_b32 v41, 0
  v_mov_b32 v42, 0
  v_mov_b32 v43, 0
  v_mov_b32 v44, 0
  v_mov_b32 v45, 0
  v_mov_b32 v46, 0
  v_mov_b32 v47, 0
  v_mov_b32 v48, 0
  v_mov_b32 v49, 0
  v_mov_b32 v50, 0
  v_mov_b32 v51, 0
  s_mul_i32 s72, s3, 3072
  s_add_u32 s72, s72, s89
  s_add_u32 s72, s72, 48758784
  s_lshl_b32 s73, s62, 12
  s_add_u32 s73, s73, s89
  s_add_u32 s73, s73, 23986176
  s_add_u32 s40, s82, 0
  s_cmp_eq_u32 s63, 0
  s_cselect_b32 s40, s36, s40
  s_add_u32 s41, s82, 4096
  s_cmp_eq_u32 s63, 1
  s_cselect_b32 s41, s36, s41
  s_add_u32 s42, s82, 16384
  s_cmp_eq_u32 s63, 2
  s_cselect_b32 s42, s36, s42
  s_add_u32 s43, s82, 20480
  s_cmp_eq_u32 s63, 3
  s_cselect_b32 s43, s36, s43
  v_mov_b32 v100, s91
  v_mov_b32 v101, 17408
  buffer_load_dwordx4 v[0:3], v148, s[8:11], s40 offen offset:0 sc1
  buffer_load_dwordx4 v[4:7], v148, s[8:11], s40 offen offset:2048 sc1
  buffer_load_dwordx4 v[8:11], v148, s[8:11], s41 offen offset:0 sc1
  buffer_load_dwordx4 v[12:15], v148, s[8:11], s41 offen offset:2048 sc1
  buffer_load_dwordx4 v[16:19], v148, s[8:11], s42 offen offset:0 sc1
  buffer_load_dwordx4 v[20:23], v148, s[8:11], s42 offen offset:2048 sc1
  buffer_load_dwordx4 v[24:27], v148, s[8:11], s43 offen offset:0 sc1
  buffer_load_dwordx4 v[28:31], v148, s[8:11], s43 offen offset:2048 sc1
L_xc_80:
  s_waitcnt vmcnt(6)
  v_bitop3_b32 v90, v0, v2, v4 bitop3:0x80
  v_bitop3_b32 v90, v90, v6, v6 bitop3:0x80
  v_and_b32 v90, 1, v90
  v_cmp_ne_u32 vcc, 1, v90
  s_cbranch_vccnz L_xp_79
  v_smfmac_f32_16x16x64_bf16 v[124:127], a[248:251], v[0:7], v132
L_xc_82:
  s_waitcnt vmcnt(4)
  v_bitop3_b32 v90, v8, v10, v12 bitop3:0x80
  v_bitop3_b32 v90, v90, v14, v14 bitop3:0x80
  v_and_b32 v90, 1, v90
  v_cmp_ne_u32 vcc, 1, v90
  s_cbranch_vccnz L_xp_81
  v_smfmac_f32_16x16x64_bf16 v[124:127], a[248:251], v[8:15], v132
L_xc_84:
  s_waitcnt vmcnt(2)
  v_bitop3_b32 v90, v16, v18, v20 bitop3:0x80
  v_bitop3_b32 v90, v90, v22, v22 bitop3:0x80
  v_and_b32 v90, 1, v90
  v_cmp_ne_u32 vcc, 1, v90
  s_cbranch_vccnz L_xp_83
  v_smfmac_f32_16x16x64_bf16 v[124:127], a[248:251], v[16:23], v132
L_xc_86:
  s_waitcnt vmcnt(0)
  v_bitop3_b32 v90, v24, v26, v28 bitop3:0x80
  v_bitop3_b32 v90, v90, v30, v30 bitop3:0x80
  v_and_b32 v90, 1, v90
  v_cmp_ne_u32 vcc, 1, v90
  s_cbranch_vccnz L_xp_85
  v_smfmac_f32_16x16x64_bf16 v[124:127], a[248:251], v[24:31], v132
  ds_write_b32 v101, v100
  s_nop 6
  v_cvt_pk_bf16_f32 v128, v124, v125
  v_cvt_pk_bf16_f32 v129, v126, v127
  v_or_b32 v128, 1, v128
  buffer_store_dwordx2 v[128:129], v150, s[8:11], s84 offen
  s_branch L_go_78
L_nr_74:
  s_add_u32 s91, s91, 1
  s_add_u32 s88, s88, 98304
  s_add_u32 s89, s89, 393216
  v_mov_b32 v40, 0
  v_mov_b32 v41, 0
  v_mov_b32 v42, 0
  v_mov_b32 v43, 0
  v_mov_b32 v44, 0
  v_mov_b32 v45, 0
  v_mov_b32 v46, 0
  v_mov_b32 v47, 0
  v_mov_b32 v48, 0
  v_mov_b32 v49, 0
  v_mov_b32 v50, 0
  v_mov_b32 v51, 0
  s_mul_i32 s72, s3, 3072
  s_add_u32 s72, s72, s89
  s_add_u32 s72, s72, 48758784
  s_lshl_b32 s73, s62, 12
  s_add_u32 s73, s73, s89
  s_add_u32 s73, s73, 23986176
  v_mov_b32 v101, 17408
L_lf_88:
  s_sub_u32 s59, s59, 1
  s_cbranch_scc1 L_end
  ds_read_b32 v100, v101
  s_waitcnt lgkmcnt(0)
  v_cmp_ne_u32 vcc, s91, v100
  s_cbranch_vccnz L_lf_88
L_go_78:
  s_cmp_ge_u32 s3, 2
  s_cbranch_scc1 L_g2_89
  buffer_load_dwordx4 v[92:95], v151, s[8:11], s86 offen offset:0 sc1
  buffer_load_dwordx4 v[96:99], v151, s[8:11], s86 offen offset:1024 sc1
  buffer_load_dwordx4 v[100:103], v157, s[8:11], s86 offen offset:0 sc1
L_gc_92:
  s_waitcnt vmcnt(2)
  v_bitop3_b32 v90, v92, v94, 1 bitop3:0x80
  v_cmp_ne_u32 vcc, 1, v90
  s_cbranch_vccnz L_gp_91
  ds_write_b128 v151, v[92:95] offset:0
L_gc_94:
  s_waitcnt vmcnt(1)
  v_bitop3_b32 v90, v96, v98, 1 bitop3:0x80
  v_cmp_ne_u32 vcc, 1, v90
  s_cbranch_vccnz L_gp_93
  ds_write_b128 v151, v[96:99] offset:1024
L_gc_96:
  s_waitcnt vmcnt(0)
  v_bitop3_b32 v90, v100, v102, 1 bitop3:0x80
  v_cmp_ne_u32 vcc, 1, v90
  s_cbranch_vccnz L_gp_95
  ds_write_b128 v157, v[100:103] offset:0
  s_branch L_g3_90
L_g2_89:
  buffer_load_dwordx4 v[92:95], v151, s[8:11], s86 offen offset:0 sc1
  buffer_load_dwordx4 v[96:99], v151, s[8:11], s86 offen offset:1024 sc1
L_gc_99:
  s_waitcnt vmcnt(1)
  v_bitop3_b32 v90, v92, v94, 1 bitop3:0x80
  v_cmp_ne_u32 vcc, 1, v90
  s_cbranch_vccnz L_gp_98
  ds_write_b128 v151, v[92:95] offset:0
L_gc_101:
  s_waitcnt vmcnt(0)
  v_bitop3_b32 v90, v96, v98, 1 bitop3:0x80
  v_cmp_ne_u32 vcc, 1, v90
  s_cbranch_vccnz L_gp_100
  ds_write_b128 v151, v[96:99] offset:1024
L_g3_90:
  s_waitcnt lgkmcnt(0)
  s_barrier
  ds_read_b64_tr_b16 v[0:1], v133 offset:0
  ds_read_b64_tr_b16 v[2:3], v134 offset:0
  ds_read_b64_tr_b16 v[4:5], v133 offset:1024
  ds_read_b64_tr_b16 v[6:7], v134 offset:1024
  ds_read_b64_tr_b16 v[8:9], v133 offset:2048
  ds_read_b64_tr_b16 v[10:11], v134 offset:2048
  ds_read_b64_tr_b16 v[12:13], v133 offset:3072
  ds_read_b64_tr_b16 v[14:15], v134 offset:3072
  ds_read_b64_tr_b16 v[16:17], v133 offset:4096
  ds_read_b64_tr_b16 v[18:19], v134 offset:4096
  ds_read_b64_tr_b16 v[20:21], v133 offset:5120
  ds_read_b64_tr_b16 v[22:23], v134 offset:5120
  s_cmp_ge_u32 s3, 2
  s_cbranch_scc1 L_s1a_106
  ds_read_b64_tr_b16 v[24:25], v133 offset:6144
  ds_read_b64_tr_b16 v[26:27], v134 offset:6144
  s_waitcnt lgkmcnt(12)
  v_smfmac_f32_16x16x64_bf16 v[40:43], v[0:3], a[0:7], v132
  v_smfmac_f32_16x16x64_bf16 v[44:47], v[0:3], a[80:87], v132
  buffer_load_dwordx4 v[64:67], v144, s[8:11], s72 offen offset:0 sc1
  ds_read_b64_tr_b16 v[28:29], v133 offset:7168
  ds_read_b64_tr_b16 v[30:31], v134 offset:7168
  s_waitcnt lgkmcnt(12)
  v_smfmac_f32_16x16x64_bf16 v[40:43], v[4:7], a[8:15], v132
  v_smfmac_f32_16x16x64_bf16 v[44:47], v[4:7], a[88:95], v132
  buffer_load_dwordx4 v[72:75], v144, s[8:11], s72 offen offset:1024 sc1
  ds_read_b64_tr_b16 v[32:33], v133 offset:8192
  ds_read_b64_tr_b16 v[34:35], v134 offset:8192
  s_waitcnt lgkmcnt(12)
  v_smfmac_f32_16x16x64_bf16 v[40:43], v[8:11], a[16:23], v132
  v_smfmac_f32_16x16x64_bf16 v[44:47], v[8:11], a[96:103], v132
  buffer_load_dwordx4 v[80:83], v144, s[8:11], s72 offen offset:2048 sc1
  ds_read_b64_tr_b16 v[36:37], v133 offset:9216
  ds_read_b64_tr_b16 v[38:39], v134 offset:9216
  s_waitcnt lgkmcnt(12)
  v_smfmac_f32_16x16x64_bf16 v[40:43], v[12:15], a[24:31], v132
  v_smfmac_f32_16x16x64_bf16 v[44:47], v[12:15], a[104:111], v132
  buffer_load_dwordx2 v[104:105], v145, s[8:11], s73 offen offset:0 sc1
  s_waitcnt lgkmcnt(10)
  v_smfmac_f32_16x16x64_bf16 v[40:43], v[16:19], a[32:39], v132
  v_smfmac_f32_16x16x64_bf16 v[44:47], v[16:19], a[112:119], v132
  buffer_load_dwordx2 v[106:107], v145, s[8:11], s73 offen offset:1024 sc1
  s_waitcnt lgkmcnt(8)
  v_smfmac_f32_16x16x64_bf16 v[40:43], v[20:23], a[40:47], v132
  v_smfmac_f32_16x16x64_bf16 v[44:47], v[20:23], a[120:127], v132
  buffer_load_dwordx2 v[108:109], v145, s[8:11], s73 offen offset:2048 sc1
  s_waitcnt lgkmcnt(6)
  v_smfmac_f32_16x16x64_bf16 v[40:43], v[24:27], a[48:55], v132
  v_smfmac_f32_16x16x64_bf16 v[44:47], v[24:27], a[128:135], v132
  buffer_load_dwordx2 v[110:111], v145, s[8:11], s73 offen offset:3072 sc1
  s_waitcnt lgkmcnt(4)
  v_smfmac_f32_16x16x64_bf16 v[40:43], v[28:31], a[56:63], v132
  v_smfmac_f32_16x16x64_bf16 v[44:47], v[28:31], a[136:143], v132
  buffer_load_dword v153, v159, s[8:11], s90 offen sc1
  s_waitcnt lgkmcnt(2)
  v_smfmac_f32_16x16x64_bf16 v[40:43], v[32:35], a[64:71], v132
  v_smfmac_f32_16x16x64_bf16 v[44:47], v[32:35], a[144:151], v132
  s_waitcnt lgkmcnt(0)
  v_smfmac_f32_16x16x64_bf16 v[40:43], v[36:39], a[72:79], v132
  v_smfmac_f32_16x16x64_bf16 v[44:47], v[36:39], a[152:159], v132
  s_branch L_s1b_107
L_s1a_106:
  ds_read_b64_tr_b16 v[24:25], v133 offset:6144
  ds_read_b64_tr_b16 v[26:27], v134 offset:6144
  s_waitcnt lgkmcnt(12)
  v_smfmac_f32_16x16x64_bf16 v[40:43], v[0:3], a[0:7], v132
  v_smfmac_f32_16x16x64_bf16 v[44:47], v[0:3], a[80:87], v132
  buffer_load_dwordx4 v[64:67], v144, s[8:11], s72 offen offset:0 sc1
  ds_read_b64_tr_b16 v[28:29], v133 offset:7168
  ds_read_b64_tr_b16 v[30:31], v134 offset:7168
  s_waitcnt lgkmcnt(12)
  v_smfmac_f32_16x16x64_bf16 v[40:43], v[4:7], a[8:15], v132
  v_smfmac_f32_16x16x64_bf16 v[44:47], v[4:7], a[88:95], v132
  buffer_load_dwordx4 v[72:75], v144, s[8:11], s72 offen offset:1024 sc1
  ds_read_b64_tr_b16 v[32:33], v133 offset:8192
  ds_read_b64_tr_b16 v[34:35], v134 offset:8192
  s_waitcnt lgkmcnt(12)
  v_smfmac_f32_16x16x64_bf16 v[40:43], v[8:11], a[16:23], v132
  v_smfmac_f32_16x16x64_bf16 v[44:47], v[8:11], a[96:103], v132
  buffer_load_dwordx4 v[80:83], v144, s[8:11], s72 offen offset:2048 sc1
  ds_read_b64_tr_b16 v[36:37], v133 offset:9216
  ds_read_b64_tr_b16 v[38:39], v134 offset:9216
  s_waitcnt lgkmcnt(12)
  v_smfmac_f32_16x16x64_bf16 v[40:43], v[12:15], a[24:31], v132
  v_smfmac_f32_16x16x64_bf16 v[44:47], v[12:15], a[104:111], v132
  s_waitcnt lgkmcnt(10)
  v_smfmac_f32_16x16x64_bf16 v[40:43], v[16:19], a[32:39], v132
  v_smfmac_f32_16x16x64_bf16 v[44:47], v[16:19], a[112:119], v132
  s_waitcnt lgkmcnt(8)
  v_smfmac_f32_16x16x64_bf16 v[40:43], v[20:23], a[40:47], v132
  v_smfmac_f32_16x16x64_bf16 v[44:47], v[20:23], a[120:127], v132
  s_waitcnt lgkmcnt(6)
  v_smfmac_f32_16x16x64_bf16 v[40:43], v[24:27], a[48:55], v132
  v_smfmac_f32_16x16x64_bf16 v[44:47], v[24:27], a[128:135], v132
  s_waitcnt lgkmcnt(4)
  v_smfmac_f32_16x16x64_bf16 v[40:43], v[28:31], a[56:63], v132
  v_smfmac_f32_16x16x64_bf16 v[44:47], v[28:31], a[136:143], v132
  s_waitcnt lgkmcnt(2)
  v_smfmac_f32_16x16x64_bf16 v[40:43], v[32:35], a[64:71], v132
  v_smfmac_f32_16x16x64_bf16 v[44:47], v[32:35], a[144:151], v132
  s_waitcnt lgkmcnt(0)
  v_smfmac_f32_16x16x64_bf16 v[40:43], v[36:39], a[72:79], v132
  v_smfmac_f32_16x16x64_bf16 v[44:47], v[36:39], a[152:159], v132
L_s1b_107:
  v_smfmac_f32_16x16x64_bf16 v[48:51], v[0:3], a[160:167], v132
  s_mul_i32 s5, s62, 1280
  s_add_u32 s5, s5, s77
  s_nop 3
  v_add_f32 v40, v40, v42
  v_add_f32 v41, v41, v43
  v_add_f32 v44, v44, v46
  v_add_f32 v45, v45, v47
  v_cvt_pk_bf16_f32 v128, v40, v41
  v_cvt_pk_bf16_f32 v129, v44, v45
  ds_write_b64 v135, v[128:129]
  v_smfmac_f32_16x16x64_bf16 v[48:51], v[4:7], a[168:175], v132
  v_smfmac_f32_16x16x64_bf16 v[48:51], v[8:11], a[176:183], v132
  v_smfmac_f32_16x16x64_bf16 v[48:51], v[12:15], a[184:191], v132
  s_waitcnt lgkmcnt(0)
  s_barrier
  ds_read_b64_tr_b16 v[52:53], v136 offset:0
  ds_read_b64_tr_b16 v[54:55], v136 offset:512
  ds_read_b64_tr_b16 v[56:57], v136 offset:1024
  ds_read_b64_tr_b16 v[58:59], v136 offset:1536
  v_smfmac_f32_16x16x64_bf16 v[48:51], v[16:19], a[192:199], v132
  v_smfmac_f32_16x16x64_bf16 v[48:51], v[20:23], a[200:207], v132
  v_smfmac_f32_16x16x64_bf16 v[48:51], v[24:27], a[208:215], v132
  v_smfmac_f32_16x16x64_bf16 v[48:51], v[28:31], a[216:223], v132
  s_cmp_ge_u32 s3, 2
  s_cbranch_scc1 L_s0_108
  s_waitcnt lgkmcnt(2)
  v_mfma_f32_16x16x32_bf16 v[100:103], v[112:115], v[52:55], 0
  s_waitcnt lgkmcnt(0)
  v_mfma_f32_16x16x32_bf16 v[100:103], v[116:119], v[56:59], v[100:103]
  v_smfmac_f32_16x16x64_bf16 v[48:51], v[32:35], a[224:231], v132
  s_nop 6
  v_or_b32 v100, 1, v100
  v_or_b32 v102, 1, v102
  buffer_store_dwordx4 v[100:103], v139, s[8:11], s5 offen
  s_branch L_sj_109
L_s0_108:
  s_waitcnt lgkmcnt(2)
  v_mfma_f32_16x16x32_bf16 v[100:103], v[52:55], v[52:55], 0
  s_waitcnt lgkmcnt(0)
  v_mfma_f32_16x16x32_bf16 v[100:103], v[56:59], v[56:59], v[100:103]
  v_smfmac_f32_16x16x64_bf16 v[48:51], v[32:35], a[224:231], v132
  s_cmp_eq_u32 s3, 3
  s_cbranch_scc1 L_s3_110
  s_nop 4
  v_or_b32 v102, 1, v102
  buffer_store_dwordx2 v[102:103], v139, s[8:11], s5 offen
L_sj_109:
  v_smfmac_f32_16x16x64_bf16 v[48:51], v[36:39], a[232:239], v132
  v_mov_b32 v12, 0
  v_mov_b32 v13, 0
  v_mov_b32 v14, 0
  v_mov_b32 v15, 0
  v_mov_b32 v16, 0
  v_mov_b32 v17, 0
  v_mov_b32 v18, 0
  v_mov_b32 v19, 0
  v_add_f32 v48, v48, v50
  v_add_f32 v49, v49, v51
  v_cvt_pk_bf16_f32 v152, v48, v49
  v_or_b32 v128, 1, v152
  buffer_store_dword v128, v141, s[8:11], s79 offen
  s_cmp_lg_u32 s3, 0
  s_cbranch_scc1 L_w0_114
  s_cmp_ge_u32 s91, 62
  s_cbranch_scc1 L_pfok_116
  s_add_u32 s7, s91, 1
  s_add_u32 s71, s7, 1
  s_lshr_b32 s7, s7, 1
  s_lshr_b32 s71, s71, 1
L_pf_115:
  s_sub_u32 s59, s59, 1
  s_cbranch_scc1 L_end
  v_readlane_b32 s5, v153, 1
  v_readlane_b32 s6, v153, 2
  s_cmp_gt_u32 s5, s71
  s_cselect_b32 s6, s6, 0
  s_cmp_gt_u32 s6, s7
  s_cbranch_scc1 L_pfok_116
  buffer_load_dword v153, v159, s[8:11], s90 offen sc1
  s_waitcnt vmcnt(0)
  s_branch L_pf_115
L_pfok_116:
L_w0_114:
  v_mov_b32 v20, 0
  v_mov_b32 v21, 0
  v_mov_b32 v22, 0
  v_mov_b32 v23, 0
  v_mov_b32 v24, 0
  v_mov_b32 v25, 0
  v_mov_b32 v26, 0
  v_mov_b32 v27, 0
  v_mov_b32 v28, 0
  v_mov_b32 v29, 0
  v_mov_b32 v30, 0
  v_mov_b32 v31, 0
  v_mov_b32 v32, 0
  v_mov_b32 v33, 0
  v_mov_b32 v34, 0
  v_mov_b32 v35, 0
  v_mov_b32 v36, 0
  v_mov_b32 v37, 0
  v_mov_b32 v38, 0
  v_mov_b32 v39, 0
  v_mov_b32 v40, 0
  v_mov_b32 v41, 0
  v_mov_b32 v42, 0
  v_mov_b32 v43, 0
  buffer_load_dwordx4 v[92:95], v140, s[8:11], s77 offen sc1
  buffer_load_dwordx4 v[96:99], v154, s[8:11], s77 offen sc1
L_pl_111:
  s_sub_u32 s59, s59, 1
  s_cbranch_scc1 L_end
  s_waitcnt vmcnt(0)
  v_bitop3_b32 v90, v92, v94, v96 bitop3:0x80
  v_bitop3_b32 v90, v90, v98, v98 bitop3:0x80
  v_and_b32 v90, 1, v90
  v_cmp_ne_u32 vcc, 1, v90
  s_cbranch_vccz L_pd_113
  buffer_load_dwordx4 v[92:95], v140, s[8:11], s77 offen sc1
  buffer_load_dwordx4 v[96:99], v154, s[8:11], s77 offen sc1
  s_branch L_pl_111
L_pd_113:
  v_fma_f32 v100, v155, v96, v92
  v_fma_f32 v101, v155, v97, v93
  v_fma_f32 v102, v155, v98, v94
  v_fma_f32 v103, v155, v99, v95
L_pj_112:
  buffer_load_dwordx4 v[68:71], v142, s[8:11], s79 offen offset:0 sc1
  v_permlane32_swap_b32 v100, v102
  v_permlane32_swap_b32 v101, v103
  v_add_f32 v100, v100, v102
  v_add_f32 v101, v101, v103
  v_max_f32 v128, v100, v101
  buffer_load_dwordx4 v[76:79], v142, s[8:11], s79 offen offset:512 sc1
  s_nop 0
  v_max_f32_dpp v128, v128, v128 row_ror:1 row_mask:0xf bank_mask:0xf
  buffer_load_dwordx4 v[84:87], v142, s[8:11], s79 offen offset:1024 sc1
  s_nop 0
  v_max_f32_dpp v128, v128, v128 row_ror:2 row_mask:0xf bank_mask:0xf
  s_nop 1
  v_max_f32_dpp v128, v128, v128 row_ror:4 row_mask:0xf bank_mask:0xf
  s_nop 1
  v_max_f32_dpp v128, v128, v128 row_ror:8 row_mask:0xf bank_mask:0xf
  v_mov_b32 v129, v128
  s_nop 1
  v_permlane32_swap_b32 v128, v129
  v_max_f32 v128, v128, v129
  v_sub_f32 v100, v100, v128
  v_sub_f32 v101, v101, v128
  v_mul_f32 v100, s93, v100
  v_mul_f32 v101, s93, v101
  v_exp_f32 v100, v100
  v_exp_f32 v101, v101
  s_nop 0
  v_cvt_pk_bf16_f32 v128, v100, v101
  ds_write_b32 v156, v128
  s_waitcnt lgkmcnt(0)
  s_barrier
  ds_read_b128 v[124:127], v91
L_hv2_118:
  s_waitcnt vmcnt(0)
  v_bitop3_b32 v128, v68, v70, v76 bitop3:0x80
  v_bitop3_b32 v128, v128, v78, v84 bitop3:0x80
  v_bitop3_b32 v128, v128, v86, v86 bitop3:0x80
  v_and_b32 v128, 1, v128
  v_cmp_ne_u32 vcc, 1, v128
  s_cbranch_vccnz L_hv_117
  s_waitcnt lgkmcnt(0)
  v_smfmac_f32_16x16x64_bf16 v[12:15], v[124:127], v[64:71], v132
  v_smfmac_f32_16x16x64_bf16 v[16:19], v[124:127], v[72:79], v132
  v_smfmac_f32_16x16x64_bf16 v[20:23], v[124:127], v[80:87], v132
  v_smfmac_f32_16x16x64_bf16 v[24:27], v[124:127], a[240:247], v132
  s_nop 4
  v_add_f32 v12, v12, v14
  v_add_f32 v13, v13, v15
  v_cvt_pk_bf16_f32 v128, v12, v13
  ds_write_b32 v137, v128
  v_add_f32 v16, v16, v18
  v_add_f32 v17, v17, v19
  v_cvt_pk_bf16_f32 v129, v16, v17
  ds_write_b32 v147, v129
  v_add_f32 v20, v20, v22
  v_add_f32 v21, v21, v23
  v_cvt_pk_bf16_f32 v130, v20, v21
  ds_write_b32 v138, v130
  v_add_f32 v24, v24, v26
  v_add_f32 v25, v25, v27
  v_rcp_f32 v12, v24
  v_rcp_f32 v13, v25
  s_waitcnt lgkmcnt(0)
  s_barrier
  ds_read_b64_tr_b16 v[0:1], v133 offset:12288
  ds_read_b64_tr_b16 v[2:3], v134 offset:12288
  ds_read_b64_tr_b16 v[4:5], v133 offset:13312
  ds_read_b64_tr_b16 v[6:7], v134 offset:13312
  ds_read_b64_tr_b16 v[8:9], v133 offset:14336
  ds_read_b64_tr_b16 v[10:11], v134 offset:14336
  s_add_u32 s5, s88, 6291456
  buffer_store_dword v152, v143, s[8:11], s5 offen sc1
  s_cmp_lg_u32 s3, 3
  s_cbranch_scc1 L_km_119
  s_sub_u32 s5, s88, 0
  buffer_store_dwordx4 v[52:55], v139, s[8:11], s5 offen sc1
  buffer_store_dwordx4 v[56:59], v139, s[8:11], s5 offen offset:512 sc1
L_km_119:
  s_waitcnt lgkmcnt(4)
  v_smfmac_f32_16x16x64_bf16 v[28:31], v[0:3], v[160:167], v132
  v_smfmac_f32_16x16x64_bf16 v[32:35], v[0:3], v[184:191], v132
  s_waitcnt lgkmcnt(2)
  v_smfmac_f32_16x16x64_bf16 v[28:31], v[4:7], v[168:175], v132
  v_smfmac_f32_16x16x64_bf16 v[32:35], v[4:7], v[192:199], v132
  s_waitcnt lgkmcnt(0)
  v_smfmac_f32_16x16x64_bf16 v[28:31], v[8:11], v[176:183], v132
  v_smfmac_f32_16x16x64_bf16 v[32:35], v[8:11], v[200:207], v132
  v_smfmac_f32_16x16x64_bf16 v[36:39], v[0:3], v[208:215], v132
  v_smfmac_f32_16x16x64_bf16 v[40:43], v[0:3], v[232:239], v132
  v_smfmac_f32_16x16x64_bf16 v[36:39], v[4:7], v[216:223], v132
  v_smfmac_f32_16x16x64_bf16 v[40:43], v[4:7], v[240:247], v132
  v_smfmac_f32_16x16x64_bf16 v[36:39], v[8:11], v[224:231], v132
  s_nop 1
  v_add_f32 v28, v28, v30
  v_add_f32 v29, v29, v31
  v_smfmac_f32_16x16x64_bf16 v[40:43], v[8:11], v[248:255], v132
  v_mul_f32 v28, v28, v12
  v_mul_f32 v29, v29, v13
  v_cvt_pk_bf16_f32 v128, v28, v29
  v_or_b32 v128, 1, v128
  v_add_f32 v32, v32, v34
  v_add_f32 v33, v33, v35
  v_mul_f32 v32, v32, v12
  v_mul_f32 v33, v33, v13
  v_cvt_pk_bf16_f32 v129, v32, v33
  buffer_store_dwordx2 v[128:129], v146, s[8:11], s81 offen sc1
  v_add_f32 v36, v36, v38
  v_add_f32 v37, v37, v39
  v_mul_f32 v36, v36, v12
  v_mul_f32 v37, v37, v13
  v_cvt_pk_bf16_f32 v130, v36, v37
  v_or_b32 v130, 1, v130
  v_add_f32 v40, v40, v42
  v_add_f32 v41, v41, v43
  v_mul_f32 v40, v40, v12
  v_mul_f32 v41, v41, v13
  v_cvt_pk_bf16_f32 v131, v40, v41
  buffer_store_dwordx2 v[130:131], v146, s[8:11], s67 offen sc1
  buffer_store_dwordx2 v[128:129], v146, s[8:11], s33 offen
  buffer_store_dwordx2 v[130:131], v146, s[8:11], s35 offen
  s_cmp_eq_u32 s92, 0
  s_cbranch_scc1 L_nr_120
  v_mov_b32 v124, 0
  v_mov_b32 v125, 0
  v_mov_b32 v126, 0
  v_mov_b32 v127, 0
  s_add_u32 s91, s91, 1
  s_add_u32 s88, s88, 98304
  s_add_u32 s89, s89, 393216
  v_mov_b32 v40, 0
  v_mov_b32 v41, 0
  v_mov_b32 v42, 0
  v_mov_b32 v43, 0
  v_mov_b32 v44, 0
  v_mov_b32 v45, 0
  v_mov_b32 v46, 0
  v_mov_b32 v47, 0
  v_mov_b32 v48, 0
  v_mov_b32 v49, 0
  v_mov_b32 v50, 0
  v_mov_b32 v51, 0
  s_mul_i32 s72, s3, 3072
  s_add_u32 s72, s72, s89
  s_add_u32 s72, s72, 48758784
  s_lshl_b32 s73, s62, 12
  s_add_u32 s73, s73, s89
  s_add_u32 s73, s73, 23986176
  s_add_u32 s40, s83, 0
  s_cmp_eq_u32 s63, 0
  s_cselect_b32 s40, s37, s40
  s_add_u32 s41, s83, 4096
  s_cmp_eq_u32 s63, 1
  s_cselect_b32 s41, s37, s41
  s_add_u32 s42, s83, 16384
  s_cmp_eq_u32 s63, 2
  s_cselect_b32 s42, s37, s42
  s_add_u32 s43, s83, 20480
  s_cmp_eq_u32 s63, 3
  s_cselect_b32 s43, s37, s43
  v_mov_b32 v100, s91
  v_mov_b32 v101, 17408
  buffer_load_dwordx4 v[0:3], v148, s[8:11], s40 offen offset:0 sc1
  buffer_load_dwordx4 v[4:7], v148, s[8:11], s40 offen offset:2048 sc1
  buffer_load_dwordx4 v[8:11], v148, s[8:11], s41 offen offset:0 sc1
  buffer_load_dwordx4 v[12:15], v148, s[8:11], s41 offen offset:2048 sc1
  buffer_load_dwordx4 v[16:19], v148, s[8:11], s42 offen offset:0 sc1
  buffer_load_dwordx4 v[20:23], v148, s[8:11], s42 offen offset:2048 sc1
  buffer_load_dwordx4 v[24:27], v148, s[8:11], s43 offen offset:0 sc1
  buffer_load_dwordx4 v[28:31], v148, s[8:11], s43 offen offset:2048 sc1
L_xc_126:
  s_waitcnt vmcnt(6)
  v_bitop3_b32 v90, v0, v2, v4 bitop3:0x80
  v_bitop3_b32 v90, v90, v6, v6 bitop3:0x80
  v_and_b32 v90, 1, v90
  v_cmp_ne_u32 vcc, 1, v90
  s_cbranch_vccnz L_xp_125
  v_smfmac_f32_16x16x64_bf16 v[124:127], a[248:251], v[0:7], v132
L_xc_128:
  s_waitcnt vmcnt(4)
  v_bitop3_b32 v90, v8, v10, v12 bitop3:0x80
  v_bitop3_b32 v90, v90, v14, v14 bitop3:0x80
  v_and_b32 v90, 1, v90
  v_cmp_ne_u32 vcc, 1, v90
  s_cbranch_vccnz L_xp_127
  v_smfmac_f32_16x16x64_bf16 v[124:127], a[248:251], v[8:15], v132
L_xc_130:
  s_waitcnt vmcnt(2)
  v_bitop3_b32 v90, v16, v18, v20 bitop3:0x80
  v_bitop3_b32 v90, v90, v22, v22 bitop3:0x80
  v_and_b32 v90, 1, v90
  v_cmp_ne_u32 vcc, 1, v90
  s_cbranch_vccnz L_xp_129
  v_smfmac_f32_16x16x64_bf16 v[124:127], a[248:251], v[16:23], v132
L_xc_132:
  s_waitcnt vmcnt(0)
  v_bitop3_b32 v90, v24, v26, v28 bitop3:0x80
  v_bitop3_b32 v90, v90, v30, v30 bitop3:0x80
  v_and_b32 v90, 1, v90
  v_cmp_ne_u32 vcc, 1, v90
  s_cbranch_vccnz L_xp_131
  v_smfmac_f32_16x16x64_bf16 v[124:127], a[248:251], v[24:31], v132
  ds_write_b32 v101, v100
  s_nop 6
  v_cvt_pk_bf16_f32 v128, v124, v125
  v_cvt_pk_bf16_f32 v129, v126, v127
  v_or_b32 v128, 1, v128
  buffer_store_dwordx2 v[128:129], v150, s[8:11], s85 offen
  s_branch L_go_124
L_nr_120:
  s_add_u32 s91, s91, 1
  s_add_u32 s88, s88, 98304
  s_add_u32 s89, s89, 393216
  v_mov_b32 v40, 0
  v_mov_b32 v41, 0
  v_mov_b32 v42, 0
  v_mov_b32 v43, 0
  v_mov_b32 v44, 0
  v_mov_b32 v45, 0
  v_mov_b32 v46, 0
  v_mov_b32 v47, 0
  v_mov_b32 v48, 0
  v_mov_b32 v49, 0
  v_mov_b32 v50, 0
  v_mov_b32 v51, 0
  s_mul_i32 s72, s3, 3072
  s_add_u32 s72, s72, s89
  s_add_u32 s72, s72, 48758784
  s_lshl_b32 s73, s62, 12
  s_add_u32 s73, s73, s89
  s_add_u32 s73, s73, 23986176
  v_mov_b32 v101, 17408
L_lf_134:
  s_sub_u32 s59, s59, 1
  s_cbranch_scc1 L_end
  ds_read_b32 v100, v101
  s_waitcnt lgkmcnt(0)
  v_cmp_ne_u32 vcc, s91, v100
  s_cbranch_vccnz L_lf_134
L_go_124:
  s_cmp_ge_u32 s3, 2
  s_cbranch_scc1 L_g2_135
  buffer_load_dwordx4 v[92:95], v151, s[8:11], s87 offen offset:0 sc1
  buffer_load_dwordx4 v[96:99], v151, s[8:11], s87 offen offset:1024 sc1
  buffer_load_dwordx4 v[100:103], v157, s[8:11], s87 offen offset:0 sc1
L_gc_138:
  s_waitcnt vmcnt(2)
  v_bitop3_b32 v90, v92, v94, 1 bitop3:0x80
  v_cmp_ne_u32 vcc, 1, v90
  s_cbranch_vccnz L_gp_137
  ds_write_b128 v151, v[92:95] offset:0
L_gc_140:
  s_waitcnt vmcnt(1)
  v_bitop3_b32 v90, v96, v98, 1 bitop3:0x80
  v_cmp_ne_u32 vcc, 1, v90
  s_cbranch_vccnz L_gp_139
  ds_write_b128 v151, v[96:99] offset:1024
L_gc_142:
  s_waitcnt vmcnt(0)
  v_bitop3_b32 v90, v100, v102, 1 bitop3:0x80
  v_cmp_ne_u32 vcc, 1, v90
  s_cbranch_vccnz L_gp_141
  ds_write_b128 v157, v[100:103] offset:0
  s_branch L_g3_136
L_g2_135:
  buffer_load_dwordx4 v[92:95], v151, s[8:11], s87 offen offset:0 sc1
  buffer_load_dwordx4 v[96:99], v151, s[8:11], s87 offen offset:1024 sc1
L_gc_145:
  s_waitcnt vmcnt(1)
  v_bitop3_b32 v90, v92, v94, 1 bitop3:0x80
  v_cmp_ne_u32 vcc, 1, v90
  s_cbranch_vccnz L_gp_144
  ds_write_b128 v151, v[92:95] offset:0
L_gc_147:
  s_waitcnt vmcnt(0)
  v_bitop3_b32 v90, v96, v98, 1 bitop3:0x80
  v_cmp_ne_u32 vcc, 1, v90
  s_cbranch_vccnz L_gp_146
  ds_write_b128 v151, v[96:99] offset:1024
L_g3_136:
  s_waitcnt lgkmcnt(0)
  s_barrier
  ds_read_b64_tr_b16 v[0:1], v133 offset:0
  ds_read_b64_tr_b16 v[2:3], v134 offset:0
  ds_read_b64_tr_b16 v[4:5], v133 offset:1024
  ds_read_b64_tr_b16 v[6:7], v134 offset:1024
  ds_read_b64_tr_b16 v[8:9], v133 offset:2048
  ds_read_b64_tr_b16 v[10:11], v134 offset:2048
  ds_read_b64_tr_b16 v[12:13], v133 offset:3072
  ds_read_b64_tr_b16 v[14:15], v134 offset:3072
  ds_read_b64_tr_b16 v[16:17], v133 offset:4096
  ds_read_b64_tr_b16 v[18:19], v134 offset:4096
  ds_read_b64_tr_b16 v[20:21], v133 offset:5120
  ds_read_b64_tr_b16 v[22:23], v134 offset:5120
  s_cmp_ge_u32 s3, 2
  s_cbranch_scc1 L_s1a_152
  ds_read_b64_tr_b16 v[24:25], v133 offset:6144
  ds_read_b64_tr_b16 v[26:27], v134 offset:6144
  s_waitcnt lgkmcnt(12)
  v_smfmac_f32_16x16x64_bf16 v[40:43], v[0:3], a[0:7], v132
  v_smfmac_f32_16x16x64_bf16 v[44:47], v[0:3], a[80:87], v132
  buffer_load_dwordx4 v[64:67], v144, s[8:11], s72 offen offset:0 sc1
  ds_read_b64_tr_b16 v[28:29], v133 offset:7168
  ds_read_b64_tr_b16 v[30:31], v134 offset:7168
  s_waitcnt lgkmcnt(12)
  v_smfmac_f32_16x16x64_bf16 v[40:43], v[4:7], a[8:15], v132
  v_smfmac_f32_16x16x64_bf16 v[44:47], v[4:7], a[88:95], v132
  buffer_load_dwordx4 v[72:75], v144, s[8:11], s72 offen offset:1024 sc1
  ds_read_b64_tr_b16 v[32:33], v133 offset:8192
  ds_read_b64_tr_b16 v[34:35], v134 offset:8192
  s_waitcnt lgkmcnt(12)
  v_smfmac_f32_16x16x64_bf16 v[40:43], v[8:11], a[16:23], v132
  v_smfmac_f32_16x16x64_bf16 v[44:47], v[8:11], a[96:103], v132
  buffer_load_dwordx4 v[80:83], v144, s[8:11], s72 offen offset:2048 sc1
  ds_read_b64_tr_b16 v[36:37], v133 offset:9216
  ds_read_b64_tr_b16 v[38:39], v134 offset:9216
  s_waitcnt lgkmcnt(12)
  v_smfmac_f32_16x16x64_bf16 v[40:43], v[12:15], a[24:31], v132
  v_smfmac_f32_16x16x64_bf16 v[44:47], v[12:15], a[104:111], v132
  buffer_load_dwordx2 v[112:113], v145, s[8:11], s73 offen offset:0 sc1
  s_waitcnt lgkmcnt(10)
  v_smfmac_f32_16x16x64_bf16 v[40:43], v[16:19], a[32:39], v132
  v_smfmac_f32_16x16x64_bf16 v[44:47], v[16:19], a[112:119], v132
  buffer_load_dwordx2 v[114:115], v145, s[8:11], s73 offen offset:1024 sc1
  s_waitcnt lgkmcnt(8)
  v_smfmac_f32_16x16x64_bf16 v[40:43], v[20:23], a[40:47], v132
  v_smfmac_f32_16x16x64_bf16 v[44:47], v[20:23], a[120:127], v132
  buffer_load_dwordx2 v[116:117], v145, s[8:11], s73 offen offset:2048 sc1
  s_waitcnt lgkmcnt(6)
  v_smfmac_f32_16x16x64_bf16 v[40:43], v[24:27], a[48:55], v132
  v_smfmac_f32_16x16x64_bf16 v[44:47], v[24:27], a[128:135], v132
  buffer_load_dwordx2 v[118:119], v145, s[8:11], s73 offen offset:3072 sc1
  s_waitcnt lgkmcnt(4)
  v_smfmac_f32_16x16x64_bf16 v[40:43], v[28:31], a[56:63], v132
  v_smfmac_f32_16x16x64_bf16 v[44:47], v[28:31], a[136:143], v132
  buffer_load_dword v153, v159, s[8:11], s90 offen sc1
  s_waitcnt lgkmcnt(2)
  v_smfmac_f32_16x16x64_bf16 v[40:43], v[32:35], a[64:71], v132
  v_smfmac_f32_16x16x64_bf16 v[44:47], v[32:35], a[144:151], v132
  s_waitcnt lgkmcnt(0)
  v_smfmac_f32_16x16x64_bf16 v[40:43], v[36:39], a[72:79], v132
  v_smfmac_f32_16x16x64_bf16 v[44:47], v[36:39], a[152:159], v132
  s_branch L_s1b_153
L_s1a_152:
  ds_read_b64_tr_b16 v[24:25], v133 offset:6144
  ds_read_b64_tr_b16 v[26:27], v134 offset:6144
  s_waitcnt lgkmcnt(12)
  v_smfmac_f32_16x16x64_bf16 v[40:43], v[0:3], a[0:7], v132
  v_smfmac_f32_16x16x64_bf16 v[44:47], v[0:3], a[80:87], v132
  buffer_load_dwordx4 v[64:67], v144, s[8:11], s72 offen offset:0 sc1
  ds_read_b64_tr_b16 v[28:29], v133 offset:7168
  ds_read_b64_tr_b16 v[30:31], v134 offset:7168
  s_waitcnt lgkmcnt(12)
  v_smfmac_f32_16x16x64_bf16 v[40:43], v[4:7], a[8:15], v132
  v_smfmac_f32_16x16x64_bf16 v[44:47], v[4:7], a[88:95], v132
  buffer_load_dwordx4 v[72:75], v144, s[8:11], s72 offen offset:1024 sc1
  ds_read_b64_tr_b16 v[32:33], v133 offset:8192
  ds_read_b64_tr_b16 v[34:35], v134 offset:8192
  s_waitcnt lgkmcnt(12)
  v_smfmac_f32_16x16x64_bf16 v[40:43], v[8:11], a[16:23], v132
  v_smfmac_f32_16x16x64_bf16 v[44:47], v[8:11], a[96:103], v132
  buffer_load_dwordx4 v[80:83], v144, s[8:11], s72 offen offset:2048 sc1
  ds_read_b64_tr_b16 v[36:37], v133 offset:9216
  ds_read_b64_tr_b16 v[38:39], v134 offset:9216
  s_waitcnt lgkmcnt(12)
  v_smfmac_f32_16x16x64_bf16 v[40:43], v[12:15], a[24:31], v132
  v_smfmac_f32_16x16x64_bf16 v[44:47], v[12:15], a[104:111], v132
  s_waitcnt lgkmcnt(10)
  v_smfmac_f32_16x16x64_bf16 v[40:43], v[16:19], a[32:39], v132
  v_smfmac_f32_16x16x64_bf16 v[44:47], v[16:19], a[112:119], v132
  s_waitcnt lgkmcnt(8)
  v_smfmac_f32_16x16x64_bf16 v[40:43], v[20:23], a[40:47], v132
  v_smfmac_f32_16x16x64_bf16 v[44:47], v[20:23], a[120:127], v132
  s_waitcnt lgkmcnt(6)
  v_smfmac_f32_16x16x64_bf16 v[40:43], v[24:27], a[48:55], v132
  v_smfmac_f32_16x16x64_bf16 v[44:47], v[24:27], a[128:135], v132
  s_waitcnt lgkmcnt(4)
  v_smfmac_f32_16x16x64_bf16 v[40:43], v[28:31], a[56:63], v132
  v_smfmac_f32_16x16x64_bf16 v[44:47], v[28:31], a[136:143], v132
  s_waitcnt lgkmcnt(2)
  v_smfmac_f32_16x16x64_bf16 v[40:43], v[32:35], a[64:71], v132
  v_smfmac_f32_16x16x64_bf16 v[44:47], v[32:35], a[144:151], v132
  s_waitcnt lgkmcnt(0)
  v_smfmac_f32_16x16x64_bf16 v[40:43], v[36:39], a[72:79], v132
  v_smfmac_f32_16x16x64_bf16 v[44:47], v[36:39], a[152:159], v132
L_s1b_153:
  v_smfmac_f32_16x16x64_bf16 v[48:51], v[0:3], a[160:167], v132
  s_mul_i32 s5, s62, 1280
  s_add_u32 s5, s5, s76
  s_nop 3
  v_add_f32 v40, v40, v42
  v_add_f32 v41, v41, v43
  v_add_f32 v44, v44, v46
  v_add_f32 v45, v45, v47
  v_cvt_pk_bf16_f32 v128, v40, v41
  v_cvt_pk_bf16_f32 v129, v44, v45
  ds_write_b64 v135, v[128:129]
  v_smfmac_f32_16x16x64_bf16 v[48:51], v[4:7], a[168:175], v132
  v_smfmac_f32_16x16x64_bf16 v[48:51], v[8:11], a[176:183], v132
  v_smfmac_f32_16x16x64_bf16 v[48:51], v[12:15], a[184:191], v132
  s_waitcnt lgkmcnt(0)
  s_barrier
  ds_read_b64_tr_b16 v[52:53], v136 offset:0
  ds_read_b64_tr_b16 v[54:55], v136 offset:512
  ds_read_b64_tr_b16 v[56:57], v136 offset:1024
  ds_read_b64_tr_b16 v[58:59], v136 offset:1536
  v_smfmac_f32_16x16x64_bf16 v[48:51], v[16:19], a[192:199], v132
  v_smfmac_f32_16x16x64_bf16 v[48:51], v[20:23], a[200:207], v132
  v_smfmac_f32_16x16x64_bf16 v[48:51], v[24:27], a[208:215], v132
  v_smfmac_f32_16x16x64_bf16 v[48:51], v[28:31], a[216:223], v132
  s_cmp_ge_u32 s3, 2
  s_cbranch_scc1 L_s0_154
  s_waitcnt lgkmcnt(2)
  v_mfma_f32_16x16x32_bf16 v[100:103], v[104:107], v[52:55], 0
  s_waitcnt lgkmcnt(0)
  v_mfma_f32_16x16x32_bf16 v[100:103], v[108:111], v[56:59], v[100:103]
  v_smfmac_f32_16x16x64_bf16 v[48:51], v[32:35], a[224:231], v132
  s_nop 6
  v_and_b32 v100, -2, v100
  v_and_b32 v102, -2, v102
  buffer_store_dwordx4 v[100:103], v139, s[8:11], s5 offen
  s_branch L_sj_155
L_s0_154:
  s_waitcnt lgkmcnt(2)
  v_mfma_f32_16x16x32_bf16 v[100:103], v[52:55], v[52:55], 0
  s_waitcnt lgkmcnt(0)
  v_mfma_f32_16x16x32_bf16 v[100:103], v[56:59], v[56:59], v[100:103]
  v_smfmac_f32_16x16x64_bf16 v[48:51], v[32:35], a[224:231], v132
  s_cmp_eq_u32 s3, 3
  s_cbranch_scc1 L_s3_156
  s_nop 4
  v_and_b32 v102, -2, v102
  buffer_store_dwordx2 v[102:103], v139, s[8:11], s5 offen
L_sj_155:
  v_smfmac_f32_16x16x64_bf16 v[48:51], v[36:39], a[232:239], v132
  v_mov_b32 v12, 0
  v_mov_b32 v13, 0
  v_mov_b32 v14, 0
  v_mov_b32 v15, 0
  v_mov_b32 v16, 0
  v_mov_b32 v17, 0
  v_mov_b32 v18, 0
  v_mov_b32 v19, 0
  v_add_f32 v48, v48, v50
  v_add_f32 v49, v49, v51
  v_cvt_pk_bf16_f32 v152, v48, v49
  v_and_b32 v128, -2, v152
  buffer_store_dword v128, v141, s[8:11], s78 offen
  s_cmp_lg_u32 s3, 0
  s_cbranch_scc1 L_w0_160
  s_cmp_ge_u32 s91, 62
  s_cbranch_scc1 L_pfok_162
  s_add_u32 s7, s91, 1
  s_add_u32 s71, s7, 1
  s_lshr_b32 s7, s7, 1
  s_lshr_b32 s71, s71, 1
L_pf_161:
  s_sub_u32 s59, s59, 1
  s_cbranch_scc1 L_end
  v_readlane_b32 s5, v153, 0
  v_readlane_b32 s6, v153, 3
  s_cmp_gt_u32 s5, s71
  s_cselect_b32 s6, s6, 0
  s_cmp_gt_u32 s6, s7
  s_cbranch_scc1 L_pfok_162
  buffer_load_dword v153, v159, s[8:11], s90 offen sc1
  s_waitcnt vmcnt(0)
  s_branch L_pf_161
L_pfok_162:
L_w0_160:
  v_mov_b32 v20, 0
  v_mov_b32 v21, 0
  v_mov_b32 v22, 0
  v_mov_b32 v23, 0
  v_mov_b32 v24, 0
  v_mov_b32 v25, 0
  v_mov_b32 v26, 0
  v_mov_b32 v27, 0
  v_mov_b32 v28, 0
  v_mov_b32 v29, 0
  v_mov_b32 v30, 0
  v_mov_b32 v31, 0
  v_mov_b32 v32, 0
  v_mov_b32 v33, 0
  v_mov_b32 v34, 0
  v_mov_b32 v35, 0
  v_mov_b32 v36, 0
  v_mov_b32 v37, 0
  v_mov_b32 v38, 0
  v_mov_b32 v39, 0
  v_mov_b32 v40, 0
  v_mov_b32 v41, 0
  v_mov_b32 v42, 0
  v_mov_b32 v43, 0
  buffer_load_dwordx4 v[92:95], v140, s[8:11], s76 offen sc1
  buffer_load_dwordx4 v[96:99], v154, s[8:11], s76 offen sc1
L_pl_157:
  s_sub_u32 s59, s59, 1
  s_cbranch_scc1 L_end
  s_waitcnt vmcnt(0)
  v_bitop3_b32 v90, v92, v94, v96 bitop3:0xfe
  v_bitop3_b32 v90, v90, v98, v98 bitop3:0xfe
  v_and_b32 v90, 1, v90
  v_cmp_ne_u32 vcc, 0, v90
  s_cbranch_vccz L_pd_159
  buffer_load_dwordx4 v[92:95], v140, s[8:11], s76 offen sc1
  buffer_load_dwordx4 v[96:99], v154, s[8:11], s76 offen sc1
  s_branch L_pl_157
L_pd_159:
  v_fma_f32 v100, v155, v96, v92
  v_fma_f32 v101, v155, v97, v93
  v_fma_f32 v102, v155, v98, v94
  v_fma_f32 v103, v155, v99, v95
L_pj_158:
  buffer_load_dwordx4 v[68:71], v142, s[8:11], s78 offen offset:0 sc1
  v_permlane32_swap_b32 v100, v102
  v_permlane32_swap_b32 v101, v103
  v_add_f32 v100, v100, v102
  v_add_f32 v101, v101, v103
  v_max_f32 v128, v100, v101
  buffer_load_dwordx4 v[76:79], v142, s[8:11], s78 offen offset:512 sc1
  s_nop 0
  v_max_f32_dpp v128, v128, v128 row_ror:1 row_mask:0xf bank_mask:0xf
  buffer_load_dwordx4 v[84:87], v142, s[8:11], s78 offen offset:1024 sc1
  s_nop 0
  v_max_f32_dpp v128, v128, v128 row_ror:2 row_mask:0xf bank_mask:0xf
  s_nop 1
  v_max_f32_dpp v128, v128, v128 row_ror:4 row_mask:0xf bank_mask:0xf
  s_nop 1
  v_max_f32_dpp v128, v128, v128 row_ror:8 row_mask:0xf bank_mask:0xf
  v_mov_b32 v129, v128
  s_nop 1
  v_permlane32_swap_b32 v128, v129
  v_max_f32 v128, v128, v129
  v_sub_f32 v100, v100, v128
  v_sub_f32 v101, v101, v128
  v_mul_f32 v100, s93, v100
  v_mul_f32 v101, s93, v101
  v_exp_f32 v100, v100
  v_exp_f32 v101, v101
  s_nop 0
  v_cvt_pk_bf16_f32 v128, v100, v101
  ds_write_b32 v156, v128
  s_waitcnt lgkmcnt(0)
  s_barrier
  ds_read_b128 v[124:127], v91
L_hv2_164:
  s_waitcnt vmcnt(0)
  v_bitop3_b32 v128, v68, v70, v76 bitop3:0xfe
  v_bitop3_b32 v128, v128, v78, v84 bitop3:0xfe
  v_bitop3_b32 v128, v128, v86, v86 bitop3:0xfe
  v_and_b32 v128, 1, v128
  v_cmp_ne_u32 vcc, 0, v128
  s_cbranch_vccnz L_hv_163
  s_waitcnt lgkmcnt(0)
  v_smfmac_f32_16x16x64_bf16 v[12:15], v[124:127], v[64:71], v132
  v_smfmac_f32_16x16x64_bf16 v[16:19], v[124:127], v[72:79], v132
  v_smfmac_f32_16x16x64_bf16 v[20:23], v[124:127], v[80:87], v132
  v_smfmac_f32_16x16x64_bf16 v[24:27], v[124:127], a[240:247], v132
  s_nop 4
  v_add_f32 v12, v12, v14
  v_add_f32 v13, v13, v15
  v_cvt_pk_bf16_f32 v128, v12, v13
  ds_write_b32 v137, v128
  v_add_f32 v16, v16, v18
  v_add_f32 v17, v17, v19
  v_cvt_pk_bf16_f32 v129, v16, v17
  ds_write_b32 v147, v129
  v_add_f32 v20, v20, v22
  v_add_f32 v21, v21, v23
  v_cvt_pk_bf16_f32 v130, v20, v21
  ds_write_b32 v138, v130
  v_add_f32 v24, v24, v26
  v_add_f32 v25, v25, v27
  v_rcp_f32 v12, v24
  v_rcp_f32 v13, v25
  s_waitcnt lgkmcnt(0)
  s_barrier
  ds_read_b64_tr_b16 v[0:1], v133 offset:12288
  ds_read_b64_tr_b16 v[2:3], v134 offset:12288
  ds_read_b64_tr_b16 v[4:5], v133 offset:13312
  ds_read_b64_tr_b16 v[6:7], v134 offset:13312
  ds_read_b64_tr_b16 v[8:9], v133 offset:14336
  ds_read_b64_tr_b16 v[10:11], v134 offset:14336
  s_add_u32 s5, s88, 6291456
  buffer_store_dword v152, v143, s[8:11], s5 offen sc1
  s_cmp_lg_u32 s3, 3
  s_cbranch_scc1 L_km_165
  s_sub_u32 s5, s88, 0
  buffer_store_dwordx4 v[52:55], v139, s[8:11], s5 offen sc1
  buffer_store_dwordx4 v[56:59], v139, s[8:11], s5 offen offset:512 sc1
L_km_165:
  s_waitcnt lgkmcnt(4)
  v_smfmac_f32_16x16x64_bf16 v[28:31], v[0:3], v[160:167], v132
  v_smfmac_f32_16x16x64_bf16 v[32:35], v[0:3], v[184:191], v132
  s_waitcnt lgkmcnt(2)
  v_smfmac_f32_16x16x64_bf16 v[28:31], v[4:7], v[168:175], v132
  v_smfmac_f32_16x16x64_bf16 v[32:35], v[4:7], v[192:199], v132
  s_waitcnt lgkmcnt(0)
  v_smfmac_f32_16x16x64_bf16 v[28:31], v[8:11], v[176:183], v132
  v_smfmac_f32_16x16x64_bf16 v[32:35], v[8:11], v[200:207], v132
  v_smfmac_f32_16x16x64_bf16 v[36:39], v[0:3], v[208:215], v132
  v_smfmac_f32_16x16x64_bf16 v[40:43], v[0:3], v[232:239], v132
  v_smfmac_f32_16x16x64_bf16 v[36:39], v[4:7], v[216:223], v132
  v_smfmac_f32_16x16x64_bf16 v[40:43], v[4:7], v[240:247], v132
  v_smfmac_f32_16x16x64_bf16 v[36:39], v[8:11], v[224:231], v132
  s_nop 1
  v_add_f32 v28, v28, v30
  v_add_f32 v29, v29, v31
  v_smfmac_f32_16x16x64_bf16 v[40:43], v[8:11], v[248:255], v132
  v_mul_f32 v28, v28, v12
  v_mul_f32 v29, v29, v13
  v_cvt_pk_bf16_f32 v128, v28, v29
  v_and_b32 v128, -2, v128
  v_add_f32 v32, v32, v34
  v_add_f32 v33, v33, v35
  v_mul_f32 v32, v32, v12
  v_mul_f32 v33, v33, v13
  v_cvt_pk_bf16_f32 v129, v32, v33
  buffer_store_dwordx2 v[128:129], v146, s[8:11], s80 offen sc1
  v_add_f32 v36, v36, v38
  v_add_f32 v37, v37, v39
  v_mul_f32 v36, v36, v12
  v_mul_f32 v37, v37, v13
  v_cvt_pk_bf16_f32 v130, v36, v37
  v_and_b32 v130, -2, v130
  v_add_f32 v40, v40, v42
  v_add_f32 v41, v41, v43
  v_mul_f32 v40, v40, v12
  v_mul_f32 v41, v41, v13
  v_cvt_pk_bf16_f32 v131, v40, v41
  buffer_store_dwordx2 v[130:131], v146, s[8:11], s66 offen sc1
  buffer_store_dwordx2 v[128:129], v146, s[8:11], s32 offen
  buffer_store_dwordx2 v[130:131], v146, s[8:11], s34 offen
  s_cmp_eq_u32 s92, 0
  s_cbranch_scc1 L_nr_166
  v_mov_b32 v124, 0
  v_mov_b32 v125, 0
  v_mov_b32 v126, 0
  v_mov_b32 v127, 0
  s_add_u32 s91, s91, 1
  s_add_u32 s88, s88, 98304
  s_add_u32 s89, s89, 393216
  v_mov_b32 v40, 0
  v_mov_b32 v41, 0
  v_mov_b32 v42, 0
  v_mov_b32 v43, 0
  v_mov_b32 v44, 0
  v_mov_b32 v45, 0
  v_mov_b32 v46, 0
  v_mov_b32 v47, 0
  v_mov_b32 v48, 0
  v_mov_b32 v49, 0
  v_mov_b32 v50, 0
  v_mov_b32 v51, 0
  s_mul_i32 s72, s3, 3072
  s_add_u32 s72, s72, s89
  s_add_u32 s72, s72, 48758784
  s_lshl_b32 s73, s62, 12
  s_add_u32 s73, s73, s89
  s_add_u32 s73, s73, 23986176
  s_add_u32 s40, s82, 0
  s_cmp_eq_u32 s63, 0
  s_cselect_b32 s40, s36, s40
  s_add_u32 s41, s82, 4096
  s_cmp_eq_u32 s63, 1
  s_cselect_b32 s41, s36, s41
  s_add_u32 s42, s82, 16384
  s_cmp_eq_u32 s63, 2
  s_cselect_b32 s42, s36, s42
  s_add_u32 s43, s82, 20480
  s_cmp_eq_u32 s63, 3
  s_cselect_b32 s43, s36, s43
  v_mov_b32 v100, s91
  v_mov_b32 v101, 17408
  buffer_load_dwordx4 v[0:3], v148, s[8:11], s40 offen offset:0 sc1
  buffer_load_dwordx4 v[4:7], v148, s[8:11], s40 offen offset:2048 sc1
  buffer_load_dwordx4 v[8:11], v148, s[8:11], s41 offen offset:0 sc1
  buffer_load_dwordx4 v[12:15], v148, s[8:11], s41 offen offset:2048 sc1
  buffer_load_dwordx4 v[16:19], v148, s[8:11], s42 offen offset:0 sc1
  buffer_load_dwordx4 v[20:23], v148, s[8:11], s42 offen offset:2048 sc1
  buffer_load_dwordx4 v[24:27], v148, s[8:11], s43 offen offset:0 sc1
  buffer_load_dwordx4 v[28:31], v148, s[8:11], s43 offen offset:2048 sc1
L_xc_172:
  s_waitcnt vmcnt(6)
  v_bitop3_b32 v90, v0, v2, v4 bitop3:0xfe
  v_bitop3_b32 v90, v90, v6, v6 bitop3:0xfe
  v_and_b32 v90, 1, v90
  v_cmp_ne_u32 vcc, 0, v90
  s_cbranch_vccnz L_xp_171
  v_smfmac_f32_16x16x64_bf16 v[124:127], a[248:251], v[0:7], v132
L_xc_174:
  s_waitcnt vmcnt(4)
  v_bitop3_b32 v90, v8, v10, v12 bitop3:0xfe
  v_bitop3_b32 v90, v90, v14, v14 bitop3:0xfe
  v_and_b32 v90, 1, v90
  v_cmp_ne_u32 vcc, 0, v90
  s_cbranch_vccnz L_xp_173
  v_smfmac_f32_16x16x64_bf16 v[124:127], a[248:251], v[8:15], v132
L_xc_176:
  s_waitcnt vmcnt(2)
  v_bitop3_b32 v90, v16, v18, v20 bitop3:0xfe
  v_bitop3_b32 v90, v90, v22, v22 bitop3:0xfe
  v_and_b32 v90, 1, v90
  v_cmp_ne_u32 vcc, 0, v90
  s_cbranch_vccnz L_xp_175
  v_smfmac_f32_16x16x64_bf16 v[124:127], a[248:251], v[16:23], v132
L_xc_178:
  s_waitcnt vmcnt(0)
  v_bitop3_b32 v90, v24, v26, v28 bitop3:0xfe
  v_bitop3_b32 v90, v90, v30, v30 bitop3:0xfe
  v_and_b32 v90, 1, v90
  v_cmp_ne_u32 vcc, 0, v90
  s_cbranch_vccnz L_xp_177
  v_smfmac_f32_16x16x64_bf16 v[124:127], a[248:251], v[24:31], v132
  ds_write_b32 v101, v100
  s_nop 6
  v_cvt_pk_bf16_f32 v128, v124, v125
  v_cvt_pk_bf16_f32 v129, v126, v127
  v_and_b32 v128, -2, v128
  buffer_store_dwordx2 v[128:129], v150, s[8:11], s84 offen
  s_branch L_go_170
L_nr_166:
  s_add_u32 s91, s91, 1
  s_add_u32 s88, s88, 98304
  s_add_u32 s89, s89, 393216
  v_mov_b32 v40, 0
  v_mov_b32 v41, 0
  v_mov_b32 v42, 0
  v_mov_b32 v43, 0
  v_mov_b32 v44, 0
  v_mov_b32 v45, 0
  v_mov_b32 v46, 0
  v_mov_b32 v47, 0
  v_mov_b32 v48, 0
  v_mov_b32 v49, 0
  v_mov_b32 v50, 0
  v_mov_b32 v51, 0
  s_mul_i32 s72, s3, 3072
  s_add_u32 s72, s72, s89
  s_add_u32 s72, s72, 48758784
  s_lshl_b32 s73, s62, 12
  s_add_u32 s73, s73, s89
  s_add_u32 s73, s73, 23986176
  v_mov_b32 v101, 17408
L_lf_180:
  s_sub_u32 s59, s59, 1
  s_cbranch_scc1 L_end
  ds_read_b32 v100, v101
  s_waitcnt lgkmcnt(0)
  v_cmp_ne_u32 vcc, s91, v100
  s_cbranch_vccnz L_lf_180
L_go_170:
  s_cmp_ge_u32 s3, 2
  s_cbranch_scc1 L_g2_181
  buffer_load_dwordx4 v[92:95], v151, s[8:11], s86 offen offset:0 sc1
  buffer_load_dwordx4 v[96:99], v151, s[8:11], s86 offen offset:1024 sc1
  buffer_load_dwordx4 v[100:103], v157, s[8:11], s86 offen offset:0 sc1
L_gc_184:
  s_waitcnt vmcnt(2)
  v_bitop3_b32 v90, v92, v94, 1 bitop3:0xa8
  v_cmp_ne_u32 vcc, 0, v90
  s_cbranch_vccnz L_gp_183
  ds_write_b128 v151, v[92:95] offset:0
L_gc_186:
  s_waitcnt vmcnt(1)
  v_bitop3_b32 v90, v96, v98, 1 bitop3:0xa8
  v_cmp_ne_u32 vcc, 0, v90
  s_cbranch_vccnz L_gp_185
  ds_write_b128 v151, v[96:99] offset:1024
L_gc_188:
  s_waitcnt vmcnt(0)
  v_bitop3_b32 v90, v100, v102, 1 bitop3:0xa8
  v_cmp_ne_u32 vcc, 0, v90
  s_cbranch_vccnz L_gp_187
  ds_write_b128 v157, v[100:103] offset:0
  s_branch L_g3_182
L_g2_181:
  buffer_load_dwordx4 v[92:95], v151, s[8:11], s86 offen offset:0 sc1
  buffer_load_dwordx4 v[96:99], v151, s[8:11], s86 offen offset:1024 sc1
L_gc_191:
  s_waitcnt vmcnt(1)
  v_bitop3_b32 v90, v92, v94, 1 bitop3:0xa8
  v_cmp_ne_u32 vcc, 0, v90
  s_cbranch_vccnz L_gp_190
  ds_write_b128 v151, v[92:95] offset:0
L_gc_193:
  s_waitcnt vmcnt(0)
  v_bitop3_b32 v90, v96, v98, 1 bitop3:0xa8
  v_cmp_ne_u32 vcc, 0, v90
  s_cbranch_vccnz L_gp_192
  ds_write_b128 v151, v[96:99] offset:1024
L_g3_182:
  s_waitcnt lgkmcnt(0)
  s_barrier
  s_cmp_eq_u32 s91, 63
  s_cbranch_scc1 L_last
  ds_read_b64_tr_b16 v[0:1], v133 offset:0
  ds_read_b64_tr_b16 v[2:3], v134 offset:0
  ds_read_b64_tr_b16 v[4:5], v133 offset:1024
  ds_read_b64_tr_b16 v[6:7], v134 offset:1024
  ds_read_b64_tr_b16 v[8:9], v133 offset:2048
  ds_read_b64_tr_b16 v[10:11], v134 offset:2048
  ds_read_b64_tr_b16 v[12:13], v133 offset:3072
  ds_read_b64_tr_b16 v[14:15], v134 offset:3072
  ds_read_b64_tr_b16 v[16:17], v133 offset:4096
  ds_read_b64_tr_b16 v[18:19], v134 offset:4096
  ds_read_b64_tr_b16 v[20:21], v133 offset:5120
  ds_read_b64_tr_b16 v[22:23], v134 offset:5120
  s_cmp_ge_u32 s3, 2
  s_cbranch_scc1 L_s1a_198
  ds_read_b64_tr_b16 v[24:25], v133 offset:6144
  ds_read_b64_tr_b16 v[26:27], v134 offset:6144
  s_waitcnt lgkmcnt(12)
  v_smfmac_f32_16x16x64_bf16 v[40:43], v[0:3], a[0:7], v132
  v_smfmac_f32_16x16x64_bf16 v[44:47], v[0:3], a[80:87], v132
  buffer_load_dwordx4 v[64:67], v144, s[8:11], s72 offen offset:0 sc1
  ds_read_b64_tr_b16 v[28:29], v133 offset:7168
  ds_read_b64_tr_b16 v[30:31], v134 offset:7168
  s_waitcnt lgkmcnt(12)
  v_smfmac_f32_16x16x64_bf16 v[40:43], v[4:7], a[8:15], v132
  v_smfmac_f32_16x16x64_bf16 v[44:47], v[4:7], a[88:95], v132
  buffer_load_dwordx4 v[72:75], v144, s[8:11], s72 offen offset:1024 sc1
  ds_read_b64_tr_b16 v[32:33], v133 offset:8192
  ds_read_b64_tr_b16 v[34:35], v134 offset:8192
  s_waitcnt lgkmcnt(12)
  v_smfmac_f32_16x16x64_bf16 v[40:43], v[8:11], a[16:23], v132
  v_smfmac_f32_16x16x64_bf16 v[44:47], v[8:11], a[96:103], v132
  buffer_load_dwordx4 v[80:83], v144, s[8:11], s72 offen offset:2048 sc1
  ds_read_b64_tr_b16 v[36:37], v133 offset:9216
  ds_read_b64_tr_b16 v[38:39], v134 offset:9216
  s_waitcnt lgkmcnt(12)
  v_smfmac_f32_16x16x64_bf16 v[40:43], v[12:15], a[24:31], v132
  v_smfmac_f32_16x16x64_bf16 v[44:47], v[12:15], a[104:111], v132
  buffer_load_dwordx2 v[104:105], v145, s[8:11], s73 offen offset:0 sc1
  s_waitcnt lgkmcnt(10)
  v_smfmac_f32_16x16x64_bf16 v[40:43], v[16:19], a[32:39], v132
  v_smfmac_f32_16x16x64_bf16 v[44:47], v[16:19], a[112:119], v132
  buffer_load_dwordx2 v[106:107], v145, s[8:11], s73 offen offset:1024 sc1
  s_waitcnt lgkmcnt(8)
  v_smfmac_f32_16x16x64_bf16 v[40:43], v[20:23], a[40:47], v132
  v_smfmac_f32_16x16x64_bf16 v[44:47], v[20:23], a[120:127], v132
  buffer_load_dwordx2 v[108:109], v145, s[8:11], s73 offen offset:2048 sc1
  s_waitcnt lgkmcnt(6)
  v_smfmac_f32_16x16x64_bf16 v[40:43], v[24:27], a[48:55], v132
  v_smfmac_f32_16x16x64_bf16 v[44:47], v[24:27], a[128:135], v132
  buffer_load_dwordx2 v[110:111], v145, s[8:11], s73 offen offset:3072 sc1
  s_waitcnt lgkmcnt(4)
  v_smfmac_f32_16x16x64_bf16 v[40:43], v[28:31], a[56:63], v132
  v_smfmac_f32_16x16x64_bf16 v[44:47], v[28:31], a[136:143], v132
  buffer_load_dword v153, v159, s[8:11], s90 offen sc1
  s_waitcnt lgkmcnt(2)
  v_smfmac_f32_16x16x64_bf16 v[40:43], v[32:35], a[64:71], v132
  v_smfmac_f32_16x16x64_bf16 v[44:47], v[32:35], a[144:151], v132
  s_waitcnt lgkmcnt(0)
  v_smfmac_f32_16x16x64_bf16 v[40:43], v[36:39], a[72:79], v132
  v_smfmac_f32_16x16x64_bf16 v[44:47], v[36:39], a[152:159], v132
  s_branch L_s1b_199
L_s1a_198:
  ds_read_b64_tr_b16 v[24:25], v133 offset:6144
  ds_read_b64_tr_b16 v[26:27], v134 offset:6144
  s_waitcnt lgkmcnt(12)
  v_smfmac_f32_16x16x64_bf16 v[40:43], v[0:3], a[0:7], v132
  v_smfmac_f32_16x16x64_bf16 v[44:47], v[0:3], a[80:87], v132
  buffer_load_dwordx4 v[64:67], v144, s[8:11], s72 offen offset:0 sc1
  ds_read_b64_tr_b16 v[28:29], v133 offset:7168
  ds_read_b64_tr_b16 v[30:31], v134 offset:7168
  s_waitcnt lgkmcnt(12)
  v_smfmac_f32_16x16x64_bf16 v[40:43], v[4:7], a[8:15], v132
  v_smfmac_f32_16x16x64_bf16 v[44:47], v[4:7], a[88:95], v132
  buffer_load_dwordx4 v[72:75], v144, s[8:11], s72 offen offset:1024 sc1
  ds_read_b64_tr_b16 v[32:33], v133 offset:8192
  ds_read_b64_tr_b16 v[34:35], v134 offset:8192
  s_waitcnt lgkmcnt(12)
  v_smfmac_f32_16x16x64_bf16 v[40:43], v[8:11], a[16:23], v132
  v_smfmac_f32_16x16x64_bf16 v[44:47], v[8:11], a[96:103], v132
  buffer_load_dwordx4 v[80:83], v144, s[8:11], s72 offen offset:2048 sc1
  ds_read_b64_tr_b16 v[36:37], v133 offset:9216
  ds_read_b64_tr_b16 v[38:39], v134 offset:9216
  s_waitcnt lgkmcnt(12)
  v_smfmac_f32_16x16x64_bf16 v[40:43], v[12:15], a[24:31], v132
  v_smfmac_f32_16x16x64_bf16 v[44:47], v[12:15], a[104:111], v132
  s_waitcnt lgkmcnt(10)
  v_smfmac_f32_16x16x64_bf16 v[40:43], v[16:19], a[32:39], v132
  v_smfmac_f32_16x16x64_bf16 v[44:47], v[16:19], a[112:119], v132
  s_waitcnt lgkmcnt(8)
  v_smfmac_f32_16x16x64_bf16 v[40:43], v[20:23], a[40:47], v132
  v_smfmac_f32_16x16x64_bf16 v[44:47], v[20:23], a[120:127], v132
  s_waitcnt lgkmcnt(6)
  v_smfmac_f32_16x16x64_bf16 v[40:43], v[24:27], a[48:55], v132
  v_smfmac_f32_16x16x64_bf16 v[44:47], v[24:27], a[128:135], v132
  s_waitcnt lgkmcnt(4)
  v_smfmac_f32_16x16x64_bf16 v[40:43], v[28:31], a[56:63], v132
  v_smfmac_f32_16x16x64_bf16 v[44:47], v[28:31], a[136:143], v132
  s_waitcnt lgkmcnt(2)
  v_smfmac_f32_16x16x64_bf16 v[40:43], v[32:35], a[64:71], v132
  v_smfmac_f32_16x16x64_bf16 v[44:47], v[32:35], a[144:151], v132
  s_waitcnt lgkmcnt(0)
  v_smfmac_f32_16x16x64_bf16 v[40:43], v[36:39], a[72:79], v132
  v_smfmac_f32_16x16x64_bf16 v[44:47], v[36:39], a[152:159], v132
L_s1b_199:
  v_smfmac_f32_16x16x64_bf16 v[48:51], v[0:3], a[160:167], v132
  s_mul_i32 s5, s62, 1280
  s_add_u32 s5, s5, s77
  s_nop 3
  v_add_f32 v40, v40, v42
  v_add_f32 v41, v41, v43
  v_add_f32 v44, v44, v46
  v_add_f32 v45, v45, v47
  v_cvt_pk_bf16_f32 v128, v40, v41
  v_cvt_pk_bf16_f32 v129, v44, v45
  ds_write_b64 v135, v[128:129]
  v_smfmac_f32_16x16x64_bf16 v[48:51], v[4:7], a[168:175], v132
  v_smfmac_f32_16x16x64_bf16 v[48:51], v[8:11], a[176:183], v132
  v_smfmac_f32_16x16x64_bf16 v[48:51], v[12:15], a[184:191], v132
  s_waitcnt lgkmcnt(0)
  s_barrier
  ds_read_b64_tr_b16 v[52:53], v136 offset:0
  ds_read_b64_tr_b16 v[54:55], v136 offset:512
  ds_read_b64_tr_b16 v[56:57], v136 offset:1024
  ds_read_b64_tr_b16 v[58:59], v136 offset:1536
  v_smfmac_f32_16x16x64_bf16 v[48:51], v[16:19], a[192:199], v132
  v_smfmac_f32_16x16x64_bf16 v[48:51], v[20:23], a[200:207], v132
  v_smfmac_f32_16x16x64_bf16 v[48:51], v[24:27], a[208:215], v132
  v_smfmac_f32_16x16x64_bf16 v[48:51], v[28:31], a[216:223], v132
  s_cmp_ge_u32 s3, 2
  s_cbranch_scc1 L_s0_200
  s_waitcnt lgkmcnt(2)
  v_mfma_f32_16x16x32_bf16 v[100:103], v[112:115], v[52:55], 0
  s_waitcnt lgkmcnt(0)
  v_mfma_f32_16x16x32_bf16 v[100:103], v[116:119], v[56:59], v[100:103]
  v_smfmac_f32_16x16x64_bf16 v[48:51], v[32:35], a[224:231], v132
  s_nop 6
  v_and_b32 v100, -2, v100
  v_and_b32 v102, -2, v102
  buffer_store_dwordx4 v[100:103], v139, s[8:11], s5 offen
  s_branch L_sj_201
L_s0_200:
  s_waitcnt lgkmcnt(2)
  v_mfma_f32_16x16x32_bf16 v[100:103], v[52:55], v[52:55], 0
  s_waitcnt lgkmcnt(0)
  v_mfma_f32_16x16x32_bf16 v[100:103], v[56:59], v[56:59], v[100:103]
  v_smfmac_f32_16x16x64_bf16 v[48:51], v[32:35], a[224:231], v132
  s_cmp_eq_u32 s3, 3
  s_cbranch_scc1 L_s3_202
  s_nop 4
  v_and_b32 v102, -2, v102
  buffer_store_dwordx2 v[102:103], v139, s[8:11], s5 offen
L_sj_201:
  v_smfmac_f32_16x16x64_bf16 v[48:51], v[36:39], a[232:239], v132
  v_mov_b32 v12, 0
  v_mov_b32 v13, 0
  v_mov_b32 v14, 0
  v_mov_b32 v15, 0
  v_mov_b32 v16, 0
  v_mov_b32 v17, 0
  v_mov_b32 v18, 0
  v_mov_b32 v19, 0
  v_add_f32 v48, v48, v50
  v_add_f32 v49, v49, v51
  v_cvt_pk_bf16_f32 v152, v48, v49
  v_and_b32 v128, -2, v152
  buffer_store_dword v128, v141, s[8:11], s79 offen
  s_cmp_lg_u32 s3, 0
  s_cbranch_scc1 L_w0_206
  s_cmp_ge_u32 s91, 62
  s_cbranch_scc1 L_pfok_208
  s_add_u32 s7, s91, 1
  s_add_u32 s71, s7, 1
  s_lshr_b32 s7, s7, 1
  s_lshr_b32 s71, s71, 1
L_pf_207:
  s_sub_u32 s59, s59, 1
  s_cbranch_scc1 L_end
  v_readlane_b32 s5, v153, 1
  v_readlane_b32 s6, v153, 2
  s_cmp_gt_u32 s5, s71
  s_cselect_b32 s6, s6, 0
  s_cmp_gt_u32 s6, s7
  s_cbranch_scc1 L_pfok_208
  buffer_load_dword v153, v159, s[8:11], s90 offen sc1
  s_waitcnt vmcnt(0)
  s_branch L_pf_207
L_pfok_208:
L_w0_206:
  v_mov_b32 v20, 0
  v_mov_b32 v21, 0
  v_mov_b32 v22, 0
  v_mov_b32 v23, 0
  v_mov_b32 v24, 0
  v_mov_b32 v25, 0
  v_mov_b32 v26, 0
  v_mov_b32 v27, 0
  v_mov_b32 v28, 0
  v_mov_b32 v29, 0
  v_mov_b32 v30, 0
  v_mov_b32 v31, 0
  v_mov_b32 v32, 0
  v_mov_b32 v33, 0
  v_mov_b32 v34, 0
  v_mov_b32 v35, 0
  v_mov_b32 v36, 0
  v_mov_b32 v37, 0
  v_mov_b32 v38, 0
  v_mov_b32 v39, 0
  v_mov_b32 v40, 0
  v_mov_b32 v41, 0
  v_mov_b32 v42, 0
  v_mov_b32 v43, 0
  buffer_load_dwordx4 v[92:95], v140, s[8:11], s77 offen sc1
  buffer_load_dwordx4 v[96:99], v154, s[8:11], s77 offen sc1
L_pl_203:
  s_sub_u32 s59, s59, 1
  s_cbranch_scc1 L_end
  s_waitcnt vmcnt(0)
  v_bitop3_b32 v90, v92, v94, v96 bitop3:0xfe
  v_bitop3_b32 v90, v90, v98, v98 bitop3:0xfe
  v_and_b32 v90, 1, v90
  v_cmp_ne_u32 vcc, 0, v90
  s_cbranch_vccz L_pd_205
  buffer_load_dwordx4 v[92:95], v140, s[8:11], s77 offen sc1
  buffer_load_dwordx4 v[96:99], v154, s[8:11], s77 offen sc1
  s_branch L_pl_203
L_pd_205:
  v_fma_f32 v100, v155, v96, v92
  v_fma_f32 v101, v155, v97, v93
  v_fma_f32 v102, v155, v98, v94
  v_fma_f32 v103, v155, v99, v95
L_pj_204:
  buffer_load_dwordx4 v[68:71], v142, s[8:11], s79 offen offset:0 sc1
  v_permlane32_swap_b32 v100, v102
  v_permlane32_swap_b32 v101, v103
  v_add_f32 v100, v100, v102
  v_add_f32 v101, v101, v103
  v_max_f32 v128, v100, v101
  buffer_load_dwordx4 v[76:79], v142, s[8:11], s79 offen offset:512 sc1
  s_nop 0
  v_max_f32_dpp v128, v128, v128 row_ror:1 row_mask:0xf bank_mask:0xf
  buffer_load_dwordx4 v[84:87], v142, s[8:11], s79 offen offset:1024 sc1
  s_nop 0
  v_max_f32_dpp v128, v128, v128 row_ror:2 row_mask:0xf bank_mask:0xf
  s_nop 1
  v_max_f32_dpp v128, v128, v128 row_ror:4 row_mask:0xf bank_mask:0xf
  s_nop 1
  v_max_f32_dpp v128, v128, v128 row_ror:8 row_mask:0xf bank_mask:0xf
  v_mov_b32 v129, v128
  s_nop 1
  v_permlane32_swap_b32 v128, v129
  v_max_f32 v128, v128, v129
  v_sub_f32 v100, v100, v128
  v_sub_f32 v101, v101, v128
  v_mul_f32 v100, s93, v100
  v_mul_f32 v101, s93, v101
  v_exp_f32 v100, v100
  v_exp_f32 v101, v101
  s_nop 0
  v_cvt_pk_bf16_f32 v128, v100, v101
  ds_write_b32 v156, v128
  s_waitcnt lgkmcnt(0)
  s_barrier
  ds_read_b128 v[124:127], v91
L_hv2_210:
  s_waitcnt vmcnt(0)
  v_bitop3_b32 v128, v68, v70, v76 bitop3:0xfe
  v_bitop3_b32 v128, v128, v78, v84 bitop3:0xfe
  v_bitop3_b32 v128, v128, v86, v86 bitop3:0xfe
  v_and_b32 v128, 1, v128
  v_cmp_ne_u32 vcc, 0, v128
  s_cbranch_vccnz L_hv_209
  s_waitcnt lgkmcnt(0)
  v_smfmac_f32_16x16x64_bf16 v[12:15], v[124:127], v[64:71], v132
  v_smfmac_f32_16x16x64_bf16 v[16:19], v[124:127], v[72:79], v132
  v_smfmac_f32_16x16x64_bf16 v[20:23], v[124:127], v[80:87], v132
  v_smfmac_f32_16x16x64_bf16 v[24:27], v[124:127], a[240:247], v132
  s_nop 4
  v_add_f32 v12, v12, v14
  v_add_f32 v13, v13, v15
  v_cvt_pk_bf16_f32 v128, v12, v13
  ds_write_b32 v137, v128
  v_add_f32 v16, v16, v18
  v_add_f32 v17, v17, v19
  v_cvt_pk_bf16_f32 v129, v16, v17
  ds_write_b32 v147, v129
  v_add_f32 v20, v20, v22
  v_add_f32 v21, v21, v23
  v_cvt_pk_bf16_f32 v130, v20, v21
  ds_write_b32 v138, v130
  v_add_f32 v24, v24, v26
  v_add_f32 v25, v25, v27
  v_rcp_f32 v12, v24
  v_rcp_f32 v13, v25
  s_waitcnt lgkmcnt(0)
  s_barrier
  ds_read_b64_tr_b16 v[0:1], v133 offset:12288
  ds_read_b64_tr_b16 v[2:3], v134 offset:12288
  ds_read_b64_tr_b16 v[4:5], v133 offset:13312
  ds_read_b64_tr_b16 v[6:7], v134 offset:13312
  ds_read_b64_tr_b16 v[8:9], v133 offset:14336
  ds_read_b64_tr_b16 v[10:11], v134 offset:14336
  s_add_u32 s5, s88, 6291456
  buffer_store_dword v152, v143, s[8:11], s5 offen sc1
  s_cmp_lg_u32 s3, 3
  s_cbranch_scc1 L_km_211
  s_sub_u32 s5, s88, 0
  buffer_store_dwordx4 v[52:55], v139, s[8:11], s5 offen sc1
  buffer_store_dwordx4 v[56:59], v139, s[8:11], s5 offen offset:512 sc1
L_km_211:
  s_waitcnt lgkmcnt(4)
  v_smfmac_f32_16x16x64_bf16 v[28:31], v[0:3], v[160:167], v132
  v_smfmac_f32_16x16x64_bf16 v[32:35], v[0:3], v[184:191], v132
  s_waitcnt lgkmcnt(2)
  v_smfmac_f32_16x16x64_bf16 v[28:31], v[4:7], v[168:175], v132
  v_smfmac_f32_16x16x64_bf16 v[32:35], v[4:7], v[192:199], v132
  s_waitcnt lgkmcnt(0)
  v_smfmac_f32_16x16x64_bf16 v[28:31], v[8:11], v[176:183], v132
  v_smfmac_f32_16x16x64_bf16 v[32:35], v[8:11], v[200:207], v132
  v_smfmac_f32_16x16x64_bf16 v[36:39], v[0:3], v[208:215], v132
  v_smfmac_f32_16x16x64_bf16 v[40:43], v[0:3], v[232:239], v132
  v_smfmac_f32_16x16x64_bf16 v[36:39], v[4:7], v[216:223], v132
  v_smfmac_f32_16x16x64_bf16 v[40:43], v[4:7], v[240:247], v132
  v_smfmac_f32_16x16x64_bf16 v[36:39], v[8:11], v[224:231], v132
  s_nop 1
  v_add_f32 v28, v28, v30
  v_add_f32 v29, v29, v31
  v_smfmac_f32_16x16x64_bf16 v[40:43], v[8:11], v[248:255], v132
  v_mul_f32 v28, v28, v12
  v_mul_f32 v29, v29, v13
  v_cvt_pk_bf16_f32 v128, v28, v29
  v_and_b32 v128, -2, v128
  v_add_f32 v32, v32, v34
  v_add_f32 v33, v33, v35
  v_mul_f32 v32, v32, v12
  v_mul_f32 v33, v33, v13
  v_cvt_pk_bf16_f32 v129, v32, v33
  buffer_store_dwordx2 v[128:129], v146, s[8:11], s81 offen sc1
  v_add_f32 v36, v36, v38
  v_add_f32 v37, v37, v39
  v_mul_f32 v36, v36, v12
  v_mul_f32 v37, v37, v13
  v_cvt_pk_bf16_f32 v130, v36, v37
  v_and_b32 v130, -2, v130
  v_add_f32 v40, v40, v42
  v_add_f32 v41, v41, v43
  v_mul_f32 v40, v40, v12
  v_mul_f32 v41, v41, v13
  v_cvt_pk_bf16_f32 v131, v40, v41
  buffer_store_dwordx2 v[130:131], v146, s[8:11], s67 offen sc1
  buffer_store_dwordx2 v[128:129], v146, s[8:11], s33 offen
  buffer_store_dwordx2 v[130:131], v146, s[8:11], s35 offen
  s_cmp_eq_u32 s92, 0
  s_cbranch_scc1 L_nr_212
  v_mov_b32 v124, 0
  v_mov_b32 v125, 0
  v_mov_b32 v126, 0
  v_mov_b32 v127, 0
  s_add_u32 s91, s91, 1
  s_add_u32 s88, s88, 98304
  s_add_u32 s89, s89, 393216
  v_mov_b32 v40, 0
  v_mov_b32 v41, 0
  v_mov_b32 v42, 0
  v_mov_b32 v43, 0
  v_mov_b32 v44, 0
  v_mov_b32 v45, 0
  v_mov_b32 v46, 0
  v_mov_b32 v47, 0
  v_mov_b32 v48, 0
  v_mov_b32 v49, 0
  v_mov_b32 v50, 0
  v_mov_b32 v51, 0
  s_mul_i32 s72, s3, 3072
  s_add_u32 s72, s72, s89
  s_add_u32 s72, s72, 48758784
  s_lshl_b32 s73, s62, 12
  s_add_u32 s73, s73, s89
  s_add_u32 s73, s73, 23986176
  s_add_u32 s40, s83, 0
  s_cmp_eq_u32 s63, 0
  s_cselect_b32 s40, s37, s40
  s_add_u32 s41, s83, 4096
  s_cmp_eq_u32 s63, 1
  s_cselect_b32 s41, s37, s41
  s_add_u32 s42, s83, 16384
  s_cmp_eq_u32 s63, 2
  s_cselect_b32 s42, s37, s42
  s_add_u32 s43, s83, 20480
  s_cmp_eq_u32 s63, 3
  s_cselect_b32 s43, s37, s43
  v_mov_b32 v100, s91
  v_mov_b32 v101, 17408
  buffer_load_dwordx4 v[0:3], v148, s[8:11], s40 offen offset:0 sc1
  buffer_load_dwordx4 v[4:7], v148, s[8:11], s40 offen offset:2048 sc1
  buffer_load_dwordx4 v[8:11], v148, s[8:11], s41 offen offset:0 sc1
  buffer_load_dwordx4 v[12:15], v148, s[8:11], s41 offen offset:2048 sc1
  buffer_load_dwordx4 v[16:19], v148, s[8:11], s42 offen offset:0 sc1
  buffer_load_dwordx4 v[20:23], v148, s[8:11], s42 offen offset:2048 sc1
  buffer_load_dwordx4 v[24:27], v148, s[8:11], s43 offen offset:0 sc1
  buffer_load_dwordx4 v[28:31], v148, s[8:11], s43 offen offset:2048 sc1
L_xc_218:
  s_waitcnt vmcnt(6)
  v_bitop3_b32 v90, v0, v2, v4 bitop3:0xfe
  v_bitop3_b32 v90, v90, v6, v6 bitop3:0xfe
  v_and_b32 v90, 1, v90
  v_cmp_ne_u32 vcc, 0, v90
  s_cbranch_vccnz L_xp_217
  v_smfmac_f32_16x16x64_bf16 v[124:127], a[248:251], v[0:7], v132
L_xc_220:
  s_waitcnt vmcnt(4)
  v_bitop3_b32 v90, v8, v10, v12 bitop3:0xfe
  v_bitop3_b32 v90, v90, v14, v14 bitop3:0xfe
  v_and_b32 v90, 1, v90
  v_cmp_ne_u32 vcc, 0, v90
  s_cbranch_vccnz L_xp_219
  v_smfmac_f32_16x16x64_bf16 v[124:127], a[248:251], v[8:15], v132
L_xc_222:
  s_waitcnt vmcnt(2)
  v_bitop3_b32 v90, v16, v18, v20 bitop3:0xfe
  v_bitop3_b32 v90, v90, v22, v22 bitop3:0xfe
  v_and_b32 v90, 1, v90
  v_cmp_ne_u32 vcc, 0, v90
  s_cbranch_vccnz L_xp_221
  v_smfmac_f32_16x16x64_bf16 v[124:127], a[248:251], v[16:23], v132
L_xc_224:
  s_waitcnt vmcnt(0)
  v_bitop3_b32 v90, v24, v26, v28 bitop3:0xfe
  v_bitop3_b32 v90, v90, v30, v30 bitop3:0xfe
  v_and_b32 v90, 1, v90
  v_cmp_ne_u32 vcc, 0, v90
  s_cbranch_vccnz L_xp_223
  v_smfmac_f32_16x16x64_bf16 v[124:127], a[248:251], v[24:31], v132
  ds_write_b32 v101, v100
  s_nop 6
  v_cvt_pk_bf16_f32 v128, v124, v125
  v_cvt_pk_bf16_f32 v129, v126, v127
  v_and_b32 v128, -2, v128
  buffer_store_dwordx2 v[128:129], v150, s[8:11], s85 offen
  s_branch L_go_216
L_nr_212:
  s_add_u32 s91, s91, 1
  s_add_u32 s88, s88, 98304
  s_add_u32 s89, s89, 393216
  v_mov_b32 v40, 0
  v_mov_b32 v41, 0
  v_mov_b32 v42, 0
  v_mov_b32 v43, 0
  v_mov_b32 v44, 0
  v_mov_b32 v45, 0
  v_mov_b32 v46, 0
  v_mov_b32 v47, 0
  v_mov_b32 v48, 0
  v_mov_b32 v49, 0
  v_mov_b32 v50, 0
  v_mov_b32 v51, 0
  s_mul_i32 s72, s3, 3072
  s_add_u32 s72, s72, s89
  s_add_u32 s72, s72, 48758784
  s_lshl_b32 s73, s62, 12
  s_add_u32 s73, s73, s89
  s_add_u32 s73, s73, 23986176
  v_mov_b32 v101, 17408
L_lf_226:
  s_sub_u32 s59, s59, 1
  s_cbranch_scc1 L_end
  ds_read_b32 v100, v101
  s_waitcnt lgkmcnt(0)
  v_cmp_ne_u32 vcc, s91, v100
  s_cbranch_vccnz L_lf_226
L_go_216:
  s_cmp_ge_u32 s3, 2
  s_cbranch_scc1 L_g2_227
  buffer_load_dwordx4 v[92:95], v151, s[8:11], s87 offen offset:0 sc1
  buffer_load_dwordx4 v[96:99], v151, s[8:11], s87 offen offset:1024 sc1
  buffer_load_dwordx4 v[100:103], v157, s[8:11], s87 offen offset:0 sc1
L_gc_230:
  s_waitcnt vmcnt(2)
  v_bitop3_b32 v90, v92, v94, 1 bitop3:0xa8
  v_cmp_ne_u32 vcc, 0, v90
  s_cbranch_vccnz L_gp_229
  ds_write_b128 v151, v[92:95] offset:0
L_gc_232:
  s_waitcnt vmcnt(1)
  v_bitop3_b32 v90, v96, v98, 1 bitop3:0xa8
  v_cmp_ne_u32 vcc, 0, v90
  s_cbranch_vccnz L_gp_231
  ds_write_b128 v151, v[96:99] offset:1024
L_gc_234:
  s_waitcnt vmcnt(0)
  v_bitop3_b32 v90, v100, v102, 1 bitop3:0xa8
  v_cmp_ne_u32 vcc, 0, v90
  s_cbranch_vccnz L_gp_233
  ds_write_b128 v157, v[100:103] offset:0
  s_branch L_g3_228
L_g2_227:
  buffer_load_dwordx4 v[92:95], v151, s[8:11], s87 offen offset:0 sc1
  buffer_load_dwordx4 v[96:99], v151, s[8:11], s87 offen offset:1024 sc1
L_gc_237:
  s_waitcnt vmcnt(1)
  v_bitop3_b32 v90, v92, v94, 1 bitop3:0xa8
  v_cmp_ne_u32 vcc, 0, v90
  s_cbranch_vccnz L_gp_236
  ds_write_b128 v151, v[92:95] offset:0
L_gc_239:
  s_waitcnt vmcnt(0)
  v_bitop3_b32 v90, v96, v98, 1 bitop3:0xa8
  v_cmp_ne_u32 vcc, 0, v90
  s_cbranch_vccnz L_gp_238
  ds_write_b128 v151, v[96:99] offset:1024
L_g3_228:
  s_waitcnt lgkmcnt(0)
  s_barrier
  s_branch L_fast
L_s3_64:
  v_mov_b32 v90, s91
  s_lshl_b32 s5, s62, 2
  s_add_u32 s5, s5, s90
  s_mov_b64 exec, 1
  buffer_store_dword v90, off, s[8:11], s5 offset:128 sc1
  s_mov_b64 exec, -1
  s_branch L_sj_63
L_hv_71:
  s_sub_u32 s59, s59, 1
  s_cbranch_scc1 L_end
  buffer_load_dwordx4 v[68:71], v142, s[8:11], s78 offen offset:0 sc1
  buffer_load_dwordx4 v[76:79], v142, s[8:11], s78 offen offset:512 sc1
  buffer_load_dwordx4 v[84:87], v142, s[8:11], s78 offen offset:1024 sc1
  s_branch L_hv2_72
L_xp_79:
  s_sub_u32 s59, s59, 1
  s_cbranch_scc1 L_end
  buffer_load_dwordx4 v[0:3], v148, s[8:11], s40 offen offset:0 sc1
  buffer_load_dwordx4 v[4:7], v148, s[8:11], s40 offen offset:2048 sc1
  buffer_load_dwordx4 v[8:11], v148, s[8:11], s41 offen offset:0 sc1
  buffer_load_dwordx4 v[12:15], v148, s[8:11], s41 offen offset:2048 sc1
  buffer_load_dwordx4 v[16:19], v148, s[8:11], s42 offen offset:0 sc1
  buffer_load_dwordx4 v[20:23], v148, s[8:11], s42 offen offset:2048 sc1
  buffer_load_dwordx4 v[24:27], v148, s[8:11], s43 offen offset:0 sc1
  buffer_load_dwordx4 v[28:31], v148, s[8:11], s43 offen offset:2048 sc1
  s_branch L_xc_80
L_xp_81:
  s_sub_u32 s59, s59, 1
  s_cbranch_scc1 L_end
  buffer_load_dwordx4 v[8:11], v148, s[8:11], s41 offen offset:0 sc1
  buffer_load_dwordx4 v[12:15], v148, s[8:11], s41 offen offset:2048 sc1
  buffer_load_dwordx4 v[16:19], v148, s[8:11], s42 offen offset:0 sc1
  buffer_load_dwordx4 v[20:23], v148, s[8:11], s42 offen offset:2048 sc1
  buffer_load_dwordx4 v[24:27], v148, s[8:11], s43 offen offset:0 sc1
  buffer_load_dwordx4 v[28:31], v148, s[8:11], s43 offen offset:2048 sc1
  s_branch L_xc_82
L_xp_83:
  s_sub_u32 s59, s59, 1
  s_cbranch_scc1 L_end
  buffer_load_dwordx4 v[16:19], v148, s[8:11], s42 offen offset:0 sc1
  buffer_load_dwordx4 v[20:23], v148, s[8:11], s42 offen offset:2048 sc1
  buffer_load_dwordx4 v[24:27], v148, s[8:11], s43 offen offset:0 sc1
  buffer_load_dwordx4 v[28:31], v148, s[8:11], s43 offen offset:2048 sc1
  s_branch L_xc_84
L_xp_85:
  s_sub_u32 s59, s59, 1
  s_cbranch_scc1 L_end
  buffer_load_dwordx4 v[24:27], v148, s[8:11], s43 offen offset:0 sc1
  buffer_load_dwordx4 v[28:31], v148, s[8:11], s43 offen offset:2048 sc1
  s_branch L_xc_86
L_gp_91:
  s_sub_u32 s59, s59, 1
  s_cbranch_scc1 L_end
  buffer_load_dwordx4 v[92:95], v151, s[8:11], s86 offen offset:0 sc1
  buffer_load_dwordx4 v[96:99], v151, s[8:11], s86 offen offset:1024 sc1
  buffer_load_dwordx4 v[100:103], v157, s[8:11], s86 offen offset:0 sc1
  s_branch L_gc_92
L_gp_93:
  s_sub_u32 s59, s59, 1
  s_cbranch_scc1 L_end
  buffer_load_dwordx4 v[96:99], v151, s[8:11], s86 offen offset:1024 sc1
  buffer_load_dwordx4 v[100:103], v157, s[8:11], s86 offen offset:0 sc1
  s_branch L_gc_94
L_gp_95:
  s_sub_u32 s59, s59, 1
  s_cbranch_scc1 L_end
  buffer_load_dwordx4 v[100:103], v157, s[8:11], s86 offen offset:0 sc1
  s_branch L_gc_96
L_gp_98:
  s_sub_u32 s59, s59, 1
  s_cbranch_scc1 L_end
  buffer_load_dwordx4 v[92:95], v151, s[8:11], s86 offen offset:0 sc1
  buffer_load_dwordx4 v[96:99], v151, s[8:11], s86 offen offset:1024 sc1
  s_branch L_gc_99
L_gp_100:
  s_sub_u32 s59, s59, 1
  s_cbranch_scc1 L_end
  buffer_load_dwordx4 v[96:99], v151, s[8:11], s86 offen offset:1024 sc1
  s_branch L_gc_101
L_s3_110:
  v_mov_b32 v90, s91
  s_lshl_b32 s5, s62, 2
  s_add_u32 s5, s5, s90
  s_mov_b64 exec, 1
  buffer_store_dword v90, off, s[8:11], s5 offset:128 sc1
  s_mov_b64 exec, -1
  s_branch L_sj_109
L_hv_117:
  s_sub_u32 s59, s59, 1
  s_cbranch_scc1 L_end
  buffer_load_dwordx4 v[68:71], v142, s[8:11], s79 offen offset:0 sc1
  buffer_load_dwordx4 v[76:79], v142, s[8:11], s79 offen offset:512 sc1
  buffer_load_dwordx4 v[84:87], v142, s[8:11], s79 offen offset:1024 sc1
  s_branch L_hv2_118
L_xp_125:
  s_sub_u32 s59, s59, 1
  s_cbranch_scc1 L_end
  buffer_load_dwordx4 v[0:3], v148, s[8:11], s40 offen offset:0 sc1
  buffer_load_dwordx4 v[4:7], v148, s[8:11], s40 offen offset:2048 sc1
  buffer_load_dwordx4 v[8:11], v148, s[8:11], s41 offen offset:0 sc1
  buffer_load_dwordx4 v[12:15], v148, s[8:11], s41 offen offset:2048 sc1
  buffer_load_dwordx4 v[16:19], v148, s[8:11], s42 offen offset:0 sc1
  buffer_load_dwordx4 v[20:23], v148, s[8:11], s42 offen offset:2048 sc1
  buffer_load_dwordx4 v[24:27], v148, s[8:11], s43 offen offset:0 sc1
  buffer_load_dwordx4 v[28:31], v148, s[8:11], s43 offen offset:2048 sc1
  s_branch L_xc_126
L_xp_127:
  s_sub_u32 s59, s59, 1
  s_cbranch_scc1 L_end
  buffer_load_dwordx4 v[8:11], v148, s[8:11], s41 offen offset:0 sc1
  buffer_load_dwordx4 v[12:15], v148, s[8:11], s41 offen offset:2048 sc1
  buffer_load_dwordx4 v[16:19], v148, s[8:11], s42 offen offset:0 sc1
  buffer_load_dwordx4 v[20:23], v148, s[8:11], s42 offen offset:2048 sc1
  buffer_load_dwordx4 v[24:27], v148, s[8:11], s43 offen offset:0 sc1
  buffer_load_dwordx4 v[28:31], v148, s[8:11], s43 offen offset:2048 sc1
  s_branch L_xc_128
L_xp_129:
  s_sub_u32 s59, s59, 1
  s_cbranch_scc1 L_end
  buffer_load_dwordx4 v[16:19], v148, s[8:11], s42 offen offset:0 sc1
  buffer_load_dwordx4 v[20:23], v148, s[8:11], s42 offen offset:2048 sc1
  buffer_load_dwordx4 v[24:27], v148, s[8:11], s43 offen offset:0 sc1
  buffer_load_dwordx4 v[28:31], v148, s[8:11], s43 offen offset:2048 sc1
  s_branch L_xc_130
L_xp_131:
  s_sub_u32 s59, s59, 1
  s_cbranch_scc1 L_end
  buffer_load_dwordx4 v[24:27], v148, s[8:11], s43 offen offset:0 sc1
  buffer_load_dwordx4 v[28:31], v148, s[8:11], s43 offen offset:2048 sc1
  s_branch L_xc_132
L_gp_137:
  s_sub_u32 s59, s59, 1
  s_cbranch_scc1 L_end
  buffer_load_dwordx4 v[92:95], v151, s[8:11], s87 offen offset:0 sc1
  buffer_load_dwordx4 v[96:99], v151, s[8:11], s87 offen offset:1024 sc1
  buffer_load_dwordx4 v[100:103], v157, s[8:11], s87 offen offset:0 sc1
  s_branch L_gc_138
L_gp_139:
  s_sub_u32 s59, s59, 1
  s_cbranch_scc1 L_end
  buffer_load_dwordx4 v[96:99], v151, s[8:11], s87 offen offset:1024 sc1
  buffer_load_dwordx4 v[100:103], v157, s[8:11], s87 offen offset:0 sc1
  s_branch L_gc_140
L_gp_141:
  s_sub_u32 s59, s59, 1
  s_cbranch_scc1 L_end
  buffer_load_dwordx4 v[100:103], v157, s[8:11], s87 offen offset:0 sc1
  s_branch L_gc_142
L_gp_144:
  s_sub_u32 s59, s59, 1
  s_cbranch_scc1 L_end
  buffer_load_dwordx4 v[92:95], v151, s[8:11], s87 offen offset:0 sc1
  buffer_load_dwordx4 v[96:99], v151, s[8:11], s87 offen offset:1024 sc1
  s_branch L_gc_145
L_gp_146:
  s_sub_u32 s59, s59, 1
  s_cbranch_scc1 L_end
  buffer_load_dwordx4 v[96:99], v151, s[8:11], s87 offen offset:1024 sc1
  s_branch L_gc_147
L_s3_156:
  v_mov_b32 v90, s91
  s_lshl_b32 s5, s62, 2
  s_add_u32 s5, s5, s90
  s_mov_b64 exec, 1
  buffer_store_dword v90, off, s[8:11], s5 offset:128 sc1
  s_mov_b64 exec, -1
  s_branch L_sj_155
L_hv_163:
  s_sub_u32 s59, s59, 1
  s_cbranch_scc1 L_end
  buffer_load_dwordx4 v[68:71], v142, s[8:11], s78 offen offset:0 sc1
  buffer_load_dwordx4 v[76:79], v142, s[8:11], s78 offen offset:512 sc1
  buffer_load_dwordx4 v[84:87], v142, s[8:11], s78 offen offset:1024 sc1
  s_branch L_hv2_164
L_xp_171:
  s_sub_u32 s59, s59, 1
  s_cbranch_scc1 L_end
  buffer_load_dwordx4 v[0:3], v148, s[8:11], s40 offen offset:0 sc1
  buffer_load_dwordx4 v[4:7], v148, s[8:11], s40 offen offset:2048 sc1
  buffer_load_dwordx4 v[8:11], v148, s[8:11], s41 offen offset:0 sc1
  buffer_load_dwordx4 v[12:15], v148, s[8:11], s41 offen offset:2048 sc1
  buffer_load_dwordx4 v[16:19], v148, s[8:11], s42 offen offset:0 sc1
  buffer_load_dwordx4 v[20:23], v148, s[8:11], s42 offen offset:2048 sc1
  buffer_load_dwordx4 v[24:27], v148, s[8:11], s43 offen offset:0 sc1
  buffer_load_dwordx4 v[28:31], v148, s[8:11], s43 offen offset:2048 sc1
  s_branch L_xc_172
L_xp_173:
  s_sub_u32 s59, s59, 1
  s_cbranch_scc1 L_end
  buffer_load_dwordx4 v[8:11], v148, s[8:11], s41 offen offset:0 sc1
  buffer_load_dwordx4 v[12:15], v148, s[8:11], s41 offen offset:2048 sc1
  buffer_load_dwordx4 v[16:19], v148, s[8:11], s42 offen offset:0 sc1
  buffer_load_dwordx4 v[20:23], v148, s[8:11], s42 offen offset:2048 sc1
  buffer_load_dwordx4 v[24:27], v148, s[8:11], s43 offen offset:0 sc1
  buffer_load_dwordx4 v[28:31], v148, s[8:11], s43 offen offset:2048 sc1
  s_branch L_xc_174
L_xp_175:
  s_sub_u32 s59, s59, 1
  s_cbranch_scc1 L_end
  buffer_load_dwordx4 v[16:19], v148, s[8:11], s42 offen offset:0 sc1
  buffer_load_dwordx4 v[20:23], v148, s[8:11], s42 offen offset:2048 sc1
  buffer_load_dwordx4 v[24:27], v148, s[8:11], s43 offen offset:0 sc1
  buffer_load_dwordx4 v[28:31], v148, s[8:11], s43 offen offset:2048 sc1
  s_branch L_xc_176
L_xp_177:
  s_sub_u32 s59, s59, 1
  s_cbranch_scc1 L_end
  buffer_load_dwordx4 v[24:27], v148, s[8:11], s43 offen offset:0 sc1
  buffer_load_dwordx4 v[28:31], v148, s[8:11], s43 offen offset:2048 sc1
  s_branch L_xc_178
L_gp_183:
  s_sub_u32 s59, s59, 1
  s_cbranch_scc1 L_end
  buffer_load_dwordx4 v[92:95], v151, s[8:11], s86 offen offset:0 sc1
  buffer_load_dwordx4 v[96:99], v151, s[8:11], s86 offen offset:1024 sc1
  buffer_load_dwordx4 v[100:103], v157, s[8:11], s86 offen offset:0 sc1
  s_branch L_gc_184
L_gp_185:
  s_sub_u32 s59, s59, 1
  s_cbranch_scc1 L_end
  buffer_load_dwordx4 v[96:99], v151, s[8:11], s86 offen offset:1024 sc1
  buffer_load_dwordx4 v[100:103], v157, s[8:11], s86 offen offset:0 sc1
  s_branch L_gc_186
L_gp_187:
  s_sub_u32 s59, s59, 1
  s_cbranch_scc1 L_end
  buffer_load_dwordx4 v[100:103], v157, s[8:11], s86 offen offset:0 sc1
  s_branch L_gc_188
L_gp_190:
  s_sub_u32 s59, s59, 1
  s_cbranch_scc1 L_end
  buffer_load_dwordx4 v[92:95], v151, s[8:11], s86 offen offset:0 sc1
  buffer_load_dwordx4 v[96:99], v151, s[8:11], s86 offen offset:1024 sc1
  s_branch L_gc_191
L_gp_192:
  s_sub_u32 s59, s59, 1
  s_cbranch_scc1 L_end
  buffer_load_dwordx4 v[96:99], v151, s[8:11], s86 offen offset:1024 sc1
  s_branch L_gc_193
L_s3_202:
  v_mov_b32 v90, s91
  s_lshl_b32 s5, s62, 2
  s_add_u32 s5, s5, s90
  s_mov_b64 exec, 1
  buffer_store_dword v90, off, s[8:11], s5 offset:128 sc1
  s_mov_b64 exec, -1
  s_branch L_sj_201
L_hv_209:
  s_sub_u32 s59, s59, 1
  s_cbranch_scc1 L_end
  buffer_load_dwordx4 v[68:71], v142, s[8:11], s79 offen offset:0 sc1
  buffer_load_dwordx4 v[76:79], v142, s[8:11], s79 offen offset:512 sc1
  buffer_load_dwordx4 v[84:87], v142, s[8:11], s79 offen offset:1024 sc1
  s_branch L_hv2_210
L_xp_217:
  s_sub_u32 s59, s59, 1
  s_cbranch_scc1 L_end
  buffer_load_dwordx4 v[0:3], v148, s[8:11], s40 offen offset:0 sc1
  buffer_load_dwordx4 v[4:7], v148, s[8:11], s40 offen offset:2048 sc1
  buffer_load_dwordx4 v[8:11], v148, s[8:11], s41 offen offset:0 sc1
  buffer_load_dwordx4 v[12:15], v148, s[8:11], s41 offen offset:2048 sc1
  buffer_load_dwordx4 v[16:19], v148, s[8:11], s42 offen offset:0 sc1
  buffer_load_dwordx4 v[20:23], v148, s[8:11], s42 offen offset:2048 sc1
  buffer_load_dwordx4 v[24:27], v148, s[8:11], s43 offen offset:0 sc1
  buffer_load_dwordx4 v[28:31], v148, s[8:11], s43 offen offset:2048 sc1
  s_branch L_xc_218
L_xp_219:
  s_sub_u32 s59, s59, 1
  s_cbranch_scc1 L_end
  buffer_load_dwordx4 v[8:11], v148, s[8:11], s41 offen offset:0 sc1
  buffer_load_dwordx4 v[12:15], v148, s[8:11], s41 offen offset:2048 sc1
  buffer_load_dwordx4 v[16:19], v148, s[8:11], s42 offen offset:0 sc1
  buffer_load_dwordx4 v[20:23], v148, s[8:11], s42 offen offset:2048 sc1
  buffer_load_dwordx4 v[24:27], v148, s[8:11], s43 offen offset:0 sc1
  buffer_load_dwordx4 v[28:31], v148, s[8:11], s43 offen offset:2048 sc1
  s_branch L_xc_220
L_xp_221:
  s_sub_u32 s59, s59, 1
  s_cbranch_scc1 L_end
  buffer_load_dwordx4 v[16:19], v148, s[8:11], s42 offen offset:0 sc1
  buffer_load_dwordx4 v[20:23], v148, s[8:11], s42 offen offset:2048 sc1
  buffer_load_dwordx4 v[24:27], v148, s[8:11], s43 offen offset:0 sc1
  buffer_load_dwordx4 v[28:31], v148, s[8:11], s43 offen offset:2048 sc1
  s_branch L_xc_222
L_xp_223:
  s_sub_u32 s59, s59, 1
  s_cbranch_scc1 L_end
  buffer_load_dwordx4 v[24:27], v148, s[8:11], s43 offen offset:0 sc1
  buffer_load_dwordx4 v[28:31], v148, s[8:11], s43 offen offset:2048 sc1
  s_branch L_xc_224
L_gp_229:
  s_sub_u32 s59, s59, 1
  s_cbranch_scc1 L_end
  buffer_load_dwordx4 v[92:95], v151, s[8:11], s87 offen offset:0 sc1
  buffer_load_dwordx4 v[96:99], v151, s[8:11], s87 offen offset:1024 sc1
  buffer_load_dwordx4 v[100:103], v157, s[8:11], s87 offen offset:0 sc1
  s_branch L_gc_230
L_gp_231:
  s_sub_u32 s59, s59, 1
  s_cbranch_scc1 L_end
  buffer_load_dwordx4 v[96:99], v151, s[8:11], s87 offen offset:1024 sc1
  buffer_load_dwordx4 v[100:103], v157, s[8:11], s87 offen offset:0 sc1
  s_branch L_gc_232
L_gp_233:
  s_sub_u32 s59, s59, 1
  s_cbranch_scc1 L_end
  buffer_load_dwordx4 v[100:103], v157, s[8:11], s87 offen offset:0 sc1
  s_branch L_gc_234
L_gp_236:
  s_sub_u32 s59, s59, 1
  s_cbranch_scc1 L_end
  buffer_load_dwordx4 v[92:95], v151, s[8:11], s87 offen offset:0 sc1
  buffer_load_dwordx4 v[96:99], v151, s[8:11], s87 offen offset:1024 sc1
  s_branch L_gc_237
L_gp_238:
  s_sub_u32 s59, s59, 1
  s_cbranch_scc1 L_end
  buffer_load_dwordx4 v[96:99], v151, s[8:11], s87 offen offset:1024 sc1
  s_branch L_gc_239
L_slow:
  ds_read_b64_tr_b16 v[0:1], v133 offset:0
  ds_read_b64_tr_b16 v[2:3], v134 offset:0
  ds_read_b64_tr_b16 v[4:5], v133 offset:1024
  ds_read_b64_tr_b16 v[6:7], v134 offset:1024
  ds_read_b64_tr_b16 v[8:9], v133 offset:2048
  ds_read_b64_tr_b16 v[10:11], v134 offset:2048
  ds_read_b64_tr_b16 v[12:13], v133 offset:3072
  ds_read_b64_tr_b16 v[14:15], v134 offset:3072
  ds_read_b64_tr_b16 v[16:17], v133 offset:4096
  ds_read_b64_tr_b16 v[18:19], v134 offset:4096
  ds_read_b64_tr_b16 v[20:21], v133 offset:5120
  ds_read_b64_tr_b16 v[22:23], v134 offset:5120
  s_cmp_ge_u32 s3, 2
  s_cbranch_scc1 L_s1a_244
  ds_read_b64_tr_b16 v[24:25], v133 offset:6144
  ds_read_b64_tr_b16 v[26:27], v134 offset:6144
  s_waitcnt lgkmcnt(12)
  v_smfmac_f32_16x16x64_bf16 v[40:43], v[0:3], a[0:7], v132
  v_smfmac_f32_16x16x64_bf16 v[44:47], v[0:3], a[80:87], v132
  buffer_load_dwordx4 v[64:67], v144, s[8:11], s72 offen offset:0 sc1
  ds_read_b64_tr_b16 v[28:29], v133 offset:7168
  ds_read_b64_tr_b16 v[30:31], v134 offset:7168
  s_waitcnt lgkmcnt(12)
  v_smfmac_f32_16x16x64_bf16 v[40:43], v[4:7], a[8:15], v132
  v_smfmac_f32_16x16x64_bf16 v[44:47], v[4:7], a[88:95], v132
  buffer_load_dwordx4 v[72:75], v144, s[8:11], s72 offen offset:1024 sc1
  ds_read_b64_tr_b16 v[32:33], v133 offset:8192
  ds_read_b64_tr_b16 v[34:35], v134 offset:8192
  s_waitcnt lgkmcnt(12)
  v_smfmac_f32_16x16x64_bf16 v[40:43], v[8:11], a[16:23], v132
  v_smfmac_f32_16x16x64_bf16 v[44:47], v[8:11], a[96:103], v132
  buffer_load_dwordx4 v[80:83], v144, s[8:11], s72 offen offset:2048 sc1
  ds_read_b64_tr_b16 v[36:37], v133 offset:9216
  ds_read_b64_tr_b16 v[38:39], v134 offset:9216
  s_waitcnt lgkmcnt(12)
  v_smfmac_f32_16x16x64_bf16 v[40:43], v[12:15], a[24:31], v132
  v_smfmac_f32_16x16x64_bf16 v[44:47], v[12:15], a[104:111], v132
  buffer_load_dwordx2 v[112:113], v145, s[8:11], s73 offen offset:0 sc1
  s_waitcnt lgkmcnt(10)
  v_smfmac_f32_16x16x64_bf16 v[40:43], v[16:19], a[32:39], v132
  v_smfmac_f32_16x16x64_bf16 v[44:47], v[16:19], a[112:119], v132
  buffer_load_dwordx2 v[114:115], v145, s[8:11], s73 offen offset:1024 sc1
  s_waitcnt lgkmcnt(8)
  v_smfmac_f32_16x16x64_bf16 v[40:43], v[20:23], a[40:47], v132
  v_smfmac_f32_16x16x64_bf16 v[44:47], v[20:23], a[120:127], v132
  buffer_load_dwordx2 v[116:117], v145, s[8:11], s73 offen offset:2048 sc1
  s_waitcnt lgkmcnt(6)
  v_smfmac_f32_16x16x64_bf16 v[40:43], v[24:27], a[48:55], v132
  v_smfmac_f32_16x16x64_bf16 v[44:47], v[24:27], a[128:135], v132
  buffer_load_dwordx2 v[118:119], v145, s[8:11], s73 offen offset:3072 sc1
  s_waitcnt lgkmcnt(4)
  v_smfmac_f32_16x16x64_bf16 v[40:43], v[28:31], a[56:63], v132
  v_smfmac_f32_16x16x64_bf16 v[44:47], v[28:31], a[136:143], v132
  buffer_load_dword v153, v159, s[8:11], s90 offen sc1
  s_waitcnt lgkmcnt(2)
  v_smfmac_f32_16x16x64_bf16 v[40:43], v[32:35], a[64:71], v132
  v_smfmac_f32_16x16x64_bf16 v[44:47], v[32:35], a[144:151], v132
  s_waitcnt lgkmcnt(0)
  v_smfmac_f32_16x16x64_bf16 v[40:43], v[36:39], a[72:79], v132
  v_smfmac_f32_16x16x64_bf16 v[44:47], v[36:39], a[152:159], v132
  s_branch L_s1b_245
L_s1a_244:
  ds_read_b64_tr_b16 v[24:25], v133 offset:6144
  ds_read_b64_tr_b16 v[26:27], v134 offset:6144
  s_waitcnt lgkmcnt(12)
  v_smfmac_f32_16x16x64_bf16 v[40:43], v[0:3], a[0:7], v132
  v_smfmac_f32_16x16x64_bf16 v[44:47], v[0:3], a[80:87], v132
  buffer_load_dwordx4 v[64:67], v144, s[8:11], s72 offen offset:0 sc1
  ds_read_b64_tr_b16 v[28:29], v133 offset:7168
  ds_read_b64_tr_b16 v[30:31], v134 offset:7168
  s_waitcnt lgkmcnt(12)
  v_smfmac_f32_16x16x64_bf16 v[40:43], v[4:7], a[8:15], v132
  v_smfmac_f32_16x16x64_bf16 v[44:47], v[4:7], a[88:95], v132
  buffer_load_dwordx4 v[72:75], v144, s[8:11], s72 offen offset:1024 sc1
  ds_read_b64_tr_b16 v[32:33], v133 offset:8192
  ds_read_b64_tr_b16 v[34:35], v134 offset:8192
  s_waitcnt lgkmcnt(12)
  v_smfmac_f32_16x16x64_bf16 v[40:43], v[8:11], a[16:23], v132
  v_smfmac_f32_16x16x64_bf16 v[44:47], v[8:11], a[96:103], v132
  buffer_load_dwordx4 v[80:83], v144, s[8:11], s72 offen offset:2048 sc1
  ds_read_b64_tr_b16 v[36:37], v133 offset:9216
  ds_read_b64_tr_b16 v[38:39], v134 offset:9216
  s_waitcnt lgkmcnt(12)
  v_smfmac_f32_16x16x64_bf16 v[40:43], v[12:15], a[24:31], v132
  v_smfmac_f32_16x16x64_bf16 v[44:47], v[12:15], a[104:111], v132
  s_waitcnt lgkmcnt(10)
  v_smfmac_f32_16x16x64_bf16 v[40:43], v[16:19], a[32:39], v132
  v_smfmac_f32_16x16x64_bf16 v[44:47], v[16:19], a[112:119], v132
  s_waitcnt lgkmcnt(8)
  v_smfmac_f32_16x16x64_bf16 v[40:43], v[20:23], a[40:47], v132
  v_smfmac_f32_16x16x64_bf16 v[44:47], v[20:23], a[120:127], v132
  s_waitcnt lgkmcnt(6)
  v_smfmac_f32_16x16x64_bf16 v[40:43], v[24:27], a[48:55], v132
  v_smfmac_f32_16x16x64_bf16 v[44:47], v[24:27], a[128:135], v132
  s_waitcnt lgkmcnt(4)
  v_smfmac_f32_16x16x64_bf16 v[40:43], v[28:31], a[56:63], v132
  v_smfmac_f32_16x16x64_bf16 v[44:47], v[28:31], a[136:143], v132
  s_waitcnt lgkmcnt(2)
  v_smfmac_f32_16x16x64_bf16 v[40:43], v[32:35], a[64:71], v132
  v_smfmac_f32_16x16x64_bf16 v[44:47], v[32:35], a[144:151], v132
  s_waitcnt lgkmcnt(0)
  v_smfmac_f32_16x16x64_bf16 v[40:43], v[36:39], a[72:79], v132
  v_smfmac_f32_16x16x64_bf16 v[44:47], v[36:39], a[152:159], v132
L_s1b_245:
  v_smfmac_f32_16x16x64_bf16 v[48:51], v[0:3], a[160:167], v132
  s_mul_i32 s5, s62, 1280
  s_add_u32 s5, s5, s76
  s_nop 3
  v_add_f32 v40, v40, v42
  v_add_f32 v41, v41, v43
  v_add_f32 v44, v44, v46
  v_add_f32 v45, v45, v47
  v_cvt_pk_bf16_f32 v128, v40, v41
  v_cvt_pk_bf16_f32 v129, v44, v45
  ds_write_b64 v135, v[128:129]
  v_smfmac_f32_16x16x64_bf16 v[48:51], v[4:7], a[168:175], v132
  v_smfmac_f32_16x16x64_bf16 v[48:51], v[8:11], a[176:183], v132
  v_smfmac_f32_16x16x64_bf16 v[48:51], v[12:15], a[184:191], v132
  s_waitcnt lgkmcnt(0)
  s_barrier
  ds_read_b64_tr_b16 v[52:53], v136 offset:0
  ds_read_b64_tr_b16 v[54:55], v136 offset:512
  ds_read_b64_tr_b16 v[56:57], v136 offset:1024
  ds_read_b64_tr_b16 v[58:59], v136 offset:1536
  v_smfmac_f32_16x16x64_bf16 v[48:51], v[16:19], a[192:199], v132
  v_smfmac_f32_16x16x64_bf16 v[48:51], v[20:23], a[200:207], v132
  v_smfmac_f32_16x16x64_bf16 v[48:51], v[24:27], a[208:215], v132
  v_smfmac_f32_16x16x64_bf16 v[48:51], v[28:31], a[216:223], v132
  s_cmp_ge_u32 s3, 2
  s_cbranch_scc1 L_s0_246
  s_waitcnt lgkmcnt(2)
  v_mfma_f32_16x16x32_bf16 v[100:103], v[104:107], v[52:55], 0
  s_waitcnt lgkmcnt(0)
  v_mfma_f32_16x16x32_bf16 v[100:103], v[108:111], v[56:59], v[100:103]
  v_smfmac_f32_16x16x64_bf16 v[48:51], v[32:35], a[224:231], v132
  s_nop 6
  v_or_b32 v100, 1, v100
  v_or_b32 v102, 1, v102
  buffer_store_dwordx4 v[100:103], v139, s[8:11], s5 offen sc1
  s_branch L_sj_247
L_s0_246:
  s_waitcnt lgkmcnt(2)
  v_mfma_f32_16x16x32_bf16 v[100:103], v[52:55], v[52:55], 0
  s_waitcnt lgkmcnt(0)
  v_mfma_f32_16x16x32_bf16 v[100:103], v[56:59], v[56:59], v[100:103]
  v_smfmac_f32_16x16x64_bf16 v[48:51], v[32:35], a[224:231], v132
  s_cmp_eq_u32 s3, 3
  s_cbranch_scc1 L_s3_248
  s_nop 4
  v_or_b32 v102, 1, v102
  buffer_store_dwordx2 v[102:103], v139, s[8:11], s5 offen sc1
L_sj_247:
  v_smfmac_f32_16x16x64_bf16 v[48:51], v[36:39], a[232:239], v132
  v_mov_b32 v12, 0
  v_mov_b32 v13, 0
  v_mov_b32 v14, 0
  v_mov_b32 v15, 0
  v_mov_b32 v16, 0
  v_mov_b32 v17, 0
  v_mov_b32 v18, 0
  v_mov_b32 v19, 0
  v_add_f32 v48, v48, v50
  v_add_f32 v49, v49, v51
  v_cvt_pk_bf16_f32 v152, v48, v49
  v_or_b32 v128, 1, v152
  buffer_store_dword v128, v141, s[8:11], s78 offen sc1
  s_cmp_lg_u32 s3, 0
  s_cbranch_scc1 L_w0_252
  s_cmp_ge_u32 s91, 62
  s_cbranch_scc1 L_pfok_254
  s_add_u32 s7, s91, 1
  s_add_u32 s71, s7, 1
  s_lshr_b32 s7, s7, 1
  s_lshr_b32 s71, s71, 1
L_pf_253:
  s_sub_u32 s59, s59, 1
  s_cbranch_scc1 L_end
  v_readlane_b32 s5, v153, 0
  v_readlane_b32 s6, v153, 3
  s_cmp_gt_u32 s5, s71
  s_cselect_b32 s6, s6, 0
  s_cmp_gt_u32 s6, s7
  s_cbranch_scc1 L_pfok_254
  buffer_load_dword v153, v159, s[8:11], s90 offen sc1
  s_waitcnt vmcnt(0)
  s_branch L_pf_253
L_pfok_254:
L_w0_252:
  v_mov_b32 v20, 0
  v_mov_b32 v21, 0
  v_mov_b32 v22, 0
  v_mov_b32 v23, 0
  v_mov_b32 v24, 0
  v_mov_b32 v25, 0
  v_mov_b32 v26, 0
  v_mov_b32 v27, 0
  v_mov_b32 v28, 0
  v_mov_b32 v29, 0
  v_mov_b32 v30, 0
  v_mov_b32 v31, 0
  v_mov_b32 v32, 0
  v_mov_b32 v33, 0
  v_mov_b32 v34, 0
  v_mov_b32 v35, 0
  v_mov_b32 v36, 0
  v_mov_b32 v37, 0
  v_mov_b32 v38, 0
  v_mov_b32 v39, 0
  v_mov_b32 v40, 0
  v_mov_b32 v41, 0
  v_mov_b32 v42, 0
  v_mov_b32 v43, 0
  buffer_load_dwordx4 v[92:95], v140, s[8:11], s76 offen sc1
  buffer_load_dwordx4 v[96:99], v154, s[8:11], s76 offen sc1
L_pl_249:
  s_sub_u32 s59, s59, 1
  s_cbranch_scc1 L_end
  s_waitcnt vmcnt(0)
  v_bitop3_b32 v90, v92, v94, v96 bitop3:0x80
  v_bitop3_b32 v90, v90, v98, v98 bitop3:0x80
  v_and_b32 v90, 1, v90
  v_cmp_ne_u32 vcc, 1, v90
  s_cbranch_vccz L_pd_251
  buffer_load_dwordx4 v[92:95], v140, s[8:11], s76 offen sc1
  buffer_load_dwordx4 v[96:99], v154, s[8:11], s76 offen sc1
  s_branch L_pl_249
L_pd_251:
  v_fma_f32 v100, v155, v96, v92
  v_fma_f32 v101, v155, v97, v93
  v_fma_f32 v102, v155, v98, v94
  v_fma_f32 v103, v155, v99, v95
L_pj_250:
  buffer_load_dwordx4 v[68:71], v142, s[8:11], s78 offen offset:0 sc1
  v_permlane32_swap_b32 v100, v102
  v_permlane32_swap_b32 v101, v103
  v_add_f32 v100, v100, v102
  v_add_f32 v101, v101, v103
  v_max_f32 v128, v100, v101
  buffer_load_dwordx4 v[76:79], v142, s[8:11], s78 offen offset:512 sc1
  s_nop 0
  v_max_f32_dpp v128, v128, v128 row_ror:1 row_mask:0xf bank_mask:0xf
  buffer_load_dwordx4 v[84:87], v142, s[8:11], s78 offen offset:1024 sc1
  s_nop 0
  v_max_f32_dpp v128, v128, v128 row_ror:2 row_mask:0xf bank_mask:0xf
  s_nop 1
  v_max_f32_dpp v128, v128, v128 row_ror:4 row_mask:0xf bank_mask:0xf
  s_nop 1
  v_max_f32_dpp v128, v128, v128 row_ror:8 row_mask:0xf bank_mask:0xf
  v_mov_b32 v129, v128
  s_nop 1
  v_permlane32_swap_b32 v128, v129
  v_max_f32 v128, v128, v129
  v_sub_f32 v100, v100, v128
  v_sub_f32 v101, v101, v128
  v_mul_f32 v100, s93, v100
  v_mul_f32 v101, s93, v101
  v_exp_f32 v100, v100
  v_exp_f32 v101, v101
  s_nop 0
  v_cvt_pk_bf16_f32 v128, v100, v101
  ds_write_b32 v156, v128
  s_waitcnt lgkmcnt(0)
  s_barrier
  ds_read_b128 v[124:127], v91
L_hv2_256:
  s_waitcnt vmcnt(0)
  v_bitop3_b32 v128, v68, v70, v76 bitop3:0x80
  v_bitop3_b32 v128, v128, v78, v84 bitop3:0x80
  v_bitop3_b32 v128, v128, v86, v86 bitop3:0x80
  v_and_b32 v128, 1, v128
  v_cmp_ne_u32 vcc, 1, v128
  s_cbranch_vccnz L_hv_255
  s_waitcnt lgkmcnt(0)
  v_smfmac_f32_16x16x64_bf16 v[12:15], v[124:127], v[64:71], v132
  v_smfmac_f32_16x16x64_bf16 v[16:19], v[124:127], v[72:79], v132
  v_smfmac_f32_16x16x64_bf16 v[20:23], v[124:127], v[80:87], v132
  v_smfmac_f32_16x16x64_bf16 v[24:27], v[124:127], a[240:247], v132
  s_nop 4
  v_add_f32 v12, v12, v14
  v_add_f32 v13, v13, v15
  v_cvt_pk_bf16_f32 v128, v12, v13
  ds_write_b32 v137, v128
  v_add_f32 v16, v16, v18
  v_add_f32 v17, v17, v19
  v_cvt_pk_bf16_f32 v129, v16, v17
  ds_write_b32 v147, v129
  v_add_f32 v20, v20, v22
  v_add_f32 v21, v21, v23
  v_cvt_pk_bf16_f32 v130, v20, v21
  ds_write_b32 v138, v130
  v_add_f32 v24, v24, v26
  v_add_f32 v25, v25, v27
  v_rcp_f32 v12, v24
  v_rcp_f32 v13, v25
  s_waitcnt lgkmcnt(0)
  s_barrier
  ds_read_b64_tr_b16 v[0:1], v133 offset:12288
  ds_read_b64_tr_b16 v[2:3], v134 offset:12288
  ds_read_b64_tr_b16 v[4:5], v133 offset:13312
  ds_read_b64_tr_b16 v[6:7], v134 offset:13312
  ds_read_b64_tr_b16 v[8:9], v133 offset:14336
  ds_read_b64_tr_b16 v[10:11], v134 offset:14336
  s_add_u32 s5, s88, 6291456
  buffer_store_dword v152, v143, s[8:11], s5 offen sc1
  s_cmp_lg_u32 s3, 3
  s_cbranch_scc1 L_km_257
  s_sub_u32 s5, s88, 0
  buffer_store_dwordx4 v[52:55], v139, s[8:11], s5 offen sc1
  buffer_store_dwordx4 v[56:59], v139, s[8:11], s5 offen offset:512 sc1
L_km_257:
  s_waitcnt lgkmcnt(4)
  v_smfmac_f32_16x16x64_bf16 v[28:31], v[0:3], v[160:167], v132
  v_smfmac_f32_16x16x64_bf16 v[32:35], v[0:3], v[184:191], v132
  s_waitcnt lgkmcnt(2)
  v_smfmac_f32_16x16x64_bf16 v[28:31], v[4:7], v[168:175], v132
  v_smfmac_f32_16x16x64_bf16 v[32:35], v[4:7], v[192:199], v132
  s_waitcnt lgkmcnt(0)
  v_smfmac_f32_16x16x64_bf16 v[28:31], v[8:11], v[176:183], v132
  v_smfmac_f32_16x16x64_bf16 v[32:35], v[8:11], v[200:207], v132
  v_smfmac_f32_16x16x64_bf16 v[36:39], v[0:3], v[208:215], v132
  v_smfmac_f32_16x16x64_bf16 v[40:43], v[0:3], v[232:239], v132
  v_smfmac_f32_16x16x64_bf16 v[36:39], v[4:7], v[216:223], v132
  v_smfmac_f32_16x16x64_bf16 v[40:43], v[4:7], v[240:247], v132
  v_smfmac_f32_16x16x64_bf16 v[36:39], v[8:11], v[224:231], v132
  s_nop 1
  v_add_f32 v28, v28, v30
  v_add_f32 v29, v29, v31
  v_smfmac_f32_16x16x64_bf16 v[40:43], v[8:11], v[248:255], v132
  v_mul_f32 v28, v28, v12
  v_mul_f32 v29, v29, v13
  v_cvt_pk_bf16_f32 v128, v28, v29
  v_or_b32 v128, 1, v128
  v_add_f32 v32, v32, v34
  v_add_f32 v33, v33, v35
  v_mul_f32 v32, v32, v12
  v_mul_f32 v33, v33, v13
  v_cvt_pk_bf16_f32 v129, v32, v33
  buffer_store_dwordx2 v[128:129], v146, s[8:11], s80 offen sc1
  v_add_f32 v36, v36, v38
  v_add_f32 v37, v37, v39
  v_mul_f32 v36, v36, v12
  v_mul_f32 v37, v37, v13
  v_cvt_pk_bf16_f32 v130, v36, v37
  v_or_b32 v130, 1, v130
  v_add_f32 v40, v40, v42
  v_add_f32 v41, v41, v43
  v_mul_f32 v40, v40, v12
  v_mul_f32 v41, v41, v13
  v_cvt_pk_bf16_f32 v131, v40, v41
  buffer_store_dwordx2 v[130:131], v146, s[8:11], s66 offen sc1
  buffer_store_dwordx2 v[128:129], v146, s[8:11], s32 offen sc1
  buffer_store_dwordx2 v[130:131], v146, s[8:11], s34 offen sc1
  s_cmp_eq_u32 s92, 0
  s_cbranch_scc1 L_nr_258
  v_mov_b32 v124, 0
  v_mov_b32 v125, 0
  v_mov_b32 v126, 0
  v_mov_b32 v127, 0
  s_add_u32 s91, s91, 1
  s_add_u32 s88, s88, 98304
  s_add_u32 s89, s89, 393216
  v_mov_b32 v40, 0
  v_mov_b32 v41, 0
  v_mov_b32 v42, 0
  v_mov_b32 v43, 0
  v_mov_b32 v44, 0
  v_mov_b32 v45, 0
  v_mov_b32 v46, 0
  v_mov_b32 v47, 0
  v_mov_b32 v48, 0
  v_mov_b32 v49, 0
  v_mov_b32 v50, 0
  v_mov_b32 v51, 0
  s_mul_i32 s72, s3, 3072
  s_add_u32 s72, s72, s89
  s_add_u32 s72, s72, 48758784
  s_lshl_b32 s73, s62, 12
  s_add_u32 s73, s73, s89
  s_add_u32 s73, s73, 23986176
  s_add_u32 s40, s82, 0
  s_cmp_eq_u32 s63, 0
  s_cselect_b32 s40, s36, s40
  s_add_u32 s41, s82, 4096
  s_cmp_eq_u32 s63, 1
  s_cselect_b32 s41, s36, s41
  s_add_u32 s42, s82, 16384
  s_cmp_eq_u32 s63, 2
  s_cselect_b32 s42, s36, s42
  s_add_u32 s43, s82, 20480
  s_cmp_eq_u32 s63, 3
  s_cselect_b32 s43, s36, s43
  v_mov_b32 v100, s91
  v_mov_b32 v101, 17408
  buffer_load_dwordx4 v[0:3], v148, s[8:11], s40 offen offset:0 sc1
  buffer_load_dwordx4 v[4:7], v148, s[8:11], s40 offen offset:2048 sc1
  buffer_load_dwordx4 v[8:11], v148, s[8:11], s41 offen offset:0 sc1
  buffer_load_dwordx4 v[12:15], v148, s[8:11], s41 offen offset:2048 sc1
  buffer_load_dwordx4 v[16:19], v148, s[8:11], s42 offen offset:0 sc1
  buffer_load_dwordx4 v[20:23], v148, s[8:11], s42 offen offset:2048 sc1
  buffer_load_dwordx4 v[24:27], v148, s[8:11], s43 offen offset:0 sc1
  buffer_load_dwordx4 v[28:31], v148, s[8:11], s43 offen offset:2048 sc1
L_xc_264:
  s_waitcnt vmcnt(6)
  v_bitop3_b32 v90, v0, v2, v4 bitop3:0x80
  v_bitop3_b32 v90, v90, v6, v6 bitop3:0x80
  v_and_b32 v90, 1, v90
  v_cmp_ne_u32 vcc, 1, v90
  s_cbranch_vccnz L_xp_263
  v_smfmac_f32_16x16x64_bf16 v[124:127], a[248:251], v[0:7], v132
L_xc_266:
  s_waitcnt vmcnt(4)
  v_bitop3_b32 v90, v8, v10, v12 bitop3:0x80
  v_bitop3_b32 v90, v90, v14, v14 bitop3:0x80
  v_and_b32 v90, 1, v90
  v_cmp_ne_u32 vcc, 1, v90
  s_cbranch_vccnz L_xp_265
  v_smfmac_f32_16x16x64_bf16 v[124:127], a[248:251], v[8:15], v132
L_xc_268:
  s_waitcnt vmcnt(2)
  v_bitop3_b32 v90, v16, v18, v20 bitop3:0x80
  v_bitop3_b32 v90, v90, v22, v22 bitop3:0x80
  v_and_b32 v90, 1, v90
  v_cmp_ne_u32 vcc, 1, v90
  s_cbranch_vccnz L_xp_267
  v_smfmac_f32_16x16x64_bf16 v[124:127], a[248:251], v[16:23], v132
L_xc_270:
  s_waitcnt vmcnt(0)
  v_bitop3_b32 v90, v24, v26, v28 bitop3:0x80
  v_bitop3_b32 v90, v90, v30, v30 bitop3:0x80
  v_and_b32 v90, 1, v90
  v_cmp_ne_u32 vcc, 1, v90
  s_cbranch_vccnz L_xp_269
  v_smfmac_f32_16x16x64_bf16 v[124:127], a[248:251], v[24:31], v132
  ds_write_b32 v101, v100
  s_nop 6
  v_cvt_pk_bf16_f32 v128, v124, v125
  v_cvt_pk_bf16_f32 v129, v126, v127
  v_or_b32 v128, 1, v128
  buffer_store_dwordx2 v[128:129], v150, s[8:11], s84 offen sc1
  s_branch L_go_262
L_nr_258:
  s_add_u32 s91, s91, 1
  s_add_u32 s88, s88, 98304
  s_add_u32 s89, s89, 393216
  v_mov_b32 v40, 0
  v_mov_b32 v41, 0
  v_mov_b32 v42, 0
  v_mov_b32 v43, 0
  v_mov_b32 v44, 0
  v_mov_b32 v45, 0
  v_mov_b32 v46, 0
  v_mov_b32 v47, 0
  v_mov_b32 v48, 0
  v_mov_b32 v49, 0
  v_mov_b32 v50, 0
  v_mov_b32 v51, 0
  s_mul_i32 s72, s3, 3072
  s_add_u32 s72, s72, s89
  s_add_u32 s72, s72, 48758784
  s_lshl_b32 s73, s62, 12
  s_add_u32 s73, s73, s89
  s_add_u32 s73, s73, 23986176
  v_mov_b32 v101, 17408
L_lf_272:
  s_sub_u32 s59, s59, 1
  s_cbranch_scc1 L_end
  ds_read_b32 v100, v101
  s_waitcnt lgkmcnt(0)
  v_cmp_ne_u32 vcc, s91, v100
  s_cbranch_vccnz L_lf_272
L_go_262:
  s_cmp_ge_u32 s3, 2
  s_cbranch_scc1 L_g2_273
  buffer_load_dwordx4 v[92:95], v151, s[8:11], s86 offen offset:0 sc1
  buffer_load_dwordx4 v[96:99], v151, s[8:11], s86 offen offset:1024 sc1
  buffer_load_dwordx4 v[100:103], v157, s[8:11], s86 offen offset:0 sc1
L_gc_276:
  s_waitcnt vmcnt(2)
  v_bitop3_b32 v90, v92, v94, 1 bitop3:0x80
  v_cmp_ne_u32 vcc, 1, v90
  s_cbranch_vccnz L_gp_275
  ds_write_b128 v151, v[92:95] offset:0
L_gc_278:
  s_waitcnt vmcnt(1)
  v_bitop3_b32 v90, v96, v98, 1 bitop3:0x80
  v_cmp_ne_u32 vcc, 1, v90
  s_cbranch_vccnz L_gp_277
  ds_write_b128 v151, v[96:99] offset:1024
L_gc_280:
  s_waitcnt vmcnt(0)
  v_bitop3_b32 v90, v100, v102, 1 bitop3:0x80
  v_cmp_ne_u32 vcc, 1, v90
  s_cbranch_vccnz L_gp_279
  ds_write_b128 v157, v[100:103] offset:0
  s_branch L_g3_274
L_g2_273:
  buffer_load_dwordx4 v[92:95], v151, s[8:11], s86 offen offset:0 sc1
  buffer_load_dwordx4 v[96:99], v151, s[8:11], s86 offen offset:1024 sc1
L_gc_283:
  s_waitcnt vmcnt(1)
  v_bitop3_b32 v90, v92, v94, 1 bitop3:0x80
  v_cmp_ne_u32 vcc, 1, v90
  s_cbranch_vccnz L_gp_282
  ds_write_b128 v151, v[92:95] offset:0
L_gc_285:
  s_waitcnt vmcnt(0)
  v_bitop3_b32 v90, v96, v98, 1 bitop3:0x80
  v_cmp_ne_u32 vcc, 1, v90
  s_cbranch_vccnz L_gp_284
  ds_write_b128 v151, v[96:99] offset:1024
L_g3_274:
  s_waitcnt lgkmcnt(0)
  s_barrier
  ds_read_b64_tr_b16 v[0:1], v133 offset:0
  ds_read_b64_tr_b16 v[2:3], v134 offset:0
  ds_read_b64_tr_b16 v[4:5], v133 offset:1024
  ds_read_b64_tr_b16 v[6:7], v134 offset:1024
  ds_read_b64_tr_b16 v[8:9], v133 offset:2048
  ds_read_b64_tr_b16 v[10:11], v134 offset:2048
  ds_read_b64_tr_b16 v[12:13], v133 offset:3072
  ds_read_b64_tr_b16 v[14:15], v134 offset:3072
  ds_read_b64_tr_b16 v[16:17], v133 offset:4096
  ds_read_b64_tr_b16 v[18:19], v134 offset:4096
  ds_read_b64_tr_b16 v[20:21], v133 offset:5120
  ds_read_b64_tr_b16 v[22:23], v134 offset:5120
  s_cmp_ge_u32 s3, 2
  s_cbranch_scc1 L_s1a_290
  ds_read_b64_tr_b16 v[24:25], v133 offset:6144
  ds_read_b64_tr_b16 v[26:27], v134 offset:6144
  s_waitcnt lgkmcnt(12)
  v_smfmac_f32_16x16x64_bf16 v[40:43], v[0:3], a[0:7], v132
  v_smfmac_f32_16x16x64_bf16 v[44:47], v[0:3], a[80:87], v132
  buffer_load_dwordx4 v[64:67], v144, s[8:11], s72 offen offset:0 sc1
  ds_read_b64_tr_b16 v[28:29], v133 offset:7168
  ds_read_b64_tr_b16 v[30:31], v134 offset:7168
  s_waitcnt lgkmcnt(12)
  v_smfmac_f32_16x16x64_bf16 v[40:43], v[4:7], a[8:15], v132
  v_smfmac_f32_16x16x64_bf16 v[44:47], v[4:7], a[88:95], v132
  buffer_load_dwordx4 v[72:75], v144, s[8:11], s72 offen offset:1024 sc1
  ds_read_b64_tr_b16 v[32:33], v133 offset:8192
  ds_read_b64_tr_b16 v[34:35], v134 offset:8192
  s_waitcnt lgkmcnt(12)
  v_smfmac_f32_16x16x64_bf16 v[40:43], v[8:11], a[16:23], v132
  v_smfmac_f32_16x16x64_bf16 v[44:47], v[8:11], a[96:103], v132
  buffer_load_dwordx4 v[80:83], v144, s[8:11], s72 offen offset:2048 sc1
  ds_read_b64_tr_b16 v[36:37], v133 offset:9216
  ds_read_b64_tr_b16 v[38:39], v134 offset:9216
  s_waitcnt lgkmcnt(12)
  v_smfmac_f32_16x16x64_bf16 v[40:43], v[12:15], a[24:31], v132
  v_smfmac_f32_16x16x64_bf16 v[44:47], v[12:15], a[104:111], v132
  buffer_load_dwordx2 v[104:105], v145, s[8:11], s73 offen offset:0 sc1
  s_waitcnt lgkmcnt(10)
  v_smfmac_f32_16x16x64_bf16 v[40:43], v[16:19], a[32:39], v132
  v_smfmac_f32_16x16x64_bf16 v[44:47], v[16:19], a[112:119], v132
  buffer_load_dwordx2 v[106:107], v145, s[8:11], s73 offen offset:1024 sc1
  s_waitcnt lgkmcnt(8)
  v_smfmac_f32_16x16x64_bf16 v[40:43], v[20:23], a[40:47], v132
  v_smfmac_f32_16x16x64_bf16 v[44:47], v[20:23], a[120:127], v132
  buffer_load_dwordx2 v[108:109], v145, s[8:11], s73 offen offset:2048 sc1
  s_waitcnt lgkmcnt(6)
  v_smfmac_f32_16x16x64_bf16 v[40:43], v[24:27], a[48:55], v132
  v_smfmac_f32_16x16x64_bf16 v[44:47], v[24:27], a[128:135], v132
  buffer_load_dwordx2 v[110:111], v145, s[8:11], s73 offen offset:3072 sc1
  s_waitcnt lgkmcnt(4)
  v_smfmac_f32_16x16x64_bf16 v[40:43], v[28:31], a[56:63], v132
  v_smfmac_f32_16x16x64_bf16 v[44:47], v[28:31], a[136:143], v132
  buffer_load_dword v153, v159, s[8:11], s90 offen sc1
  s_waitcnt lgkmcnt(2)
  v_smfmac_f32_16x16x64_bf16 v[40:43], v[32:35], a[64:71], v132
  v_smfmac_f32_16x16x64_bf16 v[44:47], v[32:35], a[144:151], v132
  s_waitcnt lgkmcnt(0)
  v_smfmac_f32_16x16x64_bf16 v[40:43], v[36:39], a[72:79], v132
  v_smfmac_f32_16x16x64_bf16 v[44:47], v[36:39], a[152:159], v132
  s_branch L_s1b_291
L_s1a_290:
  ds_read_b64_tr_b16 v[24:25], v133 offset:6144
  ds_read_b64_tr_b16 v[26:27], v134 offset:6144
  s_waitcnt lgkmcnt(12)
  v_smfmac_f32_16x16x64_bf16 v[40:43], v[0:3], a[0:7], v132
  v_smfmac_f32_16x16x64_bf16 v[44:47], v[0:3], a[80:87], v132
  buffer_load_dwordx4 v[64:67], v144, s[8:11], s72 offen offset:0 sc1
  ds_read_b64_tr_b16 v[28:29], v133 offset:7168
  ds_read_b64_tr_b16 v[30:31], v134 offset:7168
  s_waitcnt lgkmcnt(12)
  v_smfmac_f32_16x16x64_bf16 v[40:43], v[4:7], a[8:15], v132
  v_smfmac_f32_16x16x64_bf16 v[44:47], v[4:7], a[88:95], v132
  buffer_load_dwordx4 v[72:75], v144, s[8:11], s72 offen offset:1024 sc1
  ds_read_b64_tr_b16 v[32:33], v133 offset:8192
  ds_read_b64_tr_b16 v[34:35], v134 offset:8192
  s_waitcnt lgkmcnt(12)
  v_smfmac_f32_16x16x64_bf16 v[40:43], v[8:11], a[16:23], v132
  v_smfmac_f32_16x16x64_bf16 v[44:47], v[8:11], a[96:103], v132
  buffer_load_dwordx4 v[80:83], v144, s[8:11], s72 offen offset:2048 sc1
  ds_read_b64_tr_b16 v[36:37], v133 offset:9216
  ds_read_b64_tr_b16 v[38:39], v134 offset:9216
  s_waitcnt lgkmcnt(12)
  v_smfmac_f32_16x16x64_bf16 v[40:43], v[12:15], a[24:31], v132
  v_smfmac_f32_16x16x64_bf16 v[44:47], v[12:15], a[104:111], v132
  s_waitcnt lgkmcnt(10)
  v_smfmac_f32_16x16x64_bf16 v[40:43], v[16:19], a[32:39], v132
  v_smfmac_f32_16x16x64_bf16 v[44:47], v[16:19], a[112:119], v132
  s_waitcnt lgkmcnt(8)
  v_smfmac_f32_16x16x64_bf16 v[40:43], v[20:23], a[40:47], v132
  v_smfmac_f32_16x16x64_bf16 v[44:47], v[20:23], a[120:127], v132
  s_waitcnt lgkmcnt(6)
  v_smfmac_f32_16x16x64_bf16 v[40:43], v[24:27], a[48:55], v132
  v_smfmac_f32_16x16x64_bf16 v[44:47], v[24:27], a[128:135], v132
  s_waitcnt lgkmcnt(4)
  v_smfmac_f32_16x16x64_bf16 v[40:43], v[28:31], a[56:63], v132
  v_smfmac_f32_16x16x64_bf16 v[44:47], v[28:31], a[136:143], v132
  s_waitcnt lgkmcnt(2)
  v_smfmac_f32_16x16x64_bf16 v[40:43], v[32:35], a[64:71], v132
  v_smfmac_f32_16x16x64_bf16 v[44:47], v[32:35], a[144:151], v132
  s_waitcnt lgkmcnt(0)
  v_smfmac_f32_16x16x64_bf16 v[40:43], v[36:39], a[72:79], v132
  v_smfmac_f32_16x16x64_bf16 v[44:47], v[36:39], a[152:159], v132
L_s1b_291:
  v_smfmac_f32_16x16x64_bf16 v[48:51], v[0:3], a[160:167], v132
  s_mul_i32 s5, s62, 1280
  s_add_u32 s5, s5, s77
  s_nop 3
  v_add_f32 v40, v40, v42
  v_add_f32 v41, v41, v43
  v_add_f32 v44, v44, v46
  v_add_f32 v45, v45, v47
  v_cvt_pk_bf16_f32 v128, v40, v41
  v_cvt_pk_bf16_f32 v129, v44, v45
  ds_write_b64 v135, v[128:129]
  v_smfmac_f32_16x16x64_bf16 v[48:51], v[4:7], a[168:175], v132
  v_smfmac_f32_16x16x64_bf16 v[48:51], v[8:11], a[176:183], v132
  v_smfmac_f32_16x16x64_bf16 v[48:51], v[12:15], a[184:191], v132
  s_waitcnt lgkmcnt(0)
  s_barrier
  ds_read_b64_tr_b16 v[52:53], v136 offset:0
  ds_read_b64_tr_b16 v[54:55], v136 offset:512
  ds_read_b64_tr_b16 v[56:57], v136 offset:1024
  ds_read_b64_tr_b16 v[58:59], v136 offset:1536
  v_smfmac_f32_16x16x64_bf16 v[48:51], v[16:19], a[192:199], v132
  v_smfmac_f32_16x16x64_bf16 v[48:51], v[20:23], a[200:207], v132
  v_smfmac_f32_16x16x64_bf16 v[48:51], v[24:27], a[208:215], v132
  v_smfmac_f32_16x16x64_bf16 v[48:51], v[28:31], a[216:223], v132
  s_cmp_ge_u32 s3, 2
  s_cbranch_scc1 L_s0_292
  s_waitcnt lgkmcnt(2)
  v_mfma_f32_16x16x32_bf16 v[100:103], v[112:115], v[52:55], 0
  s_waitcnt lgkmcnt(0)
  v_mfma_f32_16x16x32_bf16 v[100:103], v[116:119], v[56:59], v[100:103]
  v_smfmac_f32_16x16x64_bf16 v[48:51], v[32:35], a[224:231], v132
  s_nop 6
  v_or_b32 v100, 1, v100
  v_or_b32 v102, 1, v102
  buffer_store_dwordx4 v[100:103], v139, s[8:11], s5 offen sc1
  s_branch L_sj_293
L_s0_292:
  s_waitcnt lgkmcnt(2)
  v_mfma_f32_16x16x32_bf16 v[100:103], v[52:55], v[52:55], 0
  s_waitcnt lgkmcnt(0)
  v_mfma_f32_16x16x32_bf16 v[100:103], v[56:59], v[56:59], v[100:103]
  v_smfmac_f32_16x16x64_bf16 v[48:51], v[32:35], a[224:231], v132
  s_cmp_eq_u32 s3, 3
  s_cbranch_scc1 L_s3_294
  s_nop 4
  v_or_b32 v102, 1, v102
  buffer_store_dwordx2 v[102:103], v139, s[8:11], s5 offen sc1
L_sj_293:
  v_smfmac_f32_16x16x64_bf16 v[48:51], v[36:39], a[232:239], v132
  v_mov_b32 v12, 0
  v_mov_b32 v13, 0
  v_mov_b32 v14, 0
  v_mov_b32 v15, 0
  v_mov_b32 v16, 0
  v_mov_b32 v17, 0
  v_mov_b32 v18, 0
  v_mov_b32 v19, 0
  v_add_f32 v48, v48, v50
  v_add_f32 v49, v49, v51
  v_cvt_pk_bf16_f32 v152, v48, v49
  v_or_b32 v128, 1, v152
  buffer_store_dword v128, v141, s[8:11], s79 offen sc1
  s_cmp_lg_u32 s3, 0
  s_cbranch_scc1 L_w0_298
  s_cmp_ge_u32 s91, 62
  s_cbranch_scc1 L_pfok_300
  s_add_u32 s7, s91, 1
  s_add_u32 s71, s7, 1
  s_lshr_b32 s7, s7, 1
  s_lshr_b32 s71, s71, 1
L_pf_299:
  s_sub_u32 s59, s59, 1
  s_cbranch_scc1 L_end
  v_readlane_b32 s5, v153, 1
  v_readlane_b32 s6, v153, 2
  s_cmp_gt_u32 s5, s71
  s_cselect_b32 s6, s6, 0
  s_cmp_gt_u32 s6, s7
  s_cbranch_scc1 L_pfok_300
  buffer_load_dword v153, v159, s[8:11], s90 offen sc1
  s_waitcnt vmcnt(0)
  s_branch L_pf_299
L_pfok_300:
L_w0_298:
  v_mov_b32 v20, 0
  v_mov_b32 v21, 0
  v_mov_b32 v22, 0
  v_mov_b32 v23, 0
  v_mov_b32 v24, 0
  v_mov_b32 v25, 0
  v_mov_b32 v26, 0
  v_mov_b32 v27, 0
  v_mov_b32 v28, 0
  v_mov_b32 v29, 0
  v_mov_b32 v30, 0
  v_mov_b32 v31, 0
  v_mov_b32 v32, 0
  v_mov_b32 v33, 0
  v_mov_b32 v34, 0
  v_mov_b32 v35, 0
  v_mov_b32 v36, 0
  v_mov_b32 v37, 0
  v_mov_b32 v38, 0
  v_mov_b32 v39, 0
  v_mov_b32 v40, 0
  v_mov_b32 v41, 0
  v_mov_b32 v42, 0
  v_mov_b32 v43, 0
  buffer_load_dwordx4 v[92:95], v140, s[8:11], s77 offen sc1
  buffer_load_dwordx4 v[96:99], v154, s[8:11], s77 offen sc1
L_pl_295:
  s_sub_u32 s59, s59, 1
  s_cbranch_scc1 L_end
  s_waitcnt vmcnt(0)
  v_bitop3_b32 v90, v92, v94, v96 bitop3:0x80
  v_bitop3_b32 v90, v90, v98, v98 bitop3:0x80
  v_and_b32 v90, 1, v90
  v_cmp_ne_u32 vcc, 1, v90
  s_cbranch_vccz L_pd_297
  buffer_load_dwordx4 v[92:95], v140, s[8:11], s77 offen sc1
  buffer_load_dwordx4 v[96:99], v154, s[8:11], s77 offen sc1
  s_branch L_pl_295
L_pd_297:
  v_fma_f32 v100, v155, v96, v92
  v_fma_f32 v101, v155, v97, v93
  v_fma_f32 v102, v155, v98, v94
  v_fma_f32 v103, v155, v99, v95
L_pj_296:
  buffer_load_dwordx4 v[68:71], v142, s[8:11], s79 offen offset:0 sc1
  v_permlane32_swap_b32 v100, v102
  v_permlane32_swap_b32 v101, v103
  v_add_f32 v100, v100, v102
  v_add_f32 v101, v101, v103
  v_max_f32 v128, v100, v101
  buffer_load_dwordx4 v[76:79], v142, s[8:11], s79 offen offset:512 sc1
  s_nop 0
  v_max_f32_dpp v128, v128, v128 row_ror:1 row_mask:0xf bank_mask:0xf
  buffer_load_dwordx4 v[84:87], v142, s[8:11], s79 offen offset:1024 sc1
  s_nop 0
  v_max_f32_dpp v128, v128, v128 row_ror:2 row_mask:0xf bank_mask:0xf
  s_nop 1
  v_max_f32_dpp v128, v128, v128 row_ror:4 row_mask:0xf bank_mask:0xf
  s_nop 1
  v_max_f32_dpp v128, v128, v128 row_ror:8 row_mask:0xf bank_mask:0xf
  v_mov_b32 v129, v128
  s_nop 1
  v_permlane32_swap_b32 v128, v129
  v_max_f32 v128, v128, v129
  v_sub_f32 v100, v100, v128
  v_sub_f32 v101, v101, v128
  v_mul_f32 v100, s93, v100
  v_mul_f32 v101, s93, v101
  v_exp_f32 v100, v100
  v_exp_f32 v101, v101
  s_nop 0
  v_cvt_pk_bf16_f32 v128, v100, v101
  ds_write_b32 v156, v128
  s_waitcnt lgkmcnt(0)
  s_barrier
  ds_read_b128 v[124:127], v91
L_hv2_302:
  s_waitcnt vmcnt(0)
  v_bitop3_b32 v128, v68, v70, v76 bitop3:0x80
  v_bitop3_b32 v128, v128, v78, v84 bitop3:0x80
  v_bitop3_b32 v128, v128, v86, v86 bitop3:0x80
  v_and_b32 v128, 1, v128
  v_cmp_ne_u32 vcc, 1, v128
  s_cbranch_vccnz L_hv_301
  s_waitcnt lgkmcnt(0)
  v_smfmac_f32_16x16x64_bf16 v[12:15], v[124:127], v[64:71], v132
  v_smfmac_f32_16x16x64_bf16 v[16:19], v[124:127], v[72:79], v132
  v_smfmac_f32_16x16x64_bf16 v[20:23], v[124:127], v[80:87], v132
  v_smfmac_f32_16x16x64_bf16 v[24:27], v[124:127], a[240:247], v132
  s_nop 4
  v_add_f32 v12, v12, v14
  v_add_f32 v13, v13, v15
  v_cvt_pk_bf16_f32 v128, v12, v13
  ds_write_b32 v137, v128
  v_add_f32 v16, v16, v18
  v_add_f32 v17, v17, v19
  v_cvt_pk_bf16_f32 v129, v16, v17
  ds_write_b32 v147, v129
  v_add_f32 v20, v20, v22
  v_add_f32 v21, v21, v23
  v_cvt_pk_bf16_f32 v130, v20, v21
  ds_write_b32 v138, v130
  v_add_f32 v24, v24, v26
  v_add_f32 v25, v25, v27
  v_rcp_f32 v12, v24
  v_rcp_f32 v13, v25
  s_waitcnt lgkmcnt(0)
  s_barrier
  ds_read_b64_tr_b16 v[0:1], v133 offset:12288
  ds_read_b64_tr_b16 v[2:3], v134 offset:12288
  ds_read_b64_tr_b16 v[4:5], v133 offset:13312
  ds_read_b64_tr_b16 v[6:7], v134 offset:13312
  ds_read_b64_tr_b16 v[8:9], v133 offset:14336
  ds_read_b64_tr_b16 v[10:11], v134 offset:14336
  s_add_u32 s5, s88, 6291456
  buffer_store_dword v152, v143, s[8:11], s5 offen sc1
  s_cmp_lg_u32 s3, 3
  s_cbranch_scc1 L_km_303
  s_sub_u32 s5, s88, 0
  buffer_store_dwordx4 v[52:55], v139, s[8:11], s5 offen sc1
  buffer_store_dwordx4 v[56:59], v139, s[8:11], s5 offen offset:512 sc1
L_km_303:
  s_waitcnt lgkmcnt(4)
  v_smfmac_f32_16x16x64_bf16 v[28:31], v[0:3], v[160:167], v132
  v_smfmac_f32_16x16x64_bf16 v[32:35], v[0:3], v[184:191], v132
  s_waitcnt lgkmcnt(2)
  v_smfmac_f32_16x16x64_bf16 v[28:31], v[4:7], v[168:175], v132
  v_smfmac_f32_16x16x64_bf16 v[32:35], v[4:7], v[192:199], v132
  s_waitcnt lgkmcnt(0)
  v_smfmac_f32_16x16x64_bf16 v[28:31], v[8:11], v[176:183], v132
  v_smfmac_f32_16x16x64_bf16 v[32:35], v[8:11], v[200:207], v132
  v_smfmac_f32_16x16x64_bf16 v[36:39], v[0:3], v[208:215], v132
  v_smfmac_f32_16x16x64_bf16 v[40:43], v[0:3], v[232:239], v132
  v_smfmac_f32_16x16x64_bf16 v[36:39], v[4:7], v[216:223], v132
  v_smfmac_f32_16x16x64_bf16 v[40:43], v[4:7], v[240:247], v132
  v_smfmac_f32_16x16x64_bf16 v[36:39], v[8:11], v[224:231], v132
  s_nop 1
  v_add_f32 v28, v28, v30
  v_add_f32 v29, v29, v31
  v_smfmac_f32_16x16x64_bf16 v[40:43], v[8:11], v[248:255], v132
  v_mul_f32 v28, v28, v12
  v_mul_f32 v29, v29, v13
  v_cvt_pk_bf16_f32 v128, v28, v29
  v_or_b32 v128, 1, v128
  v_add_f32 v32, v32, v34
  v_add_f32 v33, v33, v35
  v_mul_f32 v32, v32, v12
  v_mul_f32 v33, v33, v13
  v_cvt_pk_bf16_f32 v129, v32, v33
  buffer_store_dwordx2 v[128:129], v146, s[8:11], s81 offen sc1
  v_add_f32 v36, v36, v38
  v_add_f32 v37, v37, v39
  v_mul_f32 v36, v36, v12
  v_mul_f32 v37, v37, v13
  v_cvt_pk_bf16_f32 v130, v36, v37
  v_or_b32 v130, 1, v130
  v_add_f32 v40, v40, v42
  v_add_f32 v41, v41, v43
  v_mul_f32 v40, v40, v12
  v_mul_f32 v41, v41, v13
  v_cvt_pk_bf16_f32 v131, v40, v41
  buffer_store_dwordx2 v[130:131], v146, s[8:11], s67 offen sc1
  buffer_store_dwordx2 v[128:129], v146, s[8:11], s33 offen sc1
  buffer_store_dwordx2 v[130:131], v146, s[8:11], s35 offen sc1
  s_cmp_eq_u32 s92, 0
  s_cbranch_scc1 L_nr_304
  v_mov_b32 v124, 0
  v_mov_b32 v125, 0
  v_mov_b32 v126, 0
  v_mov_b32 v127, 0
  s_add_u32 s91, s91, 1
  s_add_u32 s88, s88, 98304
  s_add_u32 s89, s89, 393216
  v_mov_b32 v40, 0
  v_mov_b32 v41, 0
  v_mov_b32 v42, 0
  v_mov_b32 v43, 0
  v_mov_b32 v44, 0
  v_mov_b32 v45, 0
  v_mov_b32 v46, 0
  v_mov_b32 v47, 0
  v_mov_b32 v48, 0
  v_mov_b32 v49, 0
  v_mov_b32 v50, 0
  v_mov_b32 v51, 0
  s_mul_i32 s72, s3, 3072
  s_add_u32 s72, s72, s89
  s_add_u32 s72, s72, 48758784
  s_lshl_b32 s73, s62, 12
  s_add_u32 s73, s73, s89
  s_add_u32 s73, s73, 23986176
  s_add_u32 s40, s83, 0
  s_cmp_eq_u32 s63, 0
  s_cselect_b32 s40, s37, s40
  s_add_u32 s41, s83, 4096
  s_cmp_eq_u32 s63, 1
  s_cselect_b32 s41, s37, s41
  s_add_u32 s42, s83, 16384
  s_cmp_eq_u32 s63, 2
  s_cselect_b32 s42, s37, s42
  s_add_u32 s43, s83, 20480
  s_cmp_eq_u32 s63, 3
  s_cselect_b32 s43, s37, s43
  v_mov_b32 v100, s91
  v_mov_b32 v101, 17408
  buffer_load_dwordx4 v[0:3], v148, s[8:11], s40 offen offset:0 sc1
  buffer_load_dwordx4 v[4:7], v148, s[8:11], s40 offen offset:2048 sc1
  buffer_load_dwordx4 v[8:11], v148, s[8:11], s41 offen offset:0 sc1
  buffer_load_dwordx4 v[12:15], v148, s[8:11], s41 offen offset:2048 sc1
  buffer_load_dwordx4 v[16:19], v148, s[8:11], s42 offen offset:0 sc1
  buffer_load_dwordx4 v[20:23], v148, s[8:11], s42 offen offset:2048 sc1
  buffer_load_dwordx4 v[24:27], v148, s[8:11], s43 offen offset:0 sc1
  buffer_load_dwordx4 v[28:31], v148, s[8:11], s43 offen offset:2048 sc1
L_xc_310:
  s_waitcnt vmcnt(6)
  v_bitop3_b32 v90, v0, v2, v4 bitop3:0x80
  v_bitop3_b32 v90, v90, v6, v6 bitop3:0x80
  v_and_b32 v90, 1, v90
  v_cmp_ne_u32 vcc, 1, v90
  s_cbranch_vccnz L_xp_309
  v_smfmac_f32_16x16x64_bf16 v[124:127], a[248:251], v[0:7], v132
L_xc_312:
  s_waitcnt vmcnt(4)
  v_bitop3_b32 v90, v8, v10, v12 bitop3:0x80
  v_bitop3_b32 v90, v90, v14, v14 bitop3:0x80
  v_and_b32 v90, 1, v90
  v_cmp_ne_u32 vcc, 1, v90
  s_cbranch_vccnz L_xp_311
  v_smfmac_f32_16x16x64_bf16 v[124:127], a[248:251], v[8:15], v132
L_xc_314:
  s_waitcnt vmcnt(2)
  v_bitop3_b32 v90, v16, v18, v20 bitop3:0x80
  v_bitop3_b32 v90, v90, v22, v22 bitop3:0x80
  v_and_b32 v90, 1, v90
  v_cmp_ne_u32 vcc, 1, v90
  s_cbranch_vccnz L_xp_313
  v_smfmac_f32_16x16x64_bf16 v[124:127], a[248:251], v[16:23], v132
L_xc_316:
  s_waitcnt vmcnt(0)
  v_bitop3_b32 v90, v24, v26, v28 bitop3:0x80
  v_bitop3_b32 v90, v90, v30, v30 bitop3:0x80
  v_and_b32 v90, 1, v90
  v_cmp_ne_u32 vcc, 1, v90
  s_cbranch_vccnz L_xp_315
  v_smfmac_f32_16x16x64_bf16 v[124:127], a[248:251], v[24:31], v132
  ds_write_b32 v101, v100
  s_nop 6
  v_cvt_pk_bf16_f32 v128, v124, v125
  v_cvt_pk_bf16_f32 v129, v126, v127
  v_or_b32 v128, 1, v128
  buffer_store_dwordx2 v[128:129], v150, s[8:11], s85 offen sc1
  s_branch L_go_308
L_nr_304:
  s_add_u32 s91, s91, 1
  s_add_u32 s88, s88, 98304
  s_add_u32 s89, s89, 393216
  v_mov_b32 v40, 0
  v_mov_b32 v41, 0
  v_mov_b32 v42, 0
  v_mov_b32 v43, 0
  v_mov_b32 v44, 0
  v_mov_b32 v45, 0
  v_mov_b32 v46, 0
  v_mov_b32 v47, 0
  v_mov_b32 v48, 0
  v_mov_b32 v49, 0
  v_mov_b32 v50, 0
  v_mov_b32 v51, 0
  s_mul_i32 s72, s3, 3072
  s_add_u32 s72, s72, s89
  s_add_u32 s72, s72, 48758784
  s_lshl_b32 s73, s62, 12
  s_add_u32 s73, s73, s89
  s_add_u32 s73, s73, 23986176
  v_mov_b32 v101, 17408
L_lf_318:
  s_sub_u32 s59, s59, 1
  s_cbranch_scc1 L_end
  ds_read_b32 v100, v101
  s_waitcnt lgkmcnt(0)
  v_cmp_ne_u32 vcc, s91, v100
  s_cbranch_vccnz L_lf_318
L_go_308:
  s_cmp_ge_u32 s3, 2
  s_cbranch_scc1 L_g2_319
  buffer_load_dwordx4 v[92:95], v151, s[8:11], s87 offen offset:0 sc1
  buffer_load_dwordx4 v[96:99], v151, s[8:11], s87 offen offset:1024 sc1
  buffer_load_dwordx4 v[100:103], v157, s[8:11], s87 offen offset:0 sc1
L_gc_322:
  s_waitcnt vmcnt(2)
  v_bitop3_b32 v90, v92, v94, 1 bitop3:0x80
  v_cmp_ne_u32 vcc, 1, v90
  s_cbranch_vccnz L_gp_321
  ds_write_b128 v151, v[92:95] offset:0
L_gc_324:
  s_waitcnt vmcnt(1)
  v_bitop3_b32 v90, v96, v98, 1 bitop3:0x80
  v_cmp_ne_u32 vcc, 1, v90
  s_cbranch_vccnz L_gp_323
  ds_write_b128 v151, v[96:99] offset:1024
L_gc_326:
  s_waitcnt vmcnt(0)
  v_bitop3_b32 v90, v100, v102, 1 bitop3:0x80
  v_cmp_ne_u32 vcc, 1, v90
  s_cbranch_vccnz L_gp_325
  ds_write_b128 v157, v[100:103] offset:0
  s_branch L_g3_320
L_g2_319:
  buffer_load_dwordx4 v[92:95], v151, s[8:11], s87 offen offset:0 sc1
  buffer_load_dwordx4 v[96:99], v151, s[8:11], s87 offen offset:1024 sc1
L_gc_329:
  s_waitcnt vmcnt(1)
  v_bitop3_b32 v90, v92, v94, 1 bitop3:0x80
  v_cmp_ne_u32 vcc, 1, v90
  s_cbranch_vccnz L_gp_328
  ds_write_b128 v151, v[92:95] offset:0
L_gc_331:
  s_waitcnt vmcnt(0)
  v_bitop3_b32 v90, v96, v98, 1 bitop3:0x80
  v_cmp_ne_u32 vcc, 1, v90
  s_cbranch_vccnz L_gp_330
  ds_write_b128 v151, v[96:99] offset:1024
L_g3_320:
  s_waitcnt lgkmcnt(0)
  s_barrier
  ds_read_b64_tr_b16 v[0:1], v133 offset:0
  ds_read_b64_tr_b16 v[2:3], v134 offset:0
  ds_read_b64_tr_b16 v[4:5], v133 offset:1024
  ds_read_b64_tr_b16 v[6:7], v134 offset:1024
  ds_read_b64_tr_b16 v[8:9], v133 offset:2048
  ds_read_b64_tr_b16 v[10:11], v134 offset:2048
  ds_read_b64_tr_b16 v[12:13], v133 offset:3072
  ds_read_b64_tr_b16 v[14:15], v134 offset:3072
  ds_read_b64_tr_b16 v[16:17], v133 offset:4096
  ds_read_b64_tr_b16 v[18:19], v134 offset:4096
  ds_read_b64_tr_b16 v[20:21], v133 offset:5120
  ds_read_b64_tr_b16 v[22:23], v134 offset:5120
  s_cmp_ge_u32 s3, 2
  s_cbranch_scc1 L_s1a_336
  ds_read_b64_tr_b16 v[24:25], v133 offset:6144
  ds_read_b64_tr_b16 v[26:27], v134 offset:6144
  s_waitcnt lgkmcnt(12)
  v_smfmac_f32_16x16x64_bf16 v[40:43], v[0:3], a[0:7], v132
  v_smfmac_f32_16x16x64_bf16 v[44:47], v[0:3], a[80:87], v132
  buffer_load_dwordx4 v[64:67], v144, s[8:11], s72 offen offset:0 sc1
  ds_read_b64_tr_b16 v[28:29], v133 offset:7168
  ds_read_b64_tr_b16 v[30:31], v134 offset:7168
  s_waitcnt lgkmcnt(12)
  v_smfmac_f32_16x16x64_bf16 v[40:43], v[4:7], a[8:15], v132
  v_smfmac_f32_16x16x64_bf16 v[44:47], v[4:7], a[88:95], v132
  buffer_load_dwordx4 v[72:75], v144, s[8:11], s72 offen offset:1024 sc1
  ds_read_b64_tr_b16 v[32:33], v133 offset:8192
  ds_read_b64_tr_b16 v[34:35], v134 offset:8192
  s_waitcnt lgkmcnt(12)
  v_smfmac_f32_16x16x64_bf16 v[40:43], v[8:11], a[16:23], v132
  v_smfmac_f32_16x16x64_bf16 v[44:47], v[8:11], a[96:103], v132
  buffer_load_dwordx4 v[80:83], v144, s[8:11], s72 offen offset:2048 sc1
  ds_read_b64_tr_b16 v[36:37], v133 offset:9216
  ds_read_b64_tr_b16 v[38:39], v134 offset:9216
  s_waitcnt lgkmcnt(12)
  v_smfmac_f32_16x16x64_bf16 v[40:43], v[12:15], a[24:31], v132
  v_smfmac_f32_16x16x64_bf16 v[44:47], v[12:15], a[104:111], v132
  buffer_load_dwordx2 v[112:113], v145, s[8:11], s73 offen offset:0 sc1
  s_waitcnt lgkmcnt(10)
  v_smfmac_f32_16x16x64_bf16 v[40:43], v[16:19], a[32:39], v132
  v_smfmac_f32_16x16x64_bf16 v[44:47], v[16:19], a[112:119], v132
  buffer_load_dwordx2 v[114:115], v145, s[8:11], s73 offen offset:1024 sc1
  s_waitcnt lgkmcnt(8)
  v_smfmac_f32_16x16x64_bf16 v[40:43], v[20:23], a[40:47], v132
  v_smfmac_f32_16x16x64_bf16 v[44:47], v[20:23], a[120:127], v132
  buffer_load_dwordx2 v[116:117], v145, s[8:11], s73 offen offset:2048 sc1
  s_waitcnt lgkmcnt(6)
  v_smfmac_f32_16x16x64_bf16 v[40:43], v[24:27], a[48:55], v132
  v_smfmac_f32_16x16x64_bf16 v[44:47], v[24:27], a[128:135], v132
  buffer_load_dwordx2 v[118:119], v145, s[8:11], s73 offen offset:3072 sc1
  s_waitcnt lgkmcnt(4)
  v_smfmac_f32_16x16x64_bf16 v[40:43], v[28:31], a[56:63], v132
  v_smfmac_f32_16x16x64_bf16 v[44:47], v[28:31], a[136:143], v132
  buffer_load_dword v153, v159, s[8:11], s90 offen sc1
  s_waitcnt lgkmcnt(2)
  v_smfmac_f32_16x16x64_bf16 v[40:43], v[32:35], a[64:71], v132
  v_smfmac_f32_16x16x64_bf16 v[44:47], v[32:35], a[144:151], v132
  s_waitcnt lgkmcnt(0)
  v_smfmac_f32_16x16x64_bf16 v[40:43], v[36:39], a[72:79], v132
  v_smfmac_f32_16x16x64_bf16 v[44:47], v[36:39], a[152:159], v132
  s_branch L_s1b_337
L_s1a_336:
  ds_read_b64_tr_b16 v[24:25], v133 offset:6144
  ds_read_b64_tr_b16 v[26:27], v134 offset:6144
  s_waitcnt lgkmcnt(12)
  v_smfmac_f32_16x16x64_bf16 v[40:43], v[0:3], a[0:7], v132
  v_smfmac_f32_16x16x64_bf16 v[44:47], v[0:3], a[80:87], v132
  buffer_load_dwordx4 v[64:67], v144, s[8:11], s72 offen offset:0 sc1
  ds_read_b64_tr_b16 v[28:29], v133 offset:7168
  ds_read_b64_tr_b16 v[30:31], v134 offset:7168
  s_waitcnt lgkmcnt(12)
  v_smfmac_f32_16x16x64_bf16 v[40:43], v[4:7], a[8:15], v132
  v_smfmac_f32_16x16x64_bf16 v[44:47], v[4:7], a[88:95], v132
  buffer_load_dwordx4 v[72:75], v144, s[8:11], s72 offen offset:1024 sc1
  ds_read_b64_tr_b16 v[32:33], v133 offset:8192
  ds_read_b64_tr_b16 v[34:35], v134 offset:8192
  s_waitcnt lgkmcnt(12)
  v_smfmac_f32_16x16x64_bf16 v[40:43], v[8:11], a[16:23], v132
  v_smfmac_f32_16x16x64_bf16 v[44:47], v[8:11], a[96:103], v132
  buffer_load_dwordx4 v[80:83], v144, s[8:11], s72 offen offset:2048 sc1
  ds_read_b64_tr_b16 v[36:37], v133 offset:9216
  ds_read_b64_tr_b16 v[38:39], v134 offset:9216
  s_waitcnt lgkmcnt(12)
  v_smfmac_f32_16x16x64_bf16 v[40:43], v[12:15], a[24:31], v132
  v_smfmac_f32_16x16x64_bf16 v[44:47], v[12:15], a[104:111], v132
  s_waitcnt lgkmcnt(10)
  v_smfmac_f32_16x16x64_bf16 v[40:43], v[16:19], a[32:39], v132
  v_smfmac_f32_16x16x64_bf16 v[44:47], v[16:19], a[112:119], v132
  s_waitcnt lgkmcnt(8)
  v_smfmac_f32_16x16x64_bf16 v[40:43], v[20:23], a[40:47], v132
  v_smfmac_f32_16x16x64_bf16 v[44:47], v[20:23], a[120:127], v132
  s_waitcnt lgkmcnt(6)
  v_smfmac_f32_16x16x64_bf16 v[40:43], v[24:27], a[48:55], v132
  v_smfmac_f32_16x16x64_bf16 v[44:47], v[24:27], a[128:135], v132
  s_waitcnt lgkmcnt(4)
  v_smfmac_f32_16x16x64_bf16 v[40:43], v[28:31], a[56:63], v132
  v_smfmac_f32_16x16x64_bf16 v[44:47], v[28:31], a[136:143], v132
  s_waitcnt lgkmcnt(2)
  v_smfmac_f32_16x16x64_bf16 v[40:43], v[32:35], a[64:71], v132
  v_smfmac_f32_16x16x64_bf16 v[44:47], v[32:35], a[144:151], v132
  s_waitcnt lgkmcnt(0)
  v_smfmac_f32_16x16x64_bf16 v[40:43], v[36:39], a[72:79], v132
  v_smfmac_f32_16x16x64_bf16 v[44:47], v[36:39], a[152:159], v132
L_s1b_337:
  v_smfmac_f32_16x16x64_bf16 v[48:51], v[0:3], a[160:167], v132
  s_mul_i32 s5, s62, 1280
  s_add_u32 s5, s5, s76
  s_nop 3
  v_add_f32 v40, v40, v42
  v_add_f32 v41, v41, v43
  v_add_f32 v44, v44, v46
  v_add_f32 v45, v45, v47
  v_cvt_pk_bf16_f32 v128, v40, v41
  v_cvt_pk_bf16_f32 v129, v44, v45
  ds_write_b64 v135, v[128:129]
  v_smfmac_f32_16x16x64_bf16 v[48:51], v[4:7], a[168:175], v132
  v_smfmac_f32_16x16x64_bf16 v[48:51], v[8:11], a[176:183], v132
  v_smfmac_f32_16x16x64_bf16 v[48:51], v[12:15], a[184:191], v132
  s_waitcnt lgkmcnt(0)
  s_barrier
  ds_read_b64_tr_b16 v[52:53], v136 offset:0
  ds_read_b64_tr_b16 v[54:55], v136 offset:512
  ds_read_b64_tr_b16 v[56:57], v136 offset:1024
  ds_read_b64_tr_b16 v[58:59], v136 offset:1536
  v_smfmac_f32_16x16x64_bf16 v[48:51], v[16:19], a[192:199], v132
  v_smfmac_f32_16x16x64_bf16 v[48:51], v[20:23], a[200:207], v132
  v_smfmac_f32_16x16x64_bf16 v[48:51], v[24:27], a[208:215], v132
  v_smfmac_f32_16x16x64_bf16 v[48:51], v[28:31], a[216:223], v132
  s_cmp_ge_u32 s3, 2
  s_cbranch_scc1 L_s0_338
  s_waitcnt lgkmcnt(2)
  v_mfma_f32_16x16x32_bf16 v[100:103], v[104:107], v[52:55], 0
  s_waitcnt lgkmcnt(0)
  v_mfma_f32_16x16x32_bf16 v[100:103], v[108:111], v[56:59], v[100:103]
  v_smfmac_f32_16x16x64_bf16 v[48:51], v[32:35], a[224:231], v132
  s_nop 6
  v_and_b32 v100, -2, v100
  v_and_b32 v102, -2, v102
  buffer_store_dwordx4 v[100:103], v139, s[8:11], s5 offen sc1
  s_branch L_sj_339
L_s0_338:
  s_waitcnt lgkmcnt(2)
  v_mfma_f32_16x16x32_bf16 v[100:103], v[52:55], v[52:55], 0
  s_waitcnt lgkmcnt(0)
  v_mfma_f32_16x16x32_bf16 v[100:103], v[56:59], v[56:59], v[100:103]
  v_smfmac_f32_16x16x64_bf16 v[48:51], v[32:35], a[224:231], v132
  s_cmp_eq_u32 s3, 3
  s_cbranch_scc1 L_s3_340
  s_nop 4
  v_and_b32 v102, -2, v102
  buffer_store_dwordx2 v[102:103], v139, s[8:11], s5 offen sc1
L_sj_339:
  v_smfmac_f32_16x16x64_bf16 v[48:51], v[36:39], a[232:239], v132
  v_mov_b32 v12, 0
  v_mov_b32 v13, 0
  v_mov_b32 v14, 0
  v_mov_b32 v15, 0
  v_mov_b32 v16, 0
  v_mov_b32 v17, 0
  v_mov_b32 v18, 0
  v_mov_b32 v19, 0
  v_add_f32 v48, v48, v50
  v_add_f32 v49, v49, v51
  v_cvt_pk_bf16_f32 v152, v48, v49
  v_and_b32 v128, -2, v152
  buffer_store_dword v128, v141, s[8:11], s78 offen sc1
  s_cmp_lg_u32 s3, 0
  s_cbranch_scc1 L_w0_344
  s_cmp_ge_u32 s91, 62
  s_cbranch_scc1 L_pfok_346
  s_add_u32 s7, s91, 1
  s_add_u32 s71, s7, 1
  s_lshr_b32 s7, s7, 1
  s_lshr_b32 s71, s71, 1
L_pf_345:
  s_sub_u32 s59, s59, 1
  s_cbranch_scc1 L_end
  v_readlane_b32 s5, v153, 0
  v_readlane_b32 s6, v153, 3
  s_cmp_gt_u32 s5, s71
  s_cselect_b32 s6, s6, 0
  s_cmp_gt_u32 s6, s7
  s_cbranch_scc1 L_pfok_346
  buffer_load_dword v153, v159, s[8:11], s90 offen sc1
  s_waitcnt vmcnt(0)
  s_branch L_pf_345
L_pfok_346:
L_w0_344:
  v_mov_b32 v20, 0
  v_mov_b32 v21, 0
  v_mov_b32 v22, 0
  v_mov_b32 v23, 0
  v_mov_b32 v24, 0
  v_mov_b32 v25, 0
  v_mov_b32 v26, 0
  v_mov_b32 v27, 0
  v_mov_b32 v28, 0
  v_mov_b32 v29, 0
  v_mov_b32 v30, 0
  v_mov_b32 v31, 0
  v_mov_b32 v32, 0
  v_mov_b32 v33, 0
  v_mov_b32 v34, 0
  v_mov_b32 v35, 0
  v_mov_b32 v36, 0
  v_mov_b32 v37, 0
  v_mov_b32 v38, 0
  v_mov_b32 v39, 0
  v_mov_b32 v40, 0
  v_mov_b32 v41, 0
  v_mov_b32 v42, 0
  v_mov_b32 v43, 0
  buffer_load_dwordx4 v[92:95], v140, s[8:11], s76 offen sc1
  buffer_load_dwordx4 v[96:99], v154, s[8:11], s76 offen sc1
L_pl_341:
  s_sub_u32 s59, s59, 1
  s_cbranch_scc1 L_end
  s_waitcnt vmcnt(0)
  v_bitop3_b32 v90, v92, v94, v96 bitop3:0xfe
  v_bitop3_b32 v90, v90, v98, v98 bitop3:0xfe
  v_and_b32 v90, 1, v90
  v_cmp_ne_u32 vcc, 0, v90
  s_cbranch_vccz L_pd_343
  buffer_load_dwordx4 v[92:95], v140, s[8:11], s76 offen sc1
  buffer_load_dwordx4 v[96:99], v154, s[8:11], s76 offen sc1
  s_branch L_pl_341
L_pd_343:
  v_fma_f32 v100, v155, v96, v92
  v_fma_f32 v101, v155, v97, v93
  v_fma_f32 v102, v155, v98, v94
  v_fma_f32 v103, v155, v99, v95
L_pj_342:
  buffer_load_dwordx4 v[68:71], v142, s[8:11], s78 offen offset:0 sc1
  v_permlane32_swap_b32 v100, v102
  v_permlane32_swap_b32 v101, v103
  v_add_f32 v100, v100, v102
  v_add_f32 v101, v101, v103
  v_max_f32 v128, v100, v101
  buffer_load_dwordx4 v[76:79], v142, s[8:11], s78 offen offset:512 sc1
  s_nop 0
  v_max_f32_dpp v128, v128, v128 row_ror:1 row_mask:0xf bank_mask:0xf
  buffer_load_dwordx4 v[84:87], v142, s[8:11], s78 offen offset:1024 sc1
  s_nop 0
  v_max_f32_dpp v128, v128, v128 row_ror:2 row_mask:0xf bank_mask:0xf
  s_nop 1
  v_max_f32_dpp v128, v128, v128 row_ror:4 row_mask:0xf bank_mask:0xf
  s_nop 1
  v_max_f32_dpp v128, v128, v128 row_ror:8 row_mask:0xf bank_mask:0xf
  v_mov_b32 v129, v128
  s_nop 1
  v_permlane32_swap_b32 v128, v129
  v_max_f32 v128, v128, v129
  v_sub_f32 v100, v100, v128
  v_sub_f32 v101, v101, v128
  v_mul_f32 v100, s93, v100
  v_mul_f32 v101, s93, v101
  v_exp_f32 v100, v100
  v_exp_f32 v101, v101
  s_nop 0
  v_cvt_pk_bf16_f32 v128, v100, v101
  ds_write_b32 v156, v128
  s_waitcnt lgkmcnt(0)
  s_barrier
  ds_read_b128 v[124:127], v91
L_hv2_348:
  s_waitcnt vmcnt(0)
  v_bitop3_b32 v128, v68, v70, v76 bitop3:0xfe
  v_bitop3_b32 v128, v128, v78, v84 bitop3:0xfe
  v_bitop3_b32 v128, v128, v86, v86 bitop3:0xfe
  v_and_b32 v128, 1, v128
  v_cmp_ne_u32 vcc, 0, v128
  s_cbranch_vccnz L_hv_347
  s_waitcnt lgkmcnt(0)
  v_smfmac_f32_16x16x64_bf16 v[12:15], v[124:127], v[64:71], v132
  v_smfmac_f32_16x16x64_bf16 v[16:19], v[124:127], v[72:79], v132
  v_smfmac_f32_16x16x64_bf16 v[20:23], v[124:127], v[80:87], v132
  v_smfmac_f32_16x16x64_bf16 v[24:27], v[124:127], a[240:247], v132
  s_nop 4
  v_add_f32 v12, v12, v14
  v_add_f32 v13, v13, v15
  v_cvt_pk_bf16_f32 v128, v12, v13
  ds_write_b32 v137, v128
  v_add_f32 v16, v16, v18
  v_add_f32 v17, v17, v19
  v_cvt_pk_bf16_f32 v129, v16, v17
  ds_write_b32 v147, v129
  v_add_f32 v20, v20, v22
  v_add_f32 v21, v21, v23
  v_cvt_pk_bf16_f32 v130, v20, v21
  ds_write_b32 v138, v130
  v_add_f32 v24, v24, v26
  v_add_f32 v25, v25, v27
  v_rcp_f32 v12, v24
  v_rcp_f32 v13, v25
  s_waitcnt lgkmcnt(0)
  s_barrier
  ds_read_b64_tr_b16 v[0:1], v133 offset:12288
  ds_read_b64_tr_b16 v[2:3], v134 offset:12288
  ds_read_b64_tr_b16 v[4:5], v133 offset:13312
  ds_read_b64_tr_b16 v[6:7], v134 offset:13312
  ds_read_b64_tr_b16 v[8:9], v133 offset:14336
  ds_read_b64_tr_b16 v[10:11], v134 offset:14336
  s_add_u32 s5, s88, 6291456
  buffer_store_dword v152, v143, s[8:11], s5 offen sc1
  s_cmp_lg_u32 s3, 3
  s_cbranch_scc1 L_km_349
  s_sub_u32 s5, s88, 0
  buffer_store_dwordx4 v[52:55], v139, s[8:11], s5 offen sc1
  buffer_store_dwordx4 v[56:59], v139, s[8:11], s5 offen offset:512 sc1
L_km_349:
  s_waitcnt lgkmcnt(4)
  v_smfmac_f32_16x16x64_bf16 v[28:31], v[0:3], v[160:167], v132
  v_smfmac_f32_16x16x64_bf16 v[32:35], v[0:3], v[184:191], v132
  s_waitcnt lgkmcnt(2)
  v_smfmac_f32_16x16x64_bf16 v[28:31], v[4:7], v[168:175], v132
  v_smfmac_f32_16x16x64_bf16 v[32:35], v[4:7], v[192:199], v132
  s_waitcnt lgkmcnt(0)
  v_smfmac_f32_16x16x64_bf16 v[28:31], v[8:11], v[176:183], v132
  v_smfmac_f32_16x16x64_bf16 v[32:35], v[8:11], v[200:207], v132
  v_smfmac_f32_16x16x64_bf16 v[36:39], v[0:3], v[208:215], v132
  v_smfmac_f32_16x16x64_bf16 v[40:43], v[0:3], v[232:239], v132
  v_smfmac_f32_16x16x64_bf16 v[36:39], v[4:7], v[216:223], v132
  v_smfmac_f32_16x16x64_bf16 v[40:43], v[4:7], v[240:247], v132
  v_smfmac_f32_16x16x64_bf16 v[36:39], v[8:11], v[224:231], v132
  s_nop 1
  v_add_f32 v28, v28, v30
  v_add_f32 v29, v29, v31
  v_smfmac_f32_16x16x64_bf16 v[40:43], v[8:11], v[248:255], v132
  v_mul_f32 v28, v28, v12
  v_mul_f32 v29, v29, v13
  v_cvt_pk_bf16_f32 v128, v28, v29
  v_and_b32 v128, -2, v128
  v_add_f32 v32, v32, v34
  v_add_f32 v33, v33, v35
  v_mul_f32 v32, v32, v12
  v_mul_f32 v33, v33, v13
  v_cvt_pk_bf16_f32 v129, v32, v33
  buffer_store_dwordx2 v[128:129], v146, s[8:11], s80 offen sc1
  v_add_f32 v36, v36, v38
  v_add_f32 v37, v37, v39
  v_mul_f32 v36, v36, v12
  v_mul_f32 v37, v37, v13
  v_cvt_pk_bf16_f32 v130, v36, v37
  v_and_b32 v130, -2, v130
  v_add_f32 v40, v40, v42
  v_add_f32 v41, v41, v43
  v_mul_f32 v40, v40, v12
  v_mul_f32 v41, v41, v13
  v_cvt_pk_bf16_f32 v131, v40, v41
  buffer_store_dwordx2 v[130:131], v146, s[8:11], s66 offen sc1
  buffer_store_dwordx2 v[128:129], v146, s[8:11], s32 offen sc1
  buffer_store_dwordx2 v[130:131], v146, s[8:11], s34 offen sc1
  s_cmp_eq_u32 s92, 0
  s_cbranch_scc1 L_nr_350
  v_mov_b32 v124, 0
  v_mov_b32 v125, 0
  v_mov_b32 v126, 0
  v_mov_b32 v127, 0
  s_add_u32 s91, s91, 1
  s_add_u32 s88, s88, 98304
  s_add_u32 s89, s89, 393216
  v_mov_b32 v40, 0
  v_mov_b32 v41, 0
  v_mov_b32 v42, 0
  v_mov_b32 v43, 0
  v_mov_b32 v44, 0
  v_mov_b32 v45, 0
  v_mov_b32 v46, 0
  v_mov_b32 v47, 0
  v_mov_b32 v48, 0
  v_mov_b32 v49, 0
  v_mov_b32 v50, 0
  v_mov_b32 v51, 0
  s_mul_i32 s72, s3, 3072
  s_add_u32 s72, s72, s89
  s_add_u32 s72, s72, 48758784
  s_lshl_b32 s73, s62, 12
  s_add_u32 s73, s73, s89
  s_add_u32 s73, s73, 23986176
  s_add_u32 s40, s82, 0
  s_cmp_eq_u32 s63, 0
  s_cselect_b32 s40, s36, s40
  s_add_u32 s41, s82, 4096
  s_cmp_eq_u32 s63, 1
  s_cselect_b32 s41, s36, s41
  s_add_u32 s42, s82, 16384
  s_cmp_eq_u32 s63, 2
  s_cselect_b32 s42, s36, s42
  s_add_u32 s43, s82, 20480
  s_cmp_eq_u32 s63, 3
  s_cselect_b32 s43, s36, s43
  v_mov_b32 v100, s91
  v_mov_b32 v101, 17408
  buffer_load_dwordx4 v[0:3], v148, s[8:11], s40 offen offset:0 sc1
  buffer_load_dwordx4 v[4:7], v148, s[8:11], s40 offen offset:2048 sc1
  buffer_load_dwordx4 v[8:11], v148, s[8:11], s41 offen offset:0 sc1
  buffer_load_dwordx4 v[12:15], v148, s[8:11], s41 offen offset:2048 sc1
  buffer_load_dwordx4 v[16:19], v148, s[8:11], s42 offen offset:0 sc1
  buffer_load_dwordx4 v[20:23], v148, s[8:11], s42 offen offset:2048 sc1
  buffer_load_dwordx4 v[24:27], v148, s[8:11], s43 offen offset:0 sc1
  buffer_load_dwordx4 v[28:31], v148, s[8:11], s43 offen offset:2048 sc1
L_xc_356:
  s_waitcnt vmcnt(6)
  v_bitop3_b32 v90, v0, v2, v4 bitop3:0xfe
  v_bitop3_b32 v90, v90, v6, v6 bitop3:0xfe
  v_and_b32 v90, 1, v90
  v_cmp_ne_u32 vcc, 0, v90
  s_cbranch_vccnz L_xp_355
  v_smfmac_f32_16x16x64_bf16 v[124:127], a[248:251], v[0:7], v132
L_xc_358:
  s_waitcnt vmcnt(4)
  v_bitop3_b32 v90, v8, v10, v12 bitop3:0xfe
  v_bitop3_b32 v90, v90, v14, v14 bitop3:0xfe
  v_and_b32 v90, 1, v90
  v_cmp_ne_u32 vcc, 0, v90
  s_cbranch_vccnz L_xp_357
  v_smfmac_f32_16x16x64_bf16 v[124:127], a[248:251], v[8:15], v132
L_xc_360:
  s_waitcnt vmcnt(2)
  v_bitop3_b32 v90, v16, v18, v20 bitop3:0xfe
  v_bitop3_b32 v90, v90, v22, v22 bitop3:0xfe
  v_and_b32 v90, 1, v90
  v_cmp_ne_u32 vcc, 0, v90
  s_cbranch_vccnz L_xp_359
  v_smfmac_f32_16x16x64_bf16 v[124:127], a[248:251], v[16:23], v132
L_xc_362:
  s_waitcnt vmcnt(0)
  v_bitop3_b32 v90, v24, v26, v28 bitop3:0xfe
  v_bitop3_b32 v90, v90, v30, v30 bitop3:0xfe
  v_and_b32 v90, 1, v90
  v_cmp_ne_u32 vcc, 0, v90
  s_cbranch_vccnz L_xp_361
  v_smfmac_f32_16x16x64_bf16 v[124:127], a[248:251], v[24:31], v132
  ds_write_b32 v101, v100
  s_nop 6
  v_cvt_pk_bf16_f32 v128, v124, v125
  v_cvt_pk_bf16_f32 v129, v126, v127
  v_and_b32 v128, -2, v128
  buffer_store_dwordx2 v[128:129], v150, s[8:11], s84 offen sc1
  s_branch L_go_354
L_nr_350:
  s_add_u32 s91, s91, 1
  s_add_u32 s88, s88, 98304
  s_add_u32 s89, s89, 393216
  v_mov_b32 v40, 0
  v_mov_b32 v41, 0
  v_mov_b32 v42, 0
  v_mov_b32 v43, 0
  v_mov_b32 v44, 0
  v_mov_b32 v45, 0
  v_mov_b32 v46, 0
  v_mov_b32 v47, 0
  v_mov_b32 v48, 0
  v_mov_b32 v49, 0
  v_mov_b32 v50, 0
  v_mov_b32 v51, 0
  s_mul_i32 s72, s3, 3072
  s_add_u32 s72, s72, s89
  s_add_u32 s72, s72, 48758784
  s_lshl_b32 s73, s62, 12
  s_add_u32 s73, s73, s89
  s_add_u32 s73, s73, 23986176
  v_mov_b32 v101, 17408
L_lf_364:
  s_sub_u32 s59, s59, 1
  s_cbranch_scc1 L_end
  ds_read_b32 v100, v101
  s_waitcnt lgkmcnt(0)
  v_cmp_ne_u32 vcc, s91, v100
  s_cbranch_vccnz L_lf_364
L_go_354:
  s_cmp_ge_u32 s3, 2
  s_cbranch_scc1 L_g2_365
  buffer_load_dwordx4 v[92:95], v151, s[8:11], s86 offen offset:0 sc1
  buffer_load_dwordx4 v[96:99], v151, s[8:11], s86 offen offset:1024 sc1
  buffer_load_dwordx4 v[100:103], v157, s[8:11], s86 offen offset:0 sc1
L_gc_368:
  s_waitcnt vmcnt(2)
  v_bitop3_b32 v90, v92, v94, 1 bitop3:0xa8
  v_cmp_ne_u32 vcc, 0, v90
  s_cbranch_vccnz L_gp_367
  ds_write_b128 v151, v[92:95] offset:0
L_gc_370:
  s_waitcnt vmcnt(1)
  v_bitop3_b32 v90, v96, v98, 1 bitop3:0xa8
  v_cmp_ne_u32 vcc, 0, v90
  s_cbranch_vccnz L_gp_369
  ds_write_b128 v151, v[96:99] offset:1024
L_gc_372:
  s_waitcnt vmcnt(0)
  v_bitop3_b32 v90, v100, v102, 1 bitop3:0xa8
  v_cmp_ne_u32 vcc, 0, v90
  s_cbranch_vccnz L_gp_371
  ds_write_b128 v157, v[100:103] offset:0
  s_branch L_g3_366
L_g2_365:
  buffer_load_dwordx4 v[92:95], v151, s[8:11], s86 offen offset:0 sc1
  buffer_load_dwordx4 v[96:99], v151, s[8:11], s86 offen offset:1024 sc1
L_gc_375:
  s_waitcnt vmcnt(1)
  v_bitop3_b32 v90, v92, v94, 1 bitop3:0xa8
  v_cmp_ne_u32 vcc, 0, v90
  s_cbranch_vccnz L_gp_374
  ds_write_b128 v151, v[92:95] offset:0
L_gc_377:
  s_waitcnt vmcnt(0)
  v_bitop3_b32 v90, v96, v98, 1 bitop3:0xa8
  v_cmp_ne_u32 vcc, 0, v90
  s_cbranch_vccnz L_gp_376
  ds_write_b128 v151, v[96:99] offset:1024
L_g3_366:
  s_waitcnt lgkmcnt(0)
  s_barrier
  s_cmp_eq_u32 s91, 63
  s_cbranch_scc1 L_last
  ds_read_b64_tr_b16 v[0:1], v133 offset:0
  ds_read_b64_tr_b16 v[2:3], v134 offset:0
  ds_read_b64_tr_b16 v[4:5], v133 offset:1024
  ds_read_b64_tr_b16 v[6:7], v134 offset:1024
  ds_read_b64_tr_b16 v[8:9], v133 offset:2048
  ds_read_b64_tr_b16 v[10:11], v134 offset:2048
  ds_read_b64_tr_b16 v[12:13], v133 offset:3072
  ds_read_b64_tr_b16 v[14:15], v134 offset:3072
  ds_read_b64_tr_b16 v[16:17], v133 offset:4096
  ds_read_b64_tr_b16 v[18:19], v134 offset:4096
  ds_read_b64_tr_b16 v[20:21], v133 offset:5120
  ds_read_b64_tr_b16 v[22:23], v134 offset:5120
  s_cmp_ge_u32 s3, 2
  s_cbranch_scc1 L_s1a_382
  ds_read_b64_tr_b16 v[24:25], v133 offset:6144
  ds_read_b64_tr_b16 v[26:27], v134 offset:6144
  s_waitcnt lgkmcnt(12)
  v_smfmac_f32_16x16x64_bf16 v[40:43], v[0:3], a[0:7], v132
  v_smfmac_f32_16x16x64_bf16 v[44:47], v[0:3], a[80:87], v132
  buffer_load_dwordx4 v[64:67], v144, s[8:11], s72 offen offset:0 sc1
  ds_read_b64_tr_b16 v[28:29], v133 offset:7168
  ds_read_b64_tr_b16 v[30:31], v134 offset:7168
  s_waitcnt lgkmcnt(12)
  v_smfmac_f32_16x16x64_bf16 v[40:43], v[4:7], a[8:15], v132
  v_smfmac_f32_16x16x64_bf16 v[44:47], v[4:7], a[88:95], v132
  buffer_load_dwordx4 v[72:75], v144, s[8:11], s72 offen offset:1024 sc1
  ds_read_b64_tr_b16 v[32:33], v133 offset:8192
  ds_read_b64_tr_b16 v[34:35], v134 offset:8192
  s_waitcnt lgkmcnt(12)
  v_smfmac_f32_16x16x64_bf16 v[40:43], v[8:11], a[16:23], v132
  v_smfmac_f32_16x16x64_bf16 v[44:47], v[8:11], a[96:103], v132
  buffer_load_dwordx4 v[80:83], v144, s[8:11], s72 offen offset:2048 sc1
  ds_read_b64_tr_b16 v[36:37], v133 offset:9216
  ds_read_b64_tr_b16 v[38:39], v134 offset:9216
  s_waitcnt lgkmcnt(12)
  v_smfmac_f32_16x16x64_bf16 v[40:43], v[12:15], a[24:31], v132
  v_smfmac_f32_16x16x64_bf16 v[44:47], v[12:15], a[104:111], v132
  buffer_load_dwordx2 v[104:105], v145, s[8:11], s73 offen offset:0 sc1
  s_waitcnt lgkmcnt(10)
  v_smfmac_f32_16x16x64_bf16 v[40:43], v[16:19], a[32:39], v132
  v_smfmac_f32_16x16x64_bf16 v[44:47], v[16:19], a[112:119], v132
  buffer_load_dwordx2 v[106:107], v145, s[8:11], s73 offen offset:1024 sc1
  s_waitcnt lgkmcnt(8)
  v_smfmac_f32_16x16x64_bf16 v[40:43], v[20:23], a[40:47], v132
  v_smfmac_f32_16x16x64_bf16 v[44:47], v[20:23], a[120:127], v132
  buffer_load_dwordx2 v[108:109], v145, s[8:11], s73 offen offset:2048 sc1
  s_waitcnt lgkmcnt(6)
  v_smfmac_f32_16x16x64_bf16 v[40:43], v[24:27], a[48:55], v132
  v_smfmac_f32_16x16x64_bf16 v[44:47], v[24:27], a[128:135], v132
  buffer_load_dwordx2 v[110:111], v145, s[8:11], s73 offen offset:3072 sc1
  s_waitcnt lgkmcnt(4)
  v_smfmac_f32_16x16x64_bf16 v[40:43], v[28:31], a[56:63], v132
  v_smfmac_f32_16x16x64_bf16 v[44:47], v[28:31], a[136:143], v132
  buffer_load_dword v153, v159, s[8:11], s90 offen sc1
  s_waitcnt lgkmcnt(2)
  v_smfmac_f32_16x16x64_bf16 v[40:43], v[32:35], a[64:71], v132
  v_smfmac_f32_16x16x64_bf16 v[44:47], v[32:35], a[144:151], v132
  s_waitcnt lgkmcnt(0)
  v_smfmac_f32_16x16x64_bf16 v[40:43], v[36:39], a[72:79], v132
  v_smfmac_f32_16x16x64_bf16 v[44:47], v[36:39], a[152:159], v132
  s_branch L_s1b_383
L_s1a_382:
  ds_read_b64_tr_b16 v[24:25], v133 offset:6144
  ds_read_b64_tr_b16 v[26:27], v134 offset:6144
  s_waitcnt lgkmcnt(12)
  v_smfmac_f32_16x16x64_bf16 v[40:43], v[0:3], a[0:7], v132
  v_smfmac_f32_16x16x64_bf16 v[44:47], v[0:3], a[80:87], v132
  buffer_load_dwordx4 v[64:67], v144, s[8:11], s72 offen offset:0 sc1
  ds_read_b64_tr_b16 v[28:29], v133 offset:7168
  ds_read_b64_tr_b16 v[30:31], v134 offset:7168
  s_waitcnt lgkmcnt(12)
  v_smfmac_f32_16x16x64_bf16 v[40:43], v[4:7], a[8:15], v132
  v_smfmac_f32_16x16x64_bf16 v[44:47], v[4:7], a[88:95], v132
  buffer_load_dwordx4 v[72:75], v144, s[8:11], s72 offen offset:1024 sc1
  ds_read_b64_tr_b16 v[32:33], v133 offset:8192
  ds_read_b64_tr_b16 v[34:35], v134 offset:8192
  s_waitcnt lgkmcnt(12)
  v_smfmac_f32_16x16x64_bf16 v[40:43], v[8:11], a[16:23], v132
  v_smfmac_f32_16x16x64_bf16 v[44:47], v[8:11], a[96:103], v132
  buffer_load_dwordx4 v[80:83], v144, s[8:11], s72 offen offset:2048 sc1
  ds_read_b64_tr_b16 v[36:37], v133 offset:9216
  ds_read_b64_tr_b16 v[38:39], v134 offset:9216
  s_waitcnt lgkmcnt(12)
  v_smfmac_f32_16x16x64_bf16 v[40:43], v[12:15], a[24:31], v132
  v_smfmac_f32_16x16x64_bf16 v[44:47], v[12:15], a[104:111], v132
  s_waitcnt lgkmcnt(10)
  v_smfmac_f32_16x16x64_bf16 v[40:43], v[16:19], a[32:39], v132
  v_smfmac_f32_16x16x64_bf16 v[44:47], v[16:19], a[112:119], v132
  s_waitcnt lgkmcnt(8)
  v_smfmac_f32_16x16x64_bf16 v[40:43], v[20:23], a[40:47], v132
  v_smfmac_f32_16x16x64_bf16 v[44:47], v[20:23], a[120:127], v132
  s_waitcnt lgkmcnt(6)
  v_smfmac_f32_16x16x64_bf16 v[40:43], v[24:27], a[48:55], v132
  v_smfmac_f32_16x16x64_bf16 v[44:47], v[24:27], a[128:135], v132
  s_waitcnt lgkmcnt(4)
  v_smfmac_f32_16x16x64_bf16 v[40:43], v[28:31], a[56:63], v132
  v_smfmac_f32_16x16x64_bf16 v[44:47], v[28:31], a[136:143], v132
  s_waitcnt lgkmcnt(2)
  v_smfmac_f32_16x16x64_bf16 v[40:43], v[32:35], a[64:71], v132
  v_smfmac_f32_16x16x64_bf16 v[44:47], v[32:35], a[144:151], v132
  s_waitcnt lgkmcnt(0)
  v_smfmac_f32_16x16x64_bf16 v[40:43], v[36:39], a[72:79], v132
  v_smfmac_f32_16x16x64_bf16 v[44:47], v[36:39], a[152:159], v132
L_s1b_383:
  v_smfmac_f32_16x16x64_bf16 v[48:51], v[0:3], a[160:167], v132
  s_mul_i32 s5, s62, 1280
  s_add_u32 s5, s5, s77
  s_nop 3
  v_add_f32 v40, v40, v42
  v_add_f32 v41, v41, v43
  v_add_f32 v44, v44, v46
  v_add_f32 v45, v45, v47
  v_cvt_pk_bf16_f32 v128, v40, v41
  v_cvt_pk_bf16_f32 v129, v44, v45
  ds_write_b64 v135, v[128:129]
  v_smfmac_f32_16x16x64_bf16 v[48:51], v[4:7], a[168:175], v132
  v_smfmac_f32_16x16x64_bf16 v[48:51], v[8:11], a[176:183], v132
  v_smfmac_f32_16x16x64_bf16 v[48:51], v[12:15], a[184:191], v132
  s_waitcnt lgkmcnt(0)
  s_barrier
  ds_read_b64_tr_b16 v[52:53], v136 offset:0
  ds_read_b64_tr_b16 v[54:55], v136 offset:512
  ds_read_b64_tr_b16 v[56:57], v136 offset:1024
  ds_read_b64_tr_b16 v[58:59], v136 offset:1536
  v_smfmac_f32_16x16x64_bf16 v[48:51], v[16:19], a[192:199], v132
  v_smfmac_f32_16x16x64_bf16 v[48:51], v[20:23], a[200:207], v132
  v_smfmac_f32_16x16x64_bf16 v[48:51], v[24:27], a[208:215], v132
  v_smfmac_f32_16x16x64_bf16 v[48:51], v[28:31], a[216:223], v132
  s_cmp_ge_u32 s3, 2
  s_cbranch_scc1 L_s0_384
  s_waitcnt lgkmcnt(2)
  v_mfma_f32_16x16x32_bf16 v[100:103], v[112:115], v[52:55], 0
  s_waitcnt lgkmcnt(0)
  v_mfma_f32_16x16x32_bf16 v[100:103], v[116:119], v[56:59], v[100:103]
  v_smfmac_f32_16x16x64_bf16 v[48:51], v[32:35], a[224:231], v132
  s_nop 6
  v_and_b32 v100, -2, v100
  v_and_b32 v102, -2, v102
  buffer_store_dwordx4 v[100:103], v139, s[8:11], s5 offen sc1
  s_branch L_sj_385
L_s0_384:
  s_waitcnt lgkmcnt(2)
  v_mfma_f32_16x16x32_bf16 v[100:103], v[52:55], v[52:55], 0
  s_waitcnt lgkmcnt(0)
  v_mfma_f32_16x16x32_bf16 v[100:103], v[56:59], v[56:59], v[100:103]
  v_smfmac_f32_16x16x64_bf16 v[48:51], v[32:35], a[224:231], v132
  s_cmp_eq_u32 s3, 3
  s_cbranch_scc1 L_s3_386
  s_nop 4
  v_and_b32 v102, -2, v102
  buffer_store_dwordx2 v[102:103], v139, s[8:11], s5 offen sc1
L_sj_385:
  v_smfmac_f32_16x16x64_bf16 v[48:51], v[36:39], a[232:239], v132
  v_mov_b32 v12, 0
  v_mov_b32 v13, 0
  v_mov_b32 v14, 0
  v_mov_b32 v15, 0
  v_mov_b32 v16, 0
  v_mov_b32 v17, 0
  v_mov_b32 v18, 0
  v_mov_b32 v19, 0
  v_add_f32 v48, v48, v50
  v_add_f32 v49, v49, v51
  v_cvt_pk_bf16_f32 v152, v48, v49
  v_and_b32 v128, -2, v152
  buffer_store_dword v128, v141, s[8:11], s79 offen sc1
  s_cmp_lg_u32 s3, 0
  s_cbranch_scc1 L_w0_390
  s_cmp_ge_u32 s91, 62
  s_cbranch_scc1 L_pfok_392
  s_add_u32 s7, s91, 1
  s_add_u32 s71, s7, 1
  s_lshr_b32 s7, s7, 1
  s_lshr_b32 s71, s71, 1
L_pf_391:
  s_sub_u32 s59, s59, 1
  s_cbranch_scc1 L_end
  v_readlane_b32 s5, v153, 1
  v_readlane_b32 s6, v153, 2
  s_cmp_gt_u32 s5, s71
  s_cselect_b32 s6, s6, 0
  s_cmp_gt_u32 s6, s7
  s_cbranch_scc1 L_pfok_392
  buffer_load_dword v153, v159, s[8:11], s90 offen sc1
  s_waitcnt vmcnt(0)
  s_branch L_pf_391
L_pfok_392:
L_w0_390:
  v_mov_b32 v20, 0
  v_mov_b32 v21, 0
  v_mov_b32 v22, 0
  v_mov_b32 v23, 0
  v_mov_b32 v24, 0
  v_mov_b32 v25, 0
  v_mov_b32 v26, 0
  v_mov_b32 v27, 0
  v_mov_b32 v28, 0
  v_mov_b32 v29, 0
  v_mov_b32 v30, 0
  v_mov_b32 v31, 0
  v_mov_b32 v32, 0
  v_mov_b32 v33, 0
  v_mov_b32 v34, 0
  v_mov_b32 v35, 0
  v_mov_b32 v36, 0
  v_mov_b32 v37, 0
  v_mov_b32 v38, 0
  v_mov_b32 v39, 0
  v_mov_b32 v40, 0
  v_mov_b32 v41, 0
  v_mov_b32 v42, 0
  v_mov_b32 v43, 0
  buffer_load_dwordx4 v[92:95], v140, s[8:11], s77 offen sc1
  buffer_load_dwordx4 v[96:99], v154, s[8:11], s77 offen sc1
L_pl_387:
  s_sub_u32 s59, s59, 1
  s_cbranch_scc1 L_end
  s_waitcnt vmcnt(0)
  v_bitop3_b32 v90, v92, v94, v96 bitop3:0xfe
  v_bitop3_b32 v90, v90, v98, v98 bitop3:0xfe
  v_and_b32 v90, 1, v90
  v_cmp_ne_u32 vcc, 0, v90
  s_cbranch_vccz L_pd_389
  buffer_load_dwordx4 v[92:95], v140, s[8:11], s77 offen sc1
  buffer_load_dwordx4 v[96:99], v154, s[8:11], s77 offen sc1
  s_branch L_pl_387
L_pd_389:
  v_fma_f32 v100, v155, v96, v92
  v_fma_f32 v101, v155, v97, v93
  v_fma_f32 v102, v155, v98, v94
  v_fma_f32 v103, v155, v99, v95
L_pj_388:
  buffer_load_dwordx4 v[68:71], v142, s[8:11], s79 offen offset:0 sc1
  v_permlane32_swap_b32 v100, v102
  v_permlane32_swap_b32 v101, v103
  v_add_f32 v100, v100, v102
  v_add_f32 v101, v101, v103
  v_max_f32 v128, v100, v101
  buffer_load_dwordx4 v[76:79], v142, s[8:11], s79 offen offset:512 sc1
  s_nop 0
  v_max_f32_dpp v128, v128, v128 row_ror:1 row_mask:0xf bank_mask:0xf
  buffer_load_dwordx4 v[84:87], v142, s[8:11], s79 offen offset:1024 sc1
  s_nop 0
  v_max_f32_dpp v128, v128, v128 row_ror:2 row_mask:0xf bank_mask:0xf
  s_nop 1
  v_max_f32_dpp v128, v128, v128 row_ror:4 row_mask:0xf bank_mask:0xf
  s_nop 1
  v_max_f32_dpp v128, v128, v128 row_ror:8 row_mask:0xf bank_mask:0xf
  v_mov_b32 v129, v128
  s_nop 1
  v_permlane32_swap_b32 v128, v129
  v_max_f32 v128, v128, v129
  v_sub_f32 v100, v100, v128
  v_sub_f32 v101, v101, v128
  v_mul_f32 v100, s93, v100
  v_mul_f32 v101, s93, v101
  v_exp_f32 v100, v100
  v_exp_f32 v101, v101
  s_nop 0
  v_cvt_pk_bf16_f32 v128, v100, v101
  ds_write_b32 v156, v128
  s_waitcnt lgkmcnt(0)
  s_barrier
  ds_read_b128 v[124:127], v91
L_hv2_394:
  s_waitcnt vmcnt(0)
  v_bitop3_b32 v128, v68, v70, v76 bitop3:0xfe
  v_bitop3_b32 v128, v128, v78, v84 bitop3:0xfe
  v_bitop3_b32 v128, v128, v86, v86 bitop3:0xfe
  v_and_b32 v128, 1, v128
  v_cmp_ne_u32 vcc, 0, v128
  s_cbranch_vccnz L_hv_393
  s_waitcnt lgkmcnt(0)
  v_smfmac_f32_16x16x64_bf16 v[12:15], v[124:127], v[64:71], v132
  v_smfmac_f32_16x16x64_bf16 v[16:19], v[124:127], v[72:79], v132
  v_smfmac_f32_16x16x64_bf16 v[20:23], v[124:127], v[80:87], v132
  v_smfmac_f32_16x16x64_bf16 v[24:27], v[124:127], a[240:247], v132
  s_nop 4
  v_add_f32 v12, v12, v14
  v_add_f32 v13, v13, v15
  v_cvt_pk_bf16_f32 v128, v12, v13
  ds_write_b32 v137, v128
  v_add_f32 v16, v16, v18
  v_add_f32 v17, v17, v19
  v_cvt_pk_bf16_f32 v129, v16, v17
  ds_write_b32 v147, v129
  v_add_f32 v20, v20, v22
  v_add_f32 v21, v21, v23
  v_cvt_pk_bf16_f32 v130, v20, v21
  ds_write_b32 v138, v130
  v_add_f32 v24, v24, v26
  v_add_f32 v25, v25, v27
  v_rcp_f32 v12, v24
  v_rcp_f32 v13, v25
  s_waitcnt lgkmcnt(0)
  s_barrier
  ds_read_b64_tr_b16 v[0:1], v133 offset:12288
  ds_read_b64_tr_b16 v[2:3], v134 offset:12288
  ds_read_b64_tr_b16 v[4:5], v133 offset:13312
  ds_read_b64_tr_b16 v[6:7], v134 offset:13312
  ds_read_b64_tr_b16 v[8:9], v133 offset:14336
  ds_read_b64_tr_b16 v[10:11], v134 offset:14336
  s_add_u32 s5, s88, 6291456
  buffer_store_dword v152, v143, s[8:11], s5 offen sc1
  s_cmp_lg_u32 s3, 3
  s_cbranch_scc1 L_km_395
  s_sub_u32 s5, s88, 0
  buffer_store_dwordx4 v[52:55], v139, s[8:11], s5 offen sc1
  buffer_store_dwordx4 v[56:59], v139, s[8:11], s5 offen offset:512 sc1
L_km_395:
  s_waitcnt lgkmcnt(4)
  v_smfmac_f32_16x16x64_bf16 v[28:31], v[0:3], v[160:167], v132
  v_smfmac_f32_16x16x64_bf16 v[32:35], v[0:3], v[184:191], v132
  s_waitcnt lgkmcnt(2)
  v_smfmac_f32_16x16x64_bf16 v[28:31], v[4:7], v[168:175], v132
  v_smfmac_f32_16x16x64_bf16 v[32:35], v[4:7], v[192:199], v132
  s_waitcnt lgkmcnt(0)
  v_smfmac_f32_16x16x64_bf16 v[28:31], v[8:11], v[176:183], v132
  v_smfmac_f32_16x16x64_bf16 v[32:35], v[8:11], v[200:207], v132
  v_smfmac_f32_16x16x64_bf16 v[36:39], v[0:3], v[208:215], v132
  v_smfmac_f32_16x16x64_bf16 v[40:43], v[0:3], v[232:239], v132
  v_smfmac_f32_16x16x64_bf16 v[36:39], v[4:7], v[216:223], v132
  v_smfmac_f32_16x16x64_bf16 v[40:43], v[4:7], v[240:247], v132
  v_smfmac_f32_16x16x64_bf16 v[36:39], v[8:11], v[224:231], v132
  s_nop 1
  v_add_f32 v28, v28, v30
  v_add_f32 v29, v29, v31
  v_smfmac_f32_16x16x64_bf16 v[40:43], v[8:11], v[248:255], v132
  v_mul_f32 v28, v28, v12
  v_mul_f32 v29, v29, v13
  v_cvt_pk_bf16_f32 v128, v28, v29
  v_and_b32 v128, -2, v128
  v_add_f32 v32, v32, v34
  v_add_f32 v33, v33, v35
  v_mul_f32 v32, v32, v12
  v_mul_f32 v33, v33, v13
  v_cvt_pk_bf16_f32 v129, v32, v33
  buffer_store_dwordx2 v[128:129], v146, s[8:11], s81 offen sc1
  v_add_f32 v36, v36, v38
  v_add_f32 v37, v37, v39
  v_mul_f32 v36, v36, v12
  v_mul_f32 v37, v37, v13
  v_cvt_pk_bf16_f32 v130, v36, v37
  v_and_b32 v130, -2, v130
  v_add_f32 v40, v40, v42
  v_add_f32 v41, v41, v43
  v_mul_f32 v40, v40, v12
  v_mul_f32 v41, v41, v13
  v_cvt_pk_bf16_f32 v131, v40, v41
  buffer_store_dwordx2 v[130:131], v146, s[8:11], s67 offen sc1
  buffer_store_dwordx2 v[128:129], v146, s[8:11], s33 offen sc1
  buffer_store_dwordx2 v[130:131], v146, s[8:11], s35 offen sc1
  s_cmp_eq_u32 s92, 0
  s_cbranch_scc1 L_nr_396
  v_mov_b32 v124, 0
  v_mov_b32 v125, 0
  v_mov_b32 v126, 0
  v_mov_b32 v127, 0
  s_add_u32 s91, s91, 1
  s_add_u32 s88, s88, 98304
  s_add_u32 s89, s89, 393216
  v_mov_b32 v40, 0
  v_mov_b32 v41, 0
  v_mov_b32 v42, 0
  v_mov_b32 v43, 0
  v_mov_b32 v44, 0
  v_mov_b32 v45, 0
  v_mov_b32 v46, 0
  v_mov_b32 v47, 0
  v_mov_b32 v48, 0
  v_mov_b32 v49, 0
  v_mov_b32 v50, 0
  v_mov_b32 v51, 0
  s_mul_i32 s72, s3, 3072
  s_add_u32 s72, s72, s89
  s_add_u32 s72, s72, 48758784
  s_lshl_b32 s73, s62, 12
  s_add_u32 s73, s73, s89
  s_add_u32 s73, s73, 23986176
  s_add_u32 s40, s83, 0
  s_cmp_eq_u32 s63, 0
  s_cselect_b32 s40, s37, s40
  s_add_u32 s41, s83, 4096
  s_cmp_eq_u32 s63, 1
  s_cselect_b32 s41, s37, s41
  s_add_u32 s42, s83, 16384
  s_cmp_eq_u32 s63, 2
  s_cselect_b32 s42, s37, s42
  s_add_u32 s43, s83, 20480
  s_cmp_eq_u32 s63, 3
  s_cselect_b32 s43, s37, s43
  v_mov_b32 v100, s91
  v_mov_b32 v101, 17408
  buffer_load_dwordx4 v[0:3], v148, s[8:11], s40 offen offset:0 sc1
  buffer_load_dwordx4 v[4:7], v148, s[8:11], s40 offen offset:2048 sc1
  buffer_load_dwordx4 v[8:11], v148, s[8:11], s41 offen offset:0 sc1
  buffer_load_dwordx4 v[12:15], v148, s[8:11], s41 offen offset:2048 sc1
  buffer_load_dwordx4 v[16:19], v148, s[8:11], s42 offen offset:0 sc1
  buffer_load_dwordx4 v[20:23], v148, s[8:11], s42 offen offset:2048 sc1
  buffer_load_dwordx4 v[24:27], v148, s[8:11], s43 offen offset:0 sc1
  buffer_load_dwordx4 v[28:31], v148, s[8:11], s43 offen offset:2048 sc1
L_xc_402:
  s_waitcnt vmcnt(6)
  v_bitop3_b32 v90, v0, v2, v4 bitop3:0xfe
  v_bitop3_b32 v90, v90, v6, v6 bitop3:0xfe
  v_and_b32 v90, 1, v90
  v_cmp_ne_u32 vcc, 0, v90
  s_cbranch_vccnz L_xp_401
  v_smfmac_f32_16x16x64_bf16 v[124:127], a[248:251], v[0:7], v132
L_xc_404:
  s_waitcnt vmcnt(4)
  v_bitop3_b32 v90, v8, v10, v12 bitop3:0xfe
  v_bitop3_b32 v90, v90, v14, v14 bitop3:0xfe
  v_and_b32 v90, 1, v90
  v_cmp_ne_u32 vcc, 0, v90
  s_cbranch_vccnz L_xp_403
  v_smfmac_f32_16x16x64_bf16 v[124:127], a[248:251], v[8:15], v132
L_xc_406:
  s_waitcnt vmcnt(2)
  v_bitop3_b32 v90, v16, v18, v20 bitop3:0xfe
  v_bitop3_b32 v90, v90, v22, v22 bitop3:0xfe
  v_and_b32 v90, 1, v90
  v_cmp_ne_u32 vcc, 0, v90
  s_cbranch_vccnz L_xp_405
  v_smfmac_f32_16x16x64_bf16 v[124:127], a[248:251], v[16:23], v132
L_xc_408:
  s_waitcnt vmcnt(0)
  v_bitop3_b32 v90, v24, v26, v28 bitop3:0xfe
  v_bitop3_b32 v90, v90, v30, v30 bitop3:0xfe
  v_and_b32 v90, 1, v90
  v_cmp_ne_u32 vcc, 0, v90
  s_cbranch_vccnz L_xp_407
  v_smfmac_f32_16x16x64_bf16 v[124:127], a[248:251], v[24:31], v132
  ds_write_b32 v101, v100
  s_nop 6
  v_cvt_pk_bf16_f32 v128, v124, v125
  v_cvt_pk_bf16_f32 v129, v126, v127
  v_and_b32 v128, -2, v128
  buffer_store_dwordx2 v[128:129], v150, s[8:11], s85 offen sc1
  s_branch L_go_400
L_nr_396:
  s_add_u32 s91, s91, 1
  s_add_u32 s88, s88, 98304
  s_add_u32 s89, s89, 393216
  v_mov_b32 v40, 0
  v_mov_b32 v41, 0
  v_mov_b32 v42, 0
  v_mov_b32 v43, 0
  v_mov_b32 v44, 0
  v_mov_b32 v45, 0
  v_mov_b32 v46, 0
  v_mov_b32 v47, 0
  v_mov_b32 v48, 0
  v_mov_b32 v49, 0
  v_mov_b32 v50, 0
  v_mov_b32 v51, 0
  s_mul_i32 s72, s3, 3072
  s_add_u32 s72, s72, s89
  s_add_u32 s72, s72, 48758784
  s_lshl_b32 s73, s62, 12
  s_add_u32 s73, s73, s89
  s_add_u32 s73, s73, 23986176
  v_mov_b32 v101, 17408
L_lf_410:
  s_sub_u32 s59, s59, 1
  s_cbranch_scc1 L_end
  ds_read_b32 v100, v101
  s_waitcnt lgkmcnt(0)
  v_cmp_ne_u32 vcc, s91, v100
  s_cbranch_vccnz L_lf_410
L_go_400:
  s_cmp_ge_u32 s3, 2
  s_cbranch_scc1 L_g2_411
  buffer_load_dwordx4 v[92:95], v151, s[8:11], s87 offen offset:0 sc1
  buffer_load_dwordx4 v[96:99], v151, s[8:11], s87 offen offset:1024 sc1
  buffer_load_dwordx4 v[100:103], v157, s[8:11], s87 offen offset:0 sc1
L_gc_414:
  s_waitcnt vmcnt(2)
  v_bitop3_b32 v90, v92, v94, 1 bitop3:0xa8
  v_cmp_ne_u32 vcc, 0, v90
  s_cbranch_vccnz L_gp_413
  ds_write_b128 v151, v[92:95] offset:0
L_gc_416:
  s_waitcnt vmcnt(1)
  v_bitop3_b32 v90, v96, v98, 1 bitop3:0xa8
  v_cmp_ne_u32 vcc, 0, v90
  s_cbranch_vccnz L_gp_415
  ds_write_b128 v151, v[96:99] offset:1024
L_gc_418:
  s_waitcnt vmcnt(0)
  v_bitop3_b32 v90, v100, v102, 1 bitop3:0xa8
  v_cmp_ne_u32 vcc, 0, v90
  s_cbranch_vccnz L_gp_417
  ds_write_b128 v157, v[100:103] offset:0
  s_branch L_g3_412
L_g2_411:
  buffer_load_dwordx4 v[92:95], v151, s[8:11], s87 offen offset:0 sc1
  buffer_load_dwordx4 v[96:99], v151, s[8:11], s87 offen offset:1024 sc1
L_gc_421:
  s_waitcnt vmcnt(1)
  v_bitop3_b32 v90, v92, v94, 1 bitop3:0xa8
  v_cmp_ne_u32 vcc, 0, v90
  s_cbranch_vccnz L_gp_420
  ds_write_b128 v151, v[92:95] offset:0
L_gc_423:
  s_waitcnt vmcnt(0)
  v_bitop3_b32 v90, v96, v98, 1 bitop3:0xa8
  v_cmp_ne_u32 vcc, 0, v90
  s_cbranch_vccnz L_gp_422
  ds_write_b128 v151, v[96:99] offset:1024
L_g3_412:
  s_waitcnt lgkmcnt(0)
  s_barrier
  s_branch L_slow
L_s3_248:
  v_mov_b32 v90, s91
  s_lshl_b32 s5, s62, 2
  s_add_u32 s5, s5, s90
  s_mov_b64 exec, 1
  buffer_store_dword v90, off, s[8:11], s5 offset:128 sc1
  s_mov_b64 exec, -1
  s_branch L_sj_247
L_hv_255:
  s_sub_u32 s59, s59, 1
  s_cbranch_scc1 L_end
  buffer_load_dwordx4 v[68:71], v142, s[8:11], s78 offen offset:0 sc1
  buffer_load_dwordx4 v[76:79], v142, s[8:11], s78 offen offset:512 sc1
  buffer_load_dwordx4 v[84:87], v142, s[8:11], s78 offen offset:1024 sc1
  s_branch L_hv2_256
L_xp_263:
  s_sub_u32 s59, s59, 1
  s_cbranch_scc1 L_end
  buffer_load_dwordx4 v[0:3], v148, s[8:11], s40 offen offset:0 sc1
  buffer_load_dwordx4 v[4:7], v148, s[8:11], s40 offen offset:2048 sc1
  buffer_load_dwordx4 v[8:11], v148, s[8:11], s41 offen offset:0 sc1
  buffer_load_dwordx4 v[12:15], v148, s[8:11], s41 offen offset:2048 sc1
  buffer_load_dwordx4 v[16:19], v148, s[8:11], s42 offen offset:0 sc1
  buffer_load_dwordx4 v[20:23], v148, s[8:11], s42 offen offset:2048 sc1
  buffer_load_dwordx4 v[24:27], v148, s[8:11], s43 offen offset:0 sc1
  buffer_load_dwordx4 v[28:31], v148, s[8:11], s43 offen offset:2048 sc1
  s_branch L_xc_264
L_xp_265:
  s_sub_u32 s59, s59, 1
  s_cbranch_scc1 L_end
  buffer_load_dwordx4 v[8:11], v148, s[8:11], s41 offen offset:0 sc1
  buffer_load_dwordx4 v[12:15], v148, s[8:11], s41 offen offset:2048 sc1
  buffer_load_dwordx4 v[16:19], v148, s[8:11], s42 offen offset:0 sc1
  buffer_load_dwordx4 v[20:23], v148, s[8:11], s42 offen offset:2048 sc1
  buffer_load_dwordx4 v[24:27], v148, s[8:11], s43 offen offset:0 sc1
  buffer_load_dwordx4 v[28:31], v148, s[8:11], s43 offen offset:2048 sc1
  s_branch L_xc_266
L_xp_267:
  s_sub_u32 s59, s59, 1
  s_cbranch_scc1 L_end
  buffer_load_dwordx4 v[16:19], v148, s[8:11], s42 offen offset:0 sc1
  buffer_load_dwordx4 v[20:23], v148, s[8:11], s42 offen offset:2048 sc1
  buffer_load_dwordx4 v[24:27], v148, s[8:11], s43 offen offset:0 sc1
  buffer_load_dwordx4 v[28:31], v148, s[8:11], s43 offen offset:2048 sc1
  s_branch L_xc_268
L_xp_269:
  s_sub_u32 s59, s59, 1
  s_cbranch_scc1 L_end
  buffer_load_dwordx4 v[24:27], v148, s[8:11], s43 offen offset:0 sc1
  buffer_load_dwordx4 v[28:31], v148, s[8:11], s43 offen offset:2048 sc1
  s_branch L_xc_270
L_gp_275:
  s_sub_u32 s59, s59, 1
  s_cbranch_scc1 L_end
  buffer_load_dwordx4 v[92:95], v151, s[8:11], s86 offen offset:0 sc1
  buffer_load_dwordx4 v[96:99], v151, s[8:11], s86 offen offset:1024 sc1
  buffer_load_dwordx4 v[100:103], v157, s[8:11], s86 offen offset:0 sc1
  s_branch L_gc_276
L_gp_277:
  s_sub_u32 s59, s59, 1
  s_cbranch_scc1 L_end
  buffer_load_dwordx4 v[96:99], v151, s[8:11], s86 offen offset:1024 sc1
  buffer_load_dwordx4 v[100:103], v157, s[8:11], s86 offen offset:0 sc1
  s_branch L_gc_278
L_gp_279:
  s_sub_u32 s59, s59, 1
  s_cbranch_scc1 L_end
  buffer_load_dwordx4 v[100:103], v157, s[8:11], s86 offen offset:0 sc1
  s_branch L_gc_280
L_gp_282:
  s_sub_u32 s59, s59, 1
  s_cbranch_scc1 L_end
  buffer_load_dwordx4 v[92:95], v151, s[8:11], s86 offen offset:0 sc1
  buffer_load_dwordx4 v[96:99], v151, s[8:11], s86 offen offset:1024 sc1
  s_branch L_gc_283
L_gp_284:
  s_sub_u32 s59, s59, 1
  s_cbranch_scc1 L_end
  buffer_load_dwordx4 v[96:99], v151, s[8:11], s86 offen offset:1024 sc1
  s_branch L_gc_285
L_s3_294:
  v_mov_b32 v90, s91
  s_lshl_b32 s5, s62, 2
  s_add_u32 s5, s5, s90
  s_mov_b64 exec, 1
  buffer_store_dword v90, off, s[8:11], s5 offset:128 sc1
  s_mov_b64 exec, -1
  s_branch L_sj_293
L_hv_301:
  s_sub_u32 s59, s59, 1
  s_cbranch_scc1 L_end
  buffer_load_dwordx4 v[68:71], v142, s[8:11], s79 offen offset:0 sc1
  buffer_load_dwordx4 v[76:79], v142, s[8:11], s79 offen offset:512 sc1
  buffer_load_dwordx4 v[84:87], v142, s[8:11], s79 offen offset:1024 sc1
  s_branch L_hv2_302
L_xp_309:
  s_sub_u32 s59, s59, 1
  s_cbranch_scc1 L_end
  buffer_load_dwordx4 v[0:3], v148, s[8:11], s40 offen offset:0 sc1
  buffer_load_dwordx4 v[4:7], v148, s[8:11], s40 offen offset:2048 sc1
  buffer_load_dwordx4 v[8:11], v148, s[8:11], s41 offen offset:0 sc1
  buffer_load_dwordx4 v[12:15], v148, s[8:11], s41 offen offset:2048 sc1
  buffer_load_dwordx4 v[16:19], v148, s[8:11], s42 offen offset:0 sc1
  buffer_load_dwordx4 v[20:23], v148, s[8:11], s42 offen offset:2048 sc1
  buffer_load_dwordx4 v[24:27], v148, s[8:11], s43 offen offset:0 sc1
  buffer_load_dwordx4 v[28:31], v148, s[8:11], s43 offen offset:2048 sc1
  s_branch L_xc_310
L_xp_311:
  s_sub_u32 s59, s59, 1
  s_cbranch_scc1 L_end
  buffer_load_dwordx4 v[8:11], v148, s[8:11], s41 offen offset:0 sc1
  buffer_load_dwordx4 v[12:15], v148, s[8:11], s41 offen offset:2048 sc1
  buffer_load_dwordx4 v[16:19], v148, s[8:11], s42 offen offset:0 sc1
  buffer_load_dwordx4 v[20:23], v148, s[8:11], s42 offen offset:2048 sc1
  buffer_load_dwordx4 v[24:27], v148, s[8:11], s43 offen offset:0 sc1
  buffer_load_dwordx4 v[28:31], v148, s[8:11], s43 offen offset:2048 sc1
  s_branch L_xc_312
L_xp_313:
  s_sub_u32 s59, s59, 1
  s_cbranch_scc1 L_end
  buffer_load_dwordx4 v[16:19], v148, s[8:11], s42 offen offset:0 sc1
  buffer_load_dwordx4 v[20:23], v148, s[8:11], s42 offen offset:2048 sc1
  buffer_load_dwordx4 v[24:27], v148, s[8:11], s43 offen offset:0 sc1
  buffer_load_dwordx4 v[28:31], v148, s[8:11], s43 offen offset:2048 sc1
  s_branch L_xc_314
L_xp_315:
  s_sub_u32 s59, s59, 1
  s_cbranch_scc1 L_end
  buffer_load_dwordx4 v[24:27], v148, s[8:11], s43 offen offset:0 sc1
  buffer_load_dwordx4 v[28:31], v148, s[8:11], s43 offen offset:2048 sc1
  s_branch L_xc_316
L_gp_321:
  s_sub_u32 s59, s59, 1
  s_cbranch_scc1 L_end
  buffer_load_dwordx4 v[92:95], v151, s[8:11], s87 offen offset:0 sc1
  buffer_load_dwordx4 v[96:99], v151, s[8:11], s87 offen offset:1024 sc1
  buffer_load_dwordx4 v[100:103], v157, s[8:11], s87 offen offset:0 sc1
  s_branch L_gc_322
L_gp_323:
  s_sub_u32 s59, s59, 1
  s_cbranch_scc1 L_end
  buffer_load_dwordx4 v[96:99], v151, s[8:11], s87 offen offset:1024 sc1
  buffer_load_dwordx4 v[100:103], v157, s[8:11], s87 offen offset:0 sc1
  s_branch L_gc_324
L_gp_325:
  s_sub_u32 s59, s59, 1
  s_cbranch_scc1 L_end
  buffer_load_dwordx4 v[100:103], v157, s[8:11], s87 offen offset:0 sc1
  s_branch L_gc_326
L_gp_328:
  s_sub_u32 s59, s59, 1
  s_cbranch_scc1 L_end
  buffer_load_dwordx4 v[92:95], v151, s[8:11], s87 offen offset:0 sc1
  buffer_load_dwordx4 v[96:99], v151, s[8:11], s87 offen offset:1024 sc1
  s_branch L_gc_329
L_gp_330:
  s_sub_u32 s59, s59, 1
  s_cbranch_scc1 L_end
  buffer_load_dwordx4 v[96:99], v151, s[8:11], s87 offen offset:1024 sc1
  s_branch L_gc_331
L_s3_340:
  v_mov_b32 v90, s91
  s_lshl_b32 s5, s62, 2
  s_add_u32 s5, s5, s90
  s_mov_b64 exec, 1
  buffer_store_dword v90, off, s[8:11], s5 offset:128 sc1
  s_mov_b64 exec, -1
  s_branch L_sj_339
L_hv_347:
  s_sub_u32 s59, s59, 1
  s_cbranch_scc1 L_end
  buffer_load_dwordx4 v[68:71], v142, s[8:11], s78 offen offset:0 sc1
  buffer_load_dwordx4 v[76:79], v142, s[8:11], s78 offen offset:512 sc1
  buffer_load_dwordx4 v[84:87], v142, s[8:11], s78 offen offset:1024 sc1
  s_branch L_hv2_348
L_xp_355:
  s_sub_u32 s59, s59, 1
  s_cbranch_scc1 L_end
  buffer_load_dwordx4 v[0:3], v148, s[8:11], s40 offen offset:0 sc1
  buffer_load_dwordx4 v[4:7], v148, s[8:11], s40 offen offset:2048 sc1
  buffer_load_dwordx4 v[8:11], v148, s[8:11], s41 offen offset:0 sc1
  buffer_load_dwordx4 v[12:15], v148, s[8:11], s41 offen offset:2048 sc1
  buffer_load_dwordx4 v[16:19], v148, s[8:11], s42 offen offset:0 sc1
  buffer_load_dwordx4 v[20:23], v148, s[8:11], s42 offen offset:2048 sc1
  buffer_load_dwordx4 v[24:27], v148, s[8:11], s43 offen offset:0 sc1
  buffer_load_dwordx4 v[28:31], v148, s[8:11], s43 offen offset:2048 sc1
  s_branch L_xc_356
L_xp_357:
  s_sub_u32 s59, s59, 1
  s_cbranch_scc1 L_end
  buffer_load_dwordx4 v[8:11], v148, s[8:11], s41 offen offset:0 sc1
  buffer_load_dwordx4 v[12:15], v148, s[8:11], s41 offen offset:2048 sc1
  buffer_load_dwordx4 v[16:19], v148, s[8:11], s42 offen offset:0 sc1
  buffer_load_dwordx4 v[20:23], v148, s[8:11], s42 offen offset:2048 sc1
  buffer_load_dwordx4 v[24:27], v148, s[8:11], s43 offen offset:0 sc1
  buffer_load_dwordx4 v[28:31], v148, s[8:11], s43 offen offset:2048 sc1
  s_branch L_xc_358
L_xp_359:
  s_sub_u32 s59, s59, 1
  s_cbranch_scc1 L_end
  buffer_load_dwordx4 v[16:19], v148, s[8:11], s42 offen offset:0 sc1
  buffer_load_dwordx4 v[20:23], v148, s[8:11], s42 offen offset:2048 sc1
  buffer_load_dwordx4 v[24:27], v148, s[8:11], s43 offen offset:0 sc1
  buffer_load_dwordx4 v[28:31], v148, s[8:11], s43 offen offset:2048 sc1
  s_branch L_xc_360
L_xp_361:
  s_sub_u32 s59, s59, 1
  s_cbranch_scc1 L_end
  buffer_load_dwordx4 v[24:27], v148, s[8:11], s43 offen offset:0 sc1
  buffer_load_dwordx4 v[28:31], v148, s[8:11], s43 offen offset:2048 sc1
  s_branch L_xc_362
L_gp_367:
  s_sub_u32 s59, s59, 1
  s_cbranch_scc1 L_end
  buffer_load_dwordx4 v[92:95], v151, s[8:11], s86 offen offset:0 sc1
  buffer_load_dwordx4 v[96:99], v151, s[8:11], s86 offen offset:1024 sc1
  buffer_load_dwordx4 v[100:103], v157, s[8:11], s86 offen offset:0 sc1
  s_branch L_gc_368
L_gp_369:
  s_sub_u32 s59, s59, 1
  s_cbranch_scc1 L_end
  buffer_load_dwordx4 v[96:99], v151, s[8:11], s86 offen offset:1024 sc1
  buffer_load_dwordx4 v[100:103], v157, s[8:11], s86 offen offset:0 sc1
  s_branch L_gc_370
L_gp_371:
  s_sub_u32 s59, s59, 1
  s_cbranch_scc1 L_end
  buffer_load_dwordx4 v[100:103], v157, s[8:11], s86 offen offset:0 sc1
  s_branch L_gc_372
L_gp_374:
  s_sub_u32 s59, s59, 1
  s_cbranch_scc1 L_end
  buffer_load_dwordx4 v[92:95], v151, s[8:11], s86 offen offset:0 sc1
  buffer_load_dwordx4 v[96:99], v151, s[8:11], s86 offen offset:1024 sc1
  s_branch L_gc_375
L_gp_376:
  s_sub_u32 s59, s59, 1
  s_cbranch_scc1 L_end
  buffer_load_dwordx4 v[96:99], v151, s[8:11], s86 offen offset:1024 sc1
  s_branch L_gc_377
L_s3_386:
  v_mov_b32 v90, s91
  s_lshl_b32 s5, s62, 2
  s_add_u32 s5, s5, s90
  s_mov_b64 exec, 1
  buffer_store_dword v90, off, s[8:11], s5 offset:128 sc1
  s_mov_b64 exec, -1
  s_branch L_sj_385
L_hv_393:
  s_sub_u32 s59, s59, 1
  s_cbranch_scc1 L_end
  buffer_load_dwordx4 v[68:71], v142, s[8:11], s79 offen offset:0 sc1
  buffer_load_dwordx4 v[76:79], v142, s[8:11], s79 offen offset:512 sc1
  buffer_load_dwordx4 v[84:87], v142, s[8:11], s79 offen offset:1024 sc1
  s_branch L_hv2_394
L_xp_401:
  s_sub_u32 s59, s59, 1
  s_cbranch_scc1 L_end
  buffer_load_dwordx4 v[0:3], v148, s[8:11], s40 offen offset:0 sc1
  buffer_load_dwordx4 v[4:7], v148, s[8:11], s40 offen offset:2048 sc1
  buffer_load_dwordx4 v[8:11], v148, s[8:11], s41 offen offset:0 sc1
  buffer_load_dwordx4 v[12:15], v148, s[8:11], s41 offen offset:2048 sc1
  buffer_load_dwordx4 v[16:19], v148, s[8:11], s42 offen offset:0 sc1
  buffer_load_dwordx4 v[20:23], v148, s[8:11], s42 offen offset:2048 sc1
  buffer_load_dwordx4 v[24:27], v148, s[8:11], s43 offen offset:0 sc1
  buffer_load_dwordx4 v[28:31], v148, s[8:11], s43 offen offset:2048 sc1
  s_branch L_xc_402
L_xp_403:
  s_sub_u32 s59, s59, 1
  s_cbranch_scc1 L_end
  buffer_load_dwordx4 v[8:11], v148, s[8:11], s41 offen offset:0 sc1
  buffer_load_dwordx4 v[12:15], v148, s[8:11], s41 offen offset:2048 sc1
  buffer_load_dwordx4 v[16:19], v148, s[8:11], s42 offen offset:0 sc1
  buffer_load_dwordx4 v[20:23], v148, s[8:11], s42 offen offset:2048 sc1
  buffer_load_dwordx4 v[24:27], v148, s[8:11], s43 offen offset:0 sc1
  buffer_load_dwordx4 v[28:31], v148, s[8:11], s43 offen offset:2048 sc1
  s_branch L_xc_404
L_xp_405:
  s_sub_u32 s59, s59, 1
  s_cbranch_scc1 L_end
  buffer_load_dwordx4 v[16:19], v148, s[8:11], s42 offen offset:0 sc1
  buffer_load_dwordx4 v[20:23], v148, s[8:11], s42 offen offset:2048 sc1
  buffer_load_dwordx4 v[24:27], v148, s[8:11], s43 offen offset:0 sc1
  buffer_load_dwordx4 v[28:31], v148, s[8:11], s43 offen offset:2048 sc1
  s_branch L_xc_406
L_xp_407:
  s_sub_u32 s59, s59, 1
  s_cbranch_scc1 L_end
  buffer_load_dwordx4 v[24:27], v148, s[8:11], s43 offen offset:0 sc1
  buffer_load_dwordx4 v[28:31], v148, s[8:11], s43 offen offset:2048 sc1
  s_branch L_xc_408
L_gp_413:
  s_sub_u32 s59, s59, 1
  s_cbranch_scc1 L_end
  buffer_load_dwordx4 v[92:95], v151, s[8:11], s87 offen offset:0 sc1
  buffer_load_dwordx4 v[96:99], v151, s[8:11], s87 offen offset:1024 sc1
  buffer_load_dwordx4 v[100:103], v157, s[8:11], s87 offen offset:0 sc1
  s_branch L_gc_414
L_gp_415:
  s_sub_u32 s59, s59, 1
  s_cbranch_scc1 L_end
  buffer_load_dwordx4 v[96:99], v151, s[8:11], s87 offen offset:1024 sc1
  buffer_load_dwordx4 v[100:103], v157, s[8:11], s87 offen offset:0 sc1
  s_branch L_gc_416
L_gp_417:
  s_sub_u32 s59, s59, 1
  s_cbranch_scc1 L_end
  buffer_load_dwordx4 v[100:103], v157, s[8:11], s87 offen offset:0 sc1
  s_branch L_gc_418
L_gp_420:
  s_sub_u32 s59, s59, 1
  s_cbranch_scc1 L_end
  buffer_load_dwordx4 v[92:95], v151, s[8:11], s87 offen offset:0 sc1
  buffer_load_dwordx4 v[96:99], v151, s[8:11], s87 offen offset:1024 sc1
  s_branch L_gc_421
L_gp_422:
  s_sub_u32 s59, s59, 1
  s_cbranch_scc1 L_end
  buffer_load_dwordx4 v[96:99], v151, s[8:11], s87 offen offset:1024 sc1
  s_branch L_gc_423
L_last:
  ds_read_b64_tr_b16 v[0:1], v133 offset:0
  ds_read_b64_tr_b16 v[2:3], v134 offset:0
  ds_read_b64_tr_b16 v[4:5], v133 offset:1024
  ds_read_b64_tr_b16 v[6:7], v134 offset:1024
  ds_read_b64_tr_b16 v[8:9], v133 offset:2048
  ds_read_b64_tr_b16 v[10:11], v134 offset:2048
  ds_read_b64_tr_b16 v[12:13], v133 offset:3072
  ds_read_b64_tr_b16 v[14:15], v134 offset:3072
  ds_read_b64_tr_b16 v[16:17], v133 offset:4096
  ds_read_b64_tr_b16 v[18:19], v134 offset:4096
  ds_read_b64_tr_b16 v[20:21], v133 offset:5120
  ds_read_b64_tr_b16 v[22:23], v134 offset:5120
  s_cmp_lg_u32 s3, 3
  s_cbranch_scc1 L_lz_424
  v_mov_b32 v90, s91
  s_lshl_b32 s5, s62, 2
  s_add_u32 s5, s5, s90
  s_mov_b64 exec, 1
  buffer_store_dword v90, off, s[8:11], s5 offset:128 sc1
  s_mov_b64 exec, -1
L_lz_424:
  ds_read_b64_tr_b16 v[24:25], v133 offset:6144
  ds_read_b64_tr_b16 v[26:27], v134 offset:6144
  s_waitcnt lgkmcnt(12)
  v_smfmac_f32_16x16x64_bf16 v[44:47], v[0:3], a[80:87], v132
  ds_read_b64_tr_b16 v[28:29], v133 offset:7168
  ds_read_b64_tr_b16 v[30:31], v134 offset:7168
  s_waitcnt lgkmcnt(12)
  v_smfmac_f32_16x16x64_bf16 v[44:47], v[4:7], a[88:95], v132
  ds_read_b64_tr_b16 v[32:33], v133 offset:8192
  ds_read_b64_tr_b16 v[34:35], v134 offset:8192
  s_waitcnt lgkmcnt(12)
  v_smfmac_f32_16x16x64_bf16 v[44:47], v[8:11], a[96:103], v132
  ds_read_b64_tr_b16 v[36:37], v133 offset:9216
  ds_read_b64_tr_b16 v[38:39], v134 offset:9216
  s_waitcnt lgkmcnt(12)
  v_smfmac_f32_16x16x64_bf16 v[44:47], v[12:15], a[104:111], v132
  s_waitcnt lgkmcnt(10)
  v_smfmac_f32_16x16x64_bf16 v[44:47], v[16:19], a[112:119], v132
  s_waitcnt lgkmcnt(8)
  v_smfmac_f32_16x16x64_bf16 v[44:47], v[20:23], a[120:127], v132
  s_waitcnt lgkmcnt(6)
  v_smfmac_f32_16x16x64_bf16 v[44:47], v[24:27], a[128:135], v132
  s_waitcnt lgkmcnt(4)
  v_smfmac_f32_16x16x64_bf16 v[44:47], v[28:31], a[136:143], v132
  s_waitcnt lgkmcnt(2)
  v_smfmac_f32_16x16x64_bf16 v[44:47], v[32:35], a[144:151], v132
  s_waitcnt lgkmcnt(0)
  v_smfmac_f32_16x16x64_bf16 v[44:47], v[36:39], a[152:159], v132
  v_smfmac_f32_16x16x64_bf16 v[48:51], v[0:3], a[160:167], v132
  s_mul_i32 s5, s62, 1280
  s_add_u32 s5, s5, s77
  v_add_f32 v40, v40, v42
  v_add_f32 v41, v41, v43
  s_nop 2
  v_add_f32 v44, v44, v46
  v_add_f32 v45, v45, v47
  v_cvt_pk_bf16_f32 v128, v40, v41
  v_cvt_pk_bf16_f32 v129, v44, v45
  ds_write_b64 v135, v[128:129]
  v_smfmac_f32_16x16x64_bf16 v[48:51], v[4:7], a[168:175], v132
  v_smfmac_f32_16x16x64_bf16 v[48:51], v[8:11], a[176:183], v132
  v_smfmac_f32_16x16x64_bf16 v[48:51], v[12:15], a[184:191], v132
  s_waitcnt lgkmcnt(0)
  s_barrier
  ds_read_b64_tr_b16 v[52:53], v136 offset:0
  ds_read_b64_tr_b16 v[54:55], v136 offset:512
  ds_read_b64_tr_b16 v[56:57], v136 offset:1024
  ds_read_b64_tr_b16 v[58:59], v136 offset:1536
  v_smfmac_f32_16x16x64_bf16 v[48:51], v[16:19], a[192:199], v132
  v_smfmac_f32_16x16x64_bf16 v[48:51], v[20:23], a[200:207], v132
  v_smfmac_f32_16x16x64_bf16 v[48:51], v[24:27], a[208:215], v132
  v_smfmac_f32_16x16x64_bf16 v[48:51], v[28:31], a[216:223], v132
  s_waitcnt lgkmcnt(0)
  v_smfmac_f32_16x16x64_bf16 v[48:51], v[32:35], a[224:231], v132
  v_smfmac_f32_16x16x64_bf16 v[48:51], v[36:39], a[232:239], v132
  s_nop 7
  v_add_f32 v48, v48, v50
  v_add_f32 v49, v49, v51
  v_cvt_pk_bf16_f32 v152, v48, v49
  s_add_u32 s5, s88, 6291456
  buffer_store_dword v152, v143, s[8:11], s5 offen sc1
  s_cmp_lg_u32 s3, 3
  s_cbranch_scc1 L_km_425
  s_sub_u32 s5, s88, 0
  buffer_store_dwordx4 v[52:55], v139, s[8:11], s5 offen sc1
  buffer_store_dwordx4 v[56:59], v139, s[8:11], s5 offen offset:512 sc1
L_km_425:
  s_waitcnt vmcnt(0)
  s_barrier
  s_lshl_b32 s5, s62, 2
  s_add_u32 s5, s5, s90
  s_add_u32 s5, s5, 128
  s_cmp_lg_u32 s3, 0
  s_cbranch_scc1 L_fl_426
  v_mov_b32 v128, 64
  s_mov_b64 exec, 1
  buffer_store_dword v128, off, s[8:11], s5 sc1
  s_mov_b64 exec, -1
L_fl_426:
  s_branch L_end
L_end:
  s_endpgm
.section .rodata,"a"
.p2align 6
.amdhsa_kernel parallel_sum__memory_aug_recurrent_mem_tr__glu_gated_glu__prompt_kernel
  .amdhsa_next_free_vgpr 512
  .amdhsa_next_free_sgpr 102
  .amdhsa_accum_offset 256
  .amdhsa_group_segment_fixed_size 0
  .amdhsa_kernarg_size 112
  .amdhsa_user_sgpr_count 2
  .amdhsa_user_sgpr_kernarg_segment_ptr 1
  .amdhsa_system_sgpr_workgroup_id_x 1
.end_amdhsa_kernel
```
